```python
import torch

def _softmax(x, axis=-1):
    return torch.softmax(x, dim=axis)
def _gelu(x):
    return torch.nn.functional.gelu(x, approximate="tanh")
def _silu(x):
    return torch.nn.functional.silu(x)
def _sigmoid(x):
    return torch.sigmoid(x)
def _layernorm(x, axis=-1, eps=1e-5):
    m = x.mean(dim=axis, keepdim=True)
    v = x.var(dim=axis, keepdim=True, unbiased=False)
    return (x - m) / torch.sqrt(v + eps)
def _scatter_add(tgt, idx, src, axis=0):
    return tgt.clone().index_add_(axis, idx, src)
def _segment_sum(src, seg, n):
    out = torch.zeros((n,) + src.shape[1:], dtype=src.dtype)
    return out.index_add_(0, seg, src)
def _pad(x, pw):
    flat = tuple(v for pair in reversed(pw) for v in pair)
    return torch.nn.functional.pad(x, flat)

kernel_name = 'standalone__gqa_softmax__near_ridge'

def setup_inputs():

    _w = (lambda a: (lambda t: t.to(torch.bfloat16) if t.is_floating_point() else t)(torch.as_tensor(a)))
    B, Hq, Hkv, Sq, Sk, D = 16, 16, 8, 384, 512, 256
    return {
        "q": _w((lambda *s: torch.randn(*s, dtype=torch.bfloat16) * 0.8)(B, Hq, Sq, D)),
        "k": _w((lambda *s: torch.randn(*s, dtype=torch.bfloat16) * 0.8)(B, Hkv, Sk, D)),
        "v": _w((lambda *s: torch.randn(*s, dtype=torch.bfloat16) * 0.05)(B, Hkv, Sk, D)),
    }

def reference(q, k, v):
    B, Hq, Sq, D = q.shape
    Hkv = k.shape[1]
    rep = Hq // Hkv
    k = (lambda x, n, axis: torch.repeat_interleave(x, n, dim=axis))(k, rep, axis=1)
    v = (lambda x, n, axis: torch.repeat_interleave(x, n, dim=axis))(v, rep, axis=1)
    scale = D ** -0.5
    scores = torch.einsum("bhqd,bhkd->bhqk", q, k) * scale
    p = _softmax(scores, axis=-1)
    return torch.einsum("bhqk,bhkd->bhqd", p, v)
```

```asm
; @launch grid=(256,1,1) block=(256,1,1) lds=163840
.amdgcn_target "amdgcn-amd-amdhsa--gfx950"
.text
.globl standalone__gqa_softmax__near_ridge_kernel
.p2align 12
.p2align 8
.type standalone__gqa_softmax__near_ridge_kernel,@function
standalone__gqa_softmax__near_ridge_kernel:
s_cmp_ge_u32 s2, 256
s_cbranch_scc1 END
s_load_dwordx2 s[8:9], s[0:1], 0
s_load_dwordx2 s[12:13], s[0:1], 8
s_load_dwordx2 s[16:17], s[0:1], 16
s_load_dwordx2 s[20:21], s[0:1], 24
s_getpc_b64 s[72:73]
s_bfe_u32 s75, s2, 0x40003
s_mul_i32 s75, s75, 5120
v_mul_u32_u24 v47, 20, v0
v_add_u32 v47, s75, v47
global_load_dword v48, v47, s[72:73]
v_lshrrev_b32 v40, 6, v0
v_and_b32 v41, 63, v0
v_readfirstlane_b32 s3, v40
v_and_b32 v42, 15, v41
v_lshrrev_b32 v43, 4, v41
v_mul_u32_u24 v46, 24576, v40
v_lshl_add_u32 v44, v42, 9, v46
v_lshl_add_u32 v8, v43, 4, v44
v_lshlrev_b32 v44, 1, v43
v_and_b32 v45, 7, v41
v_xor_b32 v44, v44, v45
v_lshlrev_b32 v44, 4, v44
v_lshrrev_b32 v47, 3, v41
v_lshl_add_u32 v7, v47, 9, v44
s_and_b32 s84, s2, 48
s_lshl_b32 s84, s84, 3
s_xor_b32 s85, s84, 128
s_xor_b32 s86, s84, 256
s_xor_b32 s87, s84, 384
s_add_u32 s92, s84, 3072
s_add_u32 s93, s85, 2048
s_add_u32 s94, s86, 1024
s_add_u32 s95, s87, 0
s_and_b32 s78, s2, 7
s_lshl_b32 s75, s78, 4
s_lshr_b32 s76, s2, 5
s_lshr_b32 s7, s76, 2
s_lshl_b32 s7, s7, 3
s_add_u32 s7, s7, s78
s_lshl_b32 s7, s7, 14
s_lshl_b32 s76, s76, 1
s_add_u32 s75, s75, s76
s_bfe_u32 s79, s2, 65542
s_add_u32 s75, s75, s79
s_lshl_b32 s79, s79, 1
s_sub_u32 s79, 1, s79
s_bfe_u32 s76, s2, 0x20003
s_mul_i32 s77, s75, 393216
s_mul_i32 s78, s76, 98304
s_add_u32 s26, s77, s78
s_add_u32 s27, s26, 8192
s_add_u32 s28, s26, 16384
s_lshl_b32 s75, s75, 18
s_add_u32 s40, s75, s7
s_lshl_b32 s32, s3, 12
s_mov_b32 s10, 50331648
s_mov_b32 s11, 0x20000
s_mov_b32 s15, 0x20000
s_mov_b32 s19, 0x20000
s_mov_b32 s23, 0x20000
s_sub_u32 s14, 33557504, s32
s_and_b32 s5, s3, 1
s_lshl_b32 s5, s5, 13
s_sub_u32 s18, 33557504, s5
s_mul_i32 s6, s3, 24576
s_sub_u32 s22, 50331648, s6
s_mov_b32 s10, s22
s_lshl_b32 s4, s3, 13
s_add_u32 s4, s4, 131072
s_add_u32 s34, s32, 32768
s_add_u32 s35, s32, 49152
s_waitcnt lgkmcnt(0)
s_add_u32 s8, s8, s6
s_addc_u32 s9, s9, 0
s_add_u32 s12, s12, s32
s_addc_u32 s13, s13, 0
s_sub_u32 s12, s12, 3072
s_subb_u32 s13, s13, 0
s_mov_b32 m0, s32
s_add_u32 s90, s40, s92
buffer_load_dwordx4 v7, s[12:15], s90 offen offset:0 nt lds
s_add_u32 s90, s40, s93
buffer_load_dwordx4 v7, s[12:15], s90 offen offset:1024 nt lds
s_add_u32 s90, s40, s94
buffer_load_dwordx4 v7, s[12:15], s90 offen offset:2048 nt lds
s_add_u32 s90, s40, s95
buffer_load_dwordx4 v7, s[12:15], s90 offen offset:3072 nt lds
s_add_u32 m0, s34, 0
s_add_u32 s88, s26, s84
buffer_load_dwordx4 v7, s[8:11], s88 offen offset:0 nt lds
s_addk_i32 s88, 3072
buffer_load_dwordx4 v7, s[8:11], s88 offen offset:1024 nt lds
s_add_u32 m0, s34, 2048
s_add_u32 s88, s26, s85
buffer_load_dwordx4 v7, s[8:11], s88 offen offset:0 nt lds
s_addk_i32 s88, 3072
buffer_load_dwordx4 v7, s[8:11], s88 offen offset:1024 nt lds
s_add_u32 s16, s16, s5
s_addc_u32 s17, s17, 0
s_sub_u32 s16, s16, 3072
s_subb_u32 s17, s17, 0
s_add_u32 s33, s32, 16384
s_add_u32 s34, s32, 32768
s_add_u32 s35, s32, 49152
s_add_u32 s36, s32, 65536
s_add_u32 s37, s32, 81920
s_add_u32 s38, s32, 98304
s_add_u32 s39, s32, 114688
s_add_u32 s7, s7, 16384
s_and_b32 s7, s7, 0x3ffff
s_add_u32 s41, s75, s7
s_add_u32 s7, s7, 16384
s_and_b32 s7, s7, 0x3ffff
s_add_u32 s42, s75, s7
s_add_u32 s7, s7, 16384
s_and_b32 s7, s7, 0x3ffff
s_add_u32 s43, s75, s7
s_mov_b32 m0, s33
s_add_u32 s90, s41, s92
buffer_load_dwordx4 v7, s[12:15], s90 offen offset:0 nt lds
s_add_u32 s90, s41, s93
buffer_load_dwordx4 v7, s[12:15], s90 offen offset:1024 nt lds
s_add_u32 s90, s41, s94
buffer_load_dwordx4 v7, s[12:15], s90 offen offset:2048 nt lds
s_add_u32 s90, s41, s95
buffer_load_dwordx4 v7, s[12:15], s90 offen offset:3072 nt lds
v_and_b32 v44, 6, v42
v_xor_b32 v44, v44, v43
v_lshlrev_b32 v44, 4, v44
v_and_b32 v45, 7, v42
v_lshl_add_u32 v44, v45, 7, v44
v_lshrrev_b32 v45, 3, v42
v_lshl_add_u32 v1, v45, 12, v44
v_xor_b32 v2, 64, v1
v_lshl_add_u32 v44, v45, 10, v44
v_add_u32 v92, s34, v44
v_xor_b32 v93, 64, v92
v_add_u32 v94, s38, v44
v_xor_b32 v95, 64, v94
v_add_u32 v8, s4, v44
v_xor_b32 v96, 64, v8
v_bfe_u32 v44, v41, 2, 3
v_lshrrev_b32 v45, 1, v44
v_lshlrev_b32 v45, 5, v45
v_lshl_add_u32 v44, v44, 7, v45
v_and_b32 v45, 3, v41
v_lshl_add_u32 v44, v45, 3, v44
v_lshrrev_b32 v45, 5, v41
v_lshl_add_u32 v44, v45, 11, v44
v_add_u32 v3, 65536, v44
v_xor_b32 v4, 32, v3
v_xor_b32 v5, 64, v3
v_xor_b32 v6, 96, v3
v_and_b32 v44, 3, v41
v_cmp_eq_u32 vcc, 0, v44
v_mov_b32 v44, 0x3f803f80
s_nop 1
v_cndmask_b32 v20, 0, v44, vcc
v_cndmask_b32 v21, 0, v44, vcc
v_cndmask_b32 v22, 0, v44, vcc
v_cndmask_b32 v23, 0, v44, vcc
s_mov_b32 s24, 0x3db8aa3b
s_mov_b32 s74, 0xbdb8aa3b
s_mov_b32 s25, 0x45000000
s_add_u32 s20, s20, s6
s_addc_u32 s21, s21, 0
v_lshlrev_b32 v47, 13, v40
v_add_u32 v47, 131072, v47
v_lshl_add_u32 v9, v41, 4, v47
v_lshl_add_u32 v47, v42, 7, v47
v_lshrrev_b32 v44, 1, v43
v_add_u32 v44, 6, v44
v_and_b32 v45, 7, v42
v_xor_b32 v44, v44, v45
v_lshl_add_u32 v47, v44, 4, v47
v_and_b32 v44, 1, v43
v_lshl_add_u32 v0, v44, 3, v47
s_add_u32 s7, s7, 16384
s_and_b32 s7, s7, 0x3ffff
s_add_u32 s44, s75, s7
s_add_u32 s7, s7, 16384
s_and_b32 s7, s7, 0x3ffff
s_add_u32 s45, s75, s7
s_add_u32 s7, s7, 16384
s_and_b32 s7, s7, 0x3ffff
s_add_u32 s46, s75, s7
s_add_u32 s7, s7, 16384
s_and_b32 s7, s7, 0x3ffff
s_add_u32 s47, s75, s7
s_add_u32 s7, s7, 16384
s_and_b32 s7, s7, 0x3ffff
s_add_u32 s48, s75, s7
s_add_u32 s7, s7, 16384
s_and_b32 s7, s7, 0x3ffff
s_add_u32 s49, s75, s7
s_add_u32 s7, s7, 16384
s_and_b32 s7, s7, 0x3ffff
s_add_u32 s50, s75, s7
s_add_u32 s7, s7, 16384
s_and_b32 s7, s7, 0x3ffff
s_add_u32 s51, s75, s7
s_add_u32 s7, s7, 16384
s_and_b32 s7, s7, 0x3ffff
s_add_u32 s52, s75, s7
s_add_u32 s7, s7, 16384
s_and_b32 s7, s7, 0x3ffff
s_add_u32 s53, s75, s7
s_add_u32 s7, s7, 16384
s_and_b32 s7, s7, 0x3ffff
s_add_u32 s54, s75, s7
s_add_u32 s7, s7, 16384
s_and_b32 s7, s7, 0x3ffff
s_add_u32 s55, s75, s7
s_mul_i32 s80, s79, 262144
s_mul_i32 s79, s79, 393216
s_add_u32 s56, s40, s80
s_add_u32 s57, s41, s80
s_add_u32 s58, s42, s80
s_add_u32 s59, s43, s80
s_add_u32 s60, s44, s80
s_add_u32 s61, s45, s80
s_add_u32 s62, s46, s80
s_add_u32 s63, s47, s80
s_add_u32 s64, s48, s80
s_add_u32 s65, s49, s80
s_add_u32 s66, s50, s80
s_add_u32 s67, s51, s80
s_add_u32 s68, s52, s80
s_add_u32 s69, s53, s80
s_add_u32 s70, s54, s80
s_add_u32 s71, s55, s80
s_add_u32 s29, s26, s79
s_add_u32 s30, s27, s79
s_add_u32 s31, s28, s79
s_add_u32 s75, s26, 4096
s_add_u32 s76, s27, 4096
s_add_u32 s77, s28, 4096
s_add_u32 s78, s29, 4096
s_add_u32 s79, s30, 4096
s_add_u32 s80, s31, 4096
s_waitcnt vmcnt(12)
s_cmp_lg_u32 s3, 0
s_cbranch_scc1 HOPSKIP_1
s_mov_b64 exec, 0
s_call_b64 s[72:73], PADJ_0
s_mov_b64 exec, -1
HOPSKIP_1:
s_add_u32 m0, s35, 0
s_add_u32 s88, s26, s86
buffer_load_dwordx4 v7, s[8:11], s88 offen offset:0 nt lds
s_addk_i32 s88, 3072
buffer_load_dwordx4 v7, s[8:11], s88 offen offset:1024 nt lds
s_add_u32 m0, s35, 2048
s_add_u32 s88, s26, s87
buffer_load_dwordx4 v7, s[8:11], s88 offen offset:0 nt lds
s_addk_i32 s88, 3072
buffer_load_dwordx4 v7, s[8:11], s88 offen offset:1024 nt lds
s_cmp_lg_u32 s3, 1
s_cbranch_scc1 HOPSKIP_2
s_mov_b64 exec, 0
s_call_b64 s[72:73], PADJ_1
s_mov_b64 exec, -1
HOPSKIP_2:
s_add_u32 m0, s38, 0
s_add_u32 s88, s27, s84
buffer_load_dwordx4 v7, s[8:11], s88 offen offset:0 nt lds
s_addk_i32 s88, 3072
buffer_load_dwordx4 v7, s[8:11], s88 offen offset:1024 nt lds
s_add_u32 m0, s38, 2048
s_add_u32 s88, s27, s85
buffer_load_dwordx4 v7, s[8:11], s88 offen offset:0 nt lds
s_addk_i32 s88, 3072
buffer_load_dwordx4 v7, s[8:11], s88 offen offset:1024 nt lds
s_cmp_lg_u32 s3, 2
s_cbranch_scc1 HOPSKIP_3
s_mov_b64 exec, 0
s_call_b64 s[72:73], PADJ_2
s_mov_b64 exec, -1
HOPSKIP_3:
s_mov_b32 m0, s36
s_bitcmp1_b32 s3, 1
s_cselect_b32 s81, s41, s40
s_add_u32 s90, s81, s92
buffer_load_dwordx4 v7, s[16:19], s90 offen offset:0 nt lds
s_add_u32 s91, s81, s93
buffer_load_dwordx4 v7, s[16:19], s91 offen offset:1024 nt lds
s_addk_i32 s90, 2048
buffer_load_dwordx4 v7, s[16:19], s90 offen offset:2048 nt lds
s_addk_i32 s91, 2048
buffer_load_dwordx4 v7, s[16:19], s91 offen offset:3072 nt lds
s_cmp_lg_u32 s3, 3
s_cbranch_scc1 HOPSKIP_4
s_mov_b64 exec, 0
s_call_b64 s[72:73], PADJ_3
s_mov_b64 exec, -1
HOPSKIP_4:
s_waitcnt vmcnt(12)
s_barrier
ds_read_b128 a[96:99], v1 offset:0
ds_read_b128 a[100:103], v2 offset:0
ds_read_b128 a[104:107], v1 offset:8192
ds_read_b128 a[108:111], v2 offset:8192
ds_read_b128 a[112:115], v1 offset:16384
ds_read_b128 a[116:119], v2 offset:16384
ds_read_b128 a[120:123], v1 offset:24576
ds_read_b128 a[124:127], v2 offset:24576
ds_read_b128 a[128:131], v1 offset:1024
ds_read_b128 a[132:135], v2 offset:1024
ds_read_b128 a[136:139], v1 offset:9216
ds_read_b128 a[140:143], v2 offset:9216
ds_read_b128 a[0:3], v92 offset:0
ds_read_b128 a[12:15], v93 offset:0
s_waitcnt lgkmcnt(1)
v_mfma_f32_16x16x32_bf16 v[104:107], a[96:99], a[0:3], 0
ds_read_b128 a[144:147], v1 offset:17408
ds_read_b128 a[24:27], v92 offset:2048
ds_read_b128 a[36:39], v93 offset:2048
s_waitcnt lgkmcnt(3)
v_mfma_f32_16x16x32_bf16 v[104:107], a[100:103], a[12:15], v[104:107]
ds_read_b128 a[148:151], v2 offset:17408
s_add_u32 m0, s39, 0
s_add_u32 s88, s27, s86
buffer_load_dwordx4 v7, s[8:11], s88 offen offset:0 nt lds
v_mfma_f32_16x16x32_bf16 v[116:119], a[104:107], a[0:3], 0
ds_read_b128 a[152:155], v1 offset:25600
v_mfma_f32_16x16x32_bf16 v[116:119], a[108:111], a[12:15], v[116:119]
s_addk_i32 s88, 3072
ds_read_b128 a[156:159], v2 offset:25600
v_mfma_f32_16x16x32_bf16 v[128:131], a[112:115], a[0:3], 0
ds_read_b128 a[160:163], v1 offset:2048
buffer_load_dwordx4 v7, s[8:11], s88 offen offset:1024 nt lds
v_mfma_f32_16x16x32_bf16 v[128:131], a[116:119], a[12:15], v[128:131]
s_add_u32 m0, s39, 2048
ds_read_b128 a[164:167], v2 offset:2048
v_mfma_f32_16x16x32_bf16 v[140:143], a[120:123], a[0:3], 0
s_add_u32 s88, s27, s87
ds_read_b128 a[96:99], v1 offset:10240
v_mfma_f32_16x16x32_bf16 v[140:143], a[124:127], a[12:15], v[140:143]
s_waitcnt lgkmcnt(5)
ds_read_b128 a[100:103], v2 offset:10240
buffer_load_dwordx4 v7, s[8:11], s88 offen offset:0 nt lds
v_mfma_f32_16x16x32_bf16 v[104:107], a[128:131], a[24:27], v[104:107]
s_waitcnt vmcnt(13)
ds_read_b128 a[104:107], v1 offset:18432
ds_read_b128 a[48:51], v92 offset:16384
ds_read_b128 a[60:63], v93 offset:16384
v_mfma_f32_16x16x32_bf16 v[104:107], a[132:135], a[36:39], v[104:107]
ds_read_b128 a[108:111], v2 offset:18432
v_mfma_f32_16x16x32_bf16 v[116:119], a[136:139], a[24:27], v[116:119]
s_addk_i32 s88, 3072
ds_read_b128 a[112:115], v1 offset:26624
v_mfma_f32_16x16x32_bf16 v[116:119], a[140:143], a[36:39], v[116:119]
ds_read_b128 a[116:119], v2 offset:26624
buffer_load_dwordx4 v7, s[8:11], s88 offen offset:1024 nt lds
v_mfma_f32_16x16x32_bf16 v[128:131], a[144:147], a[24:27], v[128:131]
ds_read_b128 a[120:123], v1 offset:3072
v_mfma_f32_16x16x32_bf16 v[128:131], a[148:151], a[36:39], v[128:131]
s_waitcnt lgkmcnt(7)
ds_read_b128 a[124:127], v2 offset:3072
v_mfma_f32_16x16x32_bf16 v[140:143], a[152:155], a[24:27], v[140:143]
ds_read_b128 a[128:131], v1 offset:11264
s_mov_b32 m0, s37
s_addk_i32 s81, 2048
s_add_u32 s90, s81, s94
buffer_load_dwordx4 v7, s[16:19], s90 offen offset:0 nt lds
v_mfma_f32_16x16x32_bf16 v[140:143], a[156:159], a[36:39], v[140:143]
s_waitcnt lgkmcnt(5)
ds_read_b128 a[132:135], v2 offset:11264
v_mfma_f32_16x16x32_bf16 v[104:107], a[160:163], a[48:51], v[104:107]
s_waitcnt vmcnt(13)
ds_read_b128 a[136:139], v1 offset:19456
ds_read_b128 a[72:75], v92 offset:18432
ds_read_b128 a[84:87], v93 offset:18432
s_add_u32 s91, s81, s95
v_mfma_f32_16x16x32_bf16 v[104:107], a[164:167], a[60:63], v[104:107]
ds_read_b128 a[140:143], v2 offset:19456
buffer_load_dwordx4 v7, s[16:19], s91 offen offset:1024 nt lds
v_mfma_f32_16x16x32_bf16 v[116:119], a[96:99], a[48:51], v[116:119]
ds_read_b128 a[144:147], v1 offset:27648
v_mfma_f32_16x16x32_bf16 v[116:119], a[100:103], a[60:63], v[116:119]
ds_read_b128 a[148:151], v2 offset:27648
v_mfma_f32_16x16x32_bf16 v[128:131], a[104:107], a[48:51], v[128:131]
s_addk_i32 s90, 2048
ds_read_b128 a[152:155], v1 offset:0
v_mfma_f32_16x16x32_bf16 v[128:131], a[108:111], a[60:63], v[128:131]
s_waitcnt lgkmcnt(7)
ds_read_b128 a[156:159], v2 offset:0
buffer_load_dwordx4 v7, s[16:19], s90 offen offset:2048 nt lds
v_mfma_f32_16x16x32_bf16 v[140:143], a[112:115], a[48:51], v[140:143]
s_addk_i32 s91, 2048
ds_read_b128 a[160:163], v1 offset:8192
v_mfma_f32_16x16x32_bf16 v[140:143], a[116:119], a[60:63], v[140:143]
s_waitcnt lgkmcnt(5)
ds_read_b128 a[164:167], v2 offset:8192
v_mfma_f32_16x16x32_bf16 v[104:107], a[120:123], a[72:75], v[104:107]
ds_read_b128 a[96:99], v1 offset:16384
buffer_load_dwordx4 v7, s[16:19], s91 offen offset:3072 nt lds
v_mfma_f32_16x16x32_bf16 v[104:107], a[124:127], a[84:87], v[104:107]
ds_read_b128 a[100:103], v2 offset:16384
v_mfma_f32_16x16x32_bf16 v[116:119], a[128:131], a[72:75], v[116:119]
ds_read_b128 a[104:107], v1 offset:24576
v_mfma_f32_16x16x32_bf16 v[116:119], a[132:135], a[84:87], v[116:119]
ds_read_b128 a[108:111], v2 offset:24576
v_mfma_f32_16x16x32_bf16 v[128:131], a[136:139], a[72:75], v[128:131]
ds_read_b128 a[112:115], v1 offset:1024
v_mfma_f32_16x16x32_bf16 v[128:131], a[140:143], a[84:87], v[128:131]
s_waitcnt lgkmcnt(5)
ds_read_b128 a[116:119], v2 offset:1024
v_mfma_f32_16x16x32_bf16 v[140:143], a[144:147], a[72:75], v[140:143]
ds_read_b128 a[120:123], v1 offset:9216
v_mfma_f32_16x16x32_bf16 v[140:143], a[148:151], a[84:87], v[140:143]
ds_read_b128 a[124:127], v2 offset:9216
v_max3_f32 v11, v104, v105, v106
v_max3_f32 v11, v11, v107, v116
v_max3_f32 v11, v11, v117, v118
v_max3_f32 v11, v11, v119, v128
v_max3_f32 v11, v11, v129, v130
s_nop 1
v_max3_f32 v11, v11, v131, v140
v_max3_f32 v11, v11, v141, v142
v_max_f32 v11, v11, v143
v_mov_b32 v29, v11
s_nop 1
v_permlane16_swap_b32 v11, v29
v_max_f32 v11, v11, v29
v_mov_b32 v29, v11
s_nop 1
v_permlane32_swap_b32 v11, v29
v_max_f32 v11, v11, v29
v_mul_f32 v11, s74, v11
v_fma_f32 v104, v104, s24, v11
v_fma_f32 v105, v105, s24, v11
v_fma_f32 v106, v106, s24, v11
v_fma_f32 v107, v107, s24, v11
v_exp_f32 v28, v104
v_exp_f32 v29, v105
v_exp_f32 v30, v106
v_cvt_pk_bf16_f32 v32, v28, v29
v_add_f32 v17, v28, v29
v_exp_f32 v31, v107
v_add_f32 v17, v17, v30
v_cvt_pk_bf16_f32 v33, v30, v31
v_add_f32 v17, v17, v31
v_fma_f32 v116, v116, s24, v11
v_fma_f32 v117, v117, s24, v11
v_fma_f32 v118, v118, s24, v11
v_fma_f32 v119, v119, s24, v11
v_exp_f32 v20, v116
v_exp_f32 v21, v117
v_add_f32 v17, v17, v20
v_cvt_pk_bf16_f32 v34, v20, v21
v_add_f32 v17, v17, v21
v_exp_f32 v28, v118
v_exp_f32 v29, v119
v_add_f32 v17, v17, v28
v_cvt_pk_bf16_f32 v35, v28, v29
v_add_f32 v17, v17, v29
v_fma_f32 v128, v128, s24, v11
v_fma_f32 v129, v129, s24, v11
v_fma_f32 v130, v130, s24, v11
v_fma_f32 v131, v131, s24, v11
v_exp_f32 v30, v128
v_exp_f32 v31, v129
v_add_f32 v17, v17, v30
v_cvt_pk_bf16_f32 v36, v30, v31
v_add_f32 v17, v17, v31
v_exp_f32 v20, v130
v_exp_f32 v21, v131
v_fma_f32 v140, v140, s24, v11
v_cvt_pk_bf16_f32 v37, v20, v21
v_fma_f32 v141, v141, s24, v11
v_fma_f32 v142, v142, s24, v11
v_fma_f32 v143, v143, s24, v11
v_exp_f32 v28, v140
v_exp_f32 v29, v141
v_exp_f32 v30, v142
v_cvt_pk_bf16_f32 v38, v28, v29
v_exp_f32 v31, v143
v_add_f32 v17, v17, v20
v_cvt_pk_bf16_f32 v39, v30, v31
s_waitcnt vmcnt(14)
ds_read_b128 a[4:7], v94 offset:0
ds_read_b128 a[16:19], v95 offset:0
s_waitcnt lgkmcnt(1)
v_mfma_f32_16x16x32_bf16 v[108:111], a[152:155], a[4:7], 0
s_waitcnt vmcnt(12)
ds_read_b128 a[128:131], v1 offset:17408
ds_read_b128 a[28:31], v94 offset:2048
ds_read_b128 a[40:43], v95 offset:2048
s_waitcnt lgkmcnt(3)
v_mfma_f32_16x16x32_bf16 v[108:111], a[156:159], a[16:19], v[108:111]
ds_read_b128 a[132:135], v2 offset:17408
s_add_u32 m0, s4, 0
s_add_u32 s88, s28, s84
buffer_load_dwordx4 v7, s[8:11], s88 offen offset:0 nt lds
v_mfma_f32_16x16x32_bf16 v[120:123], a[160:163], a[4:7], 0
ds_read_b128 a[136:139], v1 offset:25600
v_add_f32 v17, v17, v21
v_mfma_f32_16x16x32_bf16 v[120:123], a[164:167], a[16:19], v[120:123]
s_addk_i32 s88, 3072
ds_read_b128 a[140:143], v2 offset:25600
v_add_f32 v17, v17, v28
v_mfma_f32_16x16x32_bf16 v[132:135], a[96:99], a[4:7], 0
ds_read_b128 a[144:147], v1 offset:2048
buffer_load_dwordx4 v7, s[8:11], s88 offen offset:1024 nt lds
v_mfma_f32_16x16x32_bf16 v[132:135], a[100:103], a[16:19], v[132:135]
s_add_u32 m0, s4, 2048
ds_read_b128 a[148:151], v2 offset:2048
v_add_f32 v17, v17, v29
v_mfma_f32_16x16x32_bf16 v[144:147], a[104:107], a[4:7], 0
s_add_u32 s88, s28, s85
ds_read_b128 a[152:155], v1 offset:10240
v_add_f32 v17, v17, v30
v_mfma_f32_16x16x32_bf16 v[144:147], a[108:111], a[16:19], v[144:147]
s_waitcnt lgkmcnt(5)
ds_read_b128 a[156:159], v2 offset:10240
buffer_load_dwordx4 v7, s[8:11], s88 offen offset:0 nt lds
v_mfma_f32_16x16x32_bf16 v[108:111], a[112:115], a[28:31], v[108:111]
s_waitcnt vmcnt(9)
ds_read_b128 a[160:163], v1 offset:18432
ds_read_b128 a[52:55], v94 offset:16384
ds_read_b128 a[64:67], v95 offset:16384
v_mfma_f32_16x16x32_bf16 v[108:111], a[116:119], a[40:43], v[108:111]
ds_read_b128 a[164:167], v2 offset:18432
v_add_f32 v17, v17, v31
v_mfma_f32_16x16x32_bf16 v[120:123], a[120:123], a[28:31], v[120:123]
ds_read_b128 a[96:99], v1 offset:26624
v_mfma_f32_16x16x32_bf16 v[120:123], a[124:127], a[40:43], v[120:123]
ds_read_b128 a[100:103], v2 offset:26624
v_mfma_f32_16x16x32_bf16 v[132:135], a[128:131], a[28:31], v[132:135]
ds_read_b128 a[104:107], v1 offset:3072
v_mfma_f32_16x16x32_bf16 v[132:135], a[132:135], a[40:43], v[132:135]
s_waitcnt lgkmcnt(7)
ds_read_b128 a[108:111], v2 offset:3072
v_mfma_f32_16x16x32_bf16 v[144:147], a[136:139], a[28:31], v[144:147]
ds_read_b128 a[112:115], v1 offset:11264
v_mfma_f32_16x16x32_bf16 v[144:147], a[140:143], a[40:43], v[144:147]
s_waitcnt lgkmcnt(5)
ds_read_b128 a[116:119], v2 offset:11264
v_mfma_f32_16x16x32_bf16 v[108:111], a[144:147], a[52:55], v[108:111]
s_waitcnt vmcnt(7)
ds_read_b128 a[120:123], v1 offset:19456
ds_read_b128 a[76:79], v94 offset:18432
ds_read_b128 a[88:91], v95 offset:18432
v_mfma_f32_16x16x32_bf16 v[108:111], a[148:151], a[64:67], v[108:111]
ds_read_b128 a[124:127], v2 offset:19456
v_mfma_f32_16x16x32_bf16 v[120:123], a[152:155], a[52:55], v[120:123]
ds_read_b128 a[128:131], v1 offset:27648
v_mfma_f32_16x16x32_bf16 v[120:123], a[156:159], a[64:67], v[120:123]
s_addk_i32 s88, 3072
ds_read_b128 a[132:135], v2 offset:27648
v_mfma_f32_16x16x32_bf16 v[132:135], a[160:163], a[52:55], v[132:135]
buffer_load_dwordx4 v7, s[8:11], s88 offen offset:1024 nt lds
v_mfma_f32_16x16x32_bf16 v[132:135], a[164:167], a[64:67], v[132:135]
s_mov_b32 m0, s34
s_add_u32 s90, s42, s92
buffer_load_dwordx4 v7, s[12:15], s90 offen offset:0 nt lds
s_waitcnt lgkmcnt(6)
v_mfma_f32_16x16x32_bf16 v[144:147], a[96:99], a[52:55], v[144:147]
s_add_u32 s90, s42, s93
buffer_load_dwordx4 v7, s[12:15], s90 offen offset:1024 nt lds
v_mfma_f32_16x16x32_bf16 v[144:147], a[100:103], a[64:67], v[144:147]
s_add_u32 s90, s42, s94
buffer_load_dwordx4 v7, s[12:15], s90 offen offset:2048 nt lds
s_waitcnt lgkmcnt(2)
v_mfma_f32_16x16x32_bf16 v[108:111], a[104:107], a[76:79], v[108:111]
s_add_u32 s90, s42, s95
buffer_load_dwordx4 v7, s[12:15], s90 offen offset:3072 nt lds
v_mfma_f32_16x16x32_bf16 v[108:111], a[108:111], a[88:91], v[108:111]
v_mfma_f32_16x16x32_bf16 v[120:123], a[112:115], a[76:79], v[120:123]
v_mfma_f32_16x16x32_bf16 v[120:123], a[116:119], a[88:91], v[120:123]
v_mfma_f32_16x16x32_bf16 v[132:135], a[120:123], a[76:79], v[132:135]
v_mfma_f32_16x16x32_bf16 v[132:135], a[124:127], a[88:91], v[132:135]
s_waitcnt lgkmcnt(0)
v_mfma_f32_16x16x32_bf16 v[144:147], a[128:131], a[76:79], v[144:147]
v_mfma_f32_16x16x32_bf16 v[144:147], a[132:135], a[88:91], v[144:147]
s_nop 0
v_max3_f32 v13, v108, v109, v110
s_nop 0
v_max3_f32 v13, v13, v111, v120
v_max3_f32 v13, v13, v121, v122
v_max3_f32 v13, v13, v123, v132
v_max3_f32 v13, v13, v133, v134
s_nop 0
v_max3_f32 v13, v13, v135, v144
v_max3_f32 v13, v13, v145, v146
v_max_f32 v13, v13, v147
v_mov_b32 v29, v13
s_nop 1
v_permlane16_swap_b32 v13, v29
v_max_f32 v13, v13, v29
v_mov_b32 v29, v13
s_nop 1
v_permlane32_swap_b32 v13, v29
v_max_f32 v13, v13, v29
v_mul_f32 v13, s74, v13
v_fma_f32 v108, v108, s24, v13
v_fma_f32 v109, v109, s24, v13
v_fma_f32 v110, v110, s24, v13
v_fma_f32 v111, v111, s24, v13
v_exp_f32 v20, v108
v_exp_f32 v21, v109
v_exp_f32 v28, v110
v_cvt_pk_bf16_f32 v44, v20, v21
v_add_f32 v18, v20, v21
v_exp_f32 v29, v111
v_add_f32 v18, v18, v28
v_cvt_pk_bf16_f32 v45, v28, v29
v_add_f32 v18, v18, v29
v_fma_f32 v120, v120, s24, v13
v_fma_f32 v121, v121, s24, v13
v_fma_f32 v122, v122, s24, v13
v_fma_f32 v123, v123, s24, v13
v_exp_f32 v30, v120
v_exp_f32 v31, v121
v_add_f32 v18, v18, v30
v_cvt_pk_bf16_f32 v46, v30, v31
v_add_f32 v18, v18, v31
v_exp_f32 v20, v122
v_exp_f32 v21, v123
v_add_f32 v18, v18, v20
v_cvt_pk_bf16_f32 v47, v20, v21
v_add_f32 v18, v18, v21
v_fma_f32 v132, v132, s24, v13
v_fma_f32 v133, v133, s24, v13
v_fma_f32 v134, v134, s24, v13
v_fma_f32 v135, v135, s24, v13
v_exp_f32 v28, v132
v_exp_f32 v29, v133
v_add_f32 v18, v18, v28
v_cvt_pk_bf16_f32 v48, v28, v29
v_add_f32 v18, v18, v29
v_exp_f32 v30, v134
v_exp_f32 v31, v135
v_fma_f32 v144, v144, s24, v13
v_cvt_pk_bf16_f32 v49, v30, v31
v_fma_f32 v145, v145, s24, v13
v_fma_f32 v146, v146, s24, v13
v_fma_f32 v147, v147, s24, v13
v_exp_f32 v20, v144
v_exp_f32 v21, v145
v_exp_f32 v28, v146
v_cvt_pk_bf16_f32 v50, v20, v21
v_exp_f32 v29, v147
v_add_f32 v18, v18, v30
v_cvt_pk_bf16_f32 v51, v28, v29
s_waitcnt vmcnt(8)
s_barrier
ds_read_b64_tr_b16 a[136:137], v3 offset:0
ds_read_b64_tr_b16 a[138:139], v3 offset:4096
ds_read_b64_tr_b16 a[140:141], v3 offset:8192
ds_read_b64_tr_b16 a[142:143], v3 offset:12288
ds_read_b64_tr_b16 a[144:145], v4 offset:0
ds_read_b64_tr_b16 a[146:147], v4 offset:4096
ds_read_b64_tr_b16 a[148:149], v4 offset:8192
ds_read_b64_tr_b16 a[150:151], v4 offset:12288
ds_read_b64_tr_b16 a[152:153], v5 offset:0
ds_read_b64_tr_b16 a[154:155], v5 offset:4096
ds_read_b64_tr_b16 a[156:157], v5 offset:8192
ds_read_b64_tr_b16 a[158:159], v5 offset:12288
s_waitcnt lgkmcnt(10)
v_mfma_f32_16x16x32_bf16 v[104:107], a[136:139], v[32:35], 0
PADJ_0:
s_cbranch_execz PADJ_4
s_waitcnt lgkmcnt(8)
ds_read_b64_tr_b16 a[160:161], v6 offset:0
v_mfma_f32_16x16x32_bf16 v[104:107], a[140:143], v[36:39], v[104:107]
ds_read_b64_tr_b16 a[162:163], v6 offset:4096
s_add_u32 m0, s4, 4096
s_add_u32 s88, s28, s86
buffer_load_dwordx4 v7, s[8:11], s88 offen offset:0 nt lds
v_mfma_f32_16x16x32_bf16 v[108:111], a[136:139], v[44:47], 0
ds_read_b64_tr_b16 a[164:165], v6 offset:8192
v_add_f32 v18, v18, v31
v_mfma_f32_16x16x32_bf16 v[108:111], a[140:143], v[48:51], v[108:111]
s_waitcnt lgkmcnt(9)
ds_read_b64_tr_b16 a[166:167], v6 offset:12288
v_add_f32 v18, v18, v20
v_mfma_f32_16x16x32_bf16 v[116:119], a[144:147], v[32:35], 0
s_waitcnt lgkmcnt(8)
ds_read_b64_tr_b16 a[96:97], v3 offset:1024
v_add_f32 v18, v18, v21
v_mfma_f32_16x16x32_bf16 v[116:119], a[148:151], v[36:39], v[116:119]
ds_read_b64_tr_b16 a[98:99], v3 offset:5120
v_add_f32 v18, v18, v28
v_mfma_f32_16x16x32_bf16 v[120:123], a[144:147], v[44:47], 0
s_addk_i32 s88, 3072
ds_read_b64_tr_b16 a[100:101], v3 offset:9216
v_add_f32 v18, v18, v29
v_mfma_f32_16x16x32_bf16 v[120:123], a[148:151], v[48:51], v[120:123]
s_waitcnt lgkmcnt(5)
ds_read_b64_tr_b16 a[102:103], v3 offset:13312
buffer_load_dwordx4 v7, s[8:11], s88 offen offset:1024 nt lds
v_mfma_f32_16x16x32_bf16 v[128:131], a[152:155], v[32:35], 0
ds_read_b64_tr_b16 a[104:105], v4 offset:1024
v_mfma_f32_16x16x32_bf16 v[128:131], a[156:159], v[36:39], v[128:131]
ds_read_b64_tr_b16 a[106:107], v4 offset:5120
v_mfma_f32_16x16x32_bf16 v[132:135], a[152:155], v[44:47], 0
ds_read_b64_tr_b16 a[108:109], v4 offset:9216
v_mfma_f32_16x16x32_bf16 v[132:135], a[156:159], v[48:51], v[132:135]
s_add_u32 m0, s4, 6144
ds_read_b64_tr_b16 a[110:111], v4 offset:13312
v_mfma_f32_16x16x32_bf16 v[140:143], a[160:163], v[32:35], 0
s_waitcnt lgkmcnt(5)
ds_read_b64_tr_b16 a[112:113], v5 offset:1024
v_mfma_f32_16x16x32_bf16 v[140:143], a[164:167], v[36:39], v[140:143]
s_add_u32 s88, s28, s87
ds_read_b64_tr_b16 a[114:115], v5 offset:5120
v_mfma_f32_16x16x32_bf16 v[144:147], a[160:163], v[44:47], 0
ds_read_b64_tr_b16 a[116:117], v5 offset:9216
buffer_load_dwordx4 v7, s[8:11], s88 offen offset:0 nt lds
v_mfma_f32_16x16x32_bf16 v[144:147], a[164:167], v[48:51], v[144:147]
ds_read_b64_tr_b16 a[118:119], v5 offset:13312
v_mfma_f32_16x16x32_bf16 v[152:155], a[96:99], v[32:35], 0
s_waitcnt lgkmcnt(5)
ds_read_b64_tr_b16 a[120:121], v6 offset:1024
v_mfma_f32_16x16x32_bf16 v[152:155], a[100:103], v[36:39], v[152:155]
ds_read_b64_tr_b16 a[122:123], v6 offset:5120
v_mfma_f32_16x16x32_bf16 v[156:159], a[96:99], v[44:47], 0
ds_read_b64_tr_b16 a[124:125], v6 offset:9216
v_mfma_f32_16x16x32_bf16 v[156:159], a[100:103], v[48:51], v[156:159]
s_addk_i32 s88, 3072
ds_read_b64_tr_b16 a[126:127], v6 offset:13312
v_mfma_f32_16x16x32_bf16 v[164:167], a[104:107], v[32:35], 0
s_waitcnt lgkmcnt(5)
ds_read_b64_tr_b16 a[128:129], v3 offset:16384
v_mfma_f32_16x16x32_bf16 v[164:167], a[108:111], v[36:39], v[164:167]
ds_read_b64_tr_b16 a[130:131], v3 offset:20480
buffer_load_dwordx4 v7, s[8:11], s88 offen offset:1024 nt lds
v_mfma_f32_16x16x32_bf16 v[168:171], a[104:107], v[44:47], 0
ds_read_b64_tr_b16 a[132:133], v3 offset:24576
v_mfma_f32_16x16x32_bf16 v[168:171], a[108:111], v[48:51], v[168:171]
ds_read_b64_tr_b16 a[134:135], v3 offset:28672
v_mfma_f32_16x16x32_bf16 v[176:179], a[112:115], v[32:35], 0
s_waitcnt lgkmcnt(5)
ds_read_b64_tr_b16 a[136:137], v4 offset:16384
v_mfma_f32_16x16x32_bf16 v[176:179], a[116:119], v[36:39], v[176:179]
ds_read_b64_tr_b16 a[138:139], v4 offset:20480
v_mfma_f32_16x16x32_bf16 v[180:183], a[112:115], v[44:47], 0
s_mov_b32 m0, s35
ds_read_b64_tr_b16 a[140:141], v4 offset:24576
v_mfma_f32_16x16x32_bf16 v[180:183], a[116:119], v[48:51], v[180:183]
s_add_u32 s90, s43, s92
ds_read_b64_tr_b16 a[142:143], v4 offset:28672
v_mfma_f32_16x16x32_bf16 v[188:191], a[120:123], v[32:35], 0
s_waitcnt lgkmcnt(5)
ds_read_b64_tr_b16 a[144:145], v5 offset:16384
buffer_load_dwordx4 v7, s[12:15], s90 offen offset:0 nt lds
v_mfma_f32_16x16x32_bf16 v[188:191], a[124:127], v[36:39], v[188:191]
ds_read_b64_tr_b16 a[146:147], v5 offset:20480
v_mfma_f32_16x16x32_bf16 v[192:195], a[120:123], v[44:47], 0
ds_read_b64_tr_b16 a[148:149], v5 offset:24576
v_mfma_f32_16x16x32_bf16 v[192:195], a[124:127], v[48:51], v[192:195]
ds_read_b64_tr_b16 a[150:151], v5 offset:28672
v_mfma_f32_16x16x32_bf16 v[200:203], a[128:131], v[32:35], 0
s_waitcnt lgkmcnt(5)
ds_read_b64_tr_b16 a[152:153], v6 offset:16384
v_mfma_f32_16x16x32_bf16 v[200:203], a[132:135], v[36:39], v[200:203]
ds_read_b64_tr_b16 a[154:155], v6 offset:20480
v_mfma_f32_16x16x32_bf16 v[204:207], a[128:131], v[44:47], 0
s_add_u32 s90, s43, s93
ds_read_b64_tr_b16 a[156:157], v6 offset:24576
v_mfma_f32_16x16x32_bf16 v[204:207], a[132:135], v[48:51], v[204:207]
ds_read_b64_tr_b16 a[158:159], v6 offset:28672
buffer_load_dwordx4 v7, s[12:15], s90 offen offset:1024 nt lds
v_mfma_f32_16x16x32_bf16 v[212:215], a[136:139], v[32:35], 0
s_waitcnt lgkmcnt(5)
ds_read_b64_tr_b16 a[160:161], v3 offset:17408
v_mfma_f32_16x16x32_bf16 v[212:215], a[140:143], v[36:39], v[212:215]
ds_read_b64_tr_b16 a[162:163], v3 offset:21504
v_mfma_f32_16x16x32_bf16 v[216:219], a[136:139], v[44:47], 0
ds_read_b64_tr_b16 a[164:165], v3 offset:25600
v_mfma_f32_16x16x32_bf16 v[216:219], a[140:143], v[48:51], v[216:219]
ds_read_b64_tr_b16 a[166:167], v3 offset:29696
v_mfma_f32_16x16x32_bf16 a[216:219], a[144:147], v[32:35], 0
s_waitcnt lgkmcnt(5)
ds_read_b64_tr_b16 a[96:97], v4 offset:17408
v_mfma_f32_16x16x32_bf16 a[216:219], a[148:151], v[36:39], a[216:219]
s_add_u32 s90, s43, s94
ds_read_b64_tr_b16 a[98:99], v4 offset:21504
v_mfma_f32_16x16x32_bf16 a[220:223], a[144:147], v[44:47], 0
ds_read_b64_tr_b16 a[100:101], v4 offset:25600
buffer_load_dwordx4 v7, s[12:15], s90 offen offset:2048 nt lds
v_mfma_f32_16x16x32_bf16 a[220:223], a[148:151], v[48:51], a[220:223]
ds_read_b64_tr_b16 a[102:103], v4 offset:29696
v_mfma_f32_16x16x32_bf16 a[228:231], a[152:155], v[32:35], 0
s_waitcnt lgkmcnt(5)
ds_read_b64_tr_b16 a[104:105], v5 offset:17408
v_mfma_f32_16x16x32_bf16 a[228:231], a[156:159], v[36:39], a[228:231]
ds_read_b64_tr_b16 a[106:107], v5 offset:21504
v_mfma_f32_16x16x32_bf16 a[232:235], a[152:155], v[44:47], 0
ds_read_b64_tr_b16 a[108:109], v5 offset:25600
v_mfma_f32_16x16x32_bf16 a[232:235], a[156:159], v[48:51], a[232:235]
s_add_u32 s90, s43, s95
ds_read_b64_tr_b16 a[110:111], v5 offset:29696
v_mfma_f32_16x16x32_bf16 a[240:243], a[160:163], v[32:35], 0
s_waitcnt lgkmcnt(5)
ds_read_b64_tr_b16 a[112:113], v6 offset:17408
v_mfma_f32_16x16x32_bf16 a[240:243], a[164:167], v[36:39], a[240:243]
ds_read_b64_tr_b16 a[114:115], v6 offset:21504
buffer_load_dwordx4 v7, s[12:15], s90 offen offset:3072 nt lds
v_mfma_f32_16x16x32_bf16 a[244:247], a[160:163], v[44:47], 0
ds_read_b64_tr_b16 a[116:117], v6 offset:25600
v_mfma_f32_16x16x32_bf16 a[244:247], a[164:167], v[48:51], a[244:247]
ds_read_b64_tr_b16 a[118:119], v6 offset:29696
v_mfma_f32_16x16x32_bf16 a[252:255], a[96:99], v[32:35], 0
s_waitcnt lgkmcnt(5)
ds_read_b128 a[120:123], v1 offset:0
v_mfma_f32_16x16x32_bf16 a[252:255], a[100:103], v[36:39], a[252:255]
ds_read_b128 a[124:127], v2 offset:0
v_mfma_f32_16x16x32_bf16 v[224:227], a[96:99], v[44:47], 0
ds_read_b128 a[128:131], v1 offset:8192
v_mfma_f32_16x16x32_bf16 v[224:227], a[100:103], v[48:51], v[224:227]
ds_read_b128 a[132:135], v2 offset:8192
v_mfma_f32_16x16x32_bf16 v[232:235], a[104:107], v[32:35], 0
s_waitcnt lgkmcnt(5)
ds_read_b128 a[136:139], v1 offset:16384
v_mfma_f32_16x16x32_bf16 v[232:235], a[108:111], v[36:39], v[232:235]
ds_read_b128 a[140:143], v2 offset:16384
v_mfma_f32_16x16x32_bf16 v[236:239], a[104:107], v[44:47], 0
ds_read_b128 a[144:147], v1 offset:24576
v_mfma_f32_16x16x32_bf16 v[236:239], a[108:111], v[48:51], v[236:239]
ds_read_b128 a[148:151], v2 offset:24576
v_mfma_f32_16x16x32_bf16 v[244:247], a[112:115], v[32:35], 0
s_waitcnt lgkmcnt(5)
ds_read_b128 a[152:155], v1 offset:1024
v_mfma_f32_16x16x32_bf16 v[244:247], a[116:119], v[36:39], v[244:247]
ds_read_b128 a[156:159], v2 offset:1024
v_mfma_f32_16x16x32_bf16 v[248:251], a[112:115], v[44:47], 0
ds_read_b128 a[160:163], v1 offset:9216
v_mfma_f32_16x16x32_bf16 v[248:251], a[116:119], v[48:51], v[248:251]
s_waitcnt vmcnt(14)
ds_read_b128 a[164:167], v2 offset:9216
ds_read_b128 a[8:11], v8 offset:0
ds_read_b128 a[20:23], v96 offset:0
s_waitcnt lgkmcnt(1)
v_mfma_f32_16x16x32_bf16 v[112:115], a[120:123], a[8:11], 0
s_waitcnt vmcnt(12)
ds_read_b128 a[96:99], v1 offset:17408
ds_read_b128 a[32:35], v8 offset:2048
ds_read_b128 a[44:47], v96 offset:2048
s_waitcnt lgkmcnt(3)
v_mfma_f32_16x16x32_bf16 v[112:115], a[124:127], a[20:23], v[112:115]
ds_read_b128 a[100:103], v2 offset:17408
s_mov_b32 m0, s38
s_bitcmp1_b32 s3, 1
s_cselect_b32 s81, s43, s42
s_add_u32 s90, s81, s92
buffer_load_dwordx4 v7, s[16:19], s90 offen offset:0 nt lds
v_mfma_f32_16x16x32_bf16 v[124:127], a[128:131], a[8:11], 0
s_add_u32 s91, s81, s93
ds_read_b128 a[104:107], v1 offset:25600
v_mfma_f32_16x16x32_bf16 v[124:127], a[132:135], a[20:23], v[124:127]
ds_read_b128 a[108:111], v2 offset:25600
buffer_load_dwordx4 v7, s[16:19], s91 offen offset:1024 nt lds
v_mfma_f32_16x16x32_bf16 v[136:139], a[136:139], a[8:11], 0
ds_read_b128 a[112:115], v1 offset:2048
v_mfma_f32_16x16x32_bf16 v[136:139], a[140:143], a[20:23], v[136:139]
s_addk_i32 s90, 2048
ds_read_b128 a[116:119], v2 offset:2048
v_mfma_f32_16x16x32_bf16 v[148:151], a[144:147], a[8:11], 0
ds_read_b128 a[120:123], v1 offset:10240
buffer_load_dwordx4 v7, s[16:19], s90 offen offset:2048 nt lds
v_mfma_f32_16x16x32_bf16 v[148:151], a[148:151], a[20:23], v[148:151]
s_waitcnt lgkmcnt(5)
ds_read_b128 a[124:127], v2 offset:10240
v_mfma_f32_16x16x32_bf16 v[112:115], a[152:155], a[32:35], v[112:115]
s_waitcnt vmcnt(9)
ds_read_b128 a[128:131], v1 offset:18432
ds_read_b128 a[56:59], v8 offset:4096
ds_read_b128 a[68:71], v96 offset:4096
s_addk_i32 s91, 2048
v_mfma_f32_16x16x32_bf16 v[112:115], a[156:159], a[44:47], v[112:115]
ds_read_b128 a[132:135], v2 offset:18432
buffer_load_dwordx4 v7, s[16:19], s91 offen offset:3072 nt lds
v_mfma_f32_16x16x32_bf16 v[124:127], a[160:163], a[32:35], v[124:127]
ds_read_b128 a[136:139], v1 offset:26624
v_mfma_f32_16x16x32_bf16 v[124:127], a[164:167], a[44:47], v[124:127]
ds_read_b128 a[140:143], v2 offset:26624
v_mfma_f32_16x16x32_bf16 v[136:139], a[96:99], a[32:35], v[136:139]
ds_read_b128 a[144:147], v1 offset:3072
v_mfma_f32_16x16x32_bf16 v[136:139], a[100:103], a[44:47], v[136:139]
s_waitcnt lgkmcnt(7)
ds_read_b128 a[148:151], v2 offset:3072
v_mfma_f32_16x16x32_bf16 v[148:151], a[104:107], a[32:35], v[148:151]
ds_read_b128 a[152:155], v1 offset:11264
v_mfma_f32_16x16x32_bf16 v[148:151], a[108:111], a[44:47], v[148:151]
s_waitcnt lgkmcnt(5)
ds_read_b128 a[156:159], v2 offset:11264
v_mfma_f32_16x16x32_bf16 v[112:115], a[112:115], a[56:59], v[112:115]
s_waitcnt vmcnt(8)
ds_read_b128 a[160:163], v1 offset:19456
ds_read_b128 a[80:83], v8 offset:6144
ds_read_b128 a[92:95], v96 offset:6144
v_mfma_f32_16x16x32_bf16 v[112:115], a[116:119], a[68:71], v[112:115]
s_mov_b32 m0, s39
ds_read_b128 a[164:167], v2 offset:19456
v_mfma_f32_16x16x32_bf16 v[124:127], a[120:123], a[56:59], v[124:127]
s_addk_i32 s81, 2048
ds_read_b128 a[96:99], v1 offset:27648
v_mfma_f32_16x16x32_bf16 v[124:127], a[124:127], a[68:71], v[124:127]
s_add_u32 s90, s81, s94
ds_read_b128 a[100:103], v2 offset:27648
v_mfma_f32_16x16x32_bf16 v[136:139], a[128:131], a[56:59], v[136:139]
buffer_load_dwordx4 v7, s[16:19], s90 offen offset:0 nt lds
v_mfma_f32_16x16x32_bf16 v[136:139], a[132:135], a[68:71], v[136:139]
s_add_u32 s91, s81, s95
buffer_load_dwordx4 v7, s[16:19], s91 offen offset:1024 nt lds
s_waitcnt lgkmcnt(6)
v_mfma_f32_16x16x32_bf16 v[148:151], a[136:139], a[56:59], v[148:151]
s_addk_i32 s90, 2048
buffer_load_dwordx4 v7, s[16:19], s90 offen offset:2048 nt lds
v_mfma_f32_16x16x32_bf16 v[148:151], a[140:143], a[68:71], v[148:151]
s_addk_i32 s91, 2048
buffer_load_dwordx4 v7, s[16:19], s91 offen offset:3072 nt lds
s_waitcnt lgkmcnt(2)
v_mfma_f32_16x16x32_bf16 v[112:115], a[144:147], a[80:83], v[112:115]
s_barrier
v_mfma_f32_16x16x32_bf16 v[112:115], a[148:151], a[92:95], v[112:115]
ds_read_b128 a[192:195], v1 offset:32768
v_mfma_f32_16x16x32_bf16 v[124:127], a[152:155], a[80:83], v[124:127]
ds_read_b128 a[196:199], v2 offset:32768
v_mfma_f32_16x16x32_bf16 v[124:127], a[156:159], a[92:95], v[124:127]
ds_read_b128 a[200:203], v1 offset:33792
v_mfma_f32_16x16x32_bf16 v[136:139], a[160:163], a[80:83], v[136:139]
v_mfma_f32_16x16x32_bf16 v[136:139], a[164:167], a[92:95], v[136:139]
s_waitcnt lgkmcnt(3)
ds_read_b128 a[204:207], v2 offset:33792
v_mfma_f32_16x16x32_bf16 v[148:151], a[96:99], a[80:83], v[148:151]
ds_read_b128 a[208:211], v1 offset:34816
v_mfma_f32_16x16x32_bf16 v[148:151], a[100:103], a[92:95], v[148:151]
s_waitcnt lgkmcnt(3)
v_max3_f32 v15, v112, v113, v114
v_max3_f32 v15, v15, v115, v124
v_mfma_f32_16x16x32_bf16 v[44:47], a[192:195], a[0:3], 0
s_barrier
v_max3_f32 v15, v15, v125, v126
v_mfma_f32_16x16x32_bf16 v[44:47], a[196:199], a[12:15], v[44:47]
ds_read_b128 a[212:215], v2 offset:34816
v_max3_f32 v15, v15, v127, v136
v_mfma_f32_16x16x32_bf16 v[48:51], a[192:195], a[4:7], 0
v_max3_f32 v15, v15, v137, v138
v_max3_f32 v15, v15, v139, v148
v_mfma_f32_16x16x32_bf16 v[48:51], a[196:199], a[16:19], v[48:51]
v_max3_f32 v15, v15, v149, v150
v_max_f32 v15, v15, v151
v_mfma_f32_16x16x32_bf16 v[52:55], a[192:195], a[8:11], 0
s_mov_b32 m0, s32
ds_read_b128 a[192:195], v1 offset:35840
v_mov_b32 v29, v15
v_mfma_f32_16x16x32_bf16 v[52:55], a[196:199], a[20:23], v[52:55]
s_waitcnt lgkmcnt(2)
v_permlane16_swap_b32 v15, v29
v_mfma_f32_16x16x32_bf16 v[44:47], a[200:203], a[24:27], v[44:47]
s_add_u32 s90, s44, s92
ds_read_b128 a[196:199], v2 offset:35840
v_max_f32 v15, v15, v29
v_mfma_f32_16x16x32_bf16 v[44:47], a[204:207], a[36:39], v[44:47]
buffer_load_dwordx4 v7, s[12:15], s90 offen offset:0 nt lds
v_mov_b32 v29, v15
v_mfma_f32_16x16x32_bf16 v[48:51], a[200:203], a[28:31], v[48:51]
v_mfma_f32_16x16x32_bf16 v[48:51], a[204:207], a[40:43], v[48:51]
v_permlane32_swap_b32 v15, v29
v_mfma_f32_16x16x32_bf16 v[52:55], a[200:203], a[32:35], v[52:55]
ds_read_b128 a[200:203], v1 offset:40960
v_max_f32 v15, v15, v29
v_mfma_f32_16x16x32_bf16 v[52:55], a[204:207], a[44:47], v[52:55]
v_mul_f32 v15, s74, v15
v_fma_f32 v112, v112, s24, v15
v_fma_f32 v113, v113, s24, v15
v_fma_f32 v114, v114, s24, v15
v_fma_f32 v115, v115, s24, v15
v_exp_f32 v30, v112
v_exp_f32 v31, v113
v_exp_f32 v20, v114
v_cvt_pk_bf16_f32 v32, v30, v31
v_add_f32 v19, v30, v31
v_exp_f32 v21, v115
v_mfma_f32_16x16x32_bf16 v[44:47], a[208:211], a[48:51], v[44:47]
s_waitcnt lgkmcnt(1)
ds_read_b128 a[204:207], v2 offset:40960
v_cvt_pk_bf16_f32 v33, v20, v21
v_mfma_f32_16x16x32_bf16 v[44:47], a[212:215], a[60:63], v[44:47]
v_add_f32 v19, v19, v20
v_add_f32 v19, v19, v21
v_fma_f32 v124, v124, s24, v15
v_mfma_f32_16x16x32_bf16 v[48:51], a[208:211], a[52:55], v[48:51]
s_add_u32 s90, s44, s93
v_exp_f32 v28, v124
v_fma_f32 v125, v125, s24, v15
v_mfma_f32_16x16x32_bf16 v[48:51], a[212:215], a[64:67], v[48:51]
buffer_load_dwordx4 v7, s[12:15], s90 offen offset:1024 nt lds
v_fma_f32 v126, v126, s24, v15
v_mfma_f32_16x16x32_bf16 v[52:55], a[208:211], a[56:59], v[52:55]
ds_read_b128 a[208:211], v1 offset:41984
v_fma_f32 v127, v127, s24, v15
v_exp_f32 v29, v125
v_mfma_f32_16x16x32_bf16 v[52:55], a[212:215], a[68:71], v[52:55]
v_exp_f32 v30, v126
v_mfma_f32_16x16x32_bf16 v[44:47], a[192:195], a[72:75], v[44:47]
ds_read_b128 a[212:215], v2 offset:41984
v_cvt_pk_bf16_f32 v34, v28, v29
v_add_f32 v19, v19, v28
v_mfma_f32_16x16x32_bf16 v[44:47], a[196:199], a[84:87], v[44:47]
v_exp_f32 v31, v127
v_add_f32 v19, v19, v29
v_mfma_f32_16x16x32_bf16 v[48:51], a[192:195], a[76:79], v[48:51]
v_cvt_pk_bf16_f32 v35, v30, v31
v_add_f32 v19, v19, v30
v_fma_f32 v136, v136, s24, v15
v_mfma_f32_16x16x32_bf16 v[48:51], a[196:199], a[88:91], v[48:51]
v_exp_f32 v20, v136
v_add_f32 v19, v19, v31
v_mfma_f32_16x16x32_bf16 v[52:55], a[192:195], a[80:83], v[52:55]
ds_read_b128 a[192:195], v1 offset:43008
v_fma_f32 v137, v137, s24, v15
v_fma_f32 v138, v138, s24, v15
v_mfma_f32_16x16x32_bf16 v[52:55], a[196:199], a[92:95], v[52:55]
s_waitcnt lgkmcnt(2)
v_exp_f32 v21, v137
v_fma_f32 v139, v139, s24, v15
v_mfma_f32_16x16x32_bf16 v[68:71], a[200:203], a[0:3], 0
s_add_u32 s90, s44, s94
ds_read_b128 a[196:199], v2 offset:43008
v_cvt_pk_bf16_f32 v36, v20, v21
v_add_f32 v19, v19, v20
v_exp_f32 v28, v138
v_mfma_f32_16x16x32_bf16 v[68:71], a[204:207], a[12:15], v[68:71]
buffer_load_dwordx4 v7, s[12:15], s90 offen offset:2048 nt lds
v_mfma_f32_16x16x32_bf16 v[72:75], a[200:203], a[4:7], 0
v_exp_f32 v29, v139
v_add_f32 v19, v19, v21
v_mfma_f32_16x16x32_bf16 v[72:75], a[204:207], a[16:19], v[72:75]
v_cvt_pk_bf16_f32 v37, v28, v29
v_add_f32 v19, v19, v28
v_fma_f32 v148, v148, s24, v15
v_mfma_f32_16x16x32_bf16 v[76:79], a[200:203], a[8:11], 0
ds_read_b128 a[200:203], v1 offset:44032
v_add_f32 v19, v19, v29
v_fma_f32 v149, v149, s24, v15
v_mfma_f32_16x16x32_bf16 v[76:79], a[204:207], a[20:23], v[76:79]
v_exp_f32 v30, v148
v_fma_f32 v150, v150, s24, v15
v_mfma_f32_16x16x32_bf16 v[68:71], a[208:211], a[24:27], v[68:71]
s_waitcnt lgkmcnt(1)
ds_read_b128 a[204:207], v2 offset:44032
v_fma_f32 v151, v151, s24, v15
v_exp_f32 v31, v149
v_mfma_f32_16x16x32_bf16 v[68:71], a[212:215], a[36:39], v[68:71]
v_exp_f32 v20, v150
v_mfma_f32_16x16x32_bf16 v[72:75], a[208:211], a[28:31], v[72:75]
s_add_u32 s90, s44, s95
v_exp_f32 v21, v151
v_cvt_pk_bf16_f32 v38, v30, v31
v_mfma_f32_16x16x32_bf16 v[72:75], a[212:215], a[40:43], v[72:75]
buffer_load_dwordx4 v7, s[12:15], s90 offen offset:3072 nt lds
v_add_f32 v19, v19, v30
v_mfma_f32_16x16x32_bf16 v[76:79], a[208:211], a[32:35], v[76:79]
v_add_f32 v19, v19, v31
v_cvt_pk_bf16_f32 v39, v20, v21
v_add_f32 v19, v19, v20
v_mfma_f32_16x16x32_bf16 v[76:79], a[212:215], a[44:47], v[76:79]
v_add_f32 v19, v19, v21
v_fma_f32 v44, v44, s24, v11
v_fma_f32 v45, v45, s24, v11
v_mfma_f32_16x16x32_bf16 v[68:71], a[192:195], a[48:51], v[68:71]
ds_read_b64_tr_b16 a[104:105], v3 offset:0
ds_read_b64_tr_b16 a[106:107], v3 offset:4096
v_fma_f32 v46, v46, s24, v11
v_mfma_f32_16x16x32_bf16 v[68:71], a[196:199], a[60:63], v[68:71]
ds_read_b64_tr_b16 a[108:109], v3 offset:8192
ds_read_b64_tr_b16 a[110:111], v3 offset:12288
v_fma_f32 v47, v47, s24, v11
v_mfma_f32_16x16x32_bf16 v[72:75], a[192:195], a[52:55], v[72:75]
ds_read_b64_tr_b16 a[112:113], v4 offset:0
ds_read_b64_tr_b16 a[114:115], v4 offset:4096
v_exp_f32 v28, v44
v_mfma_f32_16x16x32_bf16 v[72:75], a[196:199], a[64:67], v[72:75]
s_mov_b32 m0, s33
ds_read_b64_tr_b16 a[116:117], v4 offset:8192
ds_read_b64_tr_b16 a[118:119], v4 offset:12288
v_mfma_f32_16x16x32_bf16 v[76:79], a[192:195], a[56:59], v[76:79]
s_add_u32 s90, s45, s92
ds_read_b64_tr_b16 a[120:121], v5 offset:0
ds_read_b64_tr_b16 a[122:123], v5 offset:4096
v_exp_f32 v29, v45
v_mfma_f32_16x16x32_bf16 v[76:79], a[196:199], a[68:71], v[76:79]
s_waitcnt lgkmcnt(10)
ds_read_b64_tr_b16 a[124:125], v5 offset:8192
ds_read_b64_tr_b16 a[126:127], v5 offset:12288
v_cvt_pk_bf16_f32 v56, v28, v29
v_mfma_f32_16x16x32_bf16 v[68:71], a[200:203], a[72:75], v[68:71]
ds_read_b64_tr_b16 a[128:129], v6 offset:0
ds_read_b64_tr_b16 a[130:131], v6 offset:4096
buffer_load_dwordx4 v7, s[12:15], s90 offen offset:0 nt lds
v_add_f32 v24, v28, v29
v_mfma_f32_16x16x32_bf16 v[68:71], a[204:207], a[84:87], v[68:71]
ds_read_b64_tr_b16 a[132:133], v6 offset:8192
ds_read_b64_tr_b16 a[134:135], v6 offset:12288
v_exp_f32 v30, v46
v_mfma_f32_16x16x32_bf16 v[72:75], a[200:203], a[76:79], v[72:75]
ds_read_b64_tr_b16 a[136:137], v3 offset:1024
ds_read_b64_tr_b16 a[138:139], v3 offset:5120
v_mfma_f32_16x16x32_bf16 v[72:75], a[204:207], a[88:91], v[72:75]
ds_read_b64_tr_b16 a[140:141], v3 offset:9216
ds_read_b64_tr_b16 a[142:143], v3 offset:13312
v_exp_f32 v31, v47
v_mfma_f32_16x16x32_bf16 v[76:79], a[200:203], a[80:83], v[76:79]
ds_read_b64_tr_b16 a[144:145], v4 offset:1024
ds_read_b64_tr_b16 a[146:147], v4 offset:5120
v_mfma_f32_16x16x32_bf16 v[76:79], a[204:207], a[92:95], v[76:79]
s_waitcnt lgkmcnt(10)
ds_read_b64_tr_b16 a[148:149], v4 offset:9216
ds_read_b64_tr_b16 a[150:151], v4 offset:13312
v_cvt_pk_bf16_f32 v57, v30, v31
v_mfma_f32_16x16x32_bf16 v[112:115], a[104:107], v[32:35], 0
ds_read_b64_tr_b16 a[152:153], v5 offset:1024
ds_read_b64_tr_b16 a[154:155], v5 offset:5120
v_add_f32 v24, v24, v30
v_mfma_f32_16x16x32_bf16 v[112:115], a[108:111], v[36:39], v[112:115]
ds_read_b64_tr_b16 a[156:157], v5 offset:9216
ds_read_b64_tr_b16 a[158:159], v5 offset:13312
v_add_f32 v24, v24, v31
v_mfma_f32_16x16x32_bf16 v[124:127], a[112:115], v[32:35], 0
s_add_u32 s90, s45, s93
ds_read_b64_tr_b16 a[160:161], v6 offset:1024
ds_read_b64_tr_b16 a[162:163], v6 offset:5120
v_fma_f32 v48, v48, s24, v13
v_mfma_f32_16x16x32_bf16 v[124:127], a[116:119], v[36:39], v[124:127]
ds_read_b64_tr_b16 a[164:165], v6 offset:9216
ds_read_b64_tr_b16 a[166:167], v6 offset:13312
buffer_load_dwordx4 v7, s[12:15], s90 offen offset:1024 nt lds
v_fma_f32 v49, v49, s24, v13
v_mfma_f32_16x16x32_bf16 v[136:139], a[120:123], v[32:35], 0
ds_read_b64_tr_b16 a[96:97], v3 offset:16384
ds_read_b64_tr_b16 a[98:99], v3 offset:20480
v_fma_f32 v50, v50, s24, v13
v_mfma_f32_16x16x32_bf16 v[136:139], a[124:127], v[36:39], v[136:139]
s_waitcnt lgkmcnt(10)
ds_read_b64_tr_b16 a[100:101], v3 offset:24576
ds_read_b64_tr_b16 a[102:103], v3 offset:28672
v_fma_f32 v51, v51, s24, v13
v_mfma_f32_16x16x32_bf16 v[148:151], a[128:131], v[32:35], 0
ds_read_b64_tr_b16 a[104:105], v4 offset:16384
ds_read_b64_tr_b16 a[106:107], v4 offset:20480
v_exp_f32 v20, v48
v_mfma_f32_16x16x32_bf16 v[148:151], a[132:135], v[36:39], v[148:151]
ds_read_b64_tr_b16 a[108:109], v4 offset:24576
ds_read_b64_tr_b16 a[110:111], v4 offset:28672
v_mfma_f32_16x16x32_bf16 v[160:163], a[136:139], v[32:35], 0
ds_read_b64_tr_b16 a[112:113], v5 offset:16384
ds_read_b64_tr_b16 a[114:115], v5 offset:20480
v_exp_f32 v21, v49
v_mfma_f32_16x16x32_bf16 v[160:163], a[140:143], v[36:39], v[160:163]
ds_read_b64_tr_b16 a[116:117], v5 offset:24576
ds_read_b64_tr_b16 a[118:119], v5 offset:28672
v_mfma_f32_16x16x32_bf16 v[172:175], a[144:147], v[32:35], 0
ds_read_b64_tr_b16 a[120:121], v6 offset:16384
ds_read_b64_tr_b16 a[122:123], v6 offset:20480
v_cvt_pk_bf16_f32 v60, v20, v21
v_add_f32 v26, v20, v21
v_mfma_f32_16x16x32_bf16 v[172:175], a[148:151], v[36:39], v[172:175]
s_waitcnt lgkmcnt(10)
ds_read_b64_tr_b16 a[124:125], v6 offset:24576
ds_read_b64_tr_b16 a[126:127], v6 offset:28672
v_exp_f32 v28, v50
v_mfma_f32_16x16x32_bf16 v[184:187], a[152:155], v[32:35], 0
ds_read_b64_tr_b16 a[128:129], v3 offset:17408
ds_read_b64_tr_b16 a[130:131], v3 offset:21504
v_mfma_f32_16x16x32_bf16 v[184:187], a[156:159], v[36:39], v[184:187]
ds_read_b64_tr_b16 a[132:133], v3 offset:25600
ds_read_b64_tr_b16 a[134:135], v3 offset:29696
v_exp_f32 v29, v51
v_mfma_f32_16x16x32_bf16 v[196:199], a[160:163], v[32:35], 0
ds_read_b64_tr_b16 a[136:137], v4 offset:17408
ds_read_b64_tr_b16 a[138:139], v4 offset:21504
v_mfma_f32_16x16x32_bf16 v[196:199], a[164:167], v[36:39], v[196:199]
ds_read_b64_tr_b16 a[140:141], v4 offset:25600
ds_read_b64_tr_b16 a[142:143], v4 offset:29696
v_cvt_pk_bf16_f32 v61, v28, v29
v_mfma_f32_16x16x32_bf16 v[208:211], a[96:99], v[32:35], 0
ds_read_b64_tr_b16 a[144:145], v5 offset:17408
ds_read_b64_tr_b16 a[146:147], v5 offset:21504
v_add_f32 v26, v26, v28
v_mfma_f32_16x16x32_bf16 v[208:211], a[100:103], v[36:39], v[208:211]
s_waitcnt lgkmcnt(10)
ds_read_b64_tr_b16 a[148:149], v5 offset:25600
ds_read_b64_tr_b16 a[150:151], v5 offset:29696
v_add_f32 v26, v26, v29
v_mfma_f32_16x16x32_bf16 v[220:223], a[104:107], v[32:35], 0
ds_read_b64_tr_b16 a[152:153], v6 offset:17408
ds_read_b64_tr_b16 a[154:155], v6 offset:21504
v_fma_f32 v52, v52, s24, v15
v_mfma_f32_16x16x32_bf16 v[220:223], a[108:111], v[36:39], v[220:223]
s_add_u32 s90, s45, s94
ds_read_b64_tr_b16 a[156:157], v6 offset:25600
ds_read_b64_tr_b16 a[158:159], v6 offset:29696
v_fma_f32 v53, v53, s24, v15
v_mfma_f32_16x16x32_bf16 a[224:227], a[112:115], v[32:35], 0
buffer_load_dwordx4 v7, s[12:15], s90 offen offset:2048 nt lds
v_fma_f32 v54, v54, s24, v15
v_mfma_f32_16x16x32_bf16 a[224:227], a[116:119], v[36:39], a[224:227]
s_add_u32 s90, s45, s95
buffer_load_dwordx4 v7, s[12:15], s90 offen offset:3072 nt lds
v_fma_f32 v55, v55, s24, v15
v_mfma_f32_16x16x32_bf16 a[236:239], a[120:123], v[32:35], 0
v_exp_f32 v30, v52
v_exp_f32 v31, v53
v_mfma_f32_16x16x32_bf16 a[236:239], a[124:127], v[36:39], a[236:239]
s_waitcnt vmcnt(16) lgkmcnt(4)
v_exp_f32 v20, v54
v_mfma_f32_16x16x32_bf16 a[248:251], a[128:131], v[32:35], 0
s_barrier
v_cvt_pk_bf16_f32 v64, v30, v31
v_add_f32 v27, v30, v31
v_mfma_f32_16x16x32_bf16 a[248:251], a[132:135], v[36:39], a[248:251]
ds_read_b128 a[208:211], v1 offset:49152
v_add_f32 v27, v27, v20
v_exp_f32 v21, v55
v_mfma_f32_16x16x32_bf16 v[228:231], a[136:139], v[32:35], 0
ds_read_b128 a[212:215], v2 offset:49152
v_cvt_pk_bf16_f32 v65, v20, v21
v_mfma_f32_16x16x32_bf16 v[228:231], a[140:143], v[36:39], v[228:231]
ds_read_b128 a[192:195], v1 offset:50176
v_add_f32 v27, v27, v21
v_fma_f32 v68, v68, s24, v11
v_mfma_f32_16x16x32_bf16 v[240:243], a[144:147], v[32:35], 0
ds_read_b128 a[196:199], v2 offset:50176
v_fma_f32 v69, v69, s24, v11
v_fma_f32 v70, v70, s24, v11
v_fma_f32 v71, v71, s24, v11
v_mfma_f32_16x16x32_bf16 v[240:243], a[148:151], v[36:39], v[240:243]
s_waitcnt lgkmcnt(4)
v_exp_f32 v28, v68
v_exp_f32 v29, v69
v_mfma_f32_16x16x32_bf16 v[252:255], a[152:155], v[32:35], 0
ds_read_b128 a[200:203], v1 offset:51200
v_cvt_pk_bf16_f32 v58, v28, v29
v_mfma_f32_16x16x32_bf16 v[252:255], a[156:159], v[36:39], v[252:255]
s_waitcnt lgkmcnt(3)
ds_read_b128 a[204:207], v2 offset:51200
v_add_f32 v24, v24, v28
v_exp_f32 v30, v70
v_mfma_f32_16x16x32_bf16 v[32:35], a[208:211], a[0:3], 0
s_barrier
v_add_f32 v24, v24, v29
v_mfma_f32_16x16x32_bf16 v[32:35], a[212:215], a[12:15], v[32:35]
v_exp_f32 v31, v71
v_add_f32 v24, v24, v30
v_mfma_f32_16x16x32_bf16 v[36:39], a[208:211], a[4:7], 0
PADJ_1:
s_cbranch_execz PADJ_5
v_cvt_pk_bf16_f32 v59, v30, v31
v_mfma_f32_16x16x32_bf16 v[36:39], a[212:215], a[16:19], v[36:39]
v_add_f32 v24, v24, v31
v_fma_f32 v72, v72, s24, v13
v_fma_f32 v73, v73, s24, v13
v_mfma_f32_16x16x32_bf16 v[40:43], a[208:211], a[8:11], 0
s_mov_b32 m0, s34
ds_read_b128 a[208:211], v1 offset:52224
v_fma_f32 v74, v74, s24, v13
v_fma_f32 v75, v75, s24, v13
v_mfma_f32_16x16x32_bf16 v[40:43], a[212:215], a[20:23], v[40:43]
s_waitcnt lgkmcnt(1)
ds_read_b128 a[212:215], v2 offset:52224
v_fma_f32 v76, v76, s24, v15
v_exp_f32 v20, v72
v_mfma_f32_16x16x32_bf16 v[32:35], a[192:195], a[24:27], v[32:35]
s_add_u32 s90, s46, s92
v_exp_f32 v21, v73
v_add_f32 v26, v26, v20
v_mfma_f32_16x16x32_bf16 v[32:35], a[196:199], a[36:39], v[32:35]
buffer_load_dwordx4 v7, s[12:15], s90 offen offset:0 nt lds
v_cvt_pk_bf16_f32 v62, v20, v21
v_mfma_f32_16x16x32_bf16 v[36:39], a[192:195], a[28:31], v[36:39]
v_exp_f32 v28, v74
v_add_f32 v26, v26, v21
v_mfma_f32_16x16x32_bf16 v[36:39], a[196:199], a[40:43], v[36:39]
v_exp_f32 v29, v75
v_add_f32 v26, v26, v28
v_mfma_f32_16x16x32_bf16 v[40:43], a[192:195], a[32:35], v[40:43]
ds_read_b128 a[192:195], v1 offset:57344
v_cvt_pk_bf16_f32 v63, v28, v29
v_add_f32 v26, v26, v29
v_mfma_f32_16x16x32_bf16 v[40:43], a[196:199], a[44:47], v[40:43]
s_add_u32 s90, s46, s93
ds_read_b128 a[196:199], v2 offset:57344
v_fma_f32 v77, v77, s24, v15
v_fma_f32 v78, v78, s24, v15
v_fma_f32 v79, v79, s24, v15
v_mfma_f32_16x16x32_bf16 v[32:35], a[200:203], a[48:51], v[32:35]
buffer_load_dwordx4 v7, s[12:15], s90 offen offset:1024 nt lds
v_exp_f32 v30, v76
v_mfma_f32_16x16x32_bf16 v[32:35], a[204:207], a[60:63], v[32:35]
s_add_u32 s90, s46, s94
buffer_load_dwordx4 v7, s[12:15], s90 offen offset:2048 nt lds
v_mfma_f32_16x16x32_bf16 v[36:39], a[200:203], a[52:55], v[36:39]
v_exp_f32 v31, v77
v_add_f32 v27, v27, v30
v_mfma_f32_16x16x32_bf16 v[36:39], a[204:207], a[64:67], v[36:39]
v_exp_f32 v20, v78
v_cvt_pk_bf16_f32 v66, v30, v31
v_mfma_f32_16x16x32_bf16 v[40:43], a[200:203], a[56:59], v[40:43]
s_add_u32 s90, s46, s95
ds_read_b128 a[200:203], v1 offset:58368
v_add_f32 v27, v27, v31
v_exp_f32 v21, v79
v_mfma_f32_16x16x32_bf16 v[40:43], a[204:207], a[68:71], v[40:43]
s_waitcnt lgkmcnt(1)
ds_read_b128 a[204:207], v2 offset:58368
v_cvt_pk_bf16_f32 v67, v20, v21
v_add_f32 v27, v27, v20
v_mfma_f32_16x16x32_bf16 v[32:35], a[208:211], a[72:75], v[32:35]
buffer_load_dwordx4 v7, s[12:15], s90 offen offset:3072 nt lds
v_add_f32 v27, v27, v21
v_mfma_f32_16x16x32_bf16 v[32:35], a[212:215], a[84:87], v[32:35]
s_add_u32 m0, s4, 0
s_add_u32 s88, s29, s87
buffer_load_dwordx4 v7, s[8:11], s88 offen offset:0 nt lds
v_mfma_f32_16x16x32_bf16 v[36:39], a[208:211], a[76:79], v[36:39]
v_max3_f32 v25, v24, v26, v27
v_cmp_lt_f32 vcc, s25, v25
v_mfma_f32_16x16x32_bf16 v[36:39], a[212:215], a[88:91], v[36:39]
s_cbranch_vccnz STUB_2
BACK_2:
v_mfma_f32_16x16x32_bf16 v[40:43], a[208:211], a[80:83], v[40:43]
ds_read_b128 a[208:211], v1 offset:59392
v_add_f32 v19, v19, v27
v_add_f32 v17, v17, v24
v_add_f32 v18, v18, v26
v_mfma_f32_16x16x32_bf16 v[40:43], a[212:215], a[92:95], v[40:43]
s_addk_i32 s88, 3072
ds_read_b128 a[212:215], v2 offset:59392
v_fma_f32 v32, v32, s24, v11
v_fma_f32 v33, v33, s24, v11
v_mfma_f32_16x16x32_bf16 v[68:71], a[192:195], a[0:3], 0
buffer_load_dwordx4 v7, s[8:11], s88 offen offset:1024 nt lds
v_fma_f32 v34, v34, s24, v11
v_mfma_f32_16x16x32_bf16 v[68:71], a[196:199], a[12:15], v[68:71]
s_mov_b32 m0, s36
s_bitcmp1_b32 s3, 1
s_cselect_b32 s81, s45, s44
s_add_u32 s90, s81, s92
buffer_load_dwordx4 v7, s[16:19], s90 offen offset:0 nt lds
v_fma_f32 v35, v35, s24, v11
v_mfma_f32_16x16x32_bf16 v[72:75], a[192:195], a[4:7], 0
v_exp_f32 v28, v32
v_exp_f32 v29, v33
v_mfma_f32_16x16x32_bf16 v[72:75], a[196:199], a[16:19], v[72:75]
v_exp_f32 v30, v34
v_mfma_f32_16x16x32_bf16 v[76:79], a[192:195], a[8:11], 0
s_add_u32 s91, s81, s93
ds_read_b128 a[192:195], v1 offset:60416
v_cvt_pk_bf16_f32 v44, v28, v29
v_add_f32 v24, v28, v29
v_mfma_f32_16x16x32_bf16 v[76:79], a[196:199], a[20:23], v[76:79]
s_waitcnt lgkmcnt(1)
ds_read_b128 a[196:199], v2 offset:60416
v_add_f32 v24, v24, v30
v_exp_f32 v31, v35
v_mfma_f32_16x16x32_bf16 v[68:71], a[200:203], a[24:27], v[68:71]
buffer_load_dwordx4 v7, s[16:19], s91 offen offset:1024 nt lds
v_mfma_f32_16x16x32_bf16 v[68:71], a[204:207], a[36:39], v[68:71]
s_addk_i32 s90, 2048
buffer_load_dwordx4 v7, s[16:19], s90 offen offset:2048 nt lds
v_cvt_pk_bf16_f32 v45, v30, v31
v_mfma_f32_16x16x32_bf16 v[72:75], a[200:203], a[28:31], v[72:75]
v_add_f32 v24, v24, v31
v_fma_f32 v36, v36, s24, v13
v_fma_f32 v37, v37, s24, v13
v_mfma_f32_16x16x32_bf16 v[72:75], a[204:207], a[40:43], v[72:75]
s_addk_i32 s91, 2048
v_exp_f32 v20, v36
v_fma_f32 v38, v38, s24, v13
v_mfma_f32_16x16x32_bf16 v[76:79], a[200:203], a[32:35], v[76:79]
buffer_load_dwordx4 v7, s[16:19], s91 offen offset:3072 nt lds
v_fma_f32 v39, v39, s24, v13
v_exp_f32 v21, v37
v_mfma_f32_16x16x32_bf16 v[76:79], a[204:207], a[44:47], v[76:79]
v_exp_f32 v28, v38
v_mfma_f32_16x16x32_bf16 v[68:71], a[208:211], a[48:51], v[68:71]
v_exp_f32 v29, v39
v_cvt_pk_bf16_f32 v48, v20, v21
v_mfma_f32_16x16x32_bf16 v[68:71], a[212:215], a[60:63], v[68:71]
v_add_f32 v26, v20, v21
v_cvt_pk_bf16_f32 v49, v28, v29
v_add_f32 v26, v26, v28
v_mfma_f32_16x16x32_bf16 v[72:75], a[208:211], a[52:55], v[72:75]
v_add_f32 v26, v26, v29
v_fma_f32 v40, v40, s24, v15
v_fma_f32 v41, v41, s24, v15
v_mfma_f32_16x16x32_bf16 v[72:75], a[212:215], a[64:67], v[72:75]
s_waitcnt vmcnt(14) lgkmcnt(0)
v_exp_f32 v30, v40
v_fma_f32 v42, v42, s24, v15
v_mfma_f32_16x16x32_bf16 v[76:79], a[208:211], a[56:59], v[76:79]
s_barrier
v_fma_f32 v43, v43, s24, v15
v_exp_f32 v31, v41
v_mfma_f32_16x16x32_bf16 v[76:79], a[212:215], a[68:71], v[76:79]
ds_read_b128 a[200:203], v1 offset:0
v_cvt_pk_bf16_f32 v52, v30, v31
v_mfma_f32_16x16x32_bf16 v[68:71], a[192:195], a[72:75], v[68:71]
ds_read_b128 a[204:207], v2 offset:0
v_add_f32 v27, v30, v31
v_exp_f32 v20, v42
v_mfma_f32_16x16x32_bf16 v[68:71], a[196:199], a[84:87], v[68:71]
ds_read_b128 a[208:211], v1 offset:1024
v_add_f32 v27, v27, v20
v_mfma_f32_16x16x32_bf16 v[72:75], a[192:195], a[76:79], v[72:75]
s_mov_b32 m0, s37
ds_read_b128 a[212:215], v2 offset:1024
v_exp_f32 v21, v43
v_mfma_f32_16x16x32_bf16 v[72:75], a[196:199], a[88:91], v[72:75]
s_addk_i32 s81, 2048
v_cvt_pk_bf16_f32 v53, v20, v21
v_add_f32 v27, v27, v21
v_mfma_f32_16x16x32_bf16 v[76:79], a[192:195], a[80:83], v[76:79]
s_add_u32 s90, s81, s94
ds_read_b128 a[192:195], v1 offset:2048
v_fma_f32 v68, v68, s24, v11
v_fma_f32 v69, v69, s24, v11
v_mfma_f32_16x16x32_bf16 v[76:79], a[196:199], a[92:95], v[76:79]
s_waitcnt lgkmcnt(4)
ds_read_b128 a[196:199], v2 offset:2048
v_fma_f32 v70, v70, s24, v11
v_fma_f32 v71, v71, s24, v11
v_exp_f32 v28, v68
v_mfma_f32_16x16x32_bf16 v[80:83], a[200:203], a[0:3], 0
s_waitcnt lgkmcnt(4)
buffer_load_dwordx4 v7, s[16:19], s90 offen offset:0 nt lds
v_mfma_f32_16x16x32_bf16 v[80:83], a[204:207], a[12:15], v[80:83]
v_exp_f32 v29, v69
v_add_f32 v24, v24, v28
v_mfma_f32_16x16x32_bf16 v[84:87], a[200:203], a[4:7], 0
v_exp_f32 v30, v70
v_cvt_pk_bf16_f32 v46, v28, v29
v_mfma_f32_16x16x32_bf16 v[84:87], a[204:207], a[16:19], v[84:87]
v_exp_f32 v31, v71
v_add_f32 v24, v24, v29
v_mfma_f32_16x16x32_bf16 v[88:91], a[200:203], a[8:11], 0
ds_read_b128 a[200:203], v1 offset:3072
v_cvt_pk_bf16_f32 v47, v30, v31
v_add_f32 v24, v24, v30
v_mfma_f32_16x16x32_bf16 v[88:91], a[204:207], a[20:23], v[88:91]
s_waitcnt lgkmcnt(1)
ds_read_b128 a[204:207], v2 offset:3072
v_add_f32 v24, v24, v31
v_fma_f32 v72, v72, s24, v13
v_mfma_f32_16x16x32_bf16 v[80:83], a[208:211], a[24:27], v[80:83]
s_add_u32 s91, s81, s95
v_exp_f32 v20, v72
v_fma_f32 v73, v73, s24, v13
v_mfma_f32_16x16x32_bf16 v[80:83], a[212:215], a[36:39], v[80:83]
buffer_load_dwordx4 v7, s[16:19], s91 offen offset:1024 nt lds
v_fma_f32 v74, v74, s24, v13
v_fma_f32 v75, v75, s24, v13
v_mfma_f32_16x16x32_bf16 v[84:87], a[208:211], a[28:31], v[84:87]
v_exp_f32 v21, v73
v_add_f32 v26, v26, v20
v_mfma_f32_16x16x32_bf16 v[84:87], a[212:215], a[40:43], v[84:87]
v_exp_f32 v28, v74
v_cvt_pk_bf16_f32 v50, v20, v21
v_mfma_f32_16x16x32_bf16 v[88:91], a[208:211], a[32:35], v[88:91]
ds_read_b128 a[208:211], v1 offset:8192
v_add_f32 v26, v26, v21
v_exp_f32 v29, v75
v_mfma_f32_16x16x32_bf16 v[88:91], a[212:215], a[44:47], v[88:91]
ds_read_b128 a[212:215], v2 offset:8192
v_cvt_pk_bf16_f32 v51, v28, v29
v_mfma_f32_16x16x32_bf16 v[80:83], a[192:195], a[48:51], v[80:83]
v_add_f32 v26, v26, v28
v_add_f32 v26, v26, v29
v_fma_f32 v76, v76, s24, v15
v_mfma_f32_16x16x32_bf16 v[80:83], a[196:199], a[60:63], v[80:83]
v_exp_f32 v30, v76
v_fma_f32 v77, v77, s24, v15
v_mfma_f32_16x16x32_bf16 v[84:87], a[192:195], a[52:55], v[84:87]
v_exp_f32 v31, v77
v_fma_f32 v78, v78, s24, v15
v_mfma_f32_16x16x32_bf16 v[84:87], a[196:199], a[64:67], v[84:87]
v_exp_f32 v20, v78
v_fma_f32 v79, v79, s24, v15
v_cvt_pk_bf16_f32 v54, v30, v31
v_mfma_f32_16x16x32_bf16 v[88:91], a[192:195], a[56:59], v[88:91]
s_addk_i32 s90, 2048
ds_read_b128 a[192:195], v1 offset:9216
v_add_f32 v27, v27, v30
v_exp_f32 v21, v79
v_mfma_f32_16x16x32_bf16 v[88:91], a[196:199], a[68:71], v[88:91]
s_waitcnt lgkmcnt(1)
ds_read_b128 a[196:199], v2 offset:9216
v_add_f32 v27, v27, v31
v_mfma_f32_16x16x32_bf16 v[80:83], a[200:203], a[72:75], v[80:83]
buffer_load_dwordx4 v7, s[16:19], s90 offen offset:2048 nt lds
v_mfma_f32_16x16x32_bf16 v[80:83], a[204:207], a[84:87], v[80:83]
v_cvt_pk_bf16_f32 v55, v20, v21
v_add_f32 v27, v27, v20
v_mfma_f32_16x16x32_bf16 v[84:87], a[200:203], a[76:79], v[84:87]
v_add_f32 v27, v27, v21
v_max3_f32 v25, v24, v26, v27
v_mfma_f32_16x16x32_bf16 v[84:87], a[204:207], a[88:91], v[84:87]
v_cmp_lt_f32 vcc, s25, v25
s_nop 0
s_cbranch_vccnz STUB_3
BACK_3:
v_mfma_f32_16x16x32_bf16 v[88:91], a[200:203], a[80:83], v[88:91]
ds_read_b128 a[200:203], v1 offset:10240
v_add_f32 v19, v19, v27
v_mfma_f32_16x16x32_bf16 v[88:91], a[204:207], a[92:95], v[88:91]
ds_read_b128 a[204:207], v2 offset:10240
v_add_f32 v17, v17, v24
v_mfma_f32_16x16x32_bf16 v[68:71], a[208:211], a[0:3], 0
s_addk_i32 s91, 2048
v_add_f32 v18, v18, v26
v_fma_f32 v80, v80, s24, v11
v_mfma_f32_16x16x32_bf16 v[68:71], a[212:215], a[12:15], v[68:71]
buffer_load_dwordx4 v7, s[16:19], s91 offen offset:3072 nt lds
v_mfma_f32_16x16x32_bf16 v[72:75], a[208:211], a[4:7], 0
v_exp_f32 v28, v80
v_mfma_f32_16x16x32_bf16 v[72:75], a[212:215], a[16:19], v[72:75]
v_fma_f32 v81, v81, s24, v11
v_fma_f32 v82, v82, s24, v11
v_mfma_f32_16x16x32_bf16 v[76:79], a[208:211], a[8:11], 0
ds_read_b128 a[208:211], v1 offset:11264
v_fma_f32 v83, v83, s24, v11
v_mfma_f32_16x16x32_bf16 v[76:79], a[212:215], a[20:23], v[76:79]
s_waitcnt lgkmcnt(1)
ds_read_b128 a[212:215], v2 offset:11264
v_fma_f32 v84, v84, s24, v13
v_mfma_f32_16x16x32_bf16 v[68:71], a[192:195], a[24:27], v[68:71]
v_exp_f32 v29, v81
v_mfma_f32_16x16x32_bf16 v[68:71], a[196:199], a[36:39], v[68:71]
s_add_u32 m0, s4, 2048
v_exp_f32 v30, v82
v_mfma_f32_16x16x32_bf16 v[72:75], a[192:195], a[28:31], v[72:75]
s_add_u32 s88, s30, s87
v_exp_f32 v31, v83
v_mfma_f32_16x16x32_bf16 v[72:75], a[196:199], a[40:43], v[72:75]
buffer_load_dwordx4 v7, s[8:11], s88 offen offset:0 nt lds
v_mfma_f32_16x16x32_bf16 v[76:79], a[192:195], a[32:35], v[76:79]
ds_read_b64_tr_b16 a[192:193], v3 offset:32768
v_cvt_pk_bf16_f32 v32, v28, v29
v_mfma_f32_16x16x32_bf16 v[76:79], a[196:199], a[44:47], v[76:79]
ds_read_b64_tr_b16 a[194:195], v3 offset:36864
v_add_f32 v24, v28, v29
v_mfma_f32_16x16x32_bf16 v[68:71], a[200:203], a[48:51], v[68:71]
v_exp_f32 v20, v84
v_mfma_f32_16x16x32_bf16 v[68:71], a[204:207], a[60:63], v[68:71]
ds_read_b64_tr_b16 a[196:197], v3 offset:40960
v_cvt_pk_bf16_f32 v33, v30, v31
v_mfma_f32_16x16x32_bf16 v[72:75], a[200:203], a[52:55], v[72:75]
ds_read_b64_tr_b16 a[198:199], v3 offset:45056
v_add_f32 v24, v24, v30
v_mfma_f32_16x16x32_bf16 v[72:75], a[204:207], a[64:67], v[72:75]
v_add_f32 v24, v24, v31
v_fma_f32 v85, v85, s24, v13
v_mfma_f32_16x16x32_bf16 v[76:79], a[200:203], a[56:59], v[76:79]
s_addk_i32 s88, 3072
ds_read_b64_tr_b16 a[200:201], v4 offset:32768
v_fma_f32 v86, v86, s24, v13
v_mfma_f32_16x16x32_bf16 v[76:79], a[204:207], a[68:71], v[76:79]
s_waitcnt lgkmcnt(3)
ds_read_b64_tr_b16 a[202:203], v4 offset:36864
v_fma_f32 v87, v87, s24, v13
v_mfma_f32_16x16x32_bf16 v[68:71], a[208:211], a[72:75], v[68:71]
buffer_load_dwordx4 v7, s[8:11], s88 offen offset:1024 nt lds
v_mfma_f32_16x16x32_bf16 v[68:71], a[212:215], a[84:87], v[68:71]
ds_read_b64_tr_b16 a[204:205], v4 offset:40960
v_fma_f32 v88, v88, s24, v15
v_mfma_f32_16x16x32_bf16 v[72:75], a[208:211], a[76:79], v[72:75]
ds_read_b64_tr_b16 a[206:207], v4 offset:45056
v_fma_f32 v89, v89, s24, v15
v_mfma_f32_16x16x32_bf16 v[72:75], a[212:215], a[88:91], v[72:75]
v_exp_f32 v21, v85
v_mfma_f32_16x16x32_bf16 v[76:79], a[208:211], a[80:83], v[76:79]
ds_read_b64_tr_b16 a[208:209], v5 offset:32768
v_cvt_pk_bf16_f32 v36, v20, v21
v_mfma_f32_16x16x32_bf16 v[76:79], a[212:215], a[92:95], v[76:79]
ds_read_b64_tr_b16 a[210:211], v5 offset:36864
v_add_f32 v26, v20, v21
v_mfma_f32_16x16x32_bf16 v[104:107], a[192:195], v[56:59], v[104:107]
s_waitcnt lgkmcnt(4)
v_exp_f32 v28, v86
v_mfma_f32_16x16x32_bf16 v[104:107], a[196:199], v[44:47], v[104:107]
s_mov_b32 m0, s35
ds_read_b64_tr_b16 a[212:213], v5 offset:40960
v_add_f32 v26, v26, v28
v_mfma_f32_16x16x32_bf16 v[108:111], a[192:195], v[60:63], v[108:111]
s_add_u32 s90, s47, s92
ds_read_b64_tr_b16 a[214:215], v5 offset:45056
v_fma_f32 v90, v90, s24, v15
v_mfma_f32_16x16x32_bf16 v[108:111], a[196:199], v[48:51], v[108:111]
buffer_load_dwordx4 v7, s[12:15], s90 offen offset:0 nt lds
v_mfma_f32_16x16x32_bf16 v[112:115], a[192:195], v[64:67], v[112:115]
ds_read_b64_tr_b16 a[192:193], v6 offset:32768
v_fma_f32 v91, v91, s24, v15
v_mfma_f32_16x16x32_bf16 v[112:115], a[196:199], v[52:55], v[112:115]
ds_read_b64_tr_b16 a[194:195], v6 offset:36864
v_fma_f32 v68, v68, s24, v11
v_mfma_f32_16x16x32_bf16 v[116:119], a[200:203], v[56:59], v[116:119]
s_waitcnt lgkmcnt(4)
v_exp_f32 v29, v87
v_mfma_f32_16x16x32_bf16 v[116:119], a[204:207], v[44:47], v[116:119]
ds_read_b64_tr_b16 a[196:197], v6 offset:40960
v_cvt_pk_bf16_f32 v37, v28, v29
v_mfma_f32_16x16x32_bf16 v[120:123], a[200:203], v[60:63], v[120:123]
ds_read_b64_tr_b16 a[198:199], v6 offset:45056
v_add_f32 v26, v26, v29
v_mfma_f32_16x16x32_bf16 v[120:123], a[204:207], v[48:51], v[120:123]
v_exp_f32 v30, v88
v_mfma_f32_16x16x32_bf16 v[124:127], a[200:203], v[64:67], v[124:127]
ds_read_b64_tr_b16 a[200:201], v3 offset:33792
v_fma_f32 v69, v69, s24, v11
v_mfma_f32_16x16x32_bf16 v[124:127], a[204:207], v[52:55], v[124:127]
s_add_u32 s90, s47, s93
ds_read_b64_tr_b16 a[202:203], v3 offset:37888
v_fma_f32 v70, v70, s24, v11
v_mfma_f32_16x16x32_bf16 v[128:131], a[208:211], v[56:59], v[128:131]
s_waitcnt lgkmcnt(4)
buffer_load_dwordx4 v7, s[12:15], s90 offen offset:1024 nt lds
v_mfma_f32_16x16x32_bf16 v[128:131], a[212:215], v[44:47], v[128:131]
ds_read_b64_tr_b16 a[204:205], v3 offset:41984
v_fma_f32 v71, v71, s24, v11
v_mfma_f32_16x16x32_bf16 v[132:135], a[208:211], v[60:63], v[132:135]
ds_read_b64_tr_b16 a[206:207], v3 offset:46080
v_fma_f32 v72, v72, s24, v13
v_mfma_f32_16x16x32_bf16 v[132:135], a[212:215], v[48:51], v[132:135]
v_exp_f32 v31, v89
v_mfma_f32_16x16x32_bf16 v[136:139], a[208:211], v[64:67], v[136:139]
ds_read_b64_tr_b16 a[208:209], v4 offset:33792
v_cvt_pk_bf16_f32 v40, v30, v31
v_mfma_f32_16x16x32_bf16 v[136:139], a[212:215], v[52:55], v[136:139]
ds_read_b64_tr_b16 a[210:211], v4 offset:37888
v_add_f32 v27, v30, v31
v_mfma_f32_16x16x32_bf16 v[140:143], a[192:195], v[56:59], v[140:143]
s_waitcnt lgkmcnt(4)
v_exp_f32 v20, v90
v_mfma_f32_16x16x32_bf16 v[140:143], a[196:199], v[44:47], v[140:143]
ds_read_b64_tr_b16 a[212:213], v4 offset:41984
v_add_f32 v27, v27, v20
v_mfma_f32_16x16x32_bf16 v[144:147], a[192:195], v[60:63], v[144:147]
s_add_u32 s90, s47, s94
ds_read_b64_tr_b16 a[214:215], v4 offset:46080
v_fma_f32 v73, v73, s24, v13
v_mfma_f32_16x16x32_bf16 v[144:147], a[196:199], v[48:51], v[144:147]
buffer_load_dwordx4 v7, s[12:15], s90 offen offset:2048 nt lds
v_mfma_f32_16x16x32_bf16 v[148:151], a[192:195], v[64:67], v[148:151]
ds_read_b64_tr_b16 a[192:193], v5 offset:33792
v_fma_f32 v74, v74, s24, v13
v_mfma_f32_16x16x32_bf16 v[148:151], a[196:199], v[52:55], v[148:151]
ds_read_b64_tr_b16 a[194:195], v5 offset:37888
v_fma_f32 v75, v75, s24, v13
v_mfma_f32_16x16x32_bf16 v[152:155], a[200:203], v[56:59], v[152:155]
s_waitcnt lgkmcnt(4)
v_exp_f32 v21, v91
v_mfma_f32_16x16x32_bf16 v[152:155], a[204:207], v[44:47], v[152:155]
ds_read_b64_tr_b16 a[196:197], v5 offset:41984
v_cvt_pk_bf16_f32 v41, v20, v21
v_mfma_f32_16x16x32_bf16 v[156:159], a[200:203], v[60:63], v[156:159]
ds_read_b64_tr_b16 a[198:199], v5 offset:46080
v_add_f32 v27, v27, v21
v_mfma_f32_16x16x32_bf16 v[156:159], a[204:207], v[48:51], v[156:159]
v_exp_f32 v28, v68
v_mfma_f32_16x16x32_bf16 v[160:163], a[200:203], v[64:67], v[160:163]
ds_read_b64_tr_b16 a[200:201], v6 offset:33792
v_add_f32 v24, v24, v28
v_mfma_f32_16x16x32_bf16 v[160:163], a[204:207], v[52:55], v[160:163]
s_add_u32 s90, s47, s95
ds_read_b64_tr_b16 a[202:203], v6 offset:37888
v_fma_f32 v76, v76, s24, v15
v_mfma_f32_16x16x32_bf16 v[164:167], a[208:211], v[56:59], v[164:167]
s_waitcnt lgkmcnt(4)
buffer_load_dwordx4 v7, s[12:15], s90 offen offset:3072 nt lds
v_mfma_f32_16x16x32_bf16 v[164:167], a[212:215], v[44:47], v[164:167]
ds_read_b64_tr_b16 a[204:205], v6 offset:41984
v_fma_f32 v77, v77, s24, v15
v_mfma_f32_16x16x32_bf16 v[168:171], a[208:211], v[60:63], v[168:171]
ds_read_b64_tr_b16 a[206:207], v6 offset:46080
v_fma_f32 v78, v78, s24, v15
v_mfma_f32_16x16x32_bf16 v[168:171], a[212:215], v[48:51], v[168:171]
v_exp_f32 v29, v69
v_mfma_f32_16x16x32_bf16 v[172:175], a[208:211], v[64:67], v[172:175]
v_exp_f32 v30, v70
v_mfma_f32_16x16x32_bf16 v[172:175], a[212:215], v[52:55], v[172:175]
v_exp_f32 v31, v71
v_mfma_f32_16x16x32_bf16 v[176:179], a[192:195], v[56:59], v[176:179]
s_waitcnt lgkmcnt(2)
v_exp_f32 v20, v72
v_mfma_f32_16x16x32_bf16 v[176:179], a[196:199], v[44:47], v[176:179]
v_exp_f32 v21, v73
v_mfma_f32_16x16x32_bf16 v[180:183], a[192:195], v[60:63], v[180:183]
v_cvt_pk_bf16_f32 v34, v28, v29
v_add_f32 v24, v24, v29
v_mfma_f32_16x16x32_bf16 v[180:183], a[196:199], v[48:51], v[180:183]
s_waitcnt vmcnt(14) lgkmcnt(0)
v_exp_f32 v28, v74
v_mfma_f32_16x16x32_bf16 v[184:187], a[192:195], v[64:67], v[184:187]
s_barrier
ds_read_b128 a[168:171], v8 offset:0
v_mfma_f32_16x16x32_bf16 v[184:187], a[196:199], v[52:55], v[184:187]
ds_read_b128 a[208:211], v1 offset:16384
v_cvt_pk_bf16_f32 v35, v30, v31
v_mfma_f32_16x16x32_bf16 v[188:191], a[200:203], v[56:59], v[188:191]
ds_read_b128 a[212:215], v2 offset:16384
v_add_f32 v24, v24, v30
v_mfma_f32_16x16x32_bf16 v[188:191], a[204:207], v[44:47], v[188:191]
ds_read_b128 a[192:195], v1 offset:17408
v_add_f32 v24, v24, v31
v_mfma_f32_16x16x32_bf16 v[192:195], a[200:203], v[60:63], v[192:195]
s_mov_b32 m0, s38
ds_read_b128 a[196:199], v2 offset:17408
v_cvt_pk_bf16_f32 v38, v20, v21
v_mfma_f32_16x16x32_bf16 v[192:195], a[204:207], v[48:51], v[192:195]
s_bitcmp1_b32 s3, 1
s_cselect_b32 s81, s47, s46
v_add_f32 v26, v26, v20
v_mfma_f32_16x16x32_bf16 v[196:199], a[200:203], v[64:67], v[196:199]
s_add_u32 s90, s81, s92
ds_read_b128 a[200:203], v1 offset:18432
v_add_f32 v26, v26, v21
v_mfma_f32_16x16x32_bf16 v[196:199], a[204:207], v[52:55], v[196:199]
s_waitcnt lgkmcnt(4)
ds_read_b128 a[204:207], v2 offset:18432
v_add_f32 v26, v26, v28
v_mfma_f32_16x16x32_bf16 v[92:95], a[208:211], a[0:3], 0
s_waitcnt lgkmcnt(4)
buffer_load_dwordx4 v7, s[16:19], s90 offen offset:0 nt lds
v_mfma_f32_16x16x32_bf16 v[92:95], a[212:215], a[12:15], v[92:95]
v_exp_f32 v29, v75
v_mfma_f32_16x16x32_bf16 v[96:99], a[208:211], a[4:7], 0
v_exp_f32 v30, v76
v_mfma_f32_16x16x32_bf16 v[96:99], a[212:215], a[16:19], v[96:99]
v_exp_f32 v31, v77
v_mfma_f32_16x16x32_bf16 v[100:103], a[208:211], a[8:11], 0
ds_read_b128 a[208:211], v1 offset:19456
v_cvt_pk_bf16_f32 v39, v28, v29
v_mfma_f32_16x16x32_bf16 v[100:103], a[212:215], a[20:23], v[100:103]
s_waitcnt lgkmcnt(1)
ds_read_b128 a[212:215], v2 offset:19456
v_add_f32 v26, v26, v29
v_mfma_f32_16x16x32_bf16 v[92:95], a[192:195], a[24:27], v[92:95]
s_add_u32 s91, s81, s93
v_exp_f32 v20, v78
v_mfma_f32_16x16x32_bf16 v[92:95], a[196:199], a[36:39], v[92:95]
buffer_load_dwordx4 v7, s[16:19], s91 offen offset:1024 nt lds
v_mfma_f32_16x16x32_bf16 v[96:99], a[192:195], a[28:31], v[96:99]
v_fma_f32 v79, v79, s24, v15
v_cvt_pk_bf16_f32 v42, v30, v31
v_mfma_f32_16x16x32_bf16 v[96:99], a[196:199], a[40:43], v[96:99]
v_exp_f32 v21, v79
v_mfma_f32_16x16x32_bf16 v[100:103], a[192:195], a[32:35], v[100:103]
ds_read_b128 a[192:195], v1 offset:24576
v_add_f32 v27, v27, v30
v_mfma_f32_16x16x32_bf16 v[100:103], a[196:199], a[44:47], v[100:103]
ds_read_b128 a[196:199], v2 offset:24576
v_add_f32 v27, v27, v31
v_mfma_f32_16x16x32_bf16 v[92:95], a[200:203], a[48:51], v[92:95]
v_cvt_pk_bf16_f32 v43, v20, v21
v_add_f32 v27, v27, v20
v_mfma_f32_16x16x32_bf16 v[92:95], a[204:207], a[60:63], v[92:95]
v_add_f32 v27, v27, v21
v_max3_f32 v25, v24, v26, v27
v_mfma_f32_16x16x32_bf16 v[96:99], a[200:203], a[52:55], v[96:99]
v_cmp_lt_f32 vcc, s25, v25
v_xor_b32 v8, 64, v8
v_mfma_f32_16x16x32_bf16 v[96:99], a[204:207], a[64:67], v[96:99]
ds_read_b128 a[180:183], v8 offset:0
v_mfma_f32_16x16x32_bf16 v[100:103], a[200:203], a[56:59], v[100:103]
s_addk_i32 s90, 2048
ds_read_b128 a[200:203], v1 offset:25600
v_mfma_f32_16x16x32_bf16 v[100:103], a[204:207], a[68:71], v[100:103]
s_waitcnt lgkmcnt(2)
ds_read_b128 a[204:207], v2 offset:25600
v_mfma_f32_16x16x32_bf16 v[92:95], a[208:211], a[72:75], v[92:95]
buffer_load_dwordx4 v7, s[16:19], s90 offen offset:2048 nt lds
v_mfma_f32_16x16x32_bf16 v[92:95], a[212:215], a[84:87], v[92:95]
v_mfma_f32_16x16x32_bf16 v[96:99], a[208:211], a[76:79], v[96:99]
v_mfma_f32_16x16x32_bf16 v[96:99], a[212:215], a[88:91], v[96:99]
s_cbranch_vccnz STUB_4
BACK_4:
v_mfma_f32_16x16x32_bf16 v[100:103], a[208:211], a[80:83], v[100:103]
ds_read_b128 a[208:211], v1 offset:26624
v_add_f32 v19, v19, v27
v_mfma_f32_16x16x32_bf16 v[100:103], a[212:215], a[92:95], v[100:103]
ds_read_b128 a[212:215], v2 offset:26624
v_add_f32 v17, v17, v24
v_mfma_f32_16x16x32_bf16 v[80:83], a[192:195], a[0:3], 0
s_addk_i32 s91, 2048
v_add_f32 v18, v18, v26
v_fma_f32 v92, v92, s24, v11
v_mfma_f32_16x16x32_bf16 v[80:83], a[196:199], a[12:15], v[80:83]
buffer_load_dwordx4 v7, s[16:19], s91 offen offset:3072 nt lds
v_mfma_f32_16x16x32_bf16 v[84:87], a[192:195], a[4:7], 0
v_exp_f32 v28, v92
v_mfma_f32_16x16x32_bf16 v[84:87], a[196:199], a[16:19], v[84:87]
v_fma_f32 v93, v93, s24, v11
v_fma_f32 v94, v94, s24, v11
v_mfma_f32_16x16x32_bf16 v[88:91], a[192:195], a[8:11], 0
ds_read_b128 a[192:195], v1 offset:27648
v_fma_f32 v95, v95, s24, v11
v_mfma_f32_16x16x32_bf16 v[88:91], a[196:199], a[20:23], v[88:91]
s_waitcnt lgkmcnt(1)
ds_read_b128 a[196:199], v2 offset:27648
v_fma_f32 v96, v96, s24, v13
v_mfma_f32_16x16x32_bf16 v[80:83], a[200:203], a[24:27], v[80:83]
v_exp_f32 v29, v93
v_mfma_f32_16x16x32_bf16 v[80:83], a[204:207], a[36:39], v[80:83]
s_add_u32 m0, s4, 4096
v_exp_f32 v30, v94
v_mfma_f32_16x16x32_bf16 v[84:87], a[200:203], a[28:31], v[84:87]
s_add_u32 s88, s31, s87
v_exp_f32 v31, v95
v_mfma_f32_16x16x32_bf16 v[84:87], a[204:207], a[40:43], v[84:87]
buffer_load_dwordx4 v7, s[8:11], s88 offen offset:0 nt lds
v_mfma_f32_16x16x32_bf16 v[88:91], a[200:203], a[32:35], v[88:91]
ds_read_b64_tr_b16 a[200:201], v3 offset:49152
v_cvt_pk_bf16_f32 v68, v28, v29
v_mfma_f32_16x16x32_bf16 v[88:91], a[204:207], a[44:47], v[88:91]
ds_read_b64_tr_b16 a[202:203], v3 offset:53248
v_add_f32 v24, v28, v29
v_mfma_f32_16x16x32_bf16 v[80:83], a[208:211], a[48:51], v[80:83]
v_exp_f32 v20, v96
v_mfma_f32_16x16x32_bf16 v[80:83], a[212:215], a[60:63], v[80:83]
ds_read_b64_tr_b16 a[204:205], v3 offset:57344
v_cvt_pk_bf16_f32 v69, v30, v31
v_mfma_f32_16x16x32_bf16 v[84:87], a[208:211], a[52:55], v[84:87]
ds_read_b64_tr_b16 a[206:207], v3 offset:61440
v_add_f32 v24, v24, v30
v_mfma_f32_16x16x32_bf16 v[84:87], a[212:215], a[64:67], v[84:87]
v_add_f32 v24, v24, v31
v_fma_f32 v97, v97, s24, v13
v_mfma_f32_16x16x32_bf16 v[88:91], a[208:211], a[56:59], v[88:91]
s_addk_i32 s88, 3072
ds_read_b64_tr_b16 a[208:209], v4 offset:49152
v_fma_f32 v98, v98, s24, v13
v_mfma_f32_16x16x32_bf16 v[88:91], a[212:215], a[68:71], v[88:91]
s_waitcnt lgkmcnt(3)
ds_read_b64_tr_b16 a[210:211], v4 offset:53248
v_fma_f32 v99, v99, s24, v13
v_mfma_f32_16x16x32_bf16 v[80:83], a[192:195], a[72:75], v[80:83]
buffer_load_dwordx4 v7, s[8:11], s88 offen offset:1024 nt lds
v_mfma_f32_16x16x32_bf16 v[80:83], a[196:199], a[84:87], v[80:83]
ds_read_b64_tr_b16 a[212:213], v4 offset:57344
v_fma_f32 v100, v100, s24, v15
v_mfma_f32_16x16x32_bf16 v[84:87], a[192:195], a[76:79], v[84:87]
ds_read_b64_tr_b16 a[214:215], v4 offset:61440
v_fma_f32 v101, v101, s24, v15
v_mfma_f32_16x16x32_bf16 v[84:87], a[196:199], a[88:91], v[84:87]
v_exp_f32 v21, v97
v_mfma_f32_16x16x32_bf16 v[88:91], a[192:195], a[80:83], v[88:91]
ds_read_b64_tr_b16 a[192:193], v5 offset:49152
v_cvt_pk_bf16_f32 v72, v20, v21
v_mfma_f32_16x16x32_bf16 v[88:91], a[196:199], a[92:95], v[88:91]
ds_read_b64_tr_b16 a[194:195], v5 offset:53248
v_add_f32 v26, v20, v21
v_mfma_f32_16x16x32_bf16 v[200:203], a[200:203], v[56:59], v[200:203]
s_waitcnt lgkmcnt(4)
v_exp_f32 v28, v98
v_mfma_f32_16x16x32_bf16 v[200:203], a[204:207], v[44:47], v[200:203]
s_mov_b32 m0, s32
ds_read_b64_tr_b16 a[196:197], v5 offset:57344
v_add_f32 v26, v26, v28
v_mfma_f32_16x16x32_bf16 v[204:207], a[200:203], v[60:63], v[204:207]
s_add_u32 s90, s48, s92
ds_read_b64_tr_b16 a[198:199], v5 offset:61440
v_fma_f32 v102, v102, s24, v15
v_mfma_f32_16x16x32_bf16 v[204:207], a[204:207], v[48:51], v[204:207]
PADJ_2:
s_cbranch_execz PADJ_6
buffer_load_dwordx4 v7, s[12:15], s90 offen offset:0 nt lds
v_mfma_f32_16x16x32_bf16 v[208:211], a[200:203], v[64:67], v[208:211]
ds_read_b64_tr_b16 a[200:201], v6 offset:49152
v_fma_f32 v103, v103, s24, v15
v_mfma_f32_16x16x32_bf16 v[208:211], a[204:207], v[52:55], v[208:211]
ds_read_b64_tr_b16 a[202:203], v6 offset:53248
v_fma_f32 v80, v80, s24, v11
v_mfma_f32_16x16x32_bf16 v[212:215], a[208:211], v[56:59], v[212:215]
s_waitcnt lgkmcnt(4)
v_exp_f32 v29, v99
v_mfma_f32_16x16x32_bf16 v[212:215], a[212:215], v[44:47], v[212:215]
ds_read_b64_tr_b16 a[204:205], v6 offset:57344
v_cvt_pk_bf16_f32 v73, v28, v29
v_mfma_f32_16x16x32_bf16 v[216:219], a[208:211], v[60:63], v[216:219]
ds_read_b64_tr_b16 a[206:207], v6 offset:61440
v_add_f32 v26, v26, v29
v_mfma_f32_16x16x32_bf16 v[216:219], a[212:215], v[48:51], v[216:219]
v_exp_f32 v30, v100
v_mfma_f32_16x16x32_bf16 v[220:223], a[208:211], v[64:67], v[220:223]
ds_read_b64_tr_b16 a[208:209], v3 offset:50176
v_fma_f32 v81, v81, s24, v11
v_mfma_f32_16x16x32_bf16 v[220:223], a[212:215], v[52:55], v[220:223]
s_add_u32 s90, s48, s93
ds_read_b64_tr_b16 a[210:211], v3 offset:54272
v_fma_f32 v82, v82, s24, v11
v_mfma_f32_16x16x32_bf16 a[216:219], a[192:195], v[56:59], a[216:219]
s_waitcnt lgkmcnt(4)
buffer_load_dwordx4 v7, s[12:15], s90 offen offset:1024 nt lds
v_mfma_f32_16x16x32_bf16 a[216:219], a[196:199], v[44:47], a[216:219]
ds_read_b64_tr_b16 a[212:213], v3 offset:58368
v_fma_f32 v83, v83, s24, v11
v_mfma_f32_16x16x32_bf16 a[220:223], a[192:195], v[60:63], a[220:223]
ds_read_b64_tr_b16 a[214:215], v3 offset:62464
v_fma_f32 v84, v84, s24, v13
v_mfma_f32_16x16x32_bf16 a[220:223], a[196:199], v[48:51], a[220:223]
v_exp_f32 v31, v101
v_mfma_f32_16x16x32_bf16 a[224:227], a[192:195], v[64:67], a[224:227]
ds_read_b64_tr_b16 a[192:193], v4 offset:50176
v_cvt_pk_bf16_f32 v76, v30, v31
v_mfma_f32_16x16x32_bf16 a[224:227], a[196:199], v[52:55], a[224:227]
ds_read_b64_tr_b16 a[194:195], v4 offset:54272
v_add_f32 v27, v30, v31
v_mfma_f32_16x16x32_bf16 a[228:231], a[200:203], v[56:59], a[228:231]
s_waitcnt lgkmcnt(4)
v_exp_f32 v20, v102
v_mfma_f32_16x16x32_bf16 a[228:231], a[204:207], v[44:47], a[228:231]
ds_read_b64_tr_b16 a[196:197], v4 offset:58368
v_add_f32 v27, v27, v20
v_mfma_f32_16x16x32_bf16 a[232:235], a[200:203], v[60:63], a[232:235]
s_add_u32 s90, s48, s94
ds_read_b64_tr_b16 a[198:199], v4 offset:62464
v_fma_f32 v85, v85, s24, v13
v_mfma_f32_16x16x32_bf16 a[232:235], a[204:207], v[48:51], a[232:235]
buffer_load_dwordx4 v7, s[12:15], s90 offen offset:2048 nt lds
v_mfma_f32_16x16x32_bf16 a[236:239], a[200:203], v[64:67], a[236:239]
ds_read_b64_tr_b16 a[200:201], v5 offset:50176
v_fma_f32 v86, v86, s24, v13
v_mfma_f32_16x16x32_bf16 a[236:239], a[204:207], v[52:55], a[236:239]
ds_read_b64_tr_b16 a[202:203], v5 offset:54272
v_fma_f32 v87, v87, s24, v13
v_mfma_f32_16x16x32_bf16 a[240:243], a[208:211], v[56:59], a[240:243]
s_waitcnt lgkmcnt(4)
v_exp_f32 v21, v103
v_mfma_f32_16x16x32_bf16 a[240:243], a[212:215], v[44:47], a[240:243]
ds_read_b64_tr_b16 a[204:205], v5 offset:58368
v_cvt_pk_bf16_f32 v77, v20, v21
v_mfma_f32_16x16x32_bf16 a[244:247], a[208:211], v[60:63], a[244:247]
ds_read_b64_tr_b16 a[206:207], v5 offset:62464
v_add_f32 v27, v27, v21
v_mfma_f32_16x16x32_bf16 a[244:247], a[212:215], v[48:51], a[244:247]
v_exp_f32 v28, v80
v_mfma_f32_16x16x32_bf16 a[248:251], a[208:211], v[64:67], a[248:251]
ds_read_b64_tr_b16 a[208:209], v6 offset:50176
v_add_f32 v24, v24, v28
v_mfma_f32_16x16x32_bf16 a[248:251], a[212:215], v[52:55], a[248:251]
s_add_u32 s90, s48, s95
ds_read_b64_tr_b16 a[210:211], v6 offset:54272
v_fma_f32 v88, v88, s24, v15
v_mfma_f32_16x16x32_bf16 a[252:255], a[192:195], v[56:59], a[252:255]
s_waitcnt lgkmcnt(4)
buffer_load_dwordx4 v7, s[12:15], s90 offen offset:3072 nt lds
v_mfma_f32_16x16x32_bf16 a[252:255], a[196:199], v[44:47], a[252:255]
ds_read_b64_tr_b16 a[212:213], v6 offset:58368
v_fma_f32 v89, v89, s24, v15
v_mfma_f32_16x16x32_bf16 v[224:227], a[192:195], v[60:63], v[224:227]
ds_read_b64_tr_b16 a[214:215], v6 offset:62464
v_fma_f32 v90, v90, s24, v15
v_mfma_f32_16x16x32_bf16 v[224:227], a[196:199], v[48:51], v[224:227]
v_exp_f32 v29, v81
v_mfma_f32_16x16x32_bf16 v[228:231], a[192:195], v[64:67], v[228:231]
v_exp_f32 v30, v82
v_mfma_f32_16x16x32_bf16 v[228:231], a[196:199], v[52:55], v[228:231]
v_exp_f32 v31, v83
v_mfma_f32_16x16x32_bf16 v[232:235], a[200:203], v[56:59], v[232:235]
s_waitcnt lgkmcnt(2)
v_exp_f32 v20, v84
v_mfma_f32_16x16x32_bf16 v[232:235], a[204:207], v[44:47], v[232:235]
v_exp_f32 v21, v85
v_mfma_f32_16x16x32_bf16 v[236:239], a[200:203], v[60:63], v[236:239]
v_cvt_pk_bf16_f32 v70, v28, v29
v_add_f32 v24, v24, v29
v_mfma_f32_16x16x32_bf16 v[236:239], a[204:207], v[48:51], v[236:239]
s_waitcnt vmcnt(14) lgkmcnt(0)
v_exp_f32 v28, v86
v_mfma_f32_16x16x32_bf16 v[240:243], a[200:203], v[64:67], v[240:243]
s_barrier
ds_read_b128 a[184:187], v8 offset:2048
v_mfma_f32_16x16x32_bf16 v[240:243], a[204:207], v[52:55], v[240:243]
ds_read_b128 a[192:195], v1 offset:32768
v_cvt_pk_bf16_f32 v71, v30, v31
v_mfma_f32_16x16x32_bf16 v[244:247], a[208:211], v[56:59], v[244:247]
ds_read_b128 a[196:199], v2 offset:32768
v_add_f32 v24, v24, v30
v_mfma_f32_16x16x32_bf16 v[244:247], a[212:215], v[44:47], v[244:247]
ds_read_b128 a[200:203], v1 offset:33792
v_add_f32 v24, v24, v31
v_mfma_f32_16x16x32_bf16 v[248:251], a[208:211], v[60:63], v[248:251]
s_mov_b32 m0, s39
ds_read_b128 a[204:207], v2 offset:33792
v_cvt_pk_bf16_f32 v74, v20, v21
v_mfma_f32_16x16x32_bf16 v[248:251], a[212:215], v[48:51], v[248:251]
s_addk_i32 s81, 2048
v_exp_f32 v29, v87
v_mfma_f32_16x16x32_bf16 v[252:255], a[208:211], v[64:67], v[252:255]
s_add_u32 s90, s81, s94
ds_read_b128 a[208:211], v1 offset:34816
v_add_f32 v26, v26, v20
v_mfma_f32_16x16x32_bf16 v[252:255], a[212:215], v[52:55], v[252:255]
s_waitcnt lgkmcnt(4)
ds_read_b128 a[212:215], v2 offset:34816
v_add_f32 v26, v26, v21
v_mfma_f32_16x16x32_bf16 v[44:47], a[192:195], a[0:3], 0
s_waitcnt lgkmcnt(4)
buffer_load_dwordx4 v7, s[16:19], s90 offen offset:0 nt lds
v_mfma_f32_16x16x32_bf16 v[44:47], a[196:199], a[12:15], v[44:47]
v_exp_f32 v30, v88
v_mfma_f32_16x16x32_bf16 v[48:51], a[192:195], a[4:7], 0
v_exp_f32 v31, v89
v_mfma_f32_16x16x32_bf16 v[48:51], a[196:199], a[16:19], v[48:51]
v_exp_f32 v20, v90
v_mfma_f32_16x16x32_bf16 v[52:55], a[192:195], a[8:11], 0
ds_read_b128 a[192:195], v1 offset:35840
v_cvt_pk_bf16_f32 v75, v28, v29
v_mfma_f32_16x16x32_bf16 v[52:55], a[196:199], a[20:23], v[52:55]
s_waitcnt lgkmcnt(1)
ds_read_b128 a[196:199], v2 offset:35840
v_add_f32 v26, v26, v28
v_mfma_f32_16x16x32_bf16 v[44:47], a[200:203], a[24:27], v[44:47]
s_add_u32 s91, s81, s95
v_add_f32 v26, v26, v29
v_fma_f32 v91, v91, s24, v15
v_mfma_f32_16x16x32_bf16 v[44:47], a[204:207], a[36:39], v[44:47]
buffer_load_dwordx4 v7, s[16:19], s91 offen offset:1024 nt lds
v_mfma_f32_16x16x32_bf16 v[48:51], a[200:203], a[28:31], v[48:51]
v_exp_f32 v21, v91
v_mfma_f32_16x16x32_bf16 v[48:51], a[204:207], a[40:43], v[48:51]
v_cvt_pk_bf16_f32 v78, v30, v31
v_add_f32 v27, v27, v30
v_mfma_f32_16x16x32_bf16 v[52:55], a[200:203], a[32:35], v[52:55]
ds_read_b128 a[200:203], v1 offset:40960
v_add_f32 v27, v27, v31
v_mfma_f32_16x16x32_bf16 v[52:55], a[204:207], a[44:47], v[52:55]
ds_read_b128 a[204:207], v2 offset:40960
v_cvt_pk_bf16_f32 v79, v20, v21
v_mfma_f32_16x16x32_bf16 v[44:47], a[208:211], a[48:51], v[44:47]
v_add_f32 v27, v27, v20
v_add_f32 v27, v27, v21
v_mfma_f32_16x16x32_bf16 v[44:47], a[212:215], a[60:63], v[44:47]
v_max3_f32 v25, v24, v26, v27
v_cmp_lt_f32 vcc, s25, v25
v_mfma_f32_16x16x32_bf16 v[48:51], a[208:211], a[52:55], v[48:51]
v_xor_b32 v8, 64, v8
v_mfma_f32_16x16x32_bf16 v[48:51], a[212:215], a[64:67], v[48:51]
ds_read_b128 a[172:175], v8 offset:2048
v_mfma_f32_16x16x32_bf16 v[52:55], a[208:211], a[56:59], v[52:55]
s_addk_i32 s90, 2048
ds_read_b128 a[208:211], v1 offset:41984
v_mfma_f32_16x16x32_bf16 v[52:55], a[212:215], a[68:71], v[52:55]
s_waitcnt lgkmcnt(2)
ds_read_b128 a[212:215], v2 offset:41984
v_mfma_f32_16x16x32_bf16 v[44:47], a[192:195], a[72:75], v[44:47]
buffer_load_dwordx4 v7, s[16:19], s90 offen offset:2048 nt lds
v_mfma_f32_16x16x32_bf16 v[44:47], a[196:199], a[84:87], v[44:47]
v_mfma_f32_16x16x32_bf16 v[48:51], a[192:195], a[76:79], v[48:51]
v_mfma_f32_16x16x32_bf16 v[48:51], a[196:199], a[88:91], v[48:51]
s_cbranch_vccnz STUB_5
BACK_5:
v_mfma_f32_16x16x32_bf16 v[52:55], a[192:195], a[80:83], v[52:55]
ds_read_b128 a[192:195], v1 offset:43008
v_add_f32 v19, v19, v27
v_mfma_f32_16x16x32_bf16 v[52:55], a[196:199], a[92:95], v[52:55]
ds_read_b128 a[196:199], v2 offset:43008
v_add_f32 v17, v17, v24
v_mfma_f32_16x16x32_bf16 v[80:83], a[200:203], a[0:3], 0
s_addk_i32 s91, 2048
v_add_f32 v18, v18, v26
v_fma_f32 v44, v44, s24, v11
v_mfma_f32_16x16x32_bf16 v[80:83], a[204:207], a[12:15], v[80:83]
buffer_load_dwordx4 v7, s[16:19], s91 offen offset:3072 nt lds
v_mfma_f32_16x16x32_bf16 v[84:87], a[200:203], a[4:7], 0
v_exp_f32 v28, v44
v_mfma_f32_16x16x32_bf16 v[84:87], a[204:207], a[16:19], v[84:87]
v_fma_f32 v45, v45, s24, v11
v_fma_f32 v46, v46, s24, v11
v_mfma_f32_16x16x32_bf16 v[88:91], a[200:203], a[8:11], 0
ds_read_b128 a[200:203], v1 offset:44032
v_fma_f32 v47, v47, s24, v11
v_mfma_f32_16x16x32_bf16 v[88:91], a[204:207], a[20:23], v[88:91]
s_waitcnt lgkmcnt(1)
ds_read_b128 a[204:207], v2 offset:44032
v_fma_f32 v48, v48, s24, v13
v_mfma_f32_16x16x32_bf16 v[80:83], a[208:211], a[24:27], v[80:83]
v_exp_f32 v29, v45
v_mfma_f32_16x16x32_bf16 v[80:83], a[212:215], a[36:39], v[80:83]
s_add_u32 m0, s4, 6144
v_exp_f32 v30, v46
v_mfma_f32_16x16x32_bf16 v[84:87], a[208:211], a[28:31], v[84:87]
s_add_u32 s88, s29, s84
v_exp_f32 v31, v47
v_mfma_f32_16x16x32_bf16 v[84:87], a[212:215], a[40:43], v[84:87]
buffer_load_dwordx4 v7, s[8:11], s88 offen offset:0 nt lds
v_mfma_f32_16x16x32_bf16 v[88:91], a[208:211], a[32:35], v[88:91]
ds_read_b64_tr_b16 a[208:209], v3 offset:0
v_cvt_pk_bf16_f32 v56, v28, v29
v_mfma_f32_16x16x32_bf16 v[88:91], a[212:215], a[44:47], v[88:91]
ds_read_b64_tr_b16 a[210:211], v3 offset:4096
v_add_f32 v24, v28, v29
v_mfma_f32_16x16x32_bf16 v[80:83], a[192:195], a[48:51], v[80:83]
v_exp_f32 v20, v48
v_mfma_f32_16x16x32_bf16 v[80:83], a[196:199], a[60:63], v[80:83]
ds_read_b64_tr_b16 a[212:213], v3 offset:8192
v_cvt_pk_bf16_f32 v57, v30, v31
v_mfma_f32_16x16x32_bf16 v[84:87], a[192:195], a[52:55], v[84:87]
ds_read_b64_tr_b16 a[214:215], v3 offset:12288
v_add_f32 v24, v24, v30
v_mfma_f32_16x16x32_bf16 v[84:87], a[196:199], a[64:67], v[84:87]
v_add_f32 v24, v24, v31
v_fma_f32 v49, v49, s24, v13
v_mfma_f32_16x16x32_bf16 v[88:91], a[192:195], a[56:59], v[88:91]
s_addk_i32 s88, 3072
ds_read_b64_tr_b16 a[192:193], v4 offset:0
v_fma_f32 v50, v50, s24, v13
v_mfma_f32_16x16x32_bf16 v[88:91], a[196:199], a[68:71], v[88:91]
s_waitcnt lgkmcnt(3)
ds_read_b64_tr_b16 a[194:195], v4 offset:4096
v_fma_f32 v51, v51, s24, v13
v_mfma_f32_16x16x32_bf16 v[80:83], a[200:203], a[72:75], v[80:83]
buffer_load_dwordx4 v7, s[8:11], s88 offen offset:1024 nt lds
v_mfma_f32_16x16x32_bf16 v[80:83], a[204:207], a[84:87], v[80:83]
ds_read_b64_tr_b16 a[196:197], v4 offset:8192
v_fma_f32 v52, v52, s24, v15
v_mfma_f32_16x16x32_bf16 v[84:87], a[200:203], a[76:79], v[84:87]
ds_read_b64_tr_b16 a[198:199], v4 offset:12288
v_fma_f32 v53, v53, s24, v15
v_mfma_f32_16x16x32_bf16 v[84:87], a[204:207], a[88:91], v[84:87]
v_exp_f32 v21, v49
v_mfma_f32_16x16x32_bf16 v[88:91], a[200:203], a[80:83], v[88:91]
ds_read_b64_tr_b16 a[200:201], v5 offset:0
v_cvt_pk_bf16_f32 v60, v20, v21
v_mfma_f32_16x16x32_bf16 v[88:91], a[204:207], a[92:95], v[88:91]
ds_read_b64_tr_b16 a[202:203], v5 offset:4096
v_add_f32 v26, v20, v21
v_mfma_f32_16x16x32_bf16 v[104:107], a[208:211], v[32:35], v[104:107]
s_waitcnt lgkmcnt(4)
v_exp_f32 v28, v50
v_mfma_f32_16x16x32_bf16 v[104:107], a[212:215], v[68:71], v[104:107]
s_mov_b32 m0, s33
ds_read_b64_tr_b16 a[204:205], v5 offset:8192
v_add_f32 v26, v26, v28
v_mfma_f32_16x16x32_bf16 v[108:111], a[208:211], v[36:39], v[108:111]
s_add_u32 s90, s49, s92
ds_read_b64_tr_b16 a[206:207], v5 offset:12288
v_fma_f32 v54, v54, s24, v15
v_mfma_f32_16x16x32_bf16 v[108:111], a[212:215], v[72:75], v[108:111]
buffer_load_dwordx4 v7, s[12:15], s90 offen offset:0 nt lds
v_mfma_f32_16x16x32_bf16 v[112:115], a[208:211], v[40:43], v[112:115]
ds_read_b64_tr_b16 a[208:209], v6 offset:0
v_fma_f32 v55, v55, s24, v15
v_mfma_f32_16x16x32_bf16 v[112:115], a[212:215], v[76:79], v[112:115]
ds_read_b64_tr_b16 a[210:211], v6 offset:4096
v_fma_f32 v80, v80, s24, v11
v_mfma_f32_16x16x32_bf16 v[116:119], a[192:195], v[32:35], v[116:119]
s_waitcnt lgkmcnt(4)
v_exp_f32 v29, v51
v_mfma_f32_16x16x32_bf16 v[116:119], a[196:199], v[68:71], v[116:119]
ds_read_b64_tr_b16 a[212:213], v6 offset:8192
v_cvt_pk_bf16_f32 v61, v28, v29
v_mfma_f32_16x16x32_bf16 v[120:123], a[192:195], v[36:39], v[120:123]
ds_read_b64_tr_b16 a[214:215], v6 offset:12288
v_add_f32 v26, v26, v29
v_mfma_f32_16x16x32_bf16 v[120:123], a[196:199], v[72:75], v[120:123]
v_exp_f32 v30, v52
v_mfma_f32_16x16x32_bf16 v[124:127], a[192:195], v[40:43], v[124:127]
ds_read_b64_tr_b16 a[192:193], v3 offset:1024
v_fma_f32 v81, v81, s24, v11
v_mfma_f32_16x16x32_bf16 v[124:127], a[196:199], v[76:79], v[124:127]
s_add_u32 s90, s49, s93
ds_read_b64_tr_b16 a[194:195], v3 offset:5120
v_fma_f32 v82, v82, s24, v11
v_mfma_f32_16x16x32_bf16 v[128:131], a[200:203], v[32:35], v[128:131]
s_waitcnt lgkmcnt(4)
buffer_load_dwordx4 v7, s[12:15], s90 offen offset:1024 nt lds
v_mfma_f32_16x16x32_bf16 v[128:131], a[204:207], v[68:71], v[128:131]
ds_read_b64_tr_b16 a[196:197], v3 offset:9216
v_fma_f32 v83, v83, s24, v11
v_mfma_f32_16x16x32_bf16 v[132:135], a[200:203], v[36:39], v[132:135]
ds_read_b64_tr_b16 a[198:199], v3 offset:13312
v_fma_f32 v84, v84, s24, v13
v_mfma_f32_16x16x32_bf16 v[132:135], a[204:207], v[72:75], v[132:135]
v_exp_f32 v31, v53
v_mfma_f32_16x16x32_bf16 v[136:139], a[200:203], v[40:43], v[136:139]
ds_read_b64_tr_b16 a[200:201], v4 offset:1024
v_cvt_pk_bf16_f32 v64, v30, v31
v_mfma_f32_16x16x32_bf16 v[136:139], a[204:207], v[76:79], v[136:139]
ds_read_b64_tr_b16 a[202:203], v4 offset:5120
v_add_f32 v27, v30, v31
v_mfma_f32_16x16x32_bf16 v[140:143], a[208:211], v[32:35], v[140:143]
s_waitcnt lgkmcnt(4)
v_exp_f32 v20, v54
v_mfma_f32_16x16x32_bf16 v[140:143], a[212:215], v[68:71], v[140:143]
ds_read_b64_tr_b16 a[204:205], v4 offset:9216
v_add_f32 v27, v27, v20
v_mfma_f32_16x16x32_bf16 v[144:147], a[208:211], v[36:39], v[144:147]
s_add_u32 s90, s49, s94
ds_read_b64_tr_b16 a[206:207], v4 offset:13312
v_fma_f32 v85, v85, s24, v13
v_mfma_f32_16x16x32_bf16 v[144:147], a[212:215], v[72:75], v[144:147]
buffer_load_dwordx4 v7, s[12:15], s90 offen offset:2048 nt lds
v_mfma_f32_16x16x32_bf16 v[148:151], a[208:211], v[40:43], v[148:151]
ds_read_b64_tr_b16 a[208:209], v5 offset:1024
v_fma_f32 v86, v86, s24, v13
v_mfma_f32_16x16x32_bf16 v[148:151], a[212:215], v[76:79], v[148:151]
ds_read_b64_tr_b16 a[210:211], v5 offset:5120
v_fma_f32 v87, v87, s24, v13
v_mfma_f32_16x16x32_bf16 v[152:155], a[192:195], v[32:35], v[152:155]
s_waitcnt lgkmcnt(4)
v_exp_f32 v21, v55
v_mfma_f32_16x16x32_bf16 v[152:155], a[196:199], v[68:71], v[152:155]
ds_read_b64_tr_b16 a[212:213], v5 offset:9216
v_cvt_pk_bf16_f32 v65, v20, v21
v_mfma_f32_16x16x32_bf16 v[156:159], a[192:195], v[36:39], v[156:159]
ds_read_b64_tr_b16 a[214:215], v5 offset:13312
v_add_f32 v27, v27, v21
v_mfma_f32_16x16x32_bf16 v[156:159], a[196:199], v[72:75], v[156:159]
v_exp_f32 v28, v80
v_mfma_f32_16x16x32_bf16 v[160:163], a[192:195], v[40:43], v[160:163]
ds_read_b64_tr_b16 a[192:193], v6 offset:1024
v_add_f32 v24, v24, v28
v_mfma_f32_16x16x32_bf16 v[160:163], a[196:199], v[76:79], v[160:163]
s_add_u32 s90, s49, s95
ds_read_b64_tr_b16 a[194:195], v6 offset:5120
v_fma_f32 v88, v88, s24, v15
v_mfma_f32_16x16x32_bf16 v[164:167], a[200:203], v[32:35], v[164:167]
s_waitcnt lgkmcnt(4)
buffer_load_dwordx4 v7, s[12:15], s90 offen offset:3072 nt lds
v_mfma_f32_16x16x32_bf16 v[164:167], a[204:207], v[68:71], v[164:167]
ds_read_b64_tr_b16 a[196:197], v6 offset:9216
v_fma_f32 v89, v89, s24, v15
v_mfma_f32_16x16x32_bf16 v[168:171], a[200:203], v[36:39], v[168:171]
ds_read_b64_tr_b16 a[198:199], v6 offset:13312
v_fma_f32 v90, v90, s24, v15
v_mfma_f32_16x16x32_bf16 v[168:171], a[204:207], v[72:75], v[168:171]
v_exp_f32 v29, v81
v_mfma_f32_16x16x32_bf16 v[172:175], a[200:203], v[40:43], v[172:175]
v_exp_f32 v30, v82
v_mfma_f32_16x16x32_bf16 v[172:175], a[204:207], v[76:79], v[172:175]
v_exp_f32 v31, v83
v_mfma_f32_16x16x32_bf16 v[176:179], a[208:211], v[32:35], v[176:179]
s_waitcnt lgkmcnt(2)
v_exp_f32 v20, v84
v_mfma_f32_16x16x32_bf16 v[176:179], a[212:215], v[68:71], v[176:179]
v_exp_f32 v21, v85
v_mfma_f32_16x16x32_bf16 v[180:183], a[208:211], v[36:39], v[180:183]
v_cvt_pk_bf16_f32 v58, v28, v29
v_add_f32 v24, v24, v29
v_mfma_f32_16x16x32_bf16 v[180:183], a[212:215], v[72:75], v[180:183]
s_waitcnt vmcnt(14) lgkmcnt(0)
v_exp_f32 v28, v86
v_mfma_f32_16x16x32_bf16 v[184:187], a[208:211], v[40:43], v[184:187]
s_barrier
ds_read_b128 a[176:179], v8 offset:4096
v_mfma_f32_16x16x32_bf16 v[184:187], a[212:215], v[76:79], v[184:187]
ds_read_b128 a[200:203], v1 offset:49152
v_cvt_pk_bf16_f32 v59, v30, v31
v_mfma_f32_16x16x32_bf16 v[188:191], a[192:195], v[32:35], v[188:191]
ds_read_b128 a[204:207], v2 offset:49152
v_add_f32 v24, v24, v30
v_mfma_f32_16x16x32_bf16 v[188:191], a[196:199], v[68:71], v[188:191]
ds_read_b128 a[208:211], v1 offset:50176
v_add_f32 v24, v24, v31
v_mfma_f32_16x16x32_bf16 v[192:195], a[192:195], v[36:39], v[192:195]
s_mov_b32 m0, s36
ds_read_b128 a[212:215], v2 offset:50176
v_cvt_pk_bf16_f32 v62, v20, v21
v_mfma_f32_16x16x32_bf16 v[192:195], a[196:199], v[72:75], v[192:195]
s_bitcmp1_b32 s3, 1
s_cselect_b32 s81, s49, s48
v_add_f32 v26, v26, v20
v_mfma_f32_16x16x32_bf16 v[196:199], a[192:195], v[40:43], v[196:199]
s_add_u32 s90, s81, s92
ds_read_b128 a[192:195], v1 offset:51200
v_add_f32 v26, v26, v21
v_mfma_f32_16x16x32_bf16 v[196:199], a[196:199], v[76:79], v[196:199]
s_waitcnt lgkmcnt(4)
ds_read_b128 a[196:199], v2 offset:51200
v_add_f32 v26, v26, v28
v_mfma_f32_16x16x32_bf16 v[92:95], a[200:203], a[0:3], 0
s_waitcnt lgkmcnt(4)
buffer_load_dwordx4 v7, s[16:19], s90 offen offset:0 nt lds
v_mfma_f32_16x16x32_bf16 v[92:95], a[204:207], a[12:15], v[92:95]
v_exp_f32 v29, v87
v_mfma_f32_16x16x32_bf16 v[96:99], a[200:203], a[4:7], 0
v_exp_f32 v30, v88
v_mfma_f32_16x16x32_bf16 v[96:99], a[204:207], a[16:19], v[96:99]
v_exp_f32 v31, v89
v_mfma_f32_16x16x32_bf16 v[100:103], a[200:203], a[8:11], 0
ds_read_b128 a[200:203], v1 offset:52224
v_cvt_pk_bf16_f32 v63, v28, v29
v_mfma_f32_16x16x32_bf16 v[100:103], a[204:207], a[20:23], v[100:103]
s_waitcnt lgkmcnt(1)
ds_read_b128 a[204:207], v2 offset:52224
v_add_f32 v26, v26, v29
v_mfma_f32_16x16x32_bf16 v[92:95], a[208:211], a[24:27], v[92:95]
s_add_u32 s91, s81, s93
v_exp_f32 v20, v90
v_mfma_f32_16x16x32_bf16 v[92:95], a[212:215], a[36:39], v[92:95]
buffer_load_dwordx4 v7, s[16:19], s91 offen offset:1024 nt lds
v_mfma_f32_16x16x32_bf16 v[96:99], a[208:211], a[28:31], v[96:99]
v_fma_f32 v91, v91, s24, v15
v_cvt_pk_bf16_f32 v66, v30, v31
v_mfma_f32_16x16x32_bf16 v[96:99], a[212:215], a[40:43], v[96:99]
v_exp_f32 v21, v91
v_mfma_f32_16x16x32_bf16 v[100:103], a[208:211], a[32:35], v[100:103]
ds_read_b128 a[208:211], v1 offset:57344
v_add_f32 v27, v27, v30
v_mfma_f32_16x16x32_bf16 v[100:103], a[212:215], a[44:47], v[100:103]
ds_read_b128 a[212:215], v2 offset:57344
v_add_f32 v27, v27, v31
v_mfma_f32_16x16x32_bf16 v[92:95], a[192:195], a[48:51], v[92:95]
v_cvt_pk_bf16_f32 v67, v20, v21
v_add_f32 v27, v27, v20
v_mfma_f32_16x16x32_bf16 v[92:95], a[196:199], a[60:63], v[92:95]
v_add_f32 v27, v27, v21
v_max3_f32 v25, v24, v26, v27
v_mfma_f32_16x16x32_bf16 v[96:99], a[192:195], a[52:55], v[96:99]
v_cmp_lt_f32 vcc, s25, v25
v_xor_b32 v8, 64, v8
v_mfma_f32_16x16x32_bf16 v[96:99], a[196:199], a[64:67], v[96:99]
ds_read_b128 a[188:191], v8 offset:4096
v_mfma_f32_16x16x32_bf16 v[100:103], a[192:195], a[56:59], v[100:103]
s_addk_i32 s90, 2048
ds_read_b128 a[192:195], v1 offset:58368
v_mfma_f32_16x16x32_bf16 v[100:103], a[196:199], a[68:71], v[100:103]
s_waitcnt lgkmcnt(2)
ds_read_b128 a[196:199], v2 offset:58368
v_mfma_f32_16x16x32_bf16 v[92:95], a[200:203], a[72:75], v[92:95]
buffer_load_dwordx4 v7, s[16:19], s90 offen offset:2048 nt lds
v_mfma_f32_16x16x32_bf16 v[92:95], a[204:207], a[84:87], v[92:95]
v_mfma_f32_16x16x32_bf16 v[96:99], a[200:203], a[76:79], v[96:99]
v_mfma_f32_16x16x32_bf16 v[96:99], a[204:207], a[88:91], v[96:99]
s_cbranch_vccnz STUB_6
BACK_6:
v_mfma_f32_16x16x32_bf16 v[100:103], a[200:203], a[80:83], v[100:103]
ds_read_b128 a[200:203], v1 offset:59392
v_add_f32 v19, v19, v27
v_mfma_f32_16x16x32_bf16 v[100:103], a[204:207], a[92:95], v[100:103]
ds_read_b128 a[204:207], v2 offset:59392
v_add_f32 v17, v17, v24
v_mfma_f32_16x16x32_bf16 v[80:83], a[208:211], a[0:3], 0
s_addk_i32 s91, 2048
v_add_f32 v18, v18, v26
v_fma_f32 v92, v92, s24, v11
v_mfma_f32_16x16x32_bf16 v[80:83], a[212:215], a[12:15], v[80:83]
buffer_load_dwordx4 v7, s[16:19], s91 offen offset:3072 nt lds
v_mfma_f32_16x16x32_bf16 v[84:87], a[208:211], a[4:7], 0
v_exp_f32 v28, v92
v_mfma_f32_16x16x32_bf16 v[84:87], a[212:215], a[16:19], v[84:87]
v_fma_f32 v93, v93, s24, v11
v_fma_f32 v94, v94, s24, v11
v_mfma_f32_16x16x32_bf16 v[88:91], a[208:211], a[8:11], 0
ds_read_b128 a[208:211], v1 offset:60416
v_fma_f32 v95, v95, s24, v11
v_mfma_f32_16x16x32_bf16 v[88:91], a[212:215], a[20:23], v[88:91]
s_waitcnt lgkmcnt(1)
ds_read_b128 a[212:215], v2 offset:60416
v_fma_f32 v96, v96, s24, v13
v_mfma_f32_16x16x32_bf16 v[80:83], a[192:195], a[24:27], v[80:83]
v_exp_f32 v29, v93
v_mfma_f32_16x16x32_bf16 v[80:83], a[196:199], a[36:39], v[80:83]
s_add_u32 m0, s4, 0
v_exp_f32 v30, v94
v_mfma_f32_16x16x32_bf16 v[84:87], a[192:195], a[28:31], v[84:87]
s_add_u32 s88, s29, s85
v_exp_f32 v31, v95
v_mfma_f32_16x16x32_bf16 v[84:87], a[196:199], a[40:43], v[84:87]
buffer_load_dwordx4 v7, s[8:11], s88 offen offset:0 nt lds
v_mfma_f32_16x16x32_bf16 v[88:91], a[192:195], a[32:35], v[88:91]
ds_read_b64_tr_b16 a[192:193], v3 offset:16384
v_cvt_pk_bf16_f32 v44, v28, v29
v_mfma_f32_16x16x32_bf16 v[88:91], a[196:199], a[44:47], v[88:91]
ds_read_b64_tr_b16 a[194:195], v3 offset:20480
v_add_f32 v24, v28, v29
v_mfma_f32_16x16x32_bf16 v[80:83], a[200:203], a[48:51], v[80:83]
v_exp_f32 v20, v96
v_mfma_f32_16x16x32_bf16 v[80:83], a[204:207], a[60:63], v[80:83]
ds_read_b64_tr_b16 a[196:197], v3 offset:24576
v_cvt_pk_bf16_f32 v45, v30, v31
v_mfma_f32_16x16x32_bf16 v[84:87], a[200:203], a[52:55], v[84:87]
ds_read_b64_tr_b16 a[198:199], v3 offset:28672
v_add_f32 v24, v24, v30
v_mfma_f32_16x16x32_bf16 v[84:87], a[204:207], a[64:67], v[84:87]
v_add_f32 v24, v24, v31
v_fma_f32 v97, v97, s24, v13
v_mfma_f32_16x16x32_bf16 v[88:91], a[200:203], a[56:59], v[88:91]
s_addk_i32 s88, 3072
ds_read_b64_tr_b16 a[200:201], v4 offset:16384
v_fma_f32 v98, v98, s24, v13
v_mfma_f32_16x16x32_bf16 v[88:91], a[204:207], a[68:71], v[88:91]
s_waitcnt lgkmcnt(3)
ds_read_b64_tr_b16 a[202:203], v4 offset:20480
v_fma_f32 v99, v99, s24, v13
v_mfma_f32_16x16x32_bf16 v[80:83], a[208:211], a[72:75], v[80:83]
buffer_load_dwordx4 v7, s[8:11], s88 offen offset:1024 nt lds
v_mfma_f32_16x16x32_bf16 v[80:83], a[212:215], a[84:87], v[80:83]
ds_read_b64_tr_b16 a[204:205], v4 offset:24576
v_fma_f32 v100, v100, s24, v15
v_mfma_f32_16x16x32_bf16 v[84:87], a[208:211], a[76:79], v[84:87]
ds_read_b64_tr_b16 a[206:207], v4 offset:28672
v_fma_f32 v101, v101, s24, v15
v_mfma_f32_16x16x32_bf16 v[84:87], a[212:215], a[88:91], v[84:87]
v_exp_f32 v21, v97
v_mfma_f32_16x16x32_bf16 v[88:91], a[208:211], a[80:83], v[88:91]
ds_read_b64_tr_b16 a[208:209], v5 offset:16384
v_cvt_pk_bf16_f32 v48, v20, v21
v_mfma_f32_16x16x32_bf16 v[88:91], a[212:215], a[92:95], v[88:91]
ds_read_b64_tr_b16 a[210:211], v5 offset:20480
v_add_f32 v26, v20, v21
v_mfma_f32_16x16x32_bf16 v[200:203], a[192:195], v[32:35], v[200:203]
s_waitcnt lgkmcnt(4)
v_exp_f32 v28, v98
v_mfma_f32_16x16x32_bf16 v[200:203], a[196:199], v[68:71], v[200:203]
s_mov_b32 m0, s34
ds_read_b64_tr_b16 a[212:213], v5 offset:24576
v_add_f32 v26, v26, v28
v_mfma_f32_16x16x32_bf16 v[204:207], a[192:195], v[36:39], v[204:207]
s_add_u32 s90, s50, s92
ds_read_b64_tr_b16 a[214:215], v5 offset:28672
v_fma_f32 v102, v102, s24, v15
v_mfma_f32_16x16x32_bf16 v[204:207], a[196:199], v[72:75], v[204:207]
buffer_load_dwordx4 v7, s[12:15], s90 offen offset:0 nt lds
v_mfma_f32_16x16x32_bf16 v[208:211], a[192:195], v[40:43], v[208:211]
ds_read_b64_tr_b16 a[192:193], v6 offset:16384
v_fma_f32 v103, v103, s24, v15
v_mfma_f32_16x16x32_bf16 v[208:211], a[196:199], v[76:79], v[208:211]
ds_read_b64_tr_b16 a[194:195], v6 offset:20480
v_fma_f32 v80, v80, s24, v11
v_mfma_f32_16x16x32_bf16 v[212:215], a[200:203], v[32:35], v[212:215]
s_waitcnt lgkmcnt(4)
v_exp_f32 v29, v99
v_mfma_f32_16x16x32_bf16 v[212:215], a[204:207], v[68:71], v[212:215]
ds_read_b64_tr_b16 a[196:197], v6 offset:24576
v_cvt_pk_bf16_f32 v49, v28, v29
v_mfma_f32_16x16x32_bf16 v[216:219], a[200:203], v[36:39], v[216:219]
ds_read_b64_tr_b16 a[198:199], v6 offset:28672
v_add_f32 v26, v26, v29
v_mfma_f32_16x16x32_bf16 v[216:219], a[204:207], v[72:75], v[216:219]
v_exp_f32 v30, v100
v_mfma_f32_16x16x32_bf16 v[220:223], a[200:203], v[40:43], v[220:223]
ds_read_b64_tr_b16 a[200:201], v3 offset:17408
v_fma_f32 v81, v81, s24, v11
v_mfma_f32_16x16x32_bf16 v[220:223], a[204:207], v[76:79], v[220:223]
s_add_u32 s90, s50, s93
ds_read_b64_tr_b16 a[202:203], v3 offset:21504
v_fma_f32 v82, v82, s24, v11
v_mfma_f32_16x16x32_bf16 a[216:219], a[208:211], v[32:35], a[216:219]
s_waitcnt lgkmcnt(4)
buffer_load_dwordx4 v7, s[12:15], s90 offen offset:1024 nt lds
v_mfma_f32_16x16x32_bf16 a[216:219], a[212:215], v[68:71], a[216:219]
ds_read_b64_tr_b16 a[204:205], v3 offset:25600
v_fma_f32 v83, v83, s24, v11
v_mfma_f32_16x16x32_bf16 a[220:223], a[208:211], v[36:39], a[220:223]
ds_read_b64_tr_b16 a[206:207], v3 offset:29696
v_fma_f32 v84, v84, s24, v13
v_mfma_f32_16x16x32_bf16 a[220:223], a[212:215], v[72:75], a[220:223]
v_exp_f32 v31, v101
v_mfma_f32_16x16x32_bf16 a[224:227], a[208:211], v[40:43], a[224:227]
ds_read_b64_tr_b16 a[208:209], v4 offset:17408
v_cvt_pk_bf16_f32 v52, v30, v31
v_mfma_f32_16x16x32_bf16 a[224:227], a[212:215], v[76:79], a[224:227]
ds_read_b64_tr_b16 a[210:211], v4 offset:21504
v_add_f32 v27, v30, v31
v_mfma_f32_16x16x32_bf16 a[228:231], a[192:195], v[32:35], a[228:231]
s_waitcnt lgkmcnt(4)
v_exp_f32 v20, v102
v_mfma_f32_16x16x32_bf16 a[228:231], a[196:199], v[68:71], a[228:231]
ds_read_b64_tr_b16 a[212:213], v4 offset:25600
v_add_f32 v27, v27, v20
v_mfma_f32_16x16x32_bf16 a[232:235], a[192:195], v[36:39], a[232:235]
s_add_u32 s90, s50, s94
PADJ_3:
s_cbranch_execz PADJ_7
ds_read_b64_tr_b16 a[214:215], v4 offset:29696
v_mfma_f32_16x16x32_bf16 a[232:235], a[196:199], v[72:75], a[232:235]
buffer_load_dwordx4 v7, s[12:15], s90 offen offset:2048 nt lds
v_mfma_f32_16x16x32_bf16 a[236:239], a[192:195], v[40:43], a[236:239]
ds_read_b64_tr_b16 a[192:193], v5 offset:17408
v_fma_f32 v85, v85, s24, v13
v_mfma_f32_16x16x32_bf16 a[236:239], a[196:199], v[76:79], a[236:239]
ds_read_b64_tr_b16 a[194:195], v5 offset:21504
v_fma_f32 v86, v86, s24, v13
v_mfma_f32_16x16x32_bf16 a[240:243], a[200:203], v[32:35], a[240:243]
s_waitcnt lgkmcnt(4)
v_exp_f32 v21, v103
v_mfma_f32_16x16x32_bf16 a[240:243], a[204:207], v[68:71], a[240:243]
ds_read_b64_tr_b16 a[196:197], v5 offset:25600
v_cvt_pk_bf16_f32 v53, v20, v21
v_mfma_f32_16x16x32_bf16 a[244:247], a[200:203], v[36:39], a[244:247]
ds_read_b64_tr_b16 a[198:199], v5 offset:29696
v_add_f32 v27, v27, v21
v_mfma_f32_16x16x32_bf16 a[244:247], a[204:207], v[72:75], a[244:247]
v_exp_f32 v28, v80
v_mfma_f32_16x16x32_bf16 a[248:251], a[200:203], v[40:43], a[248:251]
ds_read_b64_tr_b16 a[200:201], v6 offset:17408
v_add_f32 v24, v24, v28
v_mfma_f32_16x16x32_bf16 a[248:251], a[204:207], v[76:79], a[248:251]
s_add_u32 s90, s50, s95
ds_read_b64_tr_b16 a[202:203], v6 offset:21504
v_fma_f32 v87, v87, s24, v13
v_mfma_f32_16x16x32_bf16 a[252:255], a[208:211], v[32:35], a[252:255]
s_waitcnt lgkmcnt(4)
buffer_load_dwordx4 v7, s[12:15], s90 offen offset:3072 nt lds
v_mfma_f32_16x16x32_bf16 a[252:255], a[212:215], v[68:71], a[252:255]
ds_read_b64_tr_b16 a[204:205], v6 offset:25600
v_fma_f32 v88, v88, s24, v15
v_mfma_f32_16x16x32_bf16 v[224:227], a[208:211], v[36:39], v[224:227]
ds_read_b64_tr_b16 a[206:207], v6 offset:29696
v_fma_f32 v89, v89, s24, v15
v_mfma_f32_16x16x32_bf16 v[224:227], a[212:215], v[72:75], v[224:227]
v_exp_f32 v29, v81
v_mfma_f32_16x16x32_bf16 v[228:231], a[208:211], v[40:43], v[228:231]
v_exp_f32 v30, v82
v_mfma_f32_16x16x32_bf16 v[228:231], a[212:215], v[76:79], v[228:231]
v_exp_f32 v31, v83
v_mfma_f32_16x16x32_bf16 v[232:235], a[192:195], v[32:35], v[232:235]
s_waitcnt lgkmcnt(2)
v_exp_f32 v20, v84
v_mfma_f32_16x16x32_bf16 v[232:235], a[196:199], v[68:71], v[232:235]
v_exp_f32 v21, v85
v_mfma_f32_16x16x32_bf16 v[236:239], a[192:195], v[36:39], v[236:239]
v_cvt_pk_bf16_f32 v46, v28, v29
v_add_f32 v24, v24, v29
v_mfma_f32_16x16x32_bf16 v[236:239], a[196:199], v[72:75], v[236:239]
s_waitcnt vmcnt(14) lgkmcnt(0)
v_exp_f32 v28, v86
v_mfma_f32_16x16x32_bf16 v[240:243], a[192:195], v[40:43], v[240:243]
s_barrier
ds_read_b128 a[108:111], v8 offset:6144
v_mfma_f32_16x16x32_bf16 v[240:243], a[196:199], v[76:79], v[240:243]
ds_read_b128 a[208:211], v1 offset:0
v_cvt_pk_bf16_f32 v47, v30, v31
v_mfma_f32_16x16x32_bf16 v[244:247], a[200:203], v[32:35], v[244:247]
ds_read_b128 a[212:215], v2 offset:0
v_add_f32 v24, v24, v30
v_mfma_f32_16x16x32_bf16 v[244:247], a[204:207], v[68:71], v[244:247]
ds_read_b128 a[192:195], v1 offset:1024
v_add_f32 v24, v24, v31
v_mfma_f32_16x16x32_bf16 v[248:251], a[200:203], v[36:39], v[248:251]
s_mov_b32 m0, s37
ds_read_b128 a[196:199], v2 offset:1024
v_cvt_pk_bf16_f32 v50, v20, v21
v_mfma_f32_16x16x32_bf16 v[248:251], a[204:207], v[72:75], v[248:251]
s_addk_i32 s81, 2048
v_exp_f32 v29, v87
v_mfma_f32_16x16x32_bf16 v[252:255], a[200:203], v[40:43], v[252:255]
s_add_u32 s90, s81, s94
ds_read_b128 a[200:203], v1 offset:2048
v_add_f32 v26, v26, v20
v_mfma_f32_16x16x32_bf16 v[252:255], a[204:207], v[76:79], v[252:255]
s_waitcnt lgkmcnt(4)
ds_read_b128 a[204:207], v2 offset:2048
v_add_f32 v26, v26, v21
v_mfma_f32_16x16x32_bf16 v[32:35], a[208:211], a[0:3], 0
s_waitcnt lgkmcnt(4)
buffer_load_dwordx4 v7, s[16:19], s90 offen offset:0 nt lds
v_mfma_f32_16x16x32_bf16 v[32:35], a[212:215], a[12:15], v[32:35]
v_exp_f32 v30, v88
v_mfma_f32_16x16x32_bf16 v[36:39], a[208:211], a[4:7], 0
v_exp_f32 v31, v89
v_mfma_f32_16x16x32_bf16 v[36:39], a[212:215], a[16:19], v[36:39]
v_cvt_pk_bf16_f32 v51, v28, v29
v_add_f32 v26, v26, v28
v_mfma_f32_16x16x32_bf16 v[40:43], a[208:211], a[8:11], 0
ds_read_b128 a[208:211], v1 offset:3072
v_add_f32 v26, v26, v29
v_mfma_f32_16x16x32_bf16 v[40:43], a[212:215], a[20:23], v[40:43]
s_waitcnt lgkmcnt(1)
ds_read_b128 a[212:215], v2 offset:3072
v_fma_f32 v90, v90, s24, v15
v_mfma_f32_16x16x32_bf16 v[32:35], a[192:195], a[24:27], v[32:35]
s_add_u32 s91, s81, s95
v_exp_f32 v20, v90
v_mfma_f32_16x16x32_bf16 v[32:35], a[196:199], a[36:39], v[32:35]
buffer_load_dwordx4 v7, s[16:19], s91 offen offset:1024 nt lds
v_mfma_f32_16x16x32_bf16 v[36:39], a[192:195], a[28:31], v[36:39]
v_fma_f32 v91, v91, s24, v15
v_cvt_pk_bf16_f32 v54, v30, v31
v_mfma_f32_16x16x32_bf16 v[36:39], a[196:199], a[40:43], v[36:39]
v_exp_f32 v21, v91
v_mfma_f32_16x16x32_bf16 v[40:43], a[192:195], a[32:35], v[40:43]
ds_read_b128 a[192:195], v1 offset:8192
v_add_f32 v27, v27, v30
v_mfma_f32_16x16x32_bf16 v[40:43], a[196:199], a[44:47], v[40:43]
ds_read_b128 a[196:199], v2 offset:8192
v_add_f32 v27, v27, v31
v_mfma_f32_16x16x32_bf16 v[32:35], a[200:203], a[48:51], v[32:35]
v_cvt_pk_bf16_f32 v55, v20, v21
v_add_f32 v27, v27, v20
v_mfma_f32_16x16x32_bf16 v[32:35], a[204:207], a[60:63], v[32:35]
v_add_f32 v27, v27, v21
v_max3_f32 v25, v24, v26, v27
v_mfma_f32_16x16x32_bf16 v[36:39], a[200:203], a[52:55], v[36:39]
v_cmp_lt_f32 vcc, s25, v25
v_xor_b32 v8, 64, v8
v_mfma_f32_16x16x32_bf16 v[36:39], a[204:207], a[64:67], v[36:39]
ds_read_b128 a[96:99], v8 offset:6144
v_mfma_f32_16x16x32_bf16 v[40:43], a[200:203], a[56:59], v[40:43]
s_addk_i32 s90, 2048
ds_read_b128 a[200:203], v1 offset:9216
v_mfma_f32_16x16x32_bf16 v[40:43], a[204:207], a[68:71], v[40:43]
s_waitcnt lgkmcnt(2)
ds_read_b128 a[204:207], v2 offset:9216
v_mfma_f32_16x16x32_bf16 v[32:35], a[208:211], a[72:75], v[32:35]
buffer_load_dwordx4 v7, s[16:19], s90 offen offset:2048 nt lds
v_mfma_f32_16x16x32_bf16 v[32:35], a[212:215], a[84:87], v[32:35]
v_mfma_f32_16x16x32_bf16 v[36:39], a[208:211], a[76:79], v[36:39]
v_mfma_f32_16x16x32_bf16 v[36:39], a[212:215], a[88:91], v[36:39]
s_cbranch_vccnz STUB_7
BACK_7:
v_mfma_f32_16x16x32_bf16 v[40:43], a[208:211], a[80:83], v[40:43]
ds_read_b128 a[208:211], v1 offset:10240
v_add_f32 v19, v19, v27
v_mfma_f32_16x16x32_bf16 v[40:43], a[212:215], a[92:95], v[40:43]
ds_read_b128 a[212:215], v2 offset:10240
v_add_f32 v17, v17, v24
v_mfma_f32_16x16x32_bf16 v[80:83], a[192:195], a[0:3], 0
s_addk_i32 s91, 2048
v_add_f32 v18, v18, v26
v_fma_f32 v32, v32, s24, v11
v_mfma_f32_16x16x32_bf16 v[80:83], a[196:199], a[12:15], v[80:83]
buffer_load_dwordx4 v7, s[16:19], s91 offen offset:3072 nt lds
v_mfma_f32_16x16x32_bf16 v[84:87], a[192:195], a[4:7], 0
v_exp_f32 v28, v32
v_mfma_f32_16x16x32_bf16 v[84:87], a[196:199], a[16:19], v[84:87]
v_fma_f32 v33, v33, s24, v11
v_fma_f32 v34, v34, s24, v11
v_mfma_f32_16x16x32_bf16 v[88:91], a[192:195], a[8:11], 0
ds_read_b128 a[192:195], v1 offset:11264
v_fma_f32 v35, v35, s24, v11
v_mfma_f32_16x16x32_bf16 v[88:91], a[196:199], a[20:23], v[88:91]
s_waitcnt lgkmcnt(1)
ds_read_b128 a[196:199], v2 offset:11264
v_fma_f32 v36, v36, s24, v13
v_mfma_f32_16x16x32_bf16 v[80:83], a[200:203], a[24:27], v[80:83]
v_exp_f32 v29, v33
v_mfma_f32_16x16x32_bf16 v[80:83], a[204:207], a[36:39], v[80:83]
s_add_u32 m0, s4, 2048
v_exp_f32 v30, v34
v_mfma_f32_16x16x32_bf16 v[84:87], a[200:203], a[28:31], v[84:87]
s_add_u32 s88, s29, s86
v_exp_f32 v31, v35
v_mfma_f32_16x16x32_bf16 v[84:87], a[204:207], a[40:43], v[84:87]
buffer_load_dwordx4 v7, s[8:11], s88 offen offset:0 nt lds
v_mfma_f32_16x16x32_bf16 v[88:91], a[200:203], a[32:35], v[88:91]
ds_read_b64_tr_b16 a[200:201], v3 offset:32768
v_cvt_pk_bf16_f32 v68, v28, v29
v_mfma_f32_16x16x32_bf16 v[88:91], a[204:207], a[44:47], v[88:91]
ds_read_b64_tr_b16 a[202:203], v3 offset:36864
v_add_f32 v24, v28, v29
v_mfma_f32_16x16x32_bf16 v[80:83], a[208:211], a[48:51], v[80:83]
v_exp_f32 v20, v36
v_mfma_f32_16x16x32_bf16 v[80:83], a[212:215], a[60:63], v[80:83]
ds_read_b64_tr_b16 a[204:205], v3 offset:40960
v_cvt_pk_bf16_f32 v69, v30, v31
v_mfma_f32_16x16x32_bf16 v[84:87], a[208:211], a[52:55], v[84:87]
ds_read_b64_tr_b16 a[206:207], v3 offset:45056
v_add_f32 v24, v24, v30
v_mfma_f32_16x16x32_bf16 v[84:87], a[212:215], a[64:67], v[84:87]
v_add_f32 v24, v24, v31
v_fma_f32 v37, v37, s24, v13
v_mfma_f32_16x16x32_bf16 v[88:91], a[208:211], a[56:59], v[88:91]
s_addk_i32 s88, 3072
ds_read_b64_tr_b16 a[208:209], v4 offset:32768
v_fma_f32 v38, v38, s24, v13
v_mfma_f32_16x16x32_bf16 v[88:91], a[212:215], a[68:71], v[88:91]
s_waitcnt lgkmcnt(3)
ds_read_b64_tr_b16 a[210:211], v4 offset:36864
v_fma_f32 v39, v39, s24, v13
v_mfma_f32_16x16x32_bf16 v[80:83], a[192:195], a[72:75], v[80:83]
buffer_load_dwordx4 v7, s[8:11], s88 offen offset:1024 nt lds
v_mfma_f32_16x16x32_bf16 v[80:83], a[196:199], a[84:87], v[80:83]
ds_read_b64_tr_b16 a[212:213], v4 offset:40960
v_fma_f32 v40, v40, s24, v15
v_mfma_f32_16x16x32_bf16 v[84:87], a[192:195], a[76:79], v[84:87]
ds_read_b64_tr_b16 a[214:215], v4 offset:45056
v_fma_f32 v41, v41, s24, v15
v_mfma_f32_16x16x32_bf16 v[84:87], a[196:199], a[88:91], v[84:87]
v_exp_f32 v21, v37
v_mfma_f32_16x16x32_bf16 v[88:91], a[192:195], a[80:83], v[88:91]
ds_read_b64_tr_b16 a[192:193], v5 offset:32768
v_cvt_pk_bf16_f32 v72, v20, v21
v_mfma_f32_16x16x32_bf16 v[88:91], a[196:199], a[92:95], v[88:91]
ds_read_b64_tr_b16 a[194:195], v5 offset:36864
v_add_f32 v26, v20, v21
v_mfma_f32_16x16x32_bf16 v[104:107], a[200:203], v[56:59], v[104:107]
s_waitcnt lgkmcnt(4)
v_exp_f32 v28, v38
v_mfma_f32_16x16x32_bf16 v[104:107], a[204:207], v[44:47], v[104:107]
s_mov_b32 m0, s35
ds_read_b64_tr_b16 a[196:197], v5 offset:40960
v_add_f32 v26, v26, v28
v_mfma_f32_16x16x32_bf16 v[108:111], a[200:203], v[60:63], v[108:111]
s_add_u32 s90, s51, s92
ds_read_b64_tr_b16 a[198:199], v5 offset:45056
v_fma_f32 v42, v42, s24, v15
v_mfma_f32_16x16x32_bf16 v[108:111], a[204:207], v[48:51], v[108:111]
buffer_load_dwordx4 v7, s[12:15], s90 offen offset:0 nt lds
v_mfma_f32_16x16x32_bf16 v[112:115], a[200:203], v[64:67], v[112:115]
ds_read_b64_tr_b16 a[200:201], v6 offset:32768
v_fma_f32 v43, v43, s24, v15
v_mfma_f32_16x16x32_bf16 v[112:115], a[204:207], v[52:55], v[112:115]
ds_read_b64_tr_b16 a[202:203], v6 offset:36864
v_fma_f32 v80, v80, s24, v11
v_mfma_f32_16x16x32_bf16 v[116:119], a[208:211], v[56:59], v[116:119]
s_waitcnt lgkmcnt(4)
v_exp_f32 v29, v39
v_mfma_f32_16x16x32_bf16 v[116:119], a[212:215], v[44:47], v[116:119]
ds_read_b64_tr_b16 a[204:205], v6 offset:40960
v_cvt_pk_bf16_f32 v73, v28, v29
v_mfma_f32_16x16x32_bf16 v[120:123], a[208:211], v[60:63], v[120:123]
ds_read_b64_tr_b16 a[206:207], v6 offset:45056
v_add_f32 v26, v26, v29
v_mfma_f32_16x16x32_bf16 v[120:123], a[212:215], v[48:51], v[120:123]
v_exp_f32 v30, v40
v_mfma_f32_16x16x32_bf16 v[124:127], a[208:211], v[64:67], v[124:127]
ds_read_b64_tr_b16 a[208:209], v3 offset:33792
v_fma_f32 v81, v81, s24, v11
v_mfma_f32_16x16x32_bf16 v[124:127], a[212:215], v[52:55], v[124:127]
s_add_u32 s90, s51, s93
ds_read_b64_tr_b16 a[210:211], v3 offset:37888
v_fma_f32 v82, v82, s24, v11
v_mfma_f32_16x16x32_bf16 v[128:131], a[192:195], v[56:59], v[128:131]
s_waitcnt lgkmcnt(4)
buffer_load_dwordx4 v7, s[12:15], s90 offen offset:1024 nt lds
v_mfma_f32_16x16x32_bf16 v[128:131], a[196:199], v[44:47], v[128:131]
ds_read_b64_tr_b16 a[212:213], v3 offset:41984
v_fma_f32 v83, v83, s24, v11
v_mfma_f32_16x16x32_bf16 v[132:135], a[192:195], v[60:63], v[132:135]
ds_read_b64_tr_b16 a[214:215], v3 offset:46080
v_fma_f32 v84, v84, s24, v13
v_mfma_f32_16x16x32_bf16 v[132:135], a[196:199], v[48:51], v[132:135]
v_exp_f32 v31, v41
v_mfma_f32_16x16x32_bf16 v[136:139], a[192:195], v[64:67], v[136:139]
ds_read_b64_tr_b16 a[192:193], v4 offset:33792
v_cvt_pk_bf16_f32 v76, v30, v31
v_mfma_f32_16x16x32_bf16 v[136:139], a[196:199], v[52:55], v[136:139]
ds_read_b64_tr_b16 a[194:195], v4 offset:37888
v_add_f32 v27, v30, v31
v_mfma_f32_16x16x32_bf16 v[140:143], a[200:203], v[56:59], v[140:143]
s_waitcnt lgkmcnt(4)
v_exp_f32 v20, v42
v_mfma_f32_16x16x32_bf16 v[140:143], a[204:207], v[44:47], v[140:143]
ds_read_b64_tr_b16 a[196:197], v4 offset:41984
v_add_f32 v27, v27, v20
v_mfma_f32_16x16x32_bf16 v[144:147], a[200:203], v[60:63], v[144:147]
s_add_u32 s90, s51, s94
ds_read_b64_tr_b16 a[198:199], v4 offset:46080
v_fma_f32 v85, v85, s24, v13
v_mfma_f32_16x16x32_bf16 v[144:147], a[204:207], v[48:51], v[144:147]
buffer_load_dwordx4 v7, s[12:15], s90 offen offset:2048 nt lds
v_mfma_f32_16x16x32_bf16 v[148:151], a[200:203], v[64:67], v[148:151]
ds_read_b64_tr_b16 a[200:201], v5 offset:33792
v_fma_f32 v86, v86, s24, v13
v_mfma_f32_16x16x32_bf16 v[148:151], a[204:207], v[52:55], v[148:151]
ds_read_b64_tr_b16 a[202:203], v5 offset:37888
v_fma_f32 v87, v87, s24, v13
v_mfma_f32_16x16x32_bf16 v[152:155], a[208:211], v[56:59], v[152:155]
s_waitcnt lgkmcnt(4)
v_exp_f32 v21, v43
v_mfma_f32_16x16x32_bf16 v[152:155], a[212:215], v[44:47], v[152:155]
ds_read_b64_tr_b16 a[204:205], v5 offset:41984
v_cvt_pk_bf16_f32 v77, v20, v21
v_mfma_f32_16x16x32_bf16 v[156:159], a[208:211], v[60:63], v[156:159]
ds_read_b64_tr_b16 a[206:207], v5 offset:46080
v_add_f32 v27, v27, v21
v_mfma_f32_16x16x32_bf16 v[156:159], a[212:215], v[48:51], v[156:159]
v_exp_f32 v28, v80
v_mfma_f32_16x16x32_bf16 v[160:163], a[208:211], v[64:67], v[160:163]
ds_read_b64_tr_b16 a[208:209], v6 offset:33792
v_add_f32 v24, v24, v28
v_mfma_f32_16x16x32_bf16 v[160:163], a[212:215], v[52:55], v[160:163]
s_add_u32 s90, s51, s95
ds_read_b64_tr_b16 a[210:211], v6 offset:37888
v_fma_f32 v88, v88, s24, v15
v_mfma_f32_16x16x32_bf16 v[164:167], a[192:195], v[56:59], v[164:167]
s_waitcnt lgkmcnt(4)
buffer_load_dwordx4 v7, s[12:15], s90 offen offset:3072 nt lds
v_mfma_f32_16x16x32_bf16 v[164:167], a[196:199], v[44:47], v[164:167]
ds_read_b64_tr_b16 a[212:213], v6 offset:41984
v_fma_f32 v89, v89, s24, v15
v_mfma_f32_16x16x32_bf16 v[168:171], a[192:195], v[60:63], v[168:171]
ds_read_b64_tr_b16 a[214:215], v6 offset:46080
v_fma_f32 v90, v90, s24, v15
v_mfma_f32_16x16x32_bf16 v[168:171], a[196:199], v[48:51], v[168:171]
v_exp_f32 v29, v81
v_mfma_f32_16x16x32_bf16 v[172:175], a[192:195], v[64:67], v[172:175]
v_exp_f32 v30, v82
v_mfma_f32_16x16x32_bf16 v[172:175], a[196:199], v[52:55], v[172:175]
v_exp_f32 v31, v83
v_mfma_f32_16x16x32_bf16 v[176:179], a[200:203], v[56:59], v[176:179]
s_waitcnt lgkmcnt(2)
v_exp_f32 v20, v84
v_mfma_f32_16x16x32_bf16 v[176:179], a[204:207], v[44:47], v[176:179]
v_exp_f32 v21, v85
v_mfma_f32_16x16x32_bf16 v[180:183], a[200:203], v[60:63], v[180:183]
v_cvt_pk_bf16_f32 v70, v28, v29
v_add_f32 v24, v24, v29
v_mfma_f32_16x16x32_bf16 v[180:183], a[204:207], v[48:51], v[180:183]
s_waitcnt vmcnt(14) lgkmcnt(0)
v_exp_f32 v28, v86
v_mfma_f32_16x16x32_bf16 v[184:187], a[200:203], v[64:67], v[184:187]
s_barrier
ds_read_b128 a[120:123], v8 offset:0
v_mfma_f32_16x16x32_bf16 v[184:187], a[204:207], v[52:55], v[184:187]
ds_read_b128 a[192:195], v1 offset:16384
v_cvt_pk_bf16_f32 v71, v30, v31
v_mfma_f32_16x16x32_bf16 v[188:191], a[208:211], v[56:59], v[188:191]
ds_read_b128 a[196:199], v2 offset:16384
v_add_f32 v24, v24, v30
v_mfma_f32_16x16x32_bf16 v[188:191], a[212:215], v[44:47], v[188:191]
ds_read_b128 a[200:203], v1 offset:17408
v_add_f32 v24, v24, v31
v_mfma_f32_16x16x32_bf16 v[192:195], a[208:211], v[60:63], v[192:195]
s_mov_b32 m0, s38
ds_read_b128 a[204:207], v2 offset:17408
v_cvt_pk_bf16_f32 v74, v20, v21
v_mfma_f32_16x16x32_bf16 v[192:195], a[212:215], v[48:51], v[192:195]
s_bitcmp1_b32 s3, 1
s_cselect_b32 s81, s51, s50
v_add_f32 v26, v26, v20
v_mfma_f32_16x16x32_bf16 v[196:199], a[208:211], v[64:67], v[196:199]
s_add_u32 s90, s81, s92
ds_read_b128 a[208:211], v1 offset:18432
v_add_f32 v26, v26, v21
v_mfma_f32_16x16x32_bf16 v[196:199], a[212:215], v[52:55], v[196:199]
s_waitcnt lgkmcnt(4)
ds_read_b128 a[212:215], v2 offset:18432
v_add_f32 v26, v26, v28
v_mfma_f32_16x16x32_bf16 v[92:95], a[192:195], a[0:3], 0
s_waitcnt lgkmcnt(4)
buffer_load_dwordx4 v7, s[16:19], s90 offen offset:0 nt lds
v_mfma_f32_16x16x32_bf16 v[92:95], a[196:199], a[12:15], v[92:95]
v_exp_f32 v29, v87
v_mfma_f32_16x16x32_bf16 v[96:99], a[192:195], a[4:7], 0
v_exp_f32 v30, v88
v_mfma_f32_16x16x32_bf16 v[96:99], a[196:199], a[16:19], v[96:99]
v_exp_f32 v31, v89
v_mfma_f32_16x16x32_bf16 v[100:103], a[192:195], a[8:11], 0
ds_read_b128 a[192:195], v1 offset:19456
v_cvt_pk_bf16_f32 v75, v28, v29
v_mfma_f32_16x16x32_bf16 v[100:103], a[196:199], a[20:23], v[100:103]
s_waitcnt lgkmcnt(1)
ds_read_b128 a[196:199], v2 offset:19456
v_add_f32 v26, v26, v29
v_mfma_f32_16x16x32_bf16 v[92:95], a[200:203], a[24:27], v[92:95]
s_add_u32 s91, s81, s93
v_exp_f32 v20, v90
v_mfma_f32_16x16x32_bf16 v[92:95], a[204:207], a[36:39], v[92:95]
buffer_load_dwordx4 v7, s[16:19], s91 offen offset:1024 nt lds
v_mfma_f32_16x16x32_bf16 v[96:99], a[200:203], a[28:31], v[96:99]
v_fma_f32 v91, v91, s24, v15
v_cvt_pk_bf16_f32 v78, v30, v31
v_mfma_f32_16x16x32_bf16 v[96:99], a[204:207], a[40:43], v[96:99]
v_exp_f32 v21, v91
v_mfma_f32_16x16x32_bf16 v[100:103], a[200:203], a[32:35], v[100:103]
ds_read_b128 a[200:203], v1 offset:24576
v_add_f32 v27, v27, v30
v_mfma_f32_16x16x32_bf16 v[100:103], a[204:207], a[44:47], v[100:103]
ds_read_b128 a[204:207], v2 offset:24576
v_add_f32 v27, v27, v31
v_mfma_f32_16x16x32_bf16 v[92:95], a[208:211], a[48:51], v[92:95]
v_cvt_pk_bf16_f32 v79, v20, v21
v_add_f32 v27, v27, v20
v_mfma_f32_16x16x32_bf16 v[92:95], a[212:215], a[60:63], v[92:95]
v_add_f32 v27, v27, v21
v_max3_f32 v25, v24, v26, v27
v_mfma_f32_16x16x32_bf16 v[96:99], a[208:211], a[52:55], v[96:99]
v_cmp_lt_f32 vcc, s25, v25
v_xor_b32 v8, 64, v8
v_mfma_f32_16x16x32_bf16 v[96:99], a[212:215], a[64:67], v[96:99]
ds_read_b128 a[132:135], v8 offset:0
v_mfma_f32_16x16x32_bf16 v[100:103], a[208:211], a[56:59], v[100:103]
s_addk_i32 s90, 2048
ds_read_b128 a[208:211], v1 offset:25600
v_mfma_f32_16x16x32_bf16 v[100:103], a[212:215], a[68:71], v[100:103]
s_waitcnt lgkmcnt(2)
ds_read_b128 a[212:215], v2 offset:25600
v_mfma_f32_16x16x32_bf16 v[92:95], a[192:195], a[72:75], v[92:95]
buffer_load_dwordx4 v7, s[16:19], s90 offen offset:2048 nt lds
v_mfma_f32_16x16x32_bf16 v[92:95], a[196:199], a[84:87], v[92:95]
v_mfma_f32_16x16x32_bf16 v[96:99], a[192:195], a[76:79], v[96:99]
v_mfma_f32_16x16x32_bf16 v[96:99], a[196:199], a[88:91], v[96:99]
s_cbranch_vccnz STUB_8
BACK_8:
v_mfma_f32_16x16x32_bf16 v[100:103], a[192:195], a[80:83], v[100:103]
ds_read_b128 a[192:195], v1 offset:26624
v_add_f32 v19, v19, v27
v_mfma_f32_16x16x32_bf16 v[100:103], a[196:199], a[92:95], v[100:103]
ds_read_b128 a[196:199], v2 offset:26624
v_add_f32 v17, v17, v24
v_mfma_f32_16x16x32_bf16 v[80:83], a[200:203], a[0:3], 0
s_addk_i32 s91, 2048
v_add_f32 v18, v18, v26
v_fma_f32 v92, v92, s24, v11
v_mfma_f32_16x16x32_bf16 v[80:83], a[204:207], a[12:15], v[80:83]
buffer_load_dwordx4 v7, s[16:19], s91 offen offset:3072 nt lds
v_mfma_f32_16x16x32_bf16 v[84:87], a[200:203], a[4:7], 0
v_exp_f32 v28, v92
v_mfma_f32_16x16x32_bf16 v[84:87], a[204:207], a[16:19], v[84:87]
v_fma_f32 v93, v93, s24, v11
v_fma_f32 v94, v94, s24, v11
v_mfma_f32_16x16x32_bf16 v[88:91], a[200:203], a[8:11], 0
ds_read_b128 a[200:203], v1 offset:27648
v_fma_f32 v95, v95, s24, v11
v_mfma_f32_16x16x32_bf16 v[88:91], a[204:207], a[20:23], v[88:91]
s_waitcnt lgkmcnt(1)
ds_read_b128 a[204:207], v2 offset:27648
v_fma_f32 v96, v96, s24, v13
v_mfma_f32_16x16x32_bf16 v[80:83], a[208:211], a[24:27], v[80:83]
v_exp_f32 v29, v93
v_mfma_f32_16x16x32_bf16 v[80:83], a[212:215], a[36:39], v[80:83]
s_add_u32 m0, s4, 4096
v_exp_f32 v30, v94
v_mfma_f32_16x16x32_bf16 v[84:87], a[208:211], a[28:31], v[84:87]
s_add_u32 s88, s30, s84
v_exp_f32 v31, v95
v_mfma_f32_16x16x32_bf16 v[84:87], a[212:215], a[40:43], v[84:87]
buffer_load_dwordx4 v7, s[8:11], s88 offen offset:0 nt lds
v_mfma_f32_16x16x32_bf16 v[88:91], a[208:211], a[32:35], v[88:91]
ds_read_b64_tr_b16 a[208:209], v3 offset:49152
v_cvt_pk_bf16_f32 v32, v28, v29
v_mfma_f32_16x16x32_bf16 v[88:91], a[212:215], a[44:47], v[88:91]
ds_read_b64_tr_b16 a[210:211], v3 offset:53248
v_add_f32 v24, v28, v29
v_mfma_f32_16x16x32_bf16 v[80:83], a[192:195], a[48:51], v[80:83]
v_exp_f32 v20, v96
v_mfma_f32_16x16x32_bf16 v[80:83], a[196:199], a[60:63], v[80:83]
ds_read_b64_tr_b16 a[212:213], v3 offset:57344
v_cvt_pk_bf16_f32 v33, v30, v31
v_mfma_f32_16x16x32_bf16 v[84:87], a[192:195], a[52:55], v[84:87]
ds_read_b64_tr_b16 a[214:215], v3 offset:61440
v_add_f32 v24, v24, v30
v_mfma_f32_16x16x32_bf16 v[84:87], a[196:199], a[64:67], v[84:87]
v_add_f32 v24, v24, v31
v_fma_f32 v97, v97, s24, v13
v_mfma_f32_16x16x32_bf16 v[88:91], a[192:195], a[56:59], v[88:91]
s_addk_i32 s88, 3072
ds_read_b64_tr_b16 a[192:193], v4 offset:49152
v_fma_f32 v98, v98, s24, v13
v_mfma_f32_16x16x32_bf16 v[88:91], a[196:199], a[68:71], v[88:91]
s_waitcnt lgkmcnt(3)
ds_read_b64_tr_b16 a[194:195], v4 offset:53248
v_fma_f32 v99, v99, s24, v13
v_mfma_f32_16x16x32_bf16 v[80:83], a[200:203], a[72:75], v[80:83]
buffer_load_dwordx4 v7, s[8:11], s88 offen offset:1024 nt lds
v_mfma_f32_16x16x32_bf16 v[80:83], a[204:207], a[84:87], v[80:83]
ds_read_b64_tr_b16 a[196:197], v4 offset:57344
v_fma_f32 v100, v100, s24, v15
v_mfma_f32_16x16x32_bf16 v[84:87], a[200:203], a[76:79], v[84:87]
ds_read_b64_tr_b16 a[198:199], v4 offset:61440
v_fma_f32 v101, v101, s24, v15
v_mfma_f32_16x16x32_bf16 v[84:87], a[204:207], a[88:91], v[84:87]
v_exp_f32 v21, v97
v_mfma_f32_16x16x32_bf16 v[88:91], a[200:203], a[80:83], v[88:91]
ds_read_b64_tr_b16 a[200:201], v5 offset:49152
v_cvt_pk_bf16_f32 v36, v20, v21
v_mfma_f32_16x16x32_bf16 v[88:91], a[204:207], a[92:95], v[88:91]
ds_read_b64_tr_b16 a[202:203], v5 offset:53248
v_add_f32 v26, v20, v21
v_mfma_f32_16x16x32_bf16 v[200:203], a[208:211], v[56:59], v[200:203]
s_waitcnt lgkmcnt(4)
v_exp_f32 v28, v98
v_mfma_f32_16x16x32_bf16 v[200:203], a[212:215], v[44:47], v[200:203]
s_mov_b32 m0, s32
ds_read_b64_tr_b16 a[204:205], v5 offset:57344
v_add_f32 v26, v26, v28
v_mfma_f32_16x16x32_bf16 v[204:207], a[208:211], v[60:63], v[204:207]
s_add_u32 s90, s52, s92
ds_read_b64_tr_b16 a[206:207], v5 offset:61440
v_fma_f32 v102, v102, s24, v15
v_mfma_f32_16x16x32_bf16 v[204:207], a[212:215], v[48:51], v[204:207]
buffer_load_dwordx4 v7, s[12:15], s90 offen offset:0 nt lds
v_mfma_f32_16x16x32_bf16 v[208:211], a[208:211], v[64:67], v[208:211]
ds_read_b64_tr_b16 a[208:209], v6 offset:49152
v_fma_f32 v103, v103, s24, v15
v_mfma_f32_16x16x32_bf16 v[208:211], a[212:215], v[52:55], v[208:211]
ds_read_b64_tr_b16 a[210:211], v6 offset:53248
v_fma_f32 v80, v80, s24, v11
v_mfma_f32_16x16x32_bf16 v[212:215], a[192:195], v[56:59], v[212:215]
s_waitcnt lgkmcnt(4)
v_exp_f32 v29, v99
v_mfma_f32_16x16x32_bf16 v[212:215], a[196:199], v[44:47], v[212:215]
ds_read_b64_tr_b16 a[212:213], v6 offset:57344
v_cvt_pk_bf16_f32 v37, v28, v29
v_mfma_f32_16x16x32_bf16 v[216:219], a[192:195], v[60:63], v[216:219]
ds_read_b64_tr_b16 a[214:215], v6 offset:61440
v_add_f32 v26, v26, v29
v_mfma_f32_16x16x32_bf16 v[216:219], a[196:199], v[48:51], v[216:219]
v_exp_f32 v30, v100
v_mfma_f32_16x16x32_bf16 v[220:223], a[192:195], v[64:67], v[220:223]
ds_read_b64_tr_b16 a[192:193], v3 offset:50176
v_fma_f32 v81, v81, s24, v11
v_mfma_f32_16x16x32_bf16 v[220:223], a[196:199], v[52:55], v[220:223]
s_add_u32 s90, s52, s93
ds_read_b64_tr_b16 a[194:195], v3 offset:54272
v_fma_f32 v82, v82, s24, v11
v_mfma_f32_16x16x32_bf16 a[216:219], a[200:203], v[56:59], a[216:219]
s_waitcnt lgkmcnt(4)
buffer_load_dwordx4 v7, s[12:15], s90 offen offset:1024 nt lds
v_mfma_f32_16x16x32_bf16 a[216:219], a[204:207], v[44:47], a[216:219]
ds_read_b64_tr_b16 a[196:197], v3 offset:58368
v_fma_f32 v83, v83, s24, v11
v_mfma_f32_16x16x32_bf16 a[220:223], a[200:203], v[60:63], a[220:223]
ds_read_b64_tr_b16 a[198:199], v3 offset:62464
v_fma_f32 v84, v84, s24, v13
v_mfma_f32_16x16x32_bf16 a[220:223], a[204:207], v[48:51], a[220:223]
v_exp_f32 v31, v101
v_mfma_f32_16x16x32_bf16 a[224:227], a[200:203], v[64:67], a[224:227]
ds_read_b64_tr_b16 a[200:201], v4 offset:50176
v_cvt_pk_bf16_f32 v40, v30, v31
v_mfma_f32_16x16x32_bf16 a[224:227], a[204:207], v[52:55], a[224:227]
ds_read_b64_tr_b16 a[202:203], v4 offset:54272
v_add_f32 v27, v30, v31
v_mfma_f32_16x16x32_bf16 a[228:231], a[208:211], v[56:59], a[228:231]
s_waitcnt lgkmcnt(4)
v_exp_f32 v20, v102
v_mfma_f32_16x16x32_bf16 a[228:231], a[212:215], v[44:47], a[228:231]
ds_read_b64_tr_b16 a[204:205], v4 offset:58368
v_add_f32 v27, v27, v20
v_mfma_f32_16x16x32_bf16 a[232:235], a[208:211], v[60:63], a[232:235]
s_add_u32 s90, s52, s94
ds_read_b64_tr_b16 a[206:207], v4 offset:62464
v_fma_f32 v85, v85, s24, v13
v_mfma_f32_16x16x32_bf16 a[232:235], a[212:215], v[48:51], a[232:235]
buffer_load_dwordx4 v7, s[12:15], s90 offen offset:2048 nt lds
v_mfma_f32_16x16x32_bf16 a[236:239], a[208:211], v[64:67], a[236:239]
ds_read_b64_tr_b16 a[208:209], v5 offset:50176
v_fma_f32 v86, v86, s24, v13
v_mfma_f32_16x16x32_bf16 a[236:239], a[212:215], v[52:55], a[236:239]
ds_read_b64_tr_b16 a[210:211], v5 offset:54272
v_fma_f32 v87, v87, s24, v13
v_mfma_f32_16x16x32_bf16 a[240:243], a[192:195], v[56:59], a[240:243]
s_waitcnt lgkmcnt(4)
v_exp_f32 v21, v103
v_mfma_f32_16x16x32_bf16 a[240:243], a[196:199], v[44:47], a[240:243]
ds_read_b64_tr_b16 a[212:213], v5 offset:58368
v_cvt_pk_bf16_f32 v41, v20, v21
v_mfma_f32_16x16x32_bf16 a[244:247], a[192:195], v[60:63], a[244:247]
ds_read_b64_tr_b16 a[214:215], v5 offset:62464
v_add_f32 v27, v27, v21
v_mfma_f32_16x16x32_bf16 a[244:247], a[196:199], v[48:51], a[244:247]
v_exp_f32 v28, v80
v_mfma_f32_16x16x32_bf16 a[248:251], a[192:195], v[64:67], a[248:251]
ds_read_b64_tr_b16 a[192:193], v6 offset:50176
v_add_f32 v24, v24, v28
v_mfma_f32_16x16x32_bf16 a[248:251], a[196:199], v[52:55], a[248:251]
s_add_u32 s90, s52, s95
ds_read_b64_tr_b16 a[194:195], v6 offset:54272
v_fma_f32 v88, v88, s24, v15
v_mfma_f32_16x16x32_bf16 a[252:255], a[200:203], v[56:59], a[252:255]
s_waitcnt lgkmcnt(4)
buffer_load_dwordx4 v7, s[12:15], s90 offen offset:3072 nt lds
v_mfma_f32_16x16x32_bf16 a[252:255], a[204:207], v[44:47], a[252:255]
ds_read_b64_tr_b16 a[196:197], v6 offset:58368
v_fma_f32 v89, v89, s24, v15
v_mfma_f32_16x16x32_bf16 v[224:227], a[200:203], v[60:63], v[224:227]
ds_read_b64_tr_b16 a[198:199], v6 offset:62464
v_fma_f32 v90, v90, s24, v15
v_mfma_f32_16x16x32_bf16 v[224:227], a[204:207], v[48:51], v[224:227]
v_exp_f32 v29, v81
v_mfma_f32_16x16x32_bf16 v[228:231], a[200:203], v[64:67], v[228:231]
v_exp_f32 v30, v82
v_mfma_f32_16x16x32_bf16 v[228:231], a[204:207], v[52:55], v[228:231]
v_exp_f32 v31, v83
v_mfma_f32_16x16x32_bf16 v[232:235], a[208:211], v[56:59], v[232:235]
s_waitcnt lgkmcnt(2)
v_exp_f32 v20, v84
v_mfma_f32_16x16x32_bf16 v[232:235], a[212:215], v[44:47], v[232:235]
v_exp_f32 v21, v85
v_mfma_f32_16x16x32_bf16 v[236:239], a[208:211], v[60:63], v[236:239]
v_cvt_pk_bf16_f32 v34, v28, v29
v_add_f32 v24, v24, v29
PADJ_4:
s_cbranch_execz PADJ_8
v_mfma_f32_16x16x32_bf16 v[236:239], a[212:215], v[48:51], v[236:239]
s_waitcnt vmcnt(14) lgkmcnt(0)
v_exp_f32 v28, v86
v_mfma_f32_16x16x32_bf16 v[240:243], a[208:211], v[64:67], v[240:243]
s_barrier
ds_read_b128 a[156:159], v8 offset:2048
v_mfma_f32_16x16x32_bf16 v[240:243], a[212:215], v[52:55], v[240:243]
ds_read_b128 a[200:203], v1 offset:32768
v_cvt_pk_bf16_f32 v35, v30, v31
v_mfma_f32_16x16x32_bf16 v[244:247], a[192:195], v[56:59], v[244:247]
ds_read_b128 a[204:207], v2 offset:32768
v_add_f32 v24, v24, v30
v_mfma_f32_16x16x32_bf16 v[244:247], a[196:199], v[44:47], v[244:247]
ds_read_b128 a[208:211], v1 offset:33792
v_add_f32 v24, v24, v31
v_mfma_f32_16x16x32_bf16 v[248:251], a[192:195], v[60:63], v[248:251]
s_mov_b32 m0, s39
ds_read_b128 a[212:215], v2 offset:33792
v_cvt_pk_bf16_f32 v38, v20, v21
v_mfma_f32_16x16x32_bf16 v[248:251], a[196:199], v[48:51], v[248:251]
s_addk_i32 s81, 2048
v_exp_f32 v29, v87
v_mfma_f32_16x16x32_bf16 v[252:255], a[192:195], v[64:67], v[252:255]
s_add_u32 s90, s81, s94
ds_read_b128 a[192:195], v1 offset:34816
v_add_f32 v26, v26, v20
v_mfma_f32_16x16x32_bf16 v[252:255], a[196:199], v[52:55], v[252:255]
s_waitcnt lgkmcnt(4)
ds_read_b128 a[196:199], v2 offset:34816
v_add_f32 v26, v26, v21
v_mfma_f32_16x16x32_bf16 v[44:47], a[200:203], a[0:3], 0
s_waitcnt lgkmcnt(4)
buffer_load_dwordx4 v7, s[16:19], s90 offen offset:0 nt lds
v_mfma_f32_16x16x32_bf16 v[44:47], a[204:207], a[12:15], v[44:47]
v_exp_f32 v30, v88
v_mfma_f32_16x16x32_bf16 v[48:51], a[200:203], a[4:7], 0
v_exp_f32 v31, v89
v_mfma_f32_16x16x32_bf16 v[48:51], a[204:207], a[16:19], v[48:51]
v_exp_f32 v20, v90
v_mfma_f32_16x16x32_bf16 v[52:55], a[200:203], a[8:11], 0
ds_read_b128 a[200:203], v1 offset:35840
v_cvt_pk_bf16_f32 v39, v28, v29
v_mfma_f32_16x16x32_bf16 v[52:55], a[204:207], a[20:23], v[52:55]
s_waitcnt lgkmcnt(1)
ds_read_b128 a[204:207], v2 offset:35840
v_add_f32 v26, v26, v28
v_mfma_f32_16x16x32_bf16 v[44:47], a[208:211], a[24:27], v[44:47]
s_add_u32 s91, s81, s95
v_add_f32 v26, v26, v29
v_fma_f32 v91, v91, s24, v15
v_mfma_f32_16x16x32_bf16 v[44:47], a[212:215], a[36:39], v[44:47]
buffer_load_dwordx4 v7, s[16:19], s91 offen offset:1024 nt lds
v_mfma_f32_16x16x32_bf16 v[48:51], a[208:211], a[28:31], v[48:51]
v_exp_f32 v21, v91
v_mfma_f32_16x16x32_bf16 v[48:51], a[212:215], a[40:43], v[48:51]
v_cvt_pk_bf16_f32 v42, v30, v31
v_add_f32 v27, v27, v30
v_mfma_f32_16x16x32_bf16 v[52:55], a[208:211], a[32:35], v[52:55]
ds_read_b128 a[208:211], v1 offset:40960
v_add_f32 v27, v27, v31
v_mfma_f32_16x16x32_bf16 v[52:55], a[212:215], a[44:47], v[52:55]
ds_read_b128 a[212:215], v2 offset:40960
v_cvt_pk_bf16_f32 v43, v20, v21
v_mfma_f32_16x16x32_bf16 v[44:47], a[192:195], a[48:51], v[44:47]
v_add_f32 v27, v27, v20
v_add_f32 v27, v27, v21
v_mfma_f32_16x16x32_bf16 v[44:47], a[196:199], a[60:63], v[44:47]
v_max3_f32 v25, v24, v26, v27
v_cmp_lt_f32 vcc, s25, v25
v_mfma_f32_16x16x32_bf16 v[48:51], a[192:195], a[52:55], v[48:51]
v_xor_b32 v8, 64, v8
v_mfma_f32_16x16x32_bf16 v[48:51], a[196:199], a[64:67], v[48:51]
ds_read_b128 a[144:147], v8 offset:2048
v_mfma_f32_16x16x32_bf16 v[52:55], a[192:195], a[56:59], v[52:55]
s_addk_i32 s90, 2048
ds_read_b128 a[192:195], v1 offset:41984
v_mfma_f32_16x16x32_bf16 v[52:55], a[196:199], a[68:71], v[52:55]
s_waitcnt lgkmcnt(2)
ds_read_b128 a[196:199], v2 offset:41984
v_mfma_f32_16x16x32_bf16 v[44:47], a[200:203], a[72:75], v[44:47]
buffer_load_dwordx4 v7, s[16:19], s90 offen offset:2048 nt lds
v_mfma_f32_16x16x32_bf16 v[44:47], a[204:207], a[84:87], v[44:47]
v_mfma_f32_16x16x32_bf16 v[48:51], a[200:203], a[76:79], v[48:51]
v_mfma_f32_16x16x32_bf16 v[48:51], a[204:207], a[88:91], v[48:51]
s_cbranch_vccnz STUB_9
BACK_9:
v_mfma_f32_16x16x32_bf16 v[52:55], a[200:203], a[80:83], v[52:55]
ds_read_b128 a[200:203], v1 offset:43008
v_add_f32 v19, v19, v27
v_mfma_f32_16x16x32_bf16 v[52:55], a[204:207], a[92:95], v[52:55]
ds_read_b128 a[204:207], v2 offset:43008
v_add_f32 v17, v17, v24
v_mfma_f32_16x16x32_bf16 v[80:83], a[208:211], a[0:3], 0
s_addk_i32 s91, 2048
v_add_f32 v18, v18, v26
v_fma_f32 v44, v44, s24, v11
v_mfma_f32_16x16x32_bf16 v[80:83], a[212:215], a[12:15], v[80:83]
buffer_load_dwordx4 v7, s[16:19], s91 offen offset:3072 nt lds
v_mfma_f32_16x16x32_bf16 v[84:87], a[208:211], a[4:7], 0
v_exp_f32 v28, v44
v_mfma_f32_16x16x32_bf16 v[84:87], a[212:215], a[16:19], v[84:87]
v_fma_f32 v45, v45, s24, v11
v_fma_f32 v46, v46, s24, v11
v_mfma_f32_16x16x32_bf16 v[88:91], a[208:211], a[8:11], 0
ds_read_b128 a[208:211], v1 offset:44032
v_fma_f32 v47, v47, s24, v11
v_mfma_f32_16x16x32_bf16 v[88:91], a[212:215], a[20:23], v[88:91]
s_waitcnt lgkmcnt(1)
ds_read_b128 a[212:215], v2 offset:44032
v_fma_f32 v48, v48, s24, v13
v_mfma_f32_16x16x32_bf16 v[80:83], a[192:195], a[24:27], v[80:83]
v_exp_f32 v29, v45
v_mfma_f32_16x16x32_bf16 v[80:83], a[196:199], a[36:39], v[80:83]
s_add_u32 m0, s4, 6144
v_exp_f32 v30, v46
v_mfma_f32_16x16x32_bf16 v[84:87], a[192:195], a[28:31], v[84:87]
s_add_u32 s88, s30, s85
v_exp_f32 v31, v47
v_mfma_f32_16x16x32_bf16 v[84:87], a[196:199], a[40:43], v[84:87]
buffer_load_dwordx4 v7, s[8:11], s88 offen offset:0 nt lds
v_mfma_f32_16x16x32_bf16 v[88:91], a[192:195], a[32:35], v[88:91]
ds_read_b64_tr_b16 a[192:193], v3 offset:0
v_cvt_pk_bf16_f32 v56, v28, v29
v_mfma_f32_16x16x32_bf16 v[88:91], a[196:199], a[44:47], v[88:91]
ds_read_b64_tr_b16 a[194:195], v3 offset:4096
v_add_f32 v24, v28, v29
v_mfma_f32_16x16x32_bf16 v[80:83], a[200:203], a[48:51], v[80:83]
v_exp_f32 v20, v48
v_mfma_f32_16x16x32_bf16 v[80:83], a[204:207], a[60:63], v[80:83]
ds_read_b64_tr_b16 a[196:197], v3 offset:8192
v_cvt_pk_bf16_f32 v57, v30, v31
v_mfma_f32_16x16x32_bf16 v[84:87], a[200:203], a[52:55], v[84:87]
ds_read_b64_tr_b16 a[198:199], v3 offset:12288
v_add_f32 v24, v24, v30
v_mfma_f32_16x16x32_bf16 v[84:87], a[204:207], a[64:67], v[84:87]
v_add_f32 v24, v24, v31
v_fma_f32 v49, v49, s24, v13
v_mfma_f32_16x16x32_bf16 v[88:91], a[200:203], a[56:59], v[88:91]
s_addk_i32 s88, 3072
ds_read_b64_tr_b16 a[200:201], v4 offset:0
v_fma_f32 v50, v50, s24, v13
v_mfma_f32_16x16x32_bf16 v[88:91], a[204:207], a[68:71], v[88:91]
s_waitcnt lgkmcnt(3)
ds_read_b64_tr_b16 a[202:203], v4 offset:4096
v_fma_f32 v51, v51, s24, v13
v_mfma_f32_16x16x32_bf16 v[80:83], a[208:211], a[72:75], v[80:83]
buffer_load_dwordx4 v7, s[8:11], s88 offen offset:1024 nt lds
v_mfma_f32_16x16x32_bf16 v[80:83], a[212:215], a[84:87], v[80:83]
ds_read_b64_tr_b16 a[204:205], v4 offset:8192
v_fma_f32 v52, v52, s24, v15
v_mfma_f32_16x16x32_bf16 v[84:87], a[208:211], a[76:79], v[84:87]
ds_read_b64_tr_b16 a[206:207], v4 offset:12288
v_fma_f32 v53, v53, s24, v15
v_mfma_f32_16x16x32_bf16 v[84:87], a[212:215], a[88:91], v[84:87]
v_exp_f32 v21, v49
v_mfma_f32_16x16x32_bf16 v[88:91], a[208:211], a[80:83], v[88:91]
ds_read_b64_tr_b16 a[208:209], v5 offset:0
v_cvt_pk_bf16_f32 v60, v20, v21
v_mfma_f32_16x16x32_bf16 v[88:91], a[212:215], a[92:95], v[88:91]
ds_read_b64_tr_b16 a[210:211], v5 offset:4096
v_add_f32 v26, v20, v21
v_mfma_f32_16x16x32_bf16 v[104:107], a[192:195], v[68:71], v[104:107]
s_waitcnt lgkmcnt(4)
v_exp_f32 v28, v50
v_mfma_f32_16x16x32_bf16 v[104:107], a[196:199], v[32:35], v[104:107]
s_mov_b32 m0, s33
ds_read_b64_tr_b16 a[212:213], v5 offset:8192
v_add_f32 v26, v26, v28
v_mfma_f32_16x16x32_bf16 v[108:111], a[192:195], v[72:75], v[108:111]
s_add_u32 s90, s53, s92
ds_read_b64_tr_b16 a[214:215], v5 offset:12288
v_fma_f32 v54, v54, s24, v15
v_mfma_f32_16x16x32_bf16 v[108:111], a[196:199], v[36:39], v[108:111]
buffer_load_dwordx4 v7, s[12:15], s90 offen offset:0 nt lds
v_mfma_f32_16x16x32_bf16 v[112:115], a[192:195], v[76:79], v[112:115]
ds_read_b64_tr_b16 a[192:193], v6 offset:0
v_fma_f32 v55, v55, s24, v15
v_mfma_f32_16x16x32_bf16 v[112:115], a[196:199], v[40:43], v[112:115]
ds_read_b64_tr_b16 a[194:195], v6 offset:4096
v_fma_f32 v80, v80, s24, v11
v_mfma_f32_16x16x32_bf16 v[116:119], a[200:203], v[68:71], v[116:119]
s_waitcnt lgkmcnt(4)
v_exp_f32 v29, v51
v_mfma_f32_16x16x32_bf16 v[116:119], a[204:207], v[32:35], v[116:119]
ds_read_b64_tr_b16 a[196:197], v6 offset:8192
v_cvt_pk_bf16_f32 v61, v28, v29
v_mfma_f32_16x16x32_bf16 v[120:123], a[200:203], v[72:75], v[120:123]
ds_read_b64_tr_b16 a[198:199], v6 offset:12288
v_add_f32 v26, v26, v29
v_mfma_f32_16x16x32_bf16 v[120:123], a[204:207], v[36:39], v[120:123]
v_exp_f32 v30, v52
v_mfma_f32_16x16x32_bf16 v[124:127], a[200:203], v[76:79], v[124:127]
ds_read_b64_tr_b16 a[200:201], v3 offset:1024
v_fma_f32 v81, v81, s24, v11
v_mfma_f32_16x16x32_bf16 v[124:127], a[204:207], v[40:43], v[124:127]
s_add_u32 s90, s53, s93
ds_read_b64_tr_b16 a[202:203], v3 offset:5120
v_fma_f32 v82, v82, s24, v11
v_mfma_f32_16x16x32_bf16 v[128:131], a[208:211], v[68:71], v[128:131]
s_waitcnt lgkmcnt(4)
buffer_load_dwordx4 v7, s[12:15], s90 offen offset:1024 nt lds
v_mfma_f32_16x16x32_bf16 v[128:131], a[212:215], v[32:35], v[128:131]
ds_read_b64_tr_b16 a[204:205], v3 offset:9216
v_fma_f32 v83, v83, s24, v11
v_mfma_f32_16x16x32_bf16 v[132:135], a[208:211], v[72:75], v[132:135]
ds_read_b64_tr_b16 a[206:207], v3 offset:13312
v_fma_f32 v84, v84, s24, v13
v_mfma_f32_16x16x32_bf16 v[132:135], a[212:215], v[36:39], v[132:135]
v_exp_f32 v31, v53
v_mfma_f32_16x16x32_bf16 v[136:139], a[208:211], v[76:79], v[136:139]
ds_read_b64_tr_b16 a[208:209], v4 offset:1024
v_cvt_pk_bf16_f32 v64, v30, v31
v_mfma_f32_16x16x32_bf16 v[136:139], a[212:215], v[40:43], v[136:139]
ds_read_b64_tr_b16 a[210:211], v4 offset:5120
v_add_f32 v27, v30, v31
v_mfma_f32_16x16x32_bf16 v[140:143], a[192:195], v[68:71], v[140:143]
s_waitcnt lgkmcnt(4)
v_exp_f32 v20, v54
v_mfma_f32_16x16x32_bf16 v[140:143], a[196:199], v[32:35], v[140:143]
ds_read_b64_tr_b16 a[212:213], v4 offset:9216
v_add_f32 v27, v27, v20
v_mfma_f32_16x16x32_bf16 v[144:147], a[192:195], v[72:75], v[144:147]
s_add_u32 s90, s53, s94
ds_read_b64_tr_b16 a[214:215], v4 offset:13312
v_fma_f32 v85, v85, s24, v13
v_mfma_f32_16x16x32_bf16 v[144:147], a[196:199], v[36:39], v[144:147]
buffer_load_dwordx4 v7, s[12:15], s90 offen offset:2048 nt lds
v_mfma_f32_16x16x32_bf16 v[148:151], a[192:195], v[76:79], v[148:151]
ds_read_b64_tr_b16 a[192:193], v5 offset:1024
v_fma_f32 v86, v86, s24, v13
v_mfma_f32_16x16x32_bf16 v[148:151], a[196:199], v[40:43], v[148:151]
ds_read_b64_tr_b16 a[194:195], v5 offset:5120
v_fma_f32 v87, v87, s24, v13
v_mfma_f32_16x16x32_bf16 v[152:155], a[200:203], v[68:71], v[152:155]
s_waitcnt lgkmcnt(4)
v_exp_f32 v21, v55
v_mfma_f32_16x16x32_bf16 v[152:155], a[204:207], v[32:35], v[152:155]
ds_read_b64_tr_b16 a[196:197], v5 offset:9216
v_cvt_pk_bf16_f32 v65, v20, v21
v_mfma_f32_16x16x32_bf16 v[156:159], a[200:203], v[72:75], v[156:159]
ds_read_b64_tr_b16 a[198:199], v5 offset:13312
v_add_f32 v27, v27, v21
v_mfma_f32_16x16x32_bf16 v[156:159], a[204:207], v[36:39], v[156:159]
v_exp_f32 v28, v80
v_mfma_f32_16x16x32_bf16 v[160:163], a[200:203], v[76:79], v[160:163]
ds_read_b64_tr_b16 a[200:201], v6 offset:1024
v_add_f32 v24, v24, v28
v_mfma_f32_16x16x32_bf16 v[160:163], a[204:207], v[40:43], v[160:163]
s_add_u32 s90, s53, s95
ds_read_b64_tr_b16 a[202:203], v6 offset:5120
v_fma_f32 v88, v88, s24, v15
v_mfma_f32_16x16x32_bf16 v[164:167], a[208:211], v[68:71], v[164:167]
s_waitcnt lgkmcnt(4)
buffer_load_dwordx4 v7, s[12:15], s90 offen offset:3072 nt lds
v_mfma_f32_16x16x32_bf16 v[164:167], a[212:215], v[32:35], v[164:167]
ds_read_b64_tr_b16 a[204:205], v6 offset:9216
v_fma_f32 v89, v89, s24, v15
v_mfma_f32_16x16x32_bf16 v[168:171], a[208:211], v[72:75], v[168:171]
ds_read_b64_tr_b16 a[206:207], v6 offset:13312
v_fma_f32 v90, v90, s24, v15
v_mfma_f32_16x16x32_bf16 v[168:171], a[212:215], v[36:39], v[168:171]
v_exp_f32 v29, v81
v_mfma_f32_16x16x32_bf16 v[172:175], a[208:211], v[76:79], v[172:175]
v_exp_f32 v30, v82
v_mfma_f32_16x16x32_bf16 v[172:175], a[212:215], v[40:43], v[172:175]
v_exp_f32 v31, v83
v_mfma_f32_16x16x32_bf16 v[176:179], a[192:195], v[68:71], v[176:179]
s_waitcnt lgkmcnt(2)
v_exp_f32 v20, v84
v_mfma_f32_16x16x32_bf16 v[176:179], a[196:199], v[32:35], v[176:179]
v_exp_f32 v21, v85
v_mfma_f32_16x16x32_bf16 v[180:183], a[192:195], v[72:75], v[180:183]
v_cvt_pk_bf16_f32 v58, v28, v29
v_add_f32 v24, v24, v29
v_mfma_f32_16x16x32_bf16 v[180:183], a[196:199], v[36:39], v[180:183]
s_waitcnt vmcnt(14) lgkmcnt(0)
v_exp_f32 v28, v86
v_mfma_f32_16x16x32_bf16 v[184:187], a[192:195], v[76:79], v[184:187]
s_barrier
ds_read_b128 a[100:103], v8 offset:4096
v_mfma_f32_16x16x32_bf16 v[184:187], a[196:199], v[40:43], v[184:187]
ds_read_b128 a[208:211], v1 offset:49152
v_cvt_pk_bf16_f32 v59, v30, v31
v_mfma_f32_16x16x32_bf16 v[188:191], a[200:203], v[68:71], v[188:191]
ds_read_b128 a[212:215], v2 offset:49152
v_add_f32 v24, v24, v30
v_mfma_f32_16x16x32_bf16 v[188:191], a[204:207], v[32:35], v[188:191]
ds_read_b128 a[192:195], v1 offset:50176
v_add_f32 v24, v24, v31
v_mfma_f32_16x16x32_bf16 v[192:195], a[200:203], v[72:75], v[192:195]
s_mov_b32 m0, s36
ds_read_b128 a[196:199], v2 offset:50176
v_cvt_pk_bf16_f32 v62, v20, v21
v_mfma_f32_16x16x32_bf16 v[192:195], a[204:207], v[36:39], v[192:195]
s_bitcmp1_b32 s3, 1
s_cselect_b32 s81, s53, s52
v_add_f32 v26, v26, v20
v_mfma_f32_16x16x32_bf16 v[196:199], a[200:203], v[76:79], v[196:199]
s_add_u32 s90, s81, s92
ds_read_b128 a[200:203], v1 offset:51200
v_add_f32 v26, v26, v21
v_mfma_f32_16x16x32_bf16 v[196:199], a[204:207], v[40:43], v[196:199]
s_waitcnt lgkmcnt(4)
ds_read_b128 a[204:207], v2 offset:51200
v_add_f32 v26, v26, v28
v_mfma_f32_16x16x32_bf16 v[92:95], a[208:211], a[0:3], 0
s_waitcnt lgkmcnt(4)
buffer_load_dwordx4 v7, s[16:19], s90 offen offset:0 nt lds
v_mfma_f32_16x16x32_bf16 v[92:95], a[212:215], a[12:15], v[92:95]
v_exp_f32 v29, v87
v_mfma_f32_16x16x32_bf16 v[96:99], a[208:211], a[4:7], 0
v_exp_f32 v30, v88
v_mfma_f32_16x16x32_bf16 v[96:99], a[212:215], a[16:19], v[96:99]
v_exp_f32 v31, v89
v_mfma_f32_16x16x32_bf16 v[100:103], a[208:211], a[8:11], 0
ds_read_b128 a[208:211], v1 offset:52224
v_cvt_pk_bf16_f32 v63, v28, v29
v_mfma_f32_16x16x32_bf16 v[100:103], a[212:215], a[20:23], v[100:103]
s_waitcnt lgkmcnt(1)
ds_read_b128 a[212:215], v2 offset:52224
v_add_f32 v26, v26, v29
v_mfma_f32_16x16x32_bf16 v[92:95], a[192:195], a[24:27], v[92:95]
s_add_u32 s91, s81, s93
v_exp_f32 v20, v90
v_mfma_f32_16x16x32_bf16 v[92:95], a[196:199], a[36:39], v[92:95]
buffer_load_dwordx4 v7, s[16:19], s91 offen offset:1024 nt lds
v_mfma_f32_16x16x32_bf16 v[96:99], a[192:195], a[28:31], v[96:99]
v_fma_f32 v91, v91, s24, v15
v_cvt_pk_bf16_f32 v66, v30, v31
v_mfma_f32_16x16x32_bf16 v[96:99], a[196:199], a[40:43], v[96:99]
v_exp_f32 v21, v91
v_mfma_f32_16x16x32_bf16 v[100:103], a[192:195], a[32:35], v[100:103]
ds_read_b128 a[192:195], v1 offset:57344
v_add_f32 v27, v27, v30
v_mfma_f32_16x16x32_bf16 v[100:103], a[196:199], a[44:47], v[100:103]
ds_read_b128 a[196:199], v2 offset:57344
v_add_f32 v27, v27, v31
v_mfma_f32_16x16x32_bf16 v[92:95], a[200:203], a[48:51], v[92:95]
v_cvt_pk_bf16_f32 v67, v20, v21
v_add_f32 v27, v27, v20
v_mfma_f32_16x16x32_bf16 v[92:95], a[204:207], a[60:63], v[92:95]
v_add_f32 v27, v27, v21
v_max3_f32 v25, v24, v26, v27
v_mfma_f32_16x16x32_bf16 v[96:99], a[200:203], a[52:55], v[96:99]
v_cmp_lt_f32 vcc, s25, v25
v_xor_b32 v8, 64, v8
v_mfma_f32_16x16x32_bf16 v[96:99], a[204:207], a[64:67], v[96:99]
ds_read_b128 a[112:115], v8 offset:4096
v_mfma_f32_16x16x32_bf16 v[100:103], a[200:203], a[56:59], v[100:103]
s_addk_i32 s90, 2048
ds_read_b128 a[200:203], v1 offset:58368
v_mfma_f32_16x16x32_bf16 v[100:103], a[204:207], a[68:71], v[100:103]
s_waitcnt lgkmcnt(2)
ds_read_b128 a[204:207], v2 offset:58368
v_mfma_f32_16x16x32_bf16 v[92:95], a[208:211], a[72:75], v[92:95]
buffer_load_dwordx4 v7, s[16:19], s90 offen offset:2048 nt lds
v_mfma_f32_16x16x32_bf16 v[92:95], a[212:215], a[84:87], v[92:95]
v_mfma_f32_16x16x32_bf16 v[96:99], a[208:211], a[76:79], v[96:99]
v_mfma_f32_16x16x32_bf16 v[96:99], a[212:215], a[88:91], v[96:99]
s_cbranch_vccnz STUB_10
BACK_10:
v_mfma_f32_16x16x32_bf16 v[100:103], a[208:211], a[80:83], v[100:103]
ds_read_b128 a[208:211], v1 offset:59392
v_add_f32 v19, v19, v27
v_mfma_f32_16x16x32_bf16 v[100:103], a[212:215], a[92:95], v[100:103]
ds_read_b128 a[212:215], v2 offset:59392
v_add_f32 v17, v17, v24
v_mfma_f32_16x16x32_bf16 v[80:83], a[192:195], a[0:3], 0
s_addk_i32 s91, 2048
v_add_f32 v18, v18, v26
v_fma_f32 v92, v92, s24, v11
v_mfma_f32_16x16x32_bf16 v[80:83], a[196:199], a[12:15], v[80:83]
buffer_load_dwordx4 v7, s[16:19], s91 offen offset:3072 nt lds
v_mfma_f32_16x16x32_bf16 v[84:87], a[192:195], a[4:7], 0
v_exp_f32 v28, v92
v_mfma_f32_16x16x32_bf16 v[84:87], a[196:199], a[16:19], v[84:87]
v_fma_f32 v93, v93, s24, v11
v_fma_f32 v94, v94, s24, v11
v_mfma_f32_16x16x32_bf16 v[88:91], a[192:195], a[8:11], 0
ds_read_b128 a[192:195], v1 offset:60416
v_fma_f32 v95, v95, s24, v11
v_mfma_f32_16x16x32_bf16 v[88:91], a[196:199], a[20:23], v[88:91]
s_waitcnt lgkmcnt(1)
ds_read_b128 a[196:199], v2 offset:60416
v_fma_f32 v96, v96, s24, v13
v_mfma_f32_16x16x32_bf16 v[80:83], a[200:203], a[24:27], v[80:83]
v_exp_f32 v29, v93
v_mfma_f32_16x16x32_bf16 v[80:83], a[204:207], a[36:39], v[80:83]
s_add_u32 m0, s4, 0
v_exp_f32 v30, v94
v_mfma_f32_16x16x32_bf16 v[84:87], a[200:203], a[28:31], v[84:87]
s_add_u32 s88, s30, s86
v_exp_f32 v31, v95
v_mfma_f32_16x16x32_bf16 v[84:87], a[204:207], a[40:43], v[84:87]
buffer_load_dwordx4 v7, s[8:11], s88 offen offset:0 nt lds
v_mfma_f32_16x16x32_bf16 v[88:91], a[200:203], a[32:35], v[88:91]
ds_read_b64_tr_b16 a[200:201], v3 offset:16384
v_cvt_pk_bf16_f32 v44, v28, v29
v_mfma_f32_16x16x32_bf16 v[88:91], a[204:207], a[44:47], v[88:91]
ds_read_b64_tr_b16 a[202:203], v3 offset:20480
v_add_f32 v24, v28, v29
v_mfma_f32_16x16x32_bf16 v[80:83], a[208:211], a[48:51], v[80:83]
v_exp_f32 v20, v96
v_mfma_f32_16x16x32_bf16 v[80:83], a[212:215], a[60:63], v[80:83]
ds_read_b64_tr_b16 a[204:205], v3 offset:24576
v_cvt_pk_bf16_f32 v45, v30, v31
v_mfma_f32_16x16x32_bf16 v[84:87], a[208:211], a[52:55], v[84:87]
ds_read_b64_tr_b16 a[206:207], v3 offset:28672
v_add_f32 v24, v24, v30
v_mfma_f32_16x16x32_bf16 v[84:87], a[212:215], a[64:67], v[84:87]
v_add_f32 v24, v24, v31
v_fma_f32 v97, v97, s24, v13
v_mfma_f32_16x16x32_bf16 v[88:91], a[208:211], a[56:59], v[88:91]
s_addk_i32 s88, 3072
ds_read_b64_tr_b16 a[208:209], v4 offset:16384
v_fma_f32 v98, v98, s24, v13
v_mfma_f32_16x16x32_bf16 v[88:91], a[212:215], a[68:71], v[88:91]
s_waitcnt lgkmcnt(3)
ds_read_b64_tr_b16 a[210:211], v4 offset:20480
v_fma_f32 v99, v99, s24, v13
v_mfma_f32_16x16x32_bf16 v[80:83], a[192:195], a[72:75], v[80:83]
buffer_load_dwordx4 v7, s[8:11], s88 offen offset:1024 nt lds
v_mfma_f32_16x16x32_bf16 v[80:83], a[196:199], a[84:87], v[80:83]
ds_read_b64_tr_b16 a[212:213], v4 offset:24576
v_fma_f32 v100, v100, s24, v15
v_mfma_f32_16x16x32_bf16 v[84:87], a[192:195], a[76:79], v[84:87]
ds_read_b64_tr_b16 a[214:215], v4 offset:28672
v_fma_f32 v101, v101, s24, v15
v_mfma_f32_16x16x32_bf16 v[84:87], a[196:199], a[88:91], v[84:87]
v_exp_f32 v21, v97
v_mfma_f32_16x16x32_bf16 v[88:91], a[192:195], a[80:83], v[88:91]
ds_read_b64_tr_b16 a[192:193], v5 offset:16384
v_cvt_pk_bf16_f32 v48, v20, v21
v_mfma_f32_16x16x32_bf16 v[88:91], a[196:199], a[92:95], v[88:91]
ds_read_b64_tr_b16 a[194:195], v5 offset:20480
v_add_f32 v26, v20, v21
v_mfma_f32_16x16x32_bf16 v[200:203], a[200:203], v[68:71], v[200:203]
s_waitcnt lgkmcnt(4)
v_exp_f32 v28, v98
v_mfma_f32_16x16x32_bf16 v[200:203], a[204:207], v[32:35], v[200:203]
s_mov_b32 m0, s34
ds_read_b64_tr_b16 a[196:197], v5 offset:24576
v_add_f32 v26, v26, v28
v_mfma_f32_16x16x32_bf16 v[204:207], a[200:203], v[72:75], v[204:207]
s_add_u32 s90, s54, s92
ds_read_b64_tr_b16 a[198:199], v5 offset:28672
v_fma_f32 v102, v102, s24, v15
v_mfma_f32_16x16x32_bf16 v[204:207], a[204:207], v[36:39], v[204:207]
buffer_load_dwordx4 v7, s[12:15], s90 offen offset:0 nt lds
v_mfma_f32_16x16x32_bf16 v[208:211], a[200:203], v[76:79], v[208:211]
ds_read_b64_tr_b16 a[200:201], v6 offset:16384
v_fma_f32 v103, v103, s24, v15
v_mfma_f32_16x16x32_bf16 v[208:211], a[204:207], v[40:43], v[208:211]
ds_read_b64_tr_b16 a[202:203], v6 offset:20480
v_fma_f32 v80, v80, s24, v11
v_mfma_f32_16x16x32_bf16 v[212:215], a[208:211], v[68:71], v[212:215]
s_waitcnt lgkmcnt(4)
v_exp_f32 v29, v99
v_mfma_f32_16x16x32_bf16 v[212:215], a[212:215], v[32:35], v[212:215]
ds_read_b64_tr_b16 a[204:205], v6 offset:24576
v_cvt_pk_bf16_f32 v49, v28, v29
v_mfma_f32_16x16x32_bf16 v[216:219], a[208:211], v[72:75], v[216:219]
ds_read_b64_tr_b16 a[206:207], v6 offset:28672
v_add_f32 v26, v26, v29
v_mfma_f32_16x16x32_bf16 v[216:219], a[212:215], v[36:39], v[216:219]
v_exp_f32 v30, v100
v_mfma_f32_16x16x32_bf16 v[220:223], a[208:211], v[76:79], v[220:223]
ds_read_b64_tr_b16 a[208:209], v3 offset:17408
v_fma_f32 v81, v81, s24, v11
v_mfma_f32_16x16x32_bf16 v[220:223], a[212:215], v[40:43], v[220:223]
s_add_u32 s90, s54, s93
ds_read_b64_tr_b16 a[210:211], v3 offset:21504
v_fma_f32 v82, v82, s24, v11
v_mfma_f32_16x16x32_bf16 a[216:219], a[192:195], v[68:71], a[216:219]
s_waitcnt lgkmcnt(4)
buffer_load_dwordx4 v7, s[12:15], s90 offen offset:1024 nt lds
v_mfma_f32_16x16x32_bf16 a[216:219], a[196:199], v[32:35], a[216:219]
ds_read_b64_tr_b16 a[212:213], v3 offset:25600
v_fma_f32 v83, v83, s24, v11
v_mfma_f32_16x16x32_bf16 a[220:223], a[192:195], v[72:75], a[220:223]
ds_read_b64_tr_b16 a[214:215], v3 offset:29696
v_fma_f32 v84, v84, s24, v13
v_mfma_f32_16x16x32_bf16 a[220:223], a[196:199], v[36:39], a[220:223]
v_exp_f32 v31, v101
v_mfma_f32_16x16x32_bf16 a[224:227], a[192:195], v[76:79], a[224:227]
ds_read_b64_tr_b16 a[192:193], v4 offset:17408
v_cvt_pk_bf16_f32 v52, v30, v31
v_mfma_f32_16x16x32_bf16 a[224:227], a[196:199], v[40:43], a[224:227]
ds_read_b64_tr_b16 a[194:195], v4 offset:21504
v_add_f32 v27, v30, v31
v_mfma_f32_16x16x32_bf16 a[228:231], a[200:203], v[68:71], a[228:231]
s_waitcnt lgkmcnt(4)
v_exp_f32 v20, v102
v_mfma_f32_16x16x32_bf16 a[228:231], a[204:207], v[32:35], a[228:231]
ds_read_b64_tr_b16 a[196:197], v4 offset:25600
v_add_f32 v27, v27, v20
v_mfma_f32_16x16x32_bf16 a[232:235], a[200:203], v[72:75], a[232:235]
s_add_u32 s90, s54, s94
ds_read_b64_tr_b16 a[198:199], v4 offset:29696
v_fma_f32 v85, v85, s24, v13
v_mfma_f32_16x16x32_bf16 a[232:235], a[204:207], v[36:39], a[232:235]
buffer_load_dwordx4 v7, s[12:15], s90 offen offset:2048 nt lds
v_mfma_f32_16x16x32_bf16 a[236:239], a[200:203], v[76:79], a[236:239]
ds_read_b64_tr_b16 a[200:201], v5 offset:17408
v_fma_f32 v86, v86, s24, v13
v_mfma_f32_16x16x32_bf16 a[236:239], a[204:207], v[40:43], a[236:239]
ds_read_b64_tr_b16 a[202:203], v5 offset:21504
v_fma_f32 v87, v87, s24, v13
v_mfma_f32_16x16x32_bf16 a[240:243], a[208:211], v[68:71], a[240:243]
s_waitcnt lgkmcnt(4)
v_exp_f32 v21, v103
v_mfma_f32_16x16x32_bf16 a[240:243], a[212:215], v[32:35], a[240:243]
ds_read_b64_tr_b16 a[204:205], v5 offset:25600
v_cvt_pk_bf16_f32 v53, v20, v21
v_mfma_f32_16x16x32_bf16 a[244:247], a[208:211], v[72:75], a[244:247]
ds_read_b64_tr_b16 a[206:207], v5 offset:29696
v_add_f32 v27, v27, v21
v_mfma_f32_16x16x32_bf16 a[244:247], a[212:215], v[36:39], a[244:247]
v_exp_f32 v28, v80
v_mfma_f32_16x16x32_bf16 a[248:251], a[208:211], v[76:79], a[248:251]
ds_read_b64_tr_b16 a[208:209], v6 offset:17408
v_add_f32 v24, v24, v28
v_mfma_f32_16x16x32_bf16 a[248:251], a[212:215], v[40:43], a[248:251]
s_add_u32 s90, s54, s95
ds_read_b64_tr_b16 a[210:211], v6 offset:21504
v_fma_f32 v88, v88, s24, v15
v_mfma_f32_16x16x32_bf16 a[252:255], a[192:195], v[68:71], a[252:255]
s_waitcnt lgkmcnt(4)
buffer_load_dwordx4 v7, s[12:15], s90 offen offset:3072 nt lds
v_mfma_f32_16x16x32_bf16 a[252:255], a[196:199], v[32:35], a[252:255]
ds_read_b64_tr_b16 a[212:213], v6 offset:25600
v_fma_f32 v89, v89, s24, v15
v_mfma_f32_16x16x32_bf16 v[224:227], a[192:195], v[72:75], v[224:227]
ds_read_b64_tr_b16 a[214:215], v6 offset:29696
v_fma_f32 v90, v90, s24, v15
v_mfma_f32_16x16x32_bf16 v[224:227], a[196:199], v[36:39], v[224:227]
v_exp_f32 v29, v81
v_mfma_f32_16x16x32_bf16 v[228:231], a[192:195], v[76:79], v[228:231]
v_exp_f32 v30, v82
v_mfma_f32_16x16x32_bf16 v[228:231], a[196:199], v[40:43], v[228:231]
v_exp_f32 v31, v83
v_mfma_f32_16x16x32_bf16 v[232:235], a[200:203], v[68:71], v[232:235]
s_waitcnt lgkmcnt(2)
v_exp_f32 v20, v84
v_mfma_f32_16x16x32_bf16 v[232:235], a[204:207], v[32:35], v[232:235]
v_exp_f32 v21, v85
v_mfma_f32_16x16x32_bf16 v[236:239], a[200:203], v[72:75], v[236:239]
v_cvt_pk_bf16_f32 v46, v28, v29
v_add_f32 v24, v24, v29
v_mfma_f32_16x16x32_bf16 v[236:239], a[204:207], v[36:39], v[236:239]
s_waitcnt vmcnt(14) lgkmcnt(0)
v_exp_f32 v28, v86
v_mfma_f32_16x16x32_bf16 v[240:243], a[200:203], v[76:79], v[240:243]
s_barrier
ds_read_b128 a[136:139], v8 offset:6144
v_mfma_f32_16x16x32_bf16 v[240:243], a[204:207], v[40:43], v[240:243]
ds_read_b128 a[192:195], v1 offset:0
v_cvt_pk_bf16_f32 v47, v30, v31
v_mfma_f32_16x16x32_bf16 v[244:247], a[208:211], v[68:71], v[244:247]
ds_read_b128 a[196:199], v2 offset:0
v_add_f32 v24, v24, v30
v_mfma_f32_16x16x32_bf16 v[244:247], a[212:215], v[32:35], v[244:247]
ds_read_b128 a[200:203], v1 offset:1024
v_add_f32 v24, v24, v31
v_mfma_f32_16x16x32_bf16 v[248:251], a[208:211], v[72:75], v[248:251]
s_mov_b32 m0, s37
ds_read_b128 a[204:207], v2 offset:1024
v_cvt_pk_bf16_f32 v50, v20, v21
v_mfma_f32_16x16x32_bf16 v[248:251], a[212:215], v[36:39], v[248:251]
s_addk_i32 s81, 2048
v_exp_f32 v29, v87
v_mfma_f32_16x16x32_bf16 v[252:255], a[208:211], v[76:79], v[252:255]
s_add_u32 s90, s81, s94
ds_read_b128 a[208:211], v1 offset:2048
v_add_f32 v26, v26, v20
v_mfma_f32_16x16x32_bf16 v[252:255], a[212:215], v[40:43], v[252:255]
s_waitcnt lgkmcnt(4)
ds_read_b128 a[212:215], v2 offset:2048
v_add_f32 v26, v26, v21
v_mfma_f32_16x16x32_bf16 v[32:35], a[192:195], a[0:3], 0
s_waitcnt lgkmcnt(4)
buffer_load_dwordx4 v7, s[16:19], s90 offen offset:0 nt lds
v_mfma_f32_16x16x32_bf16 v[32:35], a[196:199], a[12:15], v[32:35]
v_exp_f32 v30, v88
v_mfma_f32_16x16x32_bf16 v[36:39], a[192:195], a[4:7], 0
v_exp_f32 v31, v89
v_mfma_f32_16x16x32_bf16 v[36:39], a[196:199], a[16:19], v[36:39]
v_exp_f32 v20, v90
v_mfma_f32_16x16x32_bf16 v[40:43], a[192:195], a[8:11], 0
ds_read_b128 a[192:195], v1 offset:3072
v_cvt_pk_bf16_f32 v51, v28, v29
v_mfma_f32_16x16x32_bf16 v[40:43], a[196:199], a[20:23], v[40:43]
s_waitcnt lgkmcnt(1)
ds_read_b128 a[196:199], v2 offset:3072
v_add_f32 v26, v26, v28
v_mfma_f32_16x16x32_bf16 v[32:35], a[200:203], a[24:27], v[32:35]
s_add_u32 s91, s81, s95
v_add_f32 v26, v26, v29
v_fma_f32 v91, v91, s24, v15
v_mfma_f32_16x16x32_bf16 v[32:35], a[204:207], a[36:39], v[32:35]
buffer_load_dwordx4 v7, s[16:19], s91 offen offset:1024 nt lds
v_mfma_f32_16x16x32_bf16 v[36:39], a[200:203], a[28:31], v[36:39]
v_exp_f32 v21, v91
v_mfma_f32_16x16x32_bf16 v[36:39], a[204:207], a[40:43], v[36:39]
PADJ_5:
s_cbranch_execz PADJ_9
v_mfma_f32_16x16x32_bf16 v[40:43], a[200:203], a[32:35], v[40:43]
ds_read_b128 a[200:203], v1 offset:8192
v_cvt_pk_bf16_f32 v54, v30, v31
v_mfma_f32_16x16x32_bf16 v[40:43], a[204:207], a[44:47], v[40:43]
ds_read_b128 a[204:207], v2 offset:8192
v_add_f32 v27, v27, v30
v_mfma_f32_16x16x32_bf16 v[32:35], a[208:211], a[48:51], v[32:35]
v_add_f32 v27, v27, v31
v_cvt_pk_bf16_f32 v55, v20, v21
v_mfma_f32_16x16x32_bf16 v[32:35], a[212:215], a[60:63], v[32:35]
v_add_f32 v27, v27, v20
v_add_f32 v27, v27, v21
v_mfma_f32_16x16x32_bf16 v[36:39], a[208:211], a[52:55], v[36:39]
v_max3_f32 v25, v24, v26, v27
v_cmp_lt_f32 vcc, s25, v25
v_mfma_f32_16x16x32_bf16 v[36:39], a[212:215], a[64:67], v[36:39]
v_xor_b32 v8, 64, v8
v_mfma_f32_16x16x32_bf16 v[40:43], a[208:211], a[56:59], v[40:43]
s_addk_i32 s90, 2048
ds_read_b128 a[208:211], v1 offset:9216
ds_read_b128 a[124:127], v8 offset:6144
v_mfma_f32_16x16x32_bf16 v[40:43], a[212:215], a[68:71], v[40:43]
s_waitcnt lgkmcnt(2)
ds_read_b128 a[212:215], v2 offset:9216
v_mfma_f32_16x16x32_bf16 v[32:35], a[192:195], a[72:75], v[32:35]
buffer_load_dwordx4 v7, s[16:19], s90 offen offset:2048 nt lds
v_mfma_f32_16x16x32_bf16 v[32:35], a[196:199], a[84:87], v[32:35]
v_mfma_f32_16x16x32_bf16 v[36:39], a[192:195], a[76:79], v[36:39]
v_mfma_f32_16x16x32_bf16 v[36:39], a[196:199], a[88:91], v[36:39]
s_cbranch_vccnz STUB_11
BACK_11:
v_mfma_f32_16x16x32_bf16 v[40:43], a[192:195], a[80:83], v[40:43]
ds_read_b128 a[192:195], v1 offset:10240
v_add_f32 v19, v19, v27
v_mfma_f32_16x16x32_bf16 v[40:43], a[196:199], a[92:95], v[40:43]
ds_read_b128 a[196:199], v2 offset:10240
v_add_f32 v17, v17, v24
v_mfma_f32_16x16x32_bf16 v[80:83], a[200:203], a[0:3], 0
s_addk_i32 s91, 2048
v_add_f32 v18, v18, v26
v_fma_f32 v32, v32, s24, v11
v_mfma_f32_16x16x32_bf16 v[80:83], a[204:207], a[12:15], v[80:83]
buffer_load_dwordx4 v7, s[16:19], s91 offen offset:3072 nt lds
v_mfma_f32_16x16x32_bf16 v[84:87], a[200:203], a[4:7], 0
v_exp_f32 v28, v32
v_mfma_f32_16x16x32_bf16 v[84:87], a[204:207], a[16:19], v[84:87]
v_fma_f32 v33, v33, s24, v11
v_fma_f32 v34, v34, s24, v11
v_mfma_f32_16x16x32_bf16 v[88:91], a[200:203], a[8:11], 0
ds_read_b128 a[200:203], v1 offset:11264
v_fma_f32 v35, v35, s24, v11
v_mfma_f32_16x16x32_bf16 v[88:91], a[204:207], a[20:23], v[88:91]
s_waitcnt lgkmcnt(1)
ds_read_b128 a[204:207], v2 offset:11264
v_fma_f32 v36, v36, s24, v13
v_mfma_f32_16x16x32_bf16 v[80:83], a[208:211], a[24:27], v[80:83]
v_exp_f32 v29, v33
v_mfma_f32_16x16x32_bf16 v[80:83], a[212:215], a[36:39], v[80:83]
s_add_u32 m0, s4, 2048
v_exp_f32 v30, v34
v_mfma_f32_16x16x32_bf16 v[84:87], a[208:211], a[28:31], v[84:87]
s_add_u32 s88, s31, s84
v_exp_f32 v31, v35
v_mfma_f32_16x16x32_bf16 v[84:87], a[212:215], a[40:43], v[84:87]
buffer_load_dwordx4 v7, s[8:11], s88 offen offset:0 nt lds
v_mfma_f32_16x16x32_bf16 v[88:91], a[208:211], a[32:35], v[88:91]
ds_read_b64_tr_b16 a[208:209], v3 offset:32768
v_cvt_pk_bf16_f32 v68, v28, v29
v_mfma_f32_16x16x32_bf16 v[88:91], a[212:215], a[44:47], v[88:91]
ds_read_b64_tr_b16 a[210:211], v3 offset:36864
v_add_f32 v24, v28, v29
v_mfma_f32_16x16x32_bf16 v[80:83], a[192:195], a[48:51], v[80:83]
v_exp_f32 v20, v36
v_mfma_f32_16x16x32_bf16 v[80:83], a[196:199], a[60:63], v[80:83]
ds_read_b64_tr_b16 a[212:213], v3 offset:40960
v_cvt_pk_bf16_f32 v69, v30, v31
v_mfma_f32_16x16x32_bf16 v[84:87], a[192:195], a[52:55], v[84:87]
ds_read_b64_tr_b16 a[214:215], v3 offset:45056
v_add_f32 v24, v24, v30
v_mfma_f32_16x16x32_bf16 v[84:87], a[196:199], a[64:67], v[84:87]
v_add_f32 v24, v24, v31
v_fma_f32 v37, v37, s24, v13
v_mfma_f32_16x16x32_bf16 v[88:91], a[192:195], a[56:59], v[88:91]
s_addk_i32 s88, 3072
ds_read_b64_tr_b16 a[192:193], v4 offset:32768
v_fma_f32 v38, v38, s24, v13
v_mfma_f32_16x16x32_bf16 v[88:91], a[196:199], a[68:71], v[88:91]
s_waitcnt lgkmcnt(3)
ds_read_b64_tr_b16 a[194:195], v4 offset:36864
v_fma_f32 v39, v39, s24, v13
v_mfma_f32_16x16x32_bf16 v[80:83], a[200:203], a[72:75], v[80:83]
buffer_load_dwordx4 v7, s[8:11], s88 offen offset:1024 nt lds
v_mfma_f32_16x16x32_bf16 v[80:83], a[204:207], a[84:87], v[80:83]
ds_read_b64_tr_b16 a[196:197], v4 offset:40960
v_fma_f32 v40, v40, s24, v15
v_mfma_f32_16x16x32_bf16 v[84:87], a[200:203], a[76:79], v[84:87]
ds_read_b64_tr_b16 a[198:199], v4 offset:45056
v_fma_f32 v41, v41, s24, v15
v_mfma_f32_16x16x32_bf16 v[84:87], a[204:207], a[88:91], v[84:87]
v_exp_f32 v21, v37
v_mfma_f32_16x16x32_bf16 v[88:91], a[200:203], a[80:83], v[88:91]
ds_read_b64_tr_b16 a[200:201], v5 offset:32768
v_cvt_pk_bf16_f32 v72, v20, v21
v_mfma_f32_16x16x32_bf16 v[88:91], a[204:207], a[92:95], v[88:91]
ds_read_b64_tr_b16 a[202:203], v5 offset:36864
v_add_f32 v26, v20, v21
v_mfma_f32_16x16x32_bf16 v[104:107], a[208:211], v[56:59], v[104:107]
s_waitcnt lgkmcnt(4)
v_exp_f32 v28, v38
v_mfma_f32_16x16x32_bf16 v[104:107], a[212:215], v[44:47], v[104:107]
s_mov_b32 m0, s35
ds_read_b64_tr_b16 a[204:205], v5 offset:40960
v_add_f32 v26, v26, v28
v_mfma_f32_16x16x32_bf16 v[108:111], a[208:211], v[60:63], v[108:111]
s_add_u32 s90, s55, s92
ds_read_b64_tr_b16 a[206:207], v5 offset:45056
v_fma_f32 v42, v42, s24, v15
v_mfma_f32_16x16x32_bf16 v[108:111], a[212:215], v[48:51], v[108:111]
buffer_load_dwordx4 v7, s[12:15], s90 offen offset:0 nt lds
v_mfma_f32_16x16x32_bf16 v[112:115], a[208:211], v[64:67], v[112:115]
ds_read_b64_tr_b16 a[208:209], v6 offset:32768
v_fma_f32 v43, v43, s24, v15
v_mfma_f32_16x16x32_bf16 v[112:115], a[212:215], v[52:55], v[112:115]
ds_read_b64_tr_b16 a[210:211], v6 offset:36864
v_fma_f32 v80, v80, s24, v11
v_mfma_f32_16x16x32_bf16 v[116:119], a[192:195], v[56:59], v[116:119]
s_waitcnt lgkmcnt(4)
v_exp_f32 v29, v39
v_mfma_f32_16x16x32_bf16 v[116:119], a[196:199], v[44:47], v[116:119]
ds_read_b64_tr_b16 a[212:213], v6 offset:40960
v_cvt_pk_bf16_f32 v73, v28, v29
v_mfma_f32_16x16x32_bf16 v[120:123], a[192:195], v[60:63], v[120:123]
ds_read_b64_tr_b16 a[214:215], v6 offset:45056
v_add_f32 v26, v26, v29
v_mfma_f32_16x16x32_bf16 v[120:123], a[196:199], v[48:51], v[120:123]
v_exp_f32 v30, v40
v_mfma_f32_16x16x32_bf16 v[124:127], a[192:195], v[64:67], v[124:127]
ds_read_b64_tr_b16 a[192:193], v3 offset:33792
v_fma_f32 v81, v81, s24, v11
v_mfma_f32_16x16x32_bf16 v[124:127], a[196:199], v[52:55], v[124:127]
s_add_u32 s90, s55, s93
ds_read_b64_tr_b16 a[194:195], v3 offset:37888
v_fma_f32 v82, v82, s24, v11
v_mfma_f32_16x16x32_bf16 v[128:131], a[200:203], v[56:59], v[128:131]
s_waitcnt lgkmcnt(4)
buffer_load_dwordx4 v7, s[12:15], s90 offen offset:1024 nt lds
v_mfma_f32_16x16x32_bf16 v[128:131], a[204:207], v[44:47], v[128:131]
ds_read_b64_tr_b16 a[196:197], v3 offset:41984
v_fma_f32 v83, v83, s24, v11
v_mfma_f32_16x16x32_bf16 v[132:135], a[200:203], v[60:63], v[132:135]
ds_read_b64_tr_b16 a[198:199], v3 offset:46080
v_fma_f32 v84, v84, s24, v13
v_mfma_f32_16x16x32_bf16 v[132:135], a[204:207], v[48:51], v[132:135]
v_exp_f32 v31, v41
v_mfma_f32_16x16x32_bf16 v[136:139], a[200:203], v[64:67], v[136:139]
ds_read_b64_tr_b16 a[200:201], v4 offset:33792
v_cvt_pk_bf16_f32 v76, v30, v31
v_mfma_f32_16x16x32_bf16 v[136:139], a[204:207], v[52:55], v[136:139]
ds_read_b64_tr_b16 a[202:203], v4 offset:37888
v_add_f32 v27, v30, v31
v_mfma_f32_16x16x32_bf16 v[140:143], a[208:211], v[56:59], v[140:143]
s_waitcnt lgkmcnt(4)
v_exp_f32 v20, v42
v_mfma_f32_16x16x32_bf16 v[140:143], a[212:215], v[44:47], v[140:143]
ds_read_b64_tr_b16 a[204:205], v4 offset:41984
v_add_f32 v27, v27, v20
v_mfma_f32_16x16x32_bf16 v[144:147], a[208:211], v[60:63], v[144:147]
s_add_u32 s90, s55, s94
ds_read_b64_tr_b16 a[206:207], v4 offset:46080
v_fma_f32 v85, v85, s24, v13
v_mfma_f32_16x16x32_bf16 v[144:147], a[212:215], v[48:51], v[144:147]
buffer_load_dwordx4 v7, s[12:15], s90 offen offset:2048 nt lds
v_mfma_f32_16x16x32_bf16 v[148:151], a[208:211], v[64:67], v[148:151]
ds_read_b64_tr_b16 a[208:209], v5 offset:33792
v_fma_f32 v86, v86, s24, v13
v_mfma_f32_16x16x32_bf16 v[148:151], a[212:215], v[52:55], v[148:151]
ds_read_b64_tr_b16 a[210:211], v5 offset:37888
v_fma_f32 v87, v87, s24, v13
v_mfma_f32_16x16x32_bf16 v[152:155], a[192:195], v[56:59], v[152:155]
s_waitcnt lgkmcnt(4)
v_exp_f32 v21, v43
v_mfma_f32_16x16x32_bf16 v[152:155], a[196:199], v[44:47], v[152:155]
ds_read_b64_tr_b16 a[212:213], v5 offset:41984
v_cvt_pk_bf16_f32 v77, v20, v21
v_mfma_f32_16x16x32_bf16 v[156:159], a[192:195], v[60:63], v[156:159]
ds_read_b64_tr_b16 a[214:215], v5 offset:46080
v_add_f32 v27, v27, v21
v_mfma_f32_16x16x32_bf16 v[156:159], a[196:199], v[48:51], v[156:159]
v_exp_f32 v28, v80
v_mfma_f32_16x16x32_bf16 v[160:163], a[192:195], v[64:67], v[160:163]
ds_read_b64_tr_b16 a[192:193], v6 offset:33792
v_add_f32 v24, v24, v28
v_mfma_f32_16x16x32_bf16 v[160:163], a[196:199], v[52:55], v[160:163]
s_add_u32 s90, s55, s95
ds_read_b64_tr_b16 a[194:195], v6 offset:37888
v_fma_f32 v88, v88, s24, v15
v_mfma_f32_16x16x32_bf16 v[164:167], a[200:203], v[56:59], v[164:167]
s_waitcnt lgkmcnt(4)
buffer_load_dwordx4 v7, s[12:15], s90 offen offset:3072 nt lds
v_mfma_f32_16x16x32_bf16 v[164:167], a[204:207], v[44:47], v[164:167]
ds_read_b64_tr_b16 a[196:197], v6 offset:41984
v_fma_f32 v89, v89, s24, v15
v_mfma_f32_16x16x32_bf16 v[168:171], a[200:203], v[60:63], v[168:171]
ds_read_b64_tr_b16 a[198:199], v6 offset:46080
v_fma_f32 v90, v90, s24, v15
v_mfma_f32_16x16x32_bf16 v[168:171], a[204:207], v[48:51], v[168:171]
v_exp_f32 v29, v81
v_mfma_f32_16x16x32_bf16 v[172:175], a[200:203], v[64:67], v[172:175]
v_exp_f32 v30, v82
v_mfma_f32_16x16x32_bf16 v[172:175], a[204:207], v[52:55], v[172:175]
v_exp_f32 v31, v83
v_mfma_f32_16x16x32_bf16 v[176:179], a[208:211], v[56:59], v[176:179]
s_waitcnt lgkmcnt(2)
v_exp_f32 v20, v84
v_mfma_f32_16x16x32_bf16 v[176:179], a[212:215], v[44:47], v[176:179]
v_exp_f32 v21, v85
v_mfma_f32_16x16x32_bf16 v[180:183], a[208:211], v[60:63], v[180:183]
v_cvt_pk_bf16_f32 v70, v28, v29
v_add_f32 v24, v24, v29
v_mfma_f32_16x16x32_bf16 v[180:183], a[212:215], v[48:51], v[180:183]
s_waitcnt vmcnt(14) lgkmcnt(0)
v_exp_f32 v28, v86
v_mfma_f32_16x16x32_bf16 v[184:187], a[208:211], v[64:67], v[184:187]
s_barrier
ds_read_b128 a[148:151], v8 offset:0
v_mfma_f32_16x16x32_bf16 v[184:187], a[212:215], v[52:55], v[184:187]
ds_read_b128 a[200:203], v1 offset:16384
v_cvt_pk_bf16_f32 v71, v30, v31
v_mfma_f32_16x16x32_bf16 v[188:191], a[192:195], v[56:59], v[188:191]
ds_read_b128 a[204:207], v2 offset:16384
v_add_f32 v24, v24, v30
v_mfma_f32_16x16x32_bf16 v[188:191], a[196:199], v[44:47], v[188:191]
ds_read_b128 a[208:211], v1 offset:17408
v_add_f32 v24, v24, v31
v_mfma_f32_16x16x32_bf16 v[192:195], a[192:195], v[60:63], v[192:195]
s_mov_b32 m0, s38
ds_read_b128 a[212:215], v2 offset:17408
v_cvt_pk_bf16_f32 v74, v20, v21
v_mfma_f32_16x16x32_bf16 v[192:195], a[196:199], v[48:51], v[192:195]
s_bitcmp1_b32 s3, 1
s_cselect_b32 s81, s55, s54
v_add_f32 v26, v26, v20
v_mfma_f32_16x16x32_bf16 v[196:199], a[192:195], v[64:67], v[196:199]
s_add_u32 s90, s81, s92
ds_read_b128 a[192:195], v1 offset:18432
v_add_f32 v26, v26, v21
v_mfma_f32_16x16x32_bf16 v[196:199], a[196:199], v[52:55], v[196:199]
s_waitcnt lgkmcnt(4)
ds_read_b128 a[196:199], v2 offset:18432
v_add_f32 v26, v26, v28
v_mfma_f32_16x16x32_bf16 v[92:95], a[200:203], a[0:3], 0
s_waitcnt lgkmcnt(4)
buffer_load_dwordx4 v7, s[16:19], s90 offen offset:0 nt lds
v_mfma_f32_16x16x32_bf16 v[92:95], a[204:207], a[12:15], v[92:95]
v_exp_f32 v29, v87
v_mfma_f32_16x16x32_bf16 v[96:99], a[200:203], a[4:7], 0
v_exp_f32 v30, v88
v_mfma_f32_16x16x32_bf16 v[96:99], a[204:207], a[16:19], v[96:99]
v_exp_f32 v31, v89
v_mfma_f32_16x16x32_bf16 v[100:103], a[200:203], a[8:11], 0
ds_read_b128 a[200:203], v1 offset:19456
v_cvt_pk_bf16_f32 v75, v28, v29
v_mfma_f32_16x16x32_bf16 v[100:103], a[204:207], a[20:23], v[100:103]
s_waitcnt lgkmcnt(1)
ds_read_b128 a[204:207], v2 offset:19456
v_add_f32 v26, v26, v29
v_mfma_f32_16x16x32_bf16 v[92:95], a[208:211], a[24:27], v[92:95]
s_add_u32 s91, s81, s93
v_exp_f32 v20, v90
v_mfma_f32_16x16x32_bf16 v[92:95], a[212:215], a[36:39], v[92:95]
buffer_load_dwordx4 v7, s[16:19], s91 offen offset:1024 nt lds
v_mfma_f32_16x16x32_bf16 v[96:99], a[208:211], a[28:31], v[96:99]
v_fma_f32 v91, v91, s24, v15
v_cvt_pk_bf16_f32 v78, v30, v31
v_mfma_f32_16x16x32_bf16 v[96:99], a[212:215], a[40:43], v[96:99]
v_exp_f32 v21, v91
v_mfma_f32_16x16x32_bf16 v[100:103], a[208:211], a[32:35], v[100:103]
ds_read_b128 a[208:211], v1 offset:24576
v_add_f32 v27, v27, v30
v_mfma_f32_16x16x32_bf16 v[100:103], a[212:215], a[44:47], v[100:103]
ds_read_b128 a[212:215], v2 offset:24576
v_add_f32 v27, v27, v31
v_mfma_f32_16x16x32_bf16 v[92:95], a[192:195], a[48:51], v[92:95]
v_cvt_pk_bf16_f32 v79, v20, v21
v_add_f32 v27, v27, v20
v_mfma_f32_16x16x32_bf16 v[92:95], a[196:199], a[60:63], v[92:95]
v_add_f32 v27, v27, v21
v_max3_f32 v25, v24, v26, v27
v_mfma_f32_16x16x32_bf16 v[96:99], a[192:195], a[52:55], v[96:99]
v_cmp_lt_f32 vcc, s25, v25
v_xor_b32 v8, 64, v8
v_mfma_f32_16x16x32_bf16 v[96:99], a[196:199], a[64:67], v[96:99]
ds_read_b128 a[160:163], v8 offset:0
v_mfma_f32_16x16x32_bf16 v[100:103], a[192:195], a[56:59], v[100:103]
s_addk_i32 s90, 2048
ds_read_b128 a[192:195], v1 offset:25600
v_mfma_f32_16x16x32_bf16 v[100:103], a[196:199], a[68:71], v[100:103]
s_waitcnt lgkmcnt(2)
ds_read_b128 a[196:199], v2 offset:25600
v_mfma_f32_16x16x32_bf16 v[92:95], a[200:203], a[72:75], v[92:95]
buffer_load_dwordx4 v7, s[16:19], s90 offen offset:2048 nt lds
v_mfma_f32_16x16x32_bf16 v[92:95], a[204:207], a[84:87], v[92:95]
v_mfma_f32_16x16x32_bf16 v[96:99], a[200:203], a[76:79], v[96:99]
v_mfma_f32_16x16x32_bf16 v[96:99], a[204:207], a[88:91], v[96:99]
s_cbranch_vccnz STUB_12
BACK_12:
v_mfma_f32_16x16x32_bf16 v[100:103], a[200:203], a[80:83], v[100:103]
ds_read_b128 a[200:203], v1 offset:26624
v_add_f32 v19, v19, v27
v_mfma_f32_16x16x32_bf16 v[100:103], a[204:207], a[92:95], v[100:103]
ds_read_b128 a[204:207], v2 offset:26624
v_add_f32 v17, v17, v24
v_mfma_f32_16x16x32_bf16 v[80:83], a[208:211], a[0:3], 0
s_addk_i32 s91, 2048
v_add_f32 v18, v18, v26
v_fma_f32 v92, v92, s24, v11
v_mfma_f32_16x16x32_bf16 v[80:83], a[212:215], a[12:15], v[80:83]
buffer_load_dwordx4 v7, s[16:19], s91 offen offset:3072 nt lds
v_mfma_f32_16x16x32_bf16 v[84:87], a[208:211], a[4:7], 0
v_exp_f32 v28, v92
v_mfma_f32_16x16x32_bf16 v[84:87], a[212:215], a[16:19], v[84:87]
v_fma_f32 v93, v93, s24, v11
v_fma_f32 v94, v94, s24, v11
v_mfma_f32_16x16x32_bf16 v[88:91], a[208:211], a[8:11], 0
ds_read_b128 a[208:211], v1 offset:27648
v_fma_f32 v95, v95, s24, v11
v_mfma_f32_16x16x32_bf16 v[88:91], a[212:215], a[20:23], v[88:91]
s_waitcnt lgkmcnt(1)
ds_read_b128 a[212:215], v2 offset:27648
v_fma_f32 v96, v96, s24, v13
v_mfma_f32_16x16x32_bf16 v[80:83], a[192:195], a[24:27], v[80:83]
v_exp_f32 v29, v93
v_mfma_f32_16x16x32_bf16 v[80:83], a[196:199], a[36:39], v[80:83]
s_add_u32 m0, s4, 4096
v_exp_f32 v30, v94
v_mfma_f32_16x16x32_bf16 v[84:87], a[192:195], a[28:31], v[84:87]
s_add_u32 s88, s31, s85
v_exp_f32 v31, v95
v_mfma_f32_16x16x32_bf16 v[84:87], a[196:199], a[40:43], v[84:87]
buffer_load_dwordx4 v7, s[8:11], s88 offen offset:0 nt lds
v_mfma_f32_16x16x32_bf16 v[88:91], a[192:195], a[32:35], v[88:91]
ds_read_b64_tr_b16 a[192:193], v3 offset:49152
v_cvt_pk_bf16_f32 v32, v28, v29
v_mfma_f32_16x16x32_bf16 v[88:91], a[196:199], a[44:47], v[88:91]
ds_read_b64_tr_b16 a[194:195], v3 offset:53248
v_add_f32 v24, v28, v29
v_mfma_f32_16x16x32_bf16 v[80:83], a[200:203], a[48:51], v[80:83]
v_exp_f32 v20, v96
v_mfma_f32_16x16x32_bf16 v[80:83], a[204:207], a[60:63], v[80:83]
ds_read_b64_tr_b16 a[196:197], v3 offset:57344
v_cvt_pk_bf16_f32 v33, v30, v31
v_mfma_f32_16x16x32_bf16 v[84:87], a[200:203], a[52:55], v[84:87]
ds_read_b64_tr_b16 a[198:199], v3 offset:61440
v_add_f32 v24, v24, v30
v_mfma_f32_16x16x32_bf16 v[84:87], a[204:207], a[64:67], v[84:87]
v_add_f32 v24, v24, v31
v_fma_f32 v97, v97, s24, v13
v_mfma_f32_16x16x32_bf16 v[88:91], a[200:203], a[56:59], v[88:91]
s_addk_i32 s88, 3072
ds_read_b64_tr_b16 a[200:201], v4 offset:49152
v_fma_f32 v98, v98, s24, v13
v_mfma_f32_16x16x32_bf16 v[88:91], a[204:207], a[68:71], v[88:91]
s_waitcnt lgkmcnt(3)
ds_read_b64_tr_b16 a[202:203], v4 offset:53248
v_fma_f32 v99, v99, s24, v13
v_mfma_f32_16x16x32_bf16 v[80:83], a[208:211], a[72:75], v[80:83]
buffer_load_dwordx4 v7, s[8:11], s88 offen offset:1024 nt lds
v_mfma_f32_16x16x32_bf16 v[80:83], a[212:215], a[84:87], v[80:83]
ds_read_b64_tr_b16 a[204:205], v4 offset:57344
v_fma_f32 v100, v100, s24, v15
v_mfma_f32_16x16x32_bf16 v[84:87], a[208:211], a[76:79], v[84:87]
ds_read_b64_tr_b16 a[206:207], v4 offset:61440
v_fma_f32 v101, v101, s24, v15
v_mfma_f32_16x16x32_bf16 v[84:87], a[212:215], a[88:91], v[84:87]
v_exp_f32 v21, v97
v_mfma_f32_16x16x32_bf16 v[88:91], a[208:211], a[80:83], v[88:91]
ds_read_b64_tr_b16 a[208:209], v5 offset:49152
v_cvt_pk_bf16_f32 v36, v20, v21
v_mfma_f32_16x16x32_bf16 v[88:91], a[212:215], a[92:95], v[88:91]
ds_read_b64_tr_b16 a[210:211], v5 offset:53248
v_add_f32 v26, v20, v21
v_mfma_f32_16x16x32_bf16 v[200:203], a[192:195], v[56:59], v[200:203]
s_waitcnt lgkmcnt(4)
v_exp_f32 v28, v98
v_mfma_f32_16x16x32_bf16 v[200:203], a[196:199], v[44:47], v[200:203]
s_mov_b32 m0, s32
ds_read_b64_tr_b16 a[212:213], v5 offset:57344
v_add_f32 v26, v26, v28
v_mfma_f32_16x16x32_bf16 v[204:207], a[192:195], v[60:63], v[204:207]
s_add_u32 s90, s56, s92
ds_read_b64_tr_b16 a[214:215], v5 offset:61440
v_fma_f32 v102, v102, s24, v15
v_mfma_f32_16x16x32_bf16 v[204:207], a[196:199], v[48:51], v[204:207]
buffer_load_dwordx4 v7, s[12:15], s90 offen offset:0 nt lds
v_mfma_f32_16x16x32_bf16 v[208:211], a[192:195], v[64:67], v[208:211]
ds_read_b64_tr_b16 a[192:193], v6 offset:49152
v_fma_f32 v103, v103, s24, v15
v_mfma_f32_16x16x32_bf16 v[208:211], a[196:199], v[52:55], v[208:211]
ds_read_b64_tr_b16 a[194:195], v6 offset:53248
v_fma_f32 v80, v80, s24, v11
v_mfma_f32_16x16x32_bf16 v[212:215], a[200:203], v[56:59], v[212:215]
s_waitcnt lgkmcnt(4)
v_exp_f32 v29, v99
v_mfma_f32_16x16x32_bf16 v[212:215], a[204:207], v[44:47], v[212:215]
ds_read_b64_tr_b16 a[196:197], v6 offset:57344
v_cvt_pk_bf16_f32 v37, v28, v29
v_mfma_f32_16x16x32_bf16 v[216:219], a[200:203], v[60:63], v[216:219]
ds_read_b64_tr_b16 a[198:199], v6 offset:61440
v_add_f32 v26, v26, v29
v_mfma_f32_16x16x32_bf16 v[216:219], a[204:207], v[48:51], v[216:219]
v_exp_f32 v30, v100
v_mfma_f32_16x16x32_bf16 v[220:223], a[200:203], v[64:67], v[220:223]
ds_read_b64_tr_b16 a[200:201], v3 offset:50176
v_fma_f32 v81, v81, s24, v11
v_mfma_f32_16x16x32_bf16 v[220:223], a[204:207], v[52:55], v[220:223]
s_add_u32 s90, s56, s93
ds_read_b64_tr_b16 a[202:203], v3 offset:54272
v_fma_f32 v82, v82, s24, v11
v_mfma_f32_16x16x32_bf16 a[216:219], a[208:211], v[56:59], a[216:219]
s_waitcnt lgkmcnt(4)
buffer_load_dwordx4 v7, s[12:15], s90 offen offset:1024 nt lds
v_mfma_f32_16x16x32_bf16 a[216:219], a[212:215], v[44:47], a[216:219]
ds_read_b64_tr_b16 a[204:205], v3 offset:58368
v_fma_f32 v83, v83, s24, v11
v_mfma_f32_16x16x32_bf16 a[220:223], a[208:211], v[60:63], a[220:223]
ds_read_b64_tr_b16 a[206:207], v3 offset:62464
v_fma_f32 v84, v84, s24, v13
v_mfma_f32_16x16x32_bf16 a[220:223], a[212:215], v[48:51], a[220:223]
v_exp_f32 v31, v101
v_mfma_f32_16x16x32_bf16 a[224:227], a[208:211], v[64:67], a[224:227]
ds_read_b64_tr_b16 a[208:209], v4 offset:50176
v_cvt_pk_bf16_f32 v40, v30, v31
v_mfma_f32_16x16x32_bf16 a[224:227], a[212:215], v[52:55], a[224:227]
ds_read_b64_tr_b16 a[210:211], v4 offset:54272
v_add_f32 v27, v30, v31
v_mfma_f32_16x16x32_bf16 a[228:231], a[192:195], v[56:59], a[228:231]
s_waitcnt lgkmcnt(4)
v_exp_f32 v20, v102
v_mfma_f32_16x16x32_bf16 a[228:231], a[196:199], v[44:47], a[228:231]
ds_read_b64_tr_b16 a[212:213], v4 offset:58368
v_add_f32 v27, v27, v20
v_mfma_f32_16x16x32_bf16 a[232:235], a[192:195], v[60:63], a[232:235]
s_add_u32 s90, s56, s94
ds_read_b64_tr_b16 a[214:215], v4 offset:62464
v_fma_f32 v85, v85, s24, v13
v_mfma_f32_16x16x32_bf16 a[232:235], a[196:199], v[48:51], a[232:235]
buffer_load_dwordx4 v7, s[12:15], s90 offen offset:2048 nt lds
v_mfma_f32_16x16x32_bf16 a[236:239], a[192:195], v[64:67], a[236:239]
ds_read_b64_tr_b16 a[192:193], v5 offset:50176
v_fma_f32 v86, v86, s24, v13
v_mfma_f32_16x16x32_bf16 a[236:239], a[196:199], v[52:55], a[236:239]
ds_read_b64_tr_b16 a[194:195], v5 offset:54272
v_fma_f32 v87, v87, s24, v13
v_mfma_f32_16x16x32_bf16 a[240:243], a[200:203], v[56:59], a[240:243]
s_waitcnt lgkmcnt(4)
v_exp_f32 v21, v103
v_mfma_f32_16x16x32_bf16 a[240:243], a[204:207], v[44:47], a[240:243]
ds_read_b64_tr_b16 a[196:197], v5 offset:58368
v_cvt_pk_bf16_f32 v41, v20, v21
v_mfma_f32_16x16x32_bf16 a[244:247], a[200:203], v[60:63], a[244:247]
ds_read_b64_tr_b16 a[198:199], v5 offset:62464
v_add_f32 v27, v27, v21
v_mfma_f32_16x16x32_bf16 a[244:247], a[204:207], v[48:51], a[244:247]
v_exp_f32 v28, v80
v_mfma_f32_16x16x32_bf16 a[248:251], a[200:203], v[64:67], a[248:251]
ds_read_b64_tr_b16 a[200:201], v6 offset:50176
v_add_f32 v24, v24, v28
v_mfma_f32_16x16x32_bf16 a[248:251], a[204:207], v[52:55], a[248:251]
s_add_u32 s90, s56, s95
ds_read_b64_tr_b16 a[202:203], v6 offset:54272
v_fma_f32 v88, v88, s24, v15
v_mfma_f32_16x16x32_bf16 a[252:255], a[208:211], v[56:59], a[252:255]
s_waitcnt lgkmcnt(4)
buffer_load_dwordx4 v7, s[12:15], s90 offen offset:3072 nt lds
v_mfma_f32_16x16x32_bf16 a[252:255], a[212:215], v[44:47], a[252:255]
ds_read_b64_tr_b16 a[204:205], v6 offset:58368
v_fma_f32 v89, v89, s24, v15
v_mfma_f32_16x16x32_bf16 v[224:227], a[208:211], v[60:63], v[224:227]
ds_read_b64_tr_b16 a[206:207], v6 offset:62464
v_fma_f32 v90, v90, s24, v15
v_mfma_f32_16x16x32_bf16 v[224:227], a[212:215], v[48:51], v[224:227]
v_exp_f32 v29, v81
v_mfma_f32_16x16x32_bf16 v[228:231], a[208:211], v[64:67], v[228:231]
v_exp_f32 v30, v82
v_mfma_f32_16x16x32_bf16 v[228:231], a[212:215], v[52:55], v[228:231]
v_exp_f32 v31, v83
v_mfma_f32_16x16x32_bf16 v[232:235], a[192:195], v[56:59], v[232:235]
s_waitcnt lgkmcnt(2)
v_exp_f32 v20, v84
v_mfma_f32_16x16x32_bf16 v[232:235], a[196:199], v[44:47], v[232:235]
v_exp_f32 v21, v85
v_mfma_f32_16x16x32_bf16 v[236:239], a[192:195], v[60:63], v[236:239]
v_cvt_pk_bf16_f32 v34, v28, v29
v_add_f32 v24, v24, v29
v_mfma_f32_16x16x32_bf16 v[236:239], a[196:199], v[48:51], v[236:239]
s_waitcnt vmcnt(14) lgkmcnt(0)
v_exp_f32 v28, v86
v_mfma_f32_16x16x32_bf16 v[240:243], a[192:195], v[64:67], v[240:243]
s_barrier
ds_read_b128 a[116:119], v8 offset:2048
v_mfma_f32_16x16x32_bf16 v[240:243], a[196:199], v[52:55], v[240:243]
ds_read_b128 a[208:211], v1 offset:32768
v_cvt_pk_bf16_f32 v35, v30, v31
v_mfma_f32_16x16x32_bf16 v[244:247], a[200:203], v[56:59], v[244:247]
ds_read_b128 a[212:215], v2 offset:32768
v_add_f32 v24, v24, v30
v_mfma_f32_16x16x32_bf16 v[244:247], a[204:207], v[44:47], v[244:247]
ds_read_b128 a[192:195], v1 offset:33792
v_add_f32 v24, v24, v31
v_mfma_f32_16x16x32_bf16 v[248:251], a[200:203], v[60:63], v[248:251]
s_mov_b32 m0, s39
ds_read_b128 a[196:199], v2 offset:33792
v_cvt_pk_bf16_f32 v38, v20, v21
v_mfma_f32_16x16x32_bf16 v[248:251], a[204:207], v[48:51], v[248:251]
s_addk_i32 s81, 2048
v_exp_f32 v29, v87
v_mfma_f32_16x16x32_bf16 v[252:255], a[200:203], v[64:67], v[252:255]
s_add_u32 s90, s81, s94
ds_read_b128 a[200:203], v1 offset:34816
v_add_f32 v26, v26, v20
v_mfma_f32_16x16x32_bf16 v[252:255], a[204:207], v[52:55], v[252:255]
s_waitcnt lgkmcnt(4)
ds_read_b128 a[204:207], v2 offset:34816
v_add_f32 v26, v26, v21
v_mfma_f32_16x16x32_bf16 v[44:47], a[208:211], a[0:3], 0
s_waitcnt lgkmcnt(4)
buffer_load_dwordx4 v7, s[16:19], s90 offen offset:0 nt lds
v_mfma_f32_16x16x32_bf16 v[44:47], a[212:215], a[12:15], v[44:47]
v_exp_f32 v30, v88
v_mfma_f32_16x16x32_bf16 v[48:51], a[208:211], a[4:7], 0
v_exp_f32 v31, v89
v_mfma_f32_16x16x32_bf16 v[48:51], a[212:215], a[16:19], v[48:51]
v_exp_f32 v20, v90
v_mfma_f32_16x16x32_bf16 v[52:55], a[208:211], a[8:11], 0
ds_read_b128 a[208:211], v1 offset:35840
v_cvt_pk_bf16_f32 v39, v28, v29
v_mfma_f32_16x16x32_bf16 v[52:55], a[212:215], a[20:23], v[52:55]
s_waitcnt lgkmcnt(1)
ds_read_b128 a[212:215], v2 offset:35840
v_add_f32 v26, v26, v28
v_mfma_f32_16x16x32_bf16 v[44:47], a[192:195], a[24:27], v[44:47]
s_add_u32 s91, s81, s95
v_add_f32 v26, v26, v29
v_fma_f32 v91, v91, s24, v15
v_mfma_f32_16x16x32_bf16 v[44:47], a[196:199], a[36:39], v[44:47]
buffer_load_dwordx4 v7, s[16:19], s91 offen offset:1024 nt lds
v_mfma_f32_16x16x32_bf16 v[48:51], a[192:195], a[28:31], v[48:51]
v_exp_f32 v21, v91
v_mfma_f32_16x16x32_bf16 v[48:51], a[196:199], a[40:43], v[48:51]
v_cvt_pk_bf16_f32 v42, v30, v31
v_add_f32 v27, v27, v30
v_mfma_f32_16x16x32_bf16 v[52:55], a[192:195], a[32:35], v[52:55]
ds_read_b128 a[192:195], v1 offset:40960
v_add_f32 v27, v27, v31
v_mfma_f32_16x16x32_bf16 v[52:55], a[196:199], a[44:47], v[52:55]
ds_read_b128 a[196:199], v2 offset:40960
v_cvt_pk_bf16_f32 v43, v20, v21
v_mfma_f32_16x16x32_bf16 v[44:47], a[200:203], a[48:51], v[44:47]
v_add_f32 v27, v27, v20
v_add_f32 v27, v27, v21
v_mfma_f32_16x16x32_bf16 v[44:47], a[204:207], a[60:63], v[44:47]
v_max3_f32 v25, v24, v26, v27
v_cmp_lt_f32 vcc, s25, v25
v_mfma_f32_16x16x32_bf16 v[48:51], a[200:203], a[52:55], v[48:51]
v_xor_b32 v8, 64, v8
v_mfma_f32_16x16x32_bf16 v[48:51], a[204:207], a[64:67], v[48:51]
ds_read_b128 a[104:107], v8 offset:2048
v_mfma_f32_16x16x32_bf16 v[52:55], a[200:203], a[56:59], v[52:55]
s_addk_i32 s90, 2048
ds_read_b128 a[200:203], v1 offset:41984
v_mfma_f32_16x16x32_bf16 v[52:55], a[204:207], a[68:71], v[52:55]
s_waitcnt lgkmcnt(2)
ds_read_b128 a[204:207], v2 offset:41984
v_mfma_f32_16x16x32_bf16 v[44:47], a[208:211], a[72:75], v[44:47]
buffer_load_dwordx4 v7, s[16:19], s90 offen offset:2048 nt lds
v_mfma_f32_16x16x32_bf16 v[44:47], a[212:215], a[84:87], v[44:47]
v_mfma_f32_16x16x32_bf16 v[48:51], a[208:211], a[76:79], v[48:51]
v_mfma_f32_16x16x32_bf16 v[48:51], a[212:215], a[88:91], v[48:51]
s_cbranch_vccnz STUB_13
BACK_13:
v_mfma_f32_16x16x32_bf16 v[52:55], a[208:211], a[80:83], v[52:55]
ds_read_b128 a[208:211], v1 offset:43008
v_add_f32 v19, v19, v27
v_mfma_f32_16x16x32_bf16 v[52:55], a[212:215], a[92:95], v[52:55]
ds_read_b128 a[212:215], v2 offset:43008
v_add_f32 v17, v17, v24
v_mfma_f32_16x16x32_bf16 v[80:83], a[192:195], a[0:3], 0
s_addk_i32 s91, 2048
v_add_f32 v18, v18, v26
v_fma_f32 v44, v44, s24, v11
v_mfma_f32_16x16x32_bf16 v[80:83], a[196:199], a[12:15], v[80:83]
buffer_load_dwordx4 v7, s[16:19], s91 offen offset:3072 nt lds
v_mfma_f32_16x16x32_bf16 v[84:87], a[192:195], a[4:7], 0
v_exp_f32 v28, v44
v_mfma_f32_16x16x32_bf16 v[84:87], a[196:199], a[16:19], v[84:87]
v_fma_f32 v45, v45, s24, v11
v_fma_f32 v46, v46, s24, v11
v_mfma_f32_16x16x32_bf16 v[88:91], a[192:195], a[8:11], 0
ds_read_b128 a[192:195], v1 offset:44032
v_fma_f32 v47, v47, s24, v11
v_mfma_f32_16x16x32_bf16 v[88:91], a[196:199], a[20:23], v[88:91]
PADJ_6:
s_cbranch_execz PADJ_10
s_waitcnt lgkmcnt(1)
ds_read_b128 a[196:199], v2 offset:44032
v_mfma_f32_16x16x32_bf16 v[80:83], a[200:203], a[24:27], v[80:83]
v_exp_f32 v29, v45
v_mfma_f32_16x16x32_bf16 v[80:83], a[204:207], a[36:39], v[80:83]
s_add_u32 m0, s4, 6144
v_exp_f32 v30, v46
v_mfma_f32_16x16x32_bf16 v[84:87], a[200:203], a[28:31], v[84:87]
s_add_u32 s88, s31, s86
v_exp_f32 v31, v47
v_mfma_f32_16x16x32_bf16 v[84:87], a[204:207], a[40:43], v[84:87]
buffer_load_dwordx4 v7, s[8:11], s88 offen offset:0 nt lds
v_mfma_f32_16x16x32_bf16 v[88:91], a[200:203], a[32:35], v[88:91]
ds_read_b64_tr_b16 a[200:201], v3 offset:0
v_cvt_pk_bf16_f32 v56, v28, v29
v_mfma_f32_16x16x32_bf16 v[88:91], a[204:207], a[44:47], v[88:91]
ds_read_b64_tr_b16 a[202:203], v3 offset:4096
v_add_f32 v24, v28, v29
v_mfma_f32_16x16x32_bf16 v[80:83], a[208:211], a[48:51], v[80:83]
v_cvt_pk_bf16_f32 v57, v30, v31
v_add_f32 v24, v24, v30
v_mfma_f32_16x16x32_bf16 v[80:83], a[212:215], a[60:63], v[80:83]
ds_read_b64_tr_b16 a[204:205], v3 offset:8192
v_add_f32 v24, v24, v31
v_mfma_f32_16x16x32_bf16 v[84:87], a[208:211], a[52:55], v[84:87]
ds_read_b64_tr_b16 a[206:207], v3 offset:12288
v_fma_f32 v48, v48, s24, v13
v_mfma_f32_16x16x32_bf16 v[84:87], a[212:215], a[64:67], v[84:87]
v_exp_f32 v20, v48
v_mfma_f32_16x16x32_bf16 v[88:91], a[208:211], a[56:59], v[88:91]
s_addk_i32 s88, 3072
ds_read_b64_tr_b16 a[208:209], v4 offset:0
v_fma_f32 v49, v49, s24, v13
v_mfma_f32_16x16x32_bf16 v[88:91], a[212:215], a[68:71], v[88:91]
s_waitcnt lgkmcnt(3)
ds_read_b64_tr_b16 a[210:211], v4 offset:4096
v_fma_f32 v50, v50, s24, v13
v_mfma_f32_16x16x32_bf16 v[80:83], a[192:195], a[72:75], v[80:83]
buffer_load_dwordx4 v7, s[8:11], s88 offen offset:1024 nt lds
v_mfma_f32_16x16x32_bf16 v[80:83], a[196:199], a[84:87], v[80:83]
ds_read_b64_tr_b16 a[212:213], v4 offset:8192
v_fma_f32 v51, v51, s24, v13
v_mfma_f32_16x16x32_bf16 v[84:87], a[192:195], a[76:79], v[84:87]
ds_read_b64_tr_b16 a[214:215], v4 offset:12288
v_fma_f32 v52, v52, s24, v15
v_mfma_f32_16x16x32_bf16 v[84:87], a[196:199], a[88:91], v[84:87]
v_exp_f32 v21, v49
v_mfma_f32_16x16x32_bf16 v[88:91], a[192:195], a[80:83], v[88:91]
ds_read_b64_tr_b16 a[192:193], v5 offset:0
v_cvt_pk_bf16_f32 v60, v20, v21
v_mfma_f32_16x16x32_bf16 v[88:91], a[196:199], a[92:95], v[88:91]
ds_read_b64_tr_b16 a[194:195], v5 offset:4096
v_add_f32 v26, v20, v21
v_mfma_f32_16x16x32_bf16 v[104:107], a[200:203], v[68:71], v[104:107]
s_waitcnt lgkmcnt(4)
v_exp_f32 v28, v50
v_mfma_f32_16x16x32_bf16 v[104:107], a[204:207], v[32:35], v[104:107]
s_mov_b32 m0, s33
ds_read_b64_tr_b16 a[196:197], v5 offset:8192
v_add_f32 v26, v26, v28
v_mfma_f32_16x16x32_bf16 v[108:111], a[200:203], v[72:75], v[108:111]
s_add_u32 s90, s57, s92
ds_read_b64_tr_b16 a[198:199], v5 offset:12288
v_fma_f32 v53, v53, s24, v15
v_mfma_f32_16x16x32_bf16 v[108:111], a[204:207], v[36:39], v[108:111]
buffer_load_dwordx4 v7, s[12:15], s90 offen offset:0 nt lds
v_mfma_f32_16x16x32_bf16 v[112:115], a[200:203], v[76:79], v[112:115]
ds_read_b64_tr_b16 a[200:201], v6 offset:0
v_fma_f32 v54, v54, s24, v15
v_mfma_f32_16x16x32_bf16 v[112:115], a[204:207], v[40:43], v[112:115]
ds_read_b64_tr_b16 a[202:203], v6 offset:4096
v_fma_f32 v55, v55, s24, v15
v_mfma_f32_16x16x32_bf16 v[116:119], a[208:211], v[68:71], v[116:119]
s_waitcnt lgkmcnt(4)
v_exp_f32 v29, v51
v_mfma_f32_16x16x32_bf16 v[116:119], a[212:215], v[32:35], v[116:119]
ds_read_b64_tr_b16 a[204:205], v6 offset:8192
v_cvt_pk_bf16_f32 v61, v28, v29
v_mfma_f32_16x16x32_bf16 v[120:123], a[208:211], v[72:75], v[120:123]
ds_read_b64_tr_b16 a[206:207], v6 offset:12288
v_add_f32 v26, v26, v29
v_mfma_f32_16x16x32_bf16 v[120:123], a[212:215], v[36:39], v[120:123]
v_exp_f32 v30, v52
v_mfma_f32_16x16x32_bf16 v[124:127], a[208:211], v[76:79], v[124:127]
ds_read_b64_tr_b16 a[208:209], v3 offset:1024
v_fma_f32 v80, v80, s24, v11
v_mfma_f32_16x16x32_bf16 v[124:127], a[212:215], v[40:43], v[124:127]
s_add_u32 s90, s57, s93
ds_read_b64_tr_b16 a[210:211], v3 offset:5120
v_fma_f32 v81, v81, s24, v11
v_mfma_f32_16x16x32_bf16 v[128:131], a[192:195], v[68:71], v[128:131]
s_waitcnt lgkmcnt(4)
buffer_load_dwordx4 v7, s[12:15], s90 offen offset:1024 nt lds
v_mfma_f32_16x16x32_bf16 v[128:131], a[196:199], v[32:35], v[128:131]
ds_read_b64_tr_b16 a[212:213], v3 offset:9216
v_fma_f32 v82, v82, s24, v11
v_mfma_f32_16x16x32_bf16 v[132:135], a[192:195], v[72:75], v[132:135]
ds_read_b64_tr_b16 a[214:215], v3 offset:13312
v_fma_f32 v83, v83, s24, v11
v_mfma_f32_16x16x32_bf16 v[132:135], a[196:199], v[36:39], v[132:135]
v_exp_f32 v31, v53
v_mfma_f32_16x16x32_bf16 v[136:139], a[192:195], v[76:79], v[136:139]
ds_read_b64_tr_b16 a[192:193], v4 offset:1024
v_cvt_pk_bf16_f32 v64, v30, v31
v_mfma_f32_16x16x32_bf16 v[136:139], a[196:199], v[40:43], v[136:139]
ds_read_b64_tr_b16 a[194:195], v4 offset:5120
v_add_f32 v27, v30, v31
v_mfma_f32_16x16x32_bf16 v[140:143], a[200:203], v[68:71], v[140:143]
s_waitcnt lgkmcnt(4)
v_exp_f32 v20, v54
v_mfma_f32_16x16x32_bf16 v[140:143], a[204:207], v[32:35], v[140:143]
ds_read_b64_tr_b16 a[196:197], v4 offset:9216
v_add_f32 v27, v27, v20
v_mfma_f32_16x16x32_bf16 v[144:147], a[200:203], v[72:75], v[144:147]
s_add_u32 s90, s57, s94
ds_read_b64_tr_b16 a[198:199], v4 offset:13312
v_fma_f32 v84, v84, s24, v13
v_mfma_f32_16x16x32_bf16 v[144:147], a[204:207], v[36:39], v[144:147]
buffer_load_dwordx4 v7, s[12:15], s90 offen offset:2048 nt lds
v_mfma_f32_16x16x32_bf16 v[148:151], a[200:203], v[76:79], v[148:151]
ds_read_b64_tr_b16 a[200:201], v5 offset:1024
v_fma_f32 v85, v85, s24, v13
v_mfma_f32_16x16x32_bf16 v[148:151], a[204:207], v[40:43], v[148:151]
ds_read_b64_tr_b16 a[202:203], v5 offset:5120
v_fma_f32 v86, v86, s24, v13
v_mfma_f32_16x16x32_bf16 v[152:155], a[208:211], v[68:71], v[152:155]
s_waitcnt lgkmcnt(4)
v_exp_f32 v21, v55
v_mfma_f32_16x16x32_bf16 v[152:155], a[212:215], v[32:35], v[152:155]
ds_read_b64_tr_b16 a[204:205], v5 offset:9216
v_cvt_pk_bf16_f32 v65, v20, v21
v_mfma_f32_16x16x32_bf16 v[156:159], a[208:211], v[72:75], v[156:159]
ds_read_b64_tr_b16 a[206:207], v5 offset:13312
v_add_f32 v27, v27, v21
v_mfma_f32_16x16x32_bf16 v[156:159], a[212:215], v[36:39], v[156:159]
v_exp_f32 v28, v80
v_mfma_f32_16x16x32_bf16 v[160:163], a[208:211], v[76:79], v[160:163]
ds_read_b64_tr_b16 a[208:209], v6 offset:1024
v_add_f32 v24, v24, v28
v_mfma_f32_16x16x32_bf16 v[160:163], a[212:215], v[40:43], v[160:163]
s_add_u32 s90, s57, s95
ds_read_b64_tr_b16 a[210:211], v6 offset:5120
v_fma_f32 v87, v87, s24, v13
v_mfma_f32_16x16x32_bf16 v[164:167], a[192:195], v[68:71], v[164:167]
s_waitcnt lgkmcnt(4)
buffer_load_dwordx4 v7, s[12:15], s90 offen offset:3072 nt lds
v_mfma_f32_16x16x32_bf16 v[164:167], a[196:199], v[32:35], v[164:167]
ds_read_b64_tr_b16 a[212:213], v6 offset:9216
v_fma_f32 v88, v88, s24, v15
v_mfma_f32_16x16x32_bf16 v[168:171], a[192:195], v[72:75], v[168:171]
ds_read_b64_tr_b16 a[214:215], v6 offset:13312
v_fma_f32 v89, v89, s24, v15
v_mfma_f32_16x16x32_bf16 v[168:171], a[196:199], v[36:39], v[168:171]
v_exp_f32 v29, v81
v_mfma_f32_16x16x32_bf16 v[172:175], a[192:195], v[76:79], v[172:175]
v_exp_f32 v30, v82
v_mfma_f32_16x16x32_bf16 v[172:175], a[196:199], v[40:43], v[172:175]
v_exp_f32 v31, v83
v_mfma_f32_16x16x32_bf16 v[176:179], a[200:203], v[68:71], v[176:179]
s_waitcnt lgkmcnt(2)
v_exp_f32 v20, v84
v_mfma_f32_16x16x32_bf16 v[176:179], a[204:207], v[32:35], v[176:179]
v_exp_f32 v21, v85
v_mfma_f32_16x16x32_bf16 v[180:183], a[200:203], v[72:75], v[180:183]
v_cvt_pk_bf16_f32 v58, v28, v29
v_add_f32 v24, v24, v29
v_mfma_f32_16x16x32_bf16 v[180:183], a[204:207], v[36:39], v[180:183]
s_waitcnt vmcnt(14) lgkmcnt(0)
v_exp_f32 v28, v86
v_mfma_f32_16x16x32_bf16 v[184:187], a[200:203], v[76:79], v[184:187]
s_barrier
ds_read_b128 a[128:131], v8 offset:4096
v_mfma_f32_16x16x32_bf16 v[184:187], a[204:207], v[40:43], v[184:187]
ds_read_b128 a[192:195], v1 offset:49152
v_cvt_pk_bf16_f32 v59, v30, v31
v_mfma_f32_16x16x32_bf16 v[188:191], a[208:211], v[68:71], v[188:191]
ds_read_b128 a[196:199], v2 offset:49152
v_add_f32 v24, v24, v30
v_mfma_f32_16x16x32_bf16 v[188:191], a[212:215], v[32:35], v[188:191]
ds_read_b128 a[200:203], v1 offset:50176
v_add_f32 v24, v24, v31
v_mfma_f32_16x16x32_bf16 v[192:195], a[208:211], v[72:75], v[192:195]
s_mov_b32 m0, s36
ds_read_b128 a[204:207], v2 offset:50176
v_cvt_pk_bf16_f32 v62, v20, v21
v_mfma_f32_16x16x32_bf16 v[192:195], a[212:215], v[36:39], v[192:195]
s_bitcmp1_b32 s3, 1
s_cselect_b32 s81, s57, s56
v_add_f32 v26, v26, v20
v_mfma_f32_16x16x32_bf16 v[196:199], a[208:211], v[76:79], v[196:199]
s_add_u32 s90, s81, s92
ds_read_b128 a[208:211], v1 offset:51200
v_add_f32 v26, v26, v21
v_mfma_f32_16x16x32_bf16 v[196:199], a[212:215], v[40:43], v[196:199]
s_waitcnt lgkmcnt(4)
ds_read_b128 a[212:215], v2 offset:51200
v_add_f32 v26, v26, v28
v_mfma_f32_16x16x32_bf16 v[92:95], a[192:195], a[0:3], 0
s_waitcnt lgkmcnt(4)
buffer_load_dwordx4 v7, s[16:19], s90 offen offset:0 nt lds
v_mfma_f32_16x16x32_bf16 v[92:95], a[196:199], a[12:15], v[92:95]
v_exp_f32 v29, v87
v_mfma_f32_16x16x32_bf16 v[96:99], a[192:195], a[4:7], 0
v_exp_f32 v30, v88
v_mfma_f32_16x16x32_bf16 v[96:99], a[196:199], a[16:19], v[96:99]
v_exp_f32 v31, v89
v_mfma_f32_16x16x32_bf16 v[100:103], a[192:195], a[8:11], 0
ds_read_b128 a[192:195], v1 offset:52224
v_cvt_pk_bf16_f32 v63, v28, v29
v_mfma_f32_16x16x32_bf16 v[100:103], a[196:199], a[20:23], v[100:103]
s_waitcnt lgkmcnt(1)
ds_read_b128 a[196:199], v2 offset:52224
v_add_f32 v26, v26, v29
v_mfma_f32_16x16x32_bf16 v[92:95], a[200:203], a[24:27], v[92:95]
v_fma_f32 v90, v90, s24, v15
v_fma_f32 v91, v91, s24, v15
v_mfma_f32_16x16x32_bf16 v[92:95], a[204:207], a[36:39], v[92:95]
v_exp_f32 v20, v90
v_mfma_f32_16x16x32_bf16 v[96:99], a[200:203], a[28:31], v[96:99]
s_add_u32 s91, s81, s93
v_exp_f32 v21, v91
v_mfma_f32_16x16x32_bf16 v[96:99], a[204:207], a[40:43], v[96:99]
buffer_load_dwordx4 v7, s[16:19], s91 offen offset:1024 nt lds
v_mfma_f32_16x16x32_bf16 v[100:103], a[200:203], a[32:35], v[100:103]
ds_read_b128 a[200:203], v1 offset:57344
v_cvt_pk_bf16_f32 v66, v30, v31
v_mfma_f32_16x16x32_bf16 v[100:103], a[204:207], a[44:47], v[100:103]
ds_read_b128 a[204:207], v2 offset:57344
v_add_f32 v27, v27, v30
v_mfma_f32_16x16x32_bf16 v[92:95], a[208:211], a[48:51], v[92:95]
v_add_f32 v27, v27, v31
v_cvt_pk_bf16_f32 v67, v20, v21
v_mfma_f32_16x16x32_bf16 v[92:95], a[212:215], a[60:63], v[92:95]
v_add_f32 v27, v27, v20
v_add_f32 v27, v27, v21
v_mfma_f32_16x16x32_bf16 v[96:99], a[208:211], a[52:55], v[96:99]
v_max3_f32 v25, v24, v26, v27
v_cmp_lt_f32 vcc, s25, v25
v_mfma_f32_16x16x32_bf16 v[96:99], a[212:215], a[64:67], v[96:99]
v_xor_b32 v8, 64, v8
v_mfma_f32_16x16x32_bf16 v[100:103], a[208:211], a[56:59], v[100:103]
ds_read_b128 a[208:211], v1 offset:58368
ds_read_b128 a[140:143], v8 offset:4096
v_mfma_f32_16x16x32_bf16 v[100:103], a[212:215], a[68:71], v[100:103]
s_waitcnt lgkmcnt(2)
ds_read_b128 a[212:215], v2 offset:58368
v_mfma_f32_16x16x32_bf16 v[92:95], a[192:195], a[72:75], v[92:95]
v_mfma_f32_16x16x32_bf16 v[92:95], a[196:199], a[84:87], v[92:95]
s_addk_i32 s90, 2048
v_mfma_f32_16x16x32_bf16 v[96:99], a[192:195], a[76:79], v[96:99]
buffer_load_dwordx4 v7, s[16:19], s90 offen offset:2048 nt lds
v_mfma_f32_16x16x32_bf16 v[96:99], a[196:199], a[88:91], v[96:99]
s_cbranch_vccnz STUB_14
BACK_14:
v_mfma_f32_16x16x32_bf16 v[100:103], a[192:195], a[80:83], v[100:103]
ds_read_b128 a[192:195], v1 offset:59392
v_add_f32 v19, v19, v27
v_mfma_f32_16x16x32_bf16 v[100:103], a[196:199], a[92:95], v[100:103]
ds_read_b128 a[196:199], v2 offset:59392
v_add_f32 v17, v17, v24
v_mfma_f32_16x16x32_bf16 v[80:83], a[200:203], a[0:3], 0
v_add_f32 v18, v18, v26
v_fma_f32 v92, v92, s24, v11
v_mfma_f32_16x16x32_bf16 v[80:83], a[204:207], a[12:15], v[80:83]
v_exp_f32 v28, v92
v_mfma_f32_16x16x32_bf16 v[84:87], a[200:203], a[4:7], 0
v_fma_f32 v93, v93, s24, v11
v_fma_f32 v94, v94, s24, v11
v_mfma_f32_16x16x32_bf16 v[84:87], a[204:207], a[16:19], v[84:87]
v_exp_f32 v29, v93
v_mfma_f32_16x16x32_bf16 v[88:91], a[200:203], a[8:11], 0
ds_read_b128 a[200:203], v1 offset:60416
v_fma_f32 v95, v95, s24, v11
v_mfma_f32_16x16x32_bf16 v[88:91], a[204:207], a[20:23], v[88:91]
s_waitcnt lgkmcnt(1)
ds_read_b128 a[204:207], v2 offset:60416
v_cvt_pk_bf16_f32 v44, v28, v29
v_mfma_f32_16x16x32_bf16 v[80:83], a[208:211], a[24:27], v[80:83]
s_addk_i32 s91, 2048
v_exp_f32 v30, v94
v_mfma_f32_16x16x32_bf16 v[80:83], a[212:215], a[36:39], v[80:83]
buffer_load_dwordx4 v7, s[16:19], s91 offen offset:3072 nt lds
v_mfma_f32_16x16x32_bf16 v[84:87], a[208:211], a[28:31], v[84:87]
v_exp_f32 v31, v95
v_mfma_f32_16x16x32_bf16 v[84:87], a[212:215], a[40:43], v[84:87]
v_add_f32 v24, v28, v29
v_cvt_pk_bf16_f32 v45, v30, v31
v_mfma_f32_16x16x32_bf16 v[88:91], a[208:211], a[32:35], v[88:91]
ds_read_b64_tr_b16 a[208:209], v3 offset:16384
v_add_f32 v24, v24, v30
v_mfma_f32_16x16x32_bf16 v[88:91], a[212:215], a[44:47], v[88:91]
ds_read_b64_tr_b16 a[210:211], v3 offset:20480
v_add_f32 v24, v24, v31
v_mfma_f32_16x16x32_bf16 v[80:83], a[192:195], a[48:51], v[80:83]
v_fma_f32 v96, v96, s24, v13
v_fma_f32 v97, v97, s24, v13
v_mfma_f32_16x16x32_bf16 v[80:83], a[196:199], a[60:63], v[80:83]
ds_read_b64_tr_b16 a[212:213], v3 offset:24576
v_fma_f32 v98, v98, s24, v13
v_mfma_f32_16x16x32_bf16 v[84:87], a[192:195], a[52:55], v[84:87]
ds_read_b64_tr_b16 a[214:215], v3 offset:28672
v_fma_f32 v99, v99, s24, v13
v_mfma_f32_16x16x32_bf16 v[84:87], a[196:199], a[64:67], v[84:87]
s_mov_b32 m0, s34
v_exp_f32 v20, v96
v_mfma_f32_16x16x32_bf16 v[88:91], a[192:195], a[56:59], v[88:91]
s_add_u32 s90, s58, s92
ds_read_b64_tr_b16 a[192:193], v4 offset:16384
v_fma_f32 v100, v100, s24, v15
v_mfma_f32_16x16x32_bf16 v[88:91], a[196:199], a[68:71], v[88:91]
s_waitcnt lgkmcnt(3)
ds_read_b64_tr_b16 a[194:195], v4 offset:20480
v_fma_f32 v101, v101, s24, v15
v_mfma_f32_16x16x32_bf16 v[80:83], a[200:203], a[72:75], v[80:83]
buffer_load_dwordx4 v7, s[12:15], s90 offen offset:0 nt lds
v_mfma_f32_16x16x32_bf16 v[80:83], a[204:207], a[84:87], v[80:83]
ds_read_b64_tr_b16 a[196:197], v4 offset:24576
v_fma_f32 v102, v102, s24, v15
v_mfma_f32_16x16x32_bf16 v[84:87], a[200:203], a[76:79], v[84:87]
ds_read_b64_tr_b16 a[198:199], v4 offset:28672
v_fma_f32 v103, v103, s24, v15
v_mfma_f32_16x16x32_bf16 v[84:87], a[204:207], a[88:91], v[84:87]
v_exp_f32 v21, v97
v_mfma_f32_16x16x32_bf16 v[88:91], a[200:203], a[80:83], v[88:91]
ds_read_b64_tr_b16 a[200:201], v5 offset:16384
v_cvt_pk_bf16_f32 v48, v20, v21
v_mfma_f32_16x16x32_bf16 v[88:91], a[204:207], a[92:95], v[88:91]
ds_read_b64_tr_b16 a[202:203], v5 offset:20480
v_add_f32 v26, v20, v21
v_mfma_f32_16x16x32_bf16 v[200:203], a[208:211], v[68:71], v[200:203]
s_waitcnt lgkmcnt(4)
v_exp_f32 v28, v98
v_mfma_f32_16x16x32_bf16 v[200:203], a[212:215], v[32:35], v[200:203]
ds_read_b64_tr_b16 a[204:205], v5 offset:24576
v_add_f32 v26, v26, v28
v_mfma_f32_16x16x32_bf16 v[204:207], a[208:211], v[72:75], v[204:207]
ds_read_b64_tr_b16 a[206:207], v5 offset:28672
v_fma_f32 v80, v80, s24, v11
v_mfma_f32_16x16x32_bf16 v[204:207], a[212:215], v[36:39], v[204:207]
v_exp_f32 v29, v99
v_mfma_f32_16x16x32_bf16 v[208:211], a[208:211], v[76:79], v[208:211]
ds_read_b64_tr_b16 a[208:209], v6 offset:16384
v_cvt_pk_bf16_f32 v49, v28, v29
v_mfma_f32_16x16x32_bf16 v[208:211], a[212:215], v[40:43], v[208:211]
s_add_u32 s90, s58, s93
ds_read_b64_tr_b16 a[210:211], v6 offset:20480
v_add_f32 v26, v26, v29
v_mfma_f32_16x16x32_bf16 v[212:215], a[192:195], v[68:71], v[212:215]
s_waitcnt lgkmcnt(4)
buffer_load_dwordx4 v7, s[12:15], s90 offen offset:1024 nt lds
v_mfma_f32_16x16x32_bf16 v[212:215], a[196:199], v[32:35], v[212:215]
ds_read_b64_tr_b16 a[212:213], v6 offset:24576
v_fma_f32 v81, v81, s24, v11
v_mfma_f32_16x16x32_bf16 v[216:219], a[192:195], v[72:75], v[216:219]
ds_read_b64_tr_b16 a[214:215], v6 offset:28672
v_fma_f32 v82, v82, s24, v11
v_mfma_f32_16x16x32_bf16 v[216:219], a[196:199], v[36:39], v[216:219]
v_exp_f32 v30, v100
v_mfma_f32_16x16x32_bf16 v[220:223], a[192:195], v[76:79], v[220:223]
ds_read_b64_tr_b16 a[192:193], v3 offset:17408
v_fma_f32 v83, v83, s24, v11
v_mfma_f32_16x16x32_bf16 v[220:223], a[196:199], v[40:43], v[220:223]
ds_read_b64_tr_b16 a[194:195], v3 offset:21504
v_fma_f32 v84, v84, s24, v13
v_mfma_f32_16x16x32_bf16 a[216:219], a[200:203], v[68:71], a[216:219]
s_waitcnt lgkmcnt(4)
v_exp_f32 v31, v101
v_mfma_f32_16x16x32_bf16 a[216:219], a[204:207], v[32:35], a[216:219]
ds_read_b64_tr_b16 a[196:197], v3 offset:25600
v_cvt_pk_bf16_f32 v52, v30, v31
v_mfma_f32_16x16x32_bf16 a[220:223], a[200:203], v[72:75], a[220:223]
ds_read_b64_tr_b16 a[198:199], v3 offset:29696
v_add_f32 v27, v30, v31
v_mfma_f32_16x16x32_bf16 a[220:223], a[204:207], v[36:39], a[220:223]
v_exp_f32 v20, v102
v_mfma_f32_16x16x32_bf16 a[224:227], a[200:203], v[76:79], a[224:227]
ds_read_b64_tr_b16 a[200:201], v4 offset:17408
v_add_f32 v27, v27, v20
v_mfma_f32_16x16x32_bf16 a[224:227], a[204:207], v[40:43], a[224:227]
s_add_u32 s90, s58, s94
ds_read_b64_tr_b16 a[202:203], v4 offset:21504
v_fma_f32 v85, v85, s24, v13
v_mfma_f32_16x16x32_bf16 a[228:231], a[208:211], v[68:71], a[228:231]
s_waitcnt lgkmcnt(4)
buffer_load_dwordx4 v7, s[12:15], s90 offen offset:2048 nt lds
v_mfma_f32_16x16x32_bf16 a[228:231], a[212:215], v[32:35], a[228:231]
ds_read_b64_tr_b16 a[204:205], v4 offset:25600
v_fma_f32 v86, v86, s24, v13
v_mfma_f32_16x16x32_bf16 a[232:235], a[208:211], v[72:75], a[232:235]
ds_read_b64_tr_b16 a[206:207], v4 offset:29696
v_fma_f32 v87, v87, s24, v13
v_mfma_f32_16x16x32_bf16 a[232:235], a[212:215], v[36:39], a[232:235]
v_exp_f32 v21, v103
v_mfma_f32_16x16x32_bf16 a[236:239], a[208:211], v[76:79], a[236:239]
ds_read_b64_tr_b16 a[208:209], v5 offset:17408
v_cvt_pk_bf16_f32 v53, v20, v21
v_mfma_f32_16x16x32_bf16 a[236:239], a[212:215], v[40:43], a[236:239]
ds_read_b64_tr_b16 a[210:211], v5 offset:21504
v_add_f32 v27, v27, v21
v_mfma_f32_16x16x32_bf16 a[240:243], a[192:195], v[68:71], a[240:243]
s_waitcnt lgkmcnt(4)
v_exp_f32 v28, v80
v_mfma_f32_16x16x32_bf16 a[240:243], a[196:199], v[32:35], a[240:243]
ds_read_b64_tr_b16 a[212:213], v5 offset:25600
v_add_f32 v24, v24, v28
v_mfma_f32_16x16x32_bf16 a[244:247], a[192:195], v[72:75], a[244:247]
s_add_u32 s90, s58, s95
ds_read_b64_tr_b16 a[214:215], v5 offset:29696
v_fma_f32 v88, v88, s24, v15
v_mfma_f32_16x16x32_bf16 a[244:247], a[196:199], v[36:39], a[244:247]
buffer_load_dwordx4 v7, s[12:15], s90 offen offset:3072 nt lds
v_mfma_f32_16x16x32_bf16 a[248:251], a[192:195], v[76:79], a[248:251]
ds_read_b64_tr_b16 a[192:193], v6 offset:17408
v_fma_f32 v89, v89, s24, v15
v_mfma_f32_16x16x32_bf16 a[248:251], a[196:199], v[40:43], a[248:251]
ds_read_b64_tr_b16 a[194:195], v6 offset:21504
v_fma_f32 v90, v90, s24, v15
v_mfma_f32_16x16x32_bf16 a[252:255], a[200:203], v[68:71], a[252:255]
s_waitcnt lgkmcnt(4)
v_exp_f32 v29, v81
v_mfma_f32_16x16x32_bf16 a[252:255], a[204:207], v[32:35], a[252:255]
ds_read_b64_tr_b16 a[196:197], v6 offset:25600
v_cvt_pk_bf16_f32 v46, v28, v29
v_mfma_f32_16x16x32_bf16 v[224:227], a[200:203], v[72:75], v[224:227]
ds_read_b64_tr_b16 a[198:199], v6 offset:29696
v_add_f32 v24, v24, v29
v_mfma_f32_16x16x32_bf16 v[224:227], a[204:207], v[36:39], v[224:227]
v_exp_f32 v30, v82
v_mfma_f32_16x16x32_bf16 v[228:231], a[200:203], v[76:79], v[228:231]
v_exp_f32 v31, v83
v_mfma_f32_16x16x32_bf16 v[228:231], a[204:207], v[40:43], v[228:231]
v_exp_f32 v20, v84
v_mfma_f32_16x16x32_bf16 v[232:235], a[208:211], v[68:71], v[232:235]
s_waitcnt lgkmcnt(2)
v_exp_f32 v21, v85
v_mfma_f32_16x16x32_bf16 v[232:235], a[212:215], v[32:35], v[232:235]
v_exp_f32 v28, v86
v_mfma_f32_16x16x32_bf16 v[236:239], a[208:211], v[72:75], v[236:239]
v_exp_f32 v29, v87
v_mfma_f32_16x16x32_bf16 v[236:239], a[212:215], v[36:39], v[236:239]
s_waitcnt vmcnt(12) lgkmcnt(0)
v_cvt_pk_bf16_f32 v47, v30, v31
v_add_f32 v24, v24, v30
v_mfma_f32_16x16x32_bf16 v[240:243], a[208:211], v[76:79], v[240:243]
s_barrier
ds_read_b128 a[164:167], v8 offset:6144
v_mfma_f32_16x16x32_bf16 v[240:243], a[212:215], v[40:43], v[240:243]
ds_read_b128 a[200:203], v1 offset:0
v_xor_b32 v8, 64, v8
v_mfma_f32_16x16x32_bf16 v[244:247], a[192:195], v[68:71], v[244:247]
ds_read_b128 a[204:207], v2 offset:0
ds_read_b128 a[152:155], v8 offset:6144
v_mfma_f32_16x16x32_bf16 v[244:247], a[196:199], v[32:35], v[244:247]
ds_read_b128 a[208:211], v1 offset:1024
v_add_f32 v24, v24, v31
v_mfma_f32_16x16x32_bf16 v[248:251], a[192:195], v[72:75], v[248:251]
s_mov_b32 m0, s37
ds_read_b128 a[212:215], v2 offset:1024
v_cvt_pk_bf16_f32 v50, v20, v21
v_mfma_f32_16x16x32_bf16 v[248:251], a[196:199], v[36:39], v[248:251]
s_addk_i32 s81, 2048
v_exp_f32 v30, v88
v_mfma_f32_16x16x32_bf16 v[252:255], a[192:195], v[76:79], v[252:255]
s_add_u32 s90, s81, s94
ds_read_b128 a[192:195], v1 offset:2048
v_add_f32 v26, v26, v20
v_mfma_f32_16x16x32_bf16 v[252:255], a[196:199], v[40:43], v[252:255]
s_waitcnt lgkmcnt(5)
ds_read_b128 a[196:199], v2 offset:2048
s_waitcnt lgkmcnt(4)
v_mfma_f32_16x16x32_bf16 v[32:35], a[200:203], a[96:99], 0
buffer_load_dwordx4 v7, s[16:19], s90 offen offset:0 nt lds
v_mfma_f32_16x16x32_bf16 v[32:35], a[204:207], a[108:111], v[32:35]
v_exp_f32 v31, v89
v_mfma_f32_16x16x32_bf16 v[36:39], a[200:203], a[100:103], 0
v_exp_f32 v20, v90
v_mfma_f32_16x16x32_bf16 v[36:39], a[204:207], a[112:115], v[36:39]
v_add_f32 v26, v26, v21
v_cvt_pk_bf16_f32 v51, v28, v29
v_mfma_f32_16x16x32_bf16 v[40:43], a[200:203], a[104:107], 0
ds_read_b128 a[200:203], v1 offset:3072
v_add_f32 v26, v26, v28
v_mfma_f32_16x16x32_bf16 v[40:43], a[204:207], a[116:119], v[40:43]
s_waitcnt lgkmcnt(1)
ds_read_b128 a[204:207], v2 offset:3072
v_add_f32 v26, v26, v29
v_mfma_f32_16x16x32_bf16 v[32:35], a[208:211], a[120:123], v[32:35]
v_fma_f32 v91, v91, s24, v15
v_cvt_pk_bf16_f32 v54, v30, v31
v_mfma_f32_16x16x32_bf16 v[32:35], a[212:215], a[132:135], v[32:35]
v_exp_f32 v21, v91
v_mfma_f32_16x16x32_bf16 v[36:39], a[208:211], a[124:127], v[36:39]
s_add_u32 s91, s81, s95
v_add_f32 v27, v27, v30
v_add_f32 v27, v27, v31
v_mfma_f32_16x16x32_bf16 v[36:39], a[212:215], a[136:139], v[36:39]
buffer_load_dwordx4 v7, s[16:19], s91 offen offset:1024 nt lds
v_mfma_f32_16x16x32_bf16 v[40:43], a[208:211], a[128:131], v[40:43]
ds_read_b128 a[208:211], v1 offset:8192
v_cvt_pk_bf16_f32 v55, v20, v21
v_mfma_f32_16x16x32_bf16 v[40:43], a[212:215], a[140:143], v[40:43]
ds_read_b128 a[212:215], v2 offset:8192
v_add_f32 v27, v27, v20
v_mfma_f32_16x16x32_bf16 v[32:35], a[192:195], a[144:147], v[32:35]
v_add_f32 v27, v27, v21
v_max3_f32 v25, v24, v26, v27
v_mfma_f32_16x16x32_bf16 v[32:35], a[196:199], a[156:159], v[32:35]
v_cmp_lt_f32 vcc, s25, v25
v_mfma_f32_16x16x32_bf16 v[36:39], a[192:195], a[148:151], v[36:39]
v_mfma_f32_16x16x32_bf16 v[36:39], a[196:199], a[160:163], v[36:39]
v_mfma_f32_16x16x32_bf16 v[40:43], a[192:195], a[152:155], v[40:43]
ds_read_b128 a[192:195], v1 offset:9216
v_mfma_f32_16x16x32_bf16 v[40:43], a[196:199], a[164:167], v[40:43]
s_waitcnt lgkmcnt(1)
ds_read_b128 a[196:199], v2 offset:9216
v_mfma_f32_16x16x32_bf16 v[32:35], a[200:203], a[168:171], v[32:35]
v_mfma_f32_16x16x32_bf16 v[32:35], a[204:207], a[180:183], v[32:35]
s_addk_i32 s90, 2048
v_mfma_f32_16x16x32_bf16 v[36:39], a[200:203], a[172:175], v[36:39]
buffer_load_dwordx4 v7, s[16:19], s90 offen offset:2048 nt lds
v_mfma_f32_16x16x32_bf16 v[36:39], a[204:207], a[184:187], v[36:39]
s_cbranch_vccnz STUB_15
BACK_15:
v_mfma_f32_16x16x32_bf16 v[40:43], a[200:203], a[176:179], v[40:43]
ds_read_b128 a[200:203], v1 offset:10240
v_add_f32 v12, v17, v24
v_add_f32 v16, v19, v27
v_mfma_f32_16x16x32_bf16 v[40:43], a[204:207], a[188:191], v[40:43]
ds_read_b128 a[204:207], v2 offset:10240
v_mov_b32 v31, v12
v_mfma_f32_16x16x32_bf16 v[80:83], a[208:211], a[96:99], 0
v_max3_f32 v11, v32, v33, v34
v_max3_f32 v13, v36, v37, v38
v_permlane16_swap_b32 v12, v31
v_mfma_f32_16x16x32_bf16 v[80:83], a[212:215], a[108:111], v[80:83]
v_add_f32 v12, v12, v31
v_mov_b32 v31, v12
v_mfma_f32_16x16x32_bf16 v[84:87], a[208:211], a[100:103], 0
v_max3_f32 v15, v40, v41, v42
v_max_f32 v11, v11, v35
v_mfma_f32_16x16x32_bf16 v[84:87], a[212:215], a[112:115], v[84:87]
v_permlane32_swap_b32 v12, v31
v_mfma_f32_16x16x32_bf16 v[88:91], a[208:211], a[104:107], 0
ds_read_b128 a[208:211], v1 offset:11264
v_add_f32 v12, v12, v31
v_max_f32 v13, v13, v39
v_mfma_f32_16x16x32_bf16 v[88:91], a[212:215], a[116:119], v[88:91]
s_waitcnt lgkmcnt(1)
ds_read_b128 a[212:215], v2 offset:11264
v_max_f32 v15, v15, v43
v_mfma_f32_16x16x32_bf16 v[80:83], a[192:195], a[120:123], v[80:83]
s_addk_i32 s91, 2048
v_rcp_f32 v12, v12
v_mov_b32 v29, v11
v_mfma_f32_16x16x32_bf16 v[80:83], a[196:199], a[132:135], v[80:83]
buffer_load_dwordx4 v7, s[16:19], s91 offen offset:3072 nt lds
v_mfma_f32_16x16x32_bf16 v[84:87], a[192:195], a[124:127], v[84:87]
v_permlane16_swap_b32 v11, v29
v_mov_b32 v30, v13
v_mfma_f32_16x16x32_bf16 v[84:87], a[196:199], a[136:139], v[84:87]
v_mov_b32 v31, v15
v_max_f32 v11, v11, v29
v_mfma_f32_16x16x32_bf16 v[88:91], a[192:195], a[128:131], v[88:91]
ds_read_b64_tr_b16 a[192:193], v3 offset:32768
v_mov_b32 v29, v11
v_permlane16_swap_b32 v13, v30
v_mfma_f32_16x16x32_bf16 v[88:91], a[196:199], a[140:143], v[88:91]
ds_read_b64_tr_b16 a[194:195], v3 offset:36864
v_max_f32 v13, v13, v30
v_mfma_f32_16x16x32_bf16 v[80:83], a[200:203], a[144:147], v[80:83]
v_permlane16_swap_b32 v15, v31
v_mfma_f32_16x16x32_bf16 v[80:83], a[204:207], a[156:159], v[80:83]
ds_read_b64_tr_b16 a[196:197], v3 offset:40960
v_max_f32 v15, v15, v31
v_mfma_f32_16x16x32_bf16 v[84:87], a[200:203], a[148:151], v[84:87]
ds_read_b64_tr_b16 a[198:199], v3 offset:45056
v_mov_b32 v30, v13
v_mov_b32 v31, v15
v_mfma_f32_16x16x32_bf16 v[84:87], a[204:207], a[160:163], v[84:87]
s_mov_b32 m0, s35
v_permlane32_swap_b32 v11, v29
v_mfma_f32_16x16x32_bf16 v[88:91], a[200:203], a[152:155], v[88:91]
s_add_u32 s90, s59, s92
ds_read_b64_tr_b16 a[200:201], v4 offset:32768
v_max_f32 v11, v11, v29
v_permlane32_swap_b32 v13, v30
v_mfma_f32_16x16x32_bf16 v[88:91], a[204:207], a[164:167], v[88:91]
s_waitcnt lgkmcnt(3)
ds_read_b64_tr_b16 a[202:203], v4 offset:36864
v_max_f32 v13, v13, v30
v_mfma_f32_16x16x32_bf16 v[80:83], a[208:211], a[168:171], v[80:83]
buffer_load_dwordx4 v7, s[12:15], s90 offen offset:0 nt lds
v_mfma_f32_16x16x32_bf16 v[80:83], a[212:215], a[180:183], v[80:83]
ds_read_b64_tr_b16 a[204:205], v4 offset:40960
v_mul_f32 v11, s74, v11
v_mfma_f32_16x16x32_bf16 v[84:87], a[208:211], a[172:175], v[84:87]
ds_read_b64_tr_b16 a[206:207], v4 offset:45056
v_mul_f32 v13, s74, v13
v_permlane32_swap_b32 v15, v31
v_mfma_f32_16x16x32_bf16 v[84:87], a[212:215], a[184:187], v[84:87]
v_max_f32 v15, v15, v31
v_mul_f32 v15, s74, v15
v_mfma_f32_16x16x32_bf16 v[88:91], a[208:211], a[176:179], v[88:91]
ds_read_b64_tr_b16 a[208:209], v5 offset:32768
v_add_f32 v14, v18, v26
v_mfma_f32_16x16x32_bf16 v[88:91], a[212:215], a[188:191], v[88:91]
ds_read_b64_tr_b16 a[210:211], v5 offset:36864
v_mov_b32 v21, v16
v_mfma_f32_16x16x32_bf16 v[104:107], a[192:195], v[56:59], v[104:107]
s_waitcnt lgkmcnt(4)
PADJ_7:
s_cbranch_execz PADJ_11
v_mov_b32 v20, v14
v_mfma_f32_16x16x32_bf16 v[104:107], a[196:199], v[44:47], v[104:107]
ds_read_b64_tr_b16 a[212:213], v5 offset:40960
v_fma_f32 v32, v32, s24, v11
v_mfma_f32_16x16x32_bf16 v[108:111], a[192:195], v[60:63], v[108:111]
ds_read_b64_tr_b16 a[214:215], v5 offset:45056
v_fma_f32 v33, v33, s24, v11
v_permlane16_swap_b32 v16, v21
v_mfma_f32_16x16x32_bf16 v[108:111], a[196:199], v[48:51], v[108:111]
v_permlane16_swap_b32 v14, v20
v_mfma_f32_16x16x32_bf16 v[112:115], a[192:195], v[64:67], v[112:115]
ds_read_b64_tr_b16 a[192:193], v6 offset:32768
v_add_f32 v16, v16, v21
v_mfma_f32_16x16x32_bf16 v[112:115], a[196:199], v[52:55], v[112:115]
s_add_u32 s90, s59, s93
ds_read_b64_tr_b16 a[194:195], v6 offset:36864
v_add_f32 v14, v14, v20
v_mov_b32 v21, v16
v_mfma_f32_16x16x32_bf16 v[116:119], a[200:203], v[56:59], v[116:119]
s_waitcnt lgkmcnt(4)
buffer_load_dwordx4 v7, s[12:15], s90 offen offset:1024 nt lds
v_mfma_f32_16x16x32_bf16 v[116:119], a[204:207], v[44:47], v[116:119]
ds_read_b64_tr_b16 a[196:197], v6 offset:40960
v_mov_b32 v20, v14
v_permlane32_swap_b32 v16, v21
v_mfma_f32_16x16x32_bf16 v[120:123], a[200:203], v[60:63], v[120:123]
ds_read_b64_tr_b16 a[198:199], v6 offset:45056
v_add_f32 v16, v16, v21
v_mfma_f32_16x16x32_bf16 v[120:123], a[204:207], v[48:51], v[120:123]
v_permlane32_swap_b32 v14, v20
v_mfma_f32_16x16x32_bf16 v[124:127], a[200:203], v[64:67], v[124:127]
ds_read_b64_tr_b16 a[200:201], v3 offset:33792
v_add_f32 v14, v14, v20
v_mfma_f32_16x16x32_bf16 v[124:127], a[204:207], v[52:55], v[124:127]
ds_read_b64_tr_b16 a[202:203], v3 offset:37888
v_fma_f32 v34, v34, s24, v11
v_rcp_f32 v16, v16
v_mfma_f32_16x16x32_bf16 v[128:131], a[208:211], v[56:59], v[128:131]
s_waitcnt lgkmcnt(4)
v_rcp_f32 v14, v14
v_mfma_f32_16x16x32_bf16 v[128:131], a[212:215], v[44:47], v[128:131]
ds_read_b64_tr_b16 a[204:205], v3 offset:41984
v_fma_f32 v35, v35, s24, v11
v_mfma_f32_16x16x32_bf16 v[132:135], a[208:211], v[60:63], v[132:135]
ds_read_b64_tr_b16 a[206:207], v3 offset:46080
v_exp_f32 v28, v32
v_exp_f32 v29, v33
v_pk_mul_f32 v[104:105], v[104:105], v[12:13] op_sel_hi:[1,0]
v_pk_mul_f32 v[106:107], v[106:107], v[12:13] op_sel_hi:[1,0]
v_pk_mul_f32 v[108:109], v[108:109], v[14:15] op_sel_hi:[1,0]
v_pk_mul_f32 v[110:111], v[110:111], v[14:15] op_sel_hi:[1,0]
v_pk_mul_f32 v[112:113], v[112:113], v[16:17] op_sel_hi:[1,0]
v_pk_mul_f32 v[114:115], v[114:115], v[16:17] op_sel_hi:[1,0]
v_mfma_f32_16x16x32_bf16 v[132:135], a[212:215], v[48:51], v[132:135]
v_exp_f32 v30, v34
v_cvt_pk_bf16_f32 v68, v28, v29
v_mfma_f32_16x16x32_bf16 v[136:139], a[208:211], v[64:67], v[136:139]
ds_read_b64_tr_b16 a[208:209], v4 offset:33792
v_add_f32 v24, v28, v29
v_mfma_f32_16x16x32_bf16 v[136:139], a[212:215], v[52:55], v[136:139]
s_add_u32 s90, s59, s94
ds_read_b64_tr_b16 a[210:211], v4 offset:37888
v_add_f32 v24, v24, v30
v_exp_f32 v31, v35
v_mfma_f32_16x16x32_bf16 v[140:143], a[192:195], v[56:59], v[140:143]
s_waitcnt lgkmcnt(4)
buffer_load_dwordx4 v7, s[12:15], s90 offen offset:2048 nt lds
v_mfma_f32_16x16x32_bf16 v[140:143], a[196:199], v[44:47], v[140:143]
ds_read_b64_tr_b16 a[212:213], v4 offset:41984
v_cvt_pk_bf16_f32 v69, v30, v31
v_mfma_f32_16x16x32_bf16 v[144:147], a[192:195], v[60:63], v[144:147]
ds_read_b64_tr_b16 a[214:215], v4 offset:46080
v_add_f32 v24, v24, v31
v_fma_f32 v36, v36, s24, v13
v_exp_f32 v20, v36
v_pk_mul_f32 v[116:117], v[116:117], v[12:13] op_sel_hi:[1,0]
v_pk_mul_f32 v[118:119], v[118:119], v[12:13] op_sel_hi:[1,0]
v_pk_mul_f32 v[120:121], v[120:121], v[14:15] op_sel_hi:[1,0]
v_pk_mul_f32 v[122:123], v[122:123], v[14:15] op_sel_hi:[1,0]
v_pk_mul_f32 v[124:125], v[124:125], v[16:17] op_sel_hi:[1,0]
v_pk_mul_f32 v[126:127], v[126:127], v[16:17] op_sel_hi:[1,0]
v_mfma_f32_16x16x32_bf16 v[144:147], a[196:199], v[48:51], v[144:147]
v_fma_f32 v37, v37, s24, v13
v_fma_f32 v38, v38, s24, v13
v_fma_f32 v39, v39, s24, v13
v_mfma_f32_16x16x32_bf16 v[148:151], a[192:195], v[64:67], v[148:151]
ds_read_b64_tr_b16 a[192:193], v5 offset:33792
v_fma_f32 v40, v40, s24, v15
v_mfma_f32_16x16x32_bf16 v[148:151], a[196:199], v[52:55], v[148:151]
ds_read_b64_tr_b16 a[194:195], v5 offset:37888
v_fma_f32 v41, v41, s24, v15
v_exp_f32 v21, v37
v_mfma_f32_16x16x32_bf16 v[152:155], a[200:203], v[56:59], v[152:155]
s_waitcnt lgkmcnt(4)
v_exp_f32 v28, v38
v_mfma_f32_16x16x32_bf16 v[152:155], a[204:207], v[44:47], v[152:155]
ds_read_b64_tr_b16 a[196:197], v5 offset:41984
v_cvt_pk_bf16_f32 v72, v20, v21
v_mfma_f32_16x16x32_bf16 v[156:159], a[200:203], v[60:63], v[156:159]
s_add_u32 s90, s59, s95
ds_read_b64_tr_b16 a[198:199], v5 offset:46080
v_exp_f32 v29, v39
v_exp_f32 v30, v40
v_pk_mul_f32 v[128:129], v[128:129], v[12:13] op_sel_hi:[1,0]
v_pk_mul_f32 v[130:131], v[130:131], v[12:13] op_sel_hi:[1,0]
v_pk_mul_f32 v[132:133], v[132:133], v[14:15] op_sel_hi:[1,0]
v_pk_mul_f32 v[134:135], v[134:135], v[14:15] op_sel_hi:[1,0]
v_pk_mul_f32 v[136:137], v[136:137], v[16:17] op_sel_hi:[1,0]
v_pk_mul_f32 v[138:139], v[138:139], v[16:17] op_sel_hi:[1,0]
v_mfma_f32_16x16x32_bf16 v[156:159], a[204:207], v[48:51], v[156:159]
buffer_load_dwordx4 v7, s[12:15], s90 offen offset:3072 nt lds
v_mfma_f32_16x16x32_bf16 v[160:163], a[200:203], v[64:67], v[160:163]
ds_read_b64_tr_b16 a[200:201], v6 offset:33792
v_add_f32 v26, v20, v21
v_mfma_f32_16x16x32_bf16 v[160:163], a[204:207], v[52:55], v[160:163]
ds_read_b64_tr_b16 a[202:203], v6 offset:37888
v_cvt_pk_bf16_f32 v73, v28, v29
v_add_f32 v26, v26, v28
v_mfma_f32_16x16x32_bf16 v[164:167], a[208:211], v[56:59], v[164:167]
s_waitcnt lgkmcnt(4)
v_exp_f32 v31, v41
v_mfma_f32_16x16x32_bf16 v[164:167], a[212:215], v[44:47], v[164:167]
ds_read_b64_tr_b16 a[204:205], v6 offset:41984
v_add_f32 v26, v26, v29
v_mfma_f32_16x16x32_bf16 v[168:171], a[208:211], v[60:63], v[168:171]
ds_read_b64_tr_b16 a[206:207], v6 offset:46080
v_fma_f32 v42, v42, s24, v15
v_exp_f32 v20, v42
v_fma_f32 v43, v43, s24, v15
v_cvt_pk_bf16_f32 v76, v30, v31
v_pk_mul_f32 v[140:141], v[140:141], v[12:13] op_sel_hi:[1,0]
v_pk_mul_f32 v[142:143], v[142:143], v[12:13] op_sel_hi:[1,0]
v_pk_mul_f32 v[144:145], v[144:145], v[14:15] op_sel_hi:[1,0]
v_pk_mul_f32 v[146:147], v[146:147], v[14:15] op_sel_hi:[1,0]
v_pk_mul_f32 v[148:149], v[148:149], v[16:17] op_sel_hi:[1,0]
v_pk_mul_f32 v[150:151], v[150:151], v[16:17] op_sel_hi:[1,0]
v_mfma_f32_16x16x32_bf16 v[168:171], a[212:215], v[48:51], v[168:171]
v_exp_f32 v21, v43
v_cvt_pk_bf16_f32 v104, v104, v105
v_cvt_pk_bf16_f32 v105, v106, v107
v_xor_b32 v0, 96, v0
v_pk_mul_f32 v[152:153], v[152:153], v[12:13] op_sel_hi:[1,0]
v_pk_mul_f32 v[154:155], v[154:155], v[12:13] op_sel_hi:[1,0]
v_pk_mul_f32 v[156:157], v[156:157], v[14:15] op_sel_hi:[1,0]
v_pk_mul_f32 v[158:159], v[158:159], v[14:15] op_sel_hi:[1,0]
v_pk_mul_f32 v[160:161], v[160:161], v[16:17] op_sel_hi:[1,0]
v_pk_mul_f32 v[162:163], v[162:163], v[16:17] op_sel_hi:[1,0]
v_mfma_f32_16x16x32_bf16 v[172:175], a[208:211], v[64:67], v[172:175]
ds_write_b64 v0, v[104:105] offset:0
v_add_f32 v27, v30, v31
v_cvt_pk_bf16_f32 v77, v20, v21
v_pk_mul_f32 v[164:165], v[164:165], v[12:13] op_sel_hi:[1,0]
v_pk_mul_f32 v[166:167], v[166:167], v[12:13] op_sel_hi:[1,0]
v_pk_mul_f32 v[168:169], v[168:169], v[14:15] op_sel_hi:[1,0]
v_pk_mul_f32 v[170:171], v[170:171], v[14:15] op_sel_hi:[1,0]
v_mfma_f32_16x16x32_bf16 v[172:175], a[212:215], v[52:55], v[172:175]
v_add_f32 v27, v27, v20
v_add_f32 v27, v27, v21
v_fma_f32 v80, v80, s24, v11
v_cvt_pk_bf16_f32 v108, v108, v109
v_cvt_pk_bf16_f32 v109, v110, v111
v_mfma_f32_16x16x32_bf16 v[176:179], a[192:195], v[56:59], v[176:179]
s_waitcnt lgkmcnt(3)
ds_write_b64 v0, v[108:109] offset:2048
v_exp_f32 v28, v80
v_pk_mul_f32 v[172:173], v[172:173], v[16:17] op_sel_hi:[1,0]
v_pk_mul_f32 v[174:175], v[174:175], v[16:17] op_sel_hi:[1,0]
v_mfma_f32_16x16x32_bf16 v[176:179], a[196:199], v[44:47], v[176:179]
v_fma_f32 v81, v81, s24, v11
v_fma_f32 v82, v82, s24, v11
v_cvt_pk_bf16_f32 v112, v112, v113
v_cvt_pk_bf16_f32 v113, v114, v115
v_mfma_f32_16x16x32_bf16 v[180:183], a[192:195], v[60:63], v[180:183]
ds_write_b64 v0, v[112:113] offset:4096
v_exp_f32 v29, v81
v_cvt_pk_bf16_f32 v116, v116, v117
v_cvt_pk_bf16_f32 v117, v118, v119
v_xor_b32 v0, 32, v0
v_pk_mul_f32 v[176:177], v[176:177], v[12:13] op_sel_hi:[1,0]
v_pk_mul_f32 v[178:179], v[178:179], v[12:13] op_sel_hi:[1,0]
v_mfma_f32_16x16x32_bf16 v[180:183], a[196:199], v[48:51], v[180:183]
s_waitcnt vmcnt(16) lgkmcnt(3)
ds_write_b64 v0, v[116:117] offset:0
v_exp_f32 v30, v82
v_fma_f32 v83, v83, s24, v11
v_mfma_f32_16x16x32_bf16 v[184:187], a[192:195], v[64:67], v[184:187]
s_barrier
v_cvt_pk_bf16_f32 v70, v28, v29
v_cvt_pk_bf16_f32 v120, v120, v121
v_cvt_pk_bf16_f32 v121, v122, v123
v_mfma_f32_16x16x32_bf16 v[184:187], a[196:199], v[52:55], v[184:187]
ds_read_b128 a[208:211], v1 offset:16384
ds_write_b64 v0, v[120:121] offset:2048
v_add_f32 v24, v24, v28
v_pk_mul_f32 v[180:181], v[180:181], v[14:15] op_sel_hi:[1,0]
v_pk_mul_f32 v[182:183], v[182:183], v[14:15] op_sel_hi:[1,0]
v_mfma_f32_16x16x32_bf16 v[188:191], a[200:203], v[56:59], v[188:191]
ds_read_b128 a[212:215], v2 offset:16384
v_add_f32 v24, v24, v29
v_cvt_pk_bf16_f32 v124, v124, v125
v_cvt_pk_bf16_f32 v125, v126, v127
v_mfma_f32_16x16x32_bf16 v[188:191], a[204:207], v[44:47], v[188:191]
ds_read_b128 a[192:195], v1 offset:17408
ds_write_b64 v0, v[124:125] offset:4096
v_add_f32 v24, v24, v30
v_exp_f32 v31, v83
v_pk_mul_f32 v[184:185], v[184:185], v[16:17] op_sel_hi:[1,0]
v_pk_mul_f32 v[186:187], v[186:187], v[16:17] op_sel_hi:[1,0]
v_mfma_f32_16x16x32_bf16 v[192:195], a[200:203], v[60:63], v[192:195]
s_mov_b32 m0, s38
ds_read_b128 a[196:199], v2 offset:17408
v_cvt_pk_bf16_f32 v71, v30, v31
v_cvt_pk_bf16_f32 v128, v128, v129
v_cvt_pk_bf16_f32 v129, v130, v131
v_xor_b32 v0, 96, v0
v_pk_mul_f32 v[188:189], v[188:189], v[12:13] op_sel_hi:[1,0]
v_pk_mul_f32 v[190:191], v[190:191], v[12:13] op_sel_hi:[1,0]
v_mfma_f32_16x16x32_bf16 v[192:195], a[204:207], v[48:51], v[192:195]
s_bitcmp1_b32 s3, 1
s_cselect_b32 s81, s59, s58
ds_write_b64 v0, v[128:129] offset:0
v_add_f32 v24, v24, v31
v_mfma_f32_16x16x32_bf16 v[196:199], a[200:203], v[64:67], v[196:199]
s_add_u32 s90, s81, s92
ds_read_b128 a[200:203], v1 offset:18432
v_fma_f32 v84, v84, s24, v13
v_cvt_pk_bf16_f32 v132, v132, v133
v_cvt_pk_bf16_f32 v133, v134, v135
v_mfma_f32_16x16x32_bf16 v[196:199], a[204:207], v[52:55], v[196:199]
s_waitcnt lgkmcnt(7)
ds_read_b128 a[204:207], v2 offset:18432
ds_write_b64 v0, v[132:133] offset:2048
v_fma_f32 v85, v85, s24, v13
v_pk_mul_f32 v[192:193], v[192:193], v[14:15] op_sel_hi:[1,0]
v_pk_mul_f32 v[194:195], v[194:195], v[14:15] op_sel_hi:[1,0]
v_mfma_f32_16x16x32_bf16 v[92:95], a[208:211], a[96:99], 0
s_waitcnt lgkmcnt(7)
buffer_load_dwordx4 v7, s[16:19], s90 offen offset:0 nt lds
v_cvt_pk_bf16_f32 v136, v136, v137
v_cvt_pk_bf16_f32 v137, v138, v139
v_mfma_f32_16x16x32_bf16 v[92:95], a[212:215], a[108:111], v[92:95]
ds_write_b64 v0, v[136:137] offset:4096
v_exp_f32 v20, v84
v_pk_mul_f32 v[196:197], v[196:197], v[16:17] op_sel_hi:[1,0]
v_pk_mul_f32 v[198:199], v[198:199], v[16:17] op_sel_hi:[1,0]
v_mfma_f32_16x16x32_bf16 v[96:99], a[208:211], a[100:103], 0
v_exp_f32 v21, v85
v_fma_f32 v86, v86, s24, v13
v_cvt_pk_bf16_f32 v140, v140, v141
v_cvt_pk_bf16_f32 v141, v142, v143
v_xor_b32 v0, 32, v0
v_mfma_f32_16x16x32_bf16 v[96:99], a[212:215], a[112:115], v[96:99]
ds_write_b64 v0, v[140:141] offset:0
v_exp_f32 v28, v86
v_mfma_f32_16x16x32_bf16 v[100:103], a[208:211], a[104:107], 0
ds_read_b128 a[208:211], v1 offset:19456
ds_read_b128 a[0:3], v9 offset:0
v_fma_f32 v87, v87, s24, v13
v_cvt_pk_bf16_f32 v144, v144, v145
v_cvt_pk_bf16_f32 v145, v146, v147
v_mfma_f32_16x16x32_bf16 v[100:103], a[212:215], a[116:119], v[100:103]
s_waitcnt lgkmcnt(5)
ds_read_b128 a[212:215], v2 offset:19456
ds_read_b128 a[4:7], v9 offset:1024
v_mfma_f32_16x16x32_bf16 v[92:95], a[192:195], a[120:123], v[92:95]
s_add_u32 s91, s81, s93
ds_write_b64 v0, v[144:145] offset:2048
v_exp_f32 v29, v87
v_cvt_pk_bf16_f32 v148, v148, v149
v_cvt_pk_bf16_f32 v149, v150, v151
v_mfma_f32_16x16x32_bf16 v[92:95], a[196:199], a[132:135], v[92:95]
buffer_load_dwordx4 v7, s[16:19], s91 offen offset:1024 nt lds
ds_read_b128 a[8:11], v9 offset:2048
ds_read_b128 a[12:15], v9 offset:3072
v_cvt_pk_bf16_f32 v74, v20, v21
v_mfma_f32_16x16x32_bf16 v[96:99], a[192:195], a[124:127], v[96:99]
ds_write_b64 v0, v[148:149] offset:4096
v_add_f32 v26, v26, v20
v_cvt_pk_bf16_f32 v152, v152, v153
v_cvt_pk_bf16_f32 v153, v154, v155
v_xor_b32 v0, 96, v0
v_mfma_f32_16x16x32_bf16 v[96:99], a[196:199], a[136:139], v[96:99]
ds_read_b128 a[16:19], v9 offset:4096
v_add_f32 v26, v26, v21
v_cvt_pk_bf16_f32 v75, v28, v29
v_mfma_f32_16x16x32_bf16 v[100:103], a[192:195], a[128:131], v[100:103]
ds_read_b128 a[192:195], v1 offset:24576
v_add_f32 v26, v26, v28
v_fma_f32 v88, v88, s24, v15
v_cvt_pk_bf16_f32 v156, v156, v157
v_cvt_pk_bf16_f32 v157, v158, v159
v_mfma_f32_16x16x32_bf16 v[100:103], a[196:199], a[140:143], v[100:103]
ds_read_b128 a[196:199], v2 offset:24576
ds_read_b128 a[20:23], v9 offset:5120
v_add_f32 v26, v26, v29
v_mfma_f32_16x16x32_bf16 v[92:95], a[200:203], a[144:147], v[92:95]
ds_write_b64 v0, v[152:153] offset:0
v_exp_f32 v30, v88
v_cvt_pk_bf16_f32 v160, v160, v161
v_cvt_pk_bf16_f32 v161, v162, v163
v_mfma_f32_16x16x32_bf16 v[92:95], a[204:207], a[156:159], v[92:95]
ds_write_b64 v0, v[156:157] offset:2048
v_fma_f32 v89, v89, s24, v15
v_fma_f32 v90, v90, s24, v15
v_mfma_f32_16x16x32_bf16 v[96:99], a[200:203], a[148:151], v[96:99]
ds_write_b64 v0, v[160:161] offset:4096
v_exp_f32 v31, v89
v_fma_f32 v91, v91, s24, v15
v_cvt_pk_bf16_f32 v164, v164, v165
v_cvt_pk_bf16_f32 v165, v166, v167
v_xor_b32 v0, 32, v0
v_mfma_f32_16x16x32_bf16 v[96:99], a[204:207], a[160:163], v[96:99]
ds_write_b64 v0, v[164:165] offset:0
v_exp_f32 v20, v90
v_cvt_pk_bf16_f32 v78, v30, v31
v_mfma_f32_16x16x32_bf16 v[100:103], a[200:203], a[152:155], v[100:103]
s_addk_i32 s90, 2048
ds_read_b128 a[200:203], v1 offset:25600
v_add_f32 v27, v27, v30
v_exp_f32 v21, v91
v_cvt_pk_bf16_f32 v168, v168, v169
v_cvt_pk_bf16_f32 v169, v170, v171
v_mfma_f32_16x16x32_bf16 v[100:103], a[204:207], a[164:167], v[100:103]
s_waitcnt lgkmcnt(6)
ds_read_b128 a[204:207], v2 offset:25600
ds_write_b64 v0, v[168:169] offset:2048
v_add_f32 v27, v27, v31
v_mfma_f32_16x16x32_bf16 v[92:95], a[208:211], a[168:171], v[92:95]
buffer_load_dwordx4 v7, s[16:19], s90 offen offset:2048 nt lds
v_cvt_pk_bf16_f32 v79, v20, v21
v_cvt_pk_bf16_f32 v172, v172, v173
v_cvt_pk_bf16_f32 v173, v174, v175
v_mfma_f32_16x16x32_bf16 v[92:95], a[212:215], a[180:183], v[92:95]
ds_write_b64 v0, v[172:173] offset:4096
v_add_f32 v27, v27, v20
v_mfma_f32_16x16x32_bf16 v[96:99], a[208:211], a[172:175], v[96:99]
v_add_f32 v27, v27, v21
v_max3_f32 v25, v24, v26, v27
v_cvt_pk_bf16_f32 v176, v176, v177
v_cvt_pk_bf16_f32 v177, v178, v179
v_xor_b32 v0, 96, v0
v_mfma_f32_16x16x32_bf16 v[96:99], a[212:215], a[184:187], v[96:99]
ds_write_b64 v0, v[176:177] offset:0
v_cmp_lt_f32 vcc, s25, v25
v_cvt_pk_bf16_f32 v180, v180, v181
s_cbranch_vccnz STUB_16
BACK_16:
v_mfma_f32_16x16x32_bf16 v[100:103], a[208:211], a[176:179], v[100:103]
ds_read_b128 a[208:211], v1 offset:26624
v_bfe_u32 v25, v9, 7, 3
v_cvt_pk_bf16_f32 v181, v182, v183
v_mfma_f32_16x16x32_bf16 v[100:103], a[212:215], a[188:191], v[100:103]
ds_read_b128 a[212:215], v2 offset:26624
ds_write_b64 v0, v[180:181] offset:2048
v_lshlrev_b32 v31, 4, v25
v_mfma_f32_16x16x32_bf16 v[80:83], a[192:195], a[96:99], 0
s_addk_i32 s91, 2048
v_xor_b32 v31, v31, v9
v_and_b32 v31, 0x70, v31
v_cvt_pk_bf16_f32 v184, v184, v185
v_cvt_pk_bf16_f32 v185, v186, v187
v_mfma_f32_16x16x32_bf16 v[80:83], a[196:199], a[108:111], v[80:83]
buffer_load_dwordx4 v7, s[16:19], s91 offen offset:3072 nt lds
ds_write_b64 v0, v[184:185] offset:4096
v_lshl_add_u32 v8, v25, 9, v31
v_mfma_f32_16x16x32_bf16 v[84:87], a[192:195], a[100:103], 0
v_mov_b32 v19, v27
v_mov_b32 v17, v24
v_cvt_pk_bf16_f32 v188, v188, v189
v_cvt_pk_bf16_f32 v189, v190, v191
v_xor_b32 v0, 32, v0
v_mfma_f32_16x16x32_bf16 v[84:87], a[196:199], a[112:115], v[84:87]
ds_write_b64 v0, v[188:189] offset:0
v_mov_b32 v18, v26
v_mfma_f32_16x16x32_bf16 v[88:91], a[192:195], a[104:107], 0
ds_read_b128 a[192:195], v1 offset:27648
ds_read_b128 a[24:27], v9 offset:0
v_cvt_pk_bf16_f32 v192, v192, v193
v_cvt_pk_bf16_f32 v193, v194, v195
v_mfma_f32_16x16x32_bf16 v[88:91], a[196:199], a[116:119], v[88:91]
s_waitcnt lgkmcnt(5)
ds_read_b128 a[196:199], v2 offset:27648
v_fma_f32 v92, v92, s24, v11
v_mfma_f32_16x16x32_bf16 v[80:83], a[200:203], a[120:123], v[80:83]
ds_read_b128 a[28:31], v9 offset:1024
v_fma_f32 v93, v93, s24, v11
v_cvt_pk_bf16_f32 v196, v196, v197
v_cvt_pk_bf16_f32 v197, v198, v199
v_mfma_f32_16x16x32_bf16 v[80:83], a[204:207], a[132:135], v[80:83]
s_mov_b32 m0, s32
ds_write_b64 v0, v[192:193] offset:2048
v_exp_f32 v28, v92
v_mfma_f32_16x16x32_bf16 v[84:87], a[200:203], a[124:127], v[84:87]
s_add_u32 s90, s60, s92
ds_read_b128 a[32:35], v9 offset:2048
ds_read_b128 a[36:39], v9 offset:3072
v_mfma_f32_16x16x32_bf16 v[84:87], a[204:207], a[136:139], v[84:87]
buffer_load_dwordx4 v7, s[12:15], s90 offen offset:0 nt lds
ds_write_b64 v0, v[196:197] offset:4096
v_exp_f32 v29, v93
v_mfma_f32_16x16x32_bf16 v[88:91], a[200:203], a[128:131], v[88:91]
ds_read_b64_tr_b16 a[200:201], v3 offset:49152
v_fma_f32 v94, v94, s24, v11
v_mfma_f32_16x16x32_bf16 v[88:91], a[204:207], a[140:143], v[88:91]
ds_read_b64_tr_b16 a[202:203], v3 offset:53248
ds_read_b128 a[40:43], v9 offset:4096
v_mfma_f32_16x16x32_bf16 v[80:83], a[208:211], a[144:147], v[80:83]
ds_read_b128 a[44:47], v9 offset:5120
v_fma_f32 v95, v95, s24, v11
v_mfma_f32_16x16x32_bf16 v[80:83], a[212:215], a[156:159], v[80:83]
ds_read_b64_tr_b16 a[204:205], v3 offset:57344
v_cvt_pk_bf16_f32 v32, v28, v29
v_mfma_f32_16x16x32_bf16 v[84:87], a[208:211], a[148:151], v[84:87]
ds_read_b64_tr_b16 a[206:207], v3 offset:61440
v_add_f32 v24, v28, v29
v_mfma_f32_16x16x32_bf16 v[84:87], a[212:215], a[160:163], v[84:87]
v_exp_f32 v30, v94
v_mfma_f32_16x16x32_bf16 v[88:91], a[208:211], a[152:155], v[88:91]
s_add_u32 s90, s60, s93
ds_read_b64_tr_b16 a[208:209], v4 offset:49152
v_add_f32 v24, v24, v30
v_mfma_f32_16x16x32_bf16 v[88:91], a[212:215], a[164:167], v[88:91]
s_waitcnt lgkmcnt(5)
ds_read_b64_tr_b16 a[210:211], v4 offset:53248
v_fma_f32 v96, v96, s24, v13
v_mfma_f32_16x16x32_bf16 v[80:83], a[192:195], a[168:171], v[80:83]
buffer_load_dwordx4 v7, s[12:15], s90 offen offset:1024 nt lds
v_mfma_f32_16x16x32_bf16 v[80:83], a[196:199], a[180:183], v[80:83]
ds_read_b64_tr_b16 a[212:213], v4 offset:57344
v_fma_f32 v97, v97, s24, v13
v_mfma_f32_16x16x32_bf16 v[84:87], a[192:195], a[172:175], v[84:87]
ds_read_b64_tr_b16 a[214:215], v4 offset:61440
v_fma_f32 v98, v98, s24, v13
v_mfma_f32_16x16x32_bf16 v[84:87], a[196:199], a[184:187], v[84:87]
v_exp_f32 v31, v95
v_mfma_f32_16x16x32_bf16 v[88:91], a[192:195], a[176:179], v[88:91]
ds_read_b64_tr_b16 a[192:193], v5 offset:49152
v_cvt_pk_bf16_f32 v33, v30, v31
v_mfma_f32_16x16x32_bf16 v[88:91], a[196:199], a[188:191], v[88:91]
ds_read_b64_tr_b16 a[194:195], v5 offset:53248
v_add_f32 v24, v24, v31
v_mfma_f32_16x16x32_bf16 v[200:203], a[200:203], v[56:59], v[200:203]
s_waitcnt lgkmcnt(4)
v_exp_f32 v20, v96
v_mfma_f32_16x16x32_bf16 v[200:203], a[204:207], v[44:47], v[200:203]
ds_read_b64_tr_b16 a[196:197], v5 offset:57344
v_fma_f32 v99, v99, s24, v13
v_mfma_f32_16x16x32_bf16 v[204:207], a[200:203], v[60:63], v[204:207]
s_add_u32 s90, s60, s94
ds_read_b64_tr_b16 a[198:199], v5 offset:61440
v_fma_f32 v100, v100, s24, v15
v_mfma_f32_16x16x32_bf16 v[204:207], a[204:207], v[48:51], v[204:207]
buffer_load_dwordx4 v7, s[12:15], s90 offen offset:2048 nt lds
v_mfma_f32_16x16x32_bf16 v[208:211], a[200:203], v[64:67], v[208:211]
ds_read_b64_tr_b16 a[200:201], v6 offset:49152
v_fma_f32 v101, v101, s24, v15
v_mfma_f32_16x16x32_bf16 v[208:211], a[204:207], v[52:55], v[208:211]
ds_read_b64_tr_b16 a[202:203], v6 offset:53248
v_fma_f32 v102, v102, s24, v15
v_mfma_f32_16x16x32_bf16 v[212:215], a[208:211], v[56:59], v[212:215]
s_waitcnt lgkmcnt(4)
v_exp_f32 v21, v97
v_mfma_f32_16x16x32_bf16 v[212:215], a[212:215], v[44:47], v[212:215]
ds_read_b64_tr_b16 a[204:205], v6 offset:57344
v_cvt_pk_bf16_f32 v36, v20, v21
v_mfma_f32_16x16x32_bf16 v[216:219], a[208:211], v[60:63], v[216:219]
ds_read_b64_tr_b16 a[206:207], v6 offset:61440
v_add_f32 v26, v20, v21
v_mfma_f32_16x16x32_bf16 v[216:219], a[212:215], v[48:51], v[216:219]
v_exp_f32 v28, v98
v_mfma_f32_16x16x32_bf16 v[220:223], a[208:211], v[64:67], v[220:223]
ds_read_b64_tr_b16 a[208:209], v3 offset:50176
v_add_f32 v26, v26, v28
v_mfma_f32_16x16x32_bf16 v[220:223], a[212:215], v[52:55], v[220:223]
s_add_u32 s90, s60, s95
ds_read_b64_tr_b16 a[210:211], v3 offset:54272
v_fma_f32 v103, v103, s24, v15
v_mfma_f32_16x16x32_bf16 a[216:219], a[192:195], v[56:59], a[216:219]
s_waitcnt lgkmcnt(4)
buffer_load_dwordx4 v7, s[12:15], s90 offen offset:3072 nt lds
v_mfma_f32_16x16x32_bf16 a[216:219], a[196:199], v[44:47], a[216:219]
ds_read_b64_tr_b16 a[212:213], v3 offset:58368
v_fma_f32 v80, v80, s24, v11
v_mfma_f32_16x16x32_bf16 a[220:223], a[192:195], v[60:63], a[220:223]
ds_read_b64_tr_b16 a[214:215], v3 offset:62464
v_exp_f32 v29, v99
v_exp_f32 v30, v100
v_pk_mul_f32 v[200:201], v[200:201], v[12:13] op_sel_hi:[1,0]
v_pk_mul_f32 v[202:203], v[202:203], v[12:13] op_sel_hi:[1,0]
v_pk_mul_f32 v[204:205], v[204:205], v[14:15] op_sel_hi:[1,0]
v_pk_mul_f32 v[206:207], v[206:207], v[14:15] op_sel_hi:[1,0]
v_pk_mul_f32 v[208:209], v[208:209], v[16:17] op_sel_hi:[1,0]
v_pk_mul_f32 v[210:211], v[210:211], v[16:17] op_sel_hi:[1,0]
v_mfma_f32_16x16x32_bf16 a[220:223], a[196:199], v[48:51], a[220:223]
v_exp_f32 v31, v101
v_mfma_f32_16x16x32_bf16 a[224:227], a[192:195], v[64:67], a[224:227]
ds_read_b64_tr_b16 a[192:193], v4 offset:50176
v_cvt_pk_bf16_f32 v37, v28, v29
v_mfma_f32_16x16x32_bf16 a[224:227], a[196:199], v[52:55], a[224:227]
ds_read_b64_tr_b16 a[194:195], v4 offset:54272
v_add_f32 v26, v26, v29
v_mfma_f32_16x16x32_bf16 a[228:231], a[200:203], v[56:59], a[228:231]
s_waitcnt lgkmcnt(4)
v_exp_f32 v20, v102
v_mfma_f32_16x16x32_bf16 a[228:231], a[204:207], v[44:47], a[228:231]
ds_read_b64_tr_b16 a[196:197], v4 offset:58368
v_cvt_pk_bf16_f32 v40, v30, v31
v_mfma_f32_16x16x32_bf16 a[232:235], a[200:203], v[60:63], a[232:235]
s_add_u32 s89, s26, s84
ds_read_b64_tr_b16 a[198:199], v4 offset:62464
v_exp_f32 v21, v103
v_exp_f32 v28, v80
v_pk_mul_f32 v[212:213], v[212:213], v[12:13] op_sel_hi:[1,0]
v_pk_mul_f32 v[214:215], v[214:215], v[12:13] op_sel_hi:[1,0]
v_pk_mul_f32 v[216:217], v[216:217], v[14:15] op_sel_hi:[1,0]
v_pk_mul_f32 v[218:219], v[218:219], v[14:15] op_sel_hi:[1,0]
v_pk_mul_f32 v[220:221], v[220:221], v[16:17] op_sel_hi:[1,0]
v_pk_mul_f32 v[222:223], v[222:223], v[16:17] op_sel_hi:[1,0]
v_mfma_f32_16x16x32_bf16 a[232:235], a[204:207], v[48:51], a[232:235]
buffer_store_dwordx4 a[0:3], v8, s[20:23], s89 offen nt
v_mfma_f32_16x16x32_bf16 a[236:239], a[200:203], v[64:67], a[236:239]
ds_read_b64_tr_b16 a[200:201], v5 offset:50176
v_add_f32 v27, v30, v31
v_mfma_f32_16x16x32_bf16 a[236:239], a[204:207], v[52:55], a[236:239]
ds_read_b64_tr_b16 a[202:203], v5 offset:54272
v_cvt_pk_bf16_f32 v41, v20, v21
v_mfma_f32_16x16x32_bf16 a[240:243], a[208:211], v[56:59], a[240:243]
s_waitcnt lgkmcnt(4)
v_add_f32 v27, v27, v20
v_add_f32 v27, v27, v21
v_mfma_f32_16x16x32_bf16 a[240:243], a[212:215], v[44:47], a[240:243]
ds_read_b64_tr_b16 a[204:205], v5 offset:58368
v_fma_f32 v81, v81, s24, v11
v_mfma_f32_16x16x32_bf16 a[244:247], a[208:211], v[60:63], a[244:247]
ds_read_b64_tr_b16 a[206:207], v5 offset:62464
v_fma_f32 v82, v82, s24, v11
v_mfma_f32_16x16x32_bf16 a[244:247], a[212:215], v[48:51], a[244:247]
v_exp_f32 v29, v81
v_mfma_f32_16x16x32_bf16 a[248:251], a[208:211], v[64:67], a[248:251]
ds_read_b64_tr_b16 a[208:209], v6 offset:50176
v_fma_f32 v83, v83, s24, v11
v_mfma_f32_16x16x32_bf16 a[248:251], a[212:215], v[52:55], a[248:251]
s_add_u32 s89, s26, s85
ds_read_b64_tr_b16 a[210:211], v6 offset:54272
v_cvt_pk_bf16_f32 v34, v28, v29
v_mfma_f32_16x16x32_bf16 a[252:255], a[192:195], v[56:59], a[252:255]
s_waitcnt lgkmcnt(4)
buffer_store_dwordx4 a[24:27], v8, s[20:23], s89 offen nt
v_mfma_f32_16x16x32_bf16 a[252:255], a[196:199], v[44:47], a[252:255]
ds_read_b64_tr_b16 a[212:213], v6 offset:58368
v_add_f32 v24, v24, v28
v_mfma_f32_16x16x32_bf16 v[224:227], a[192:195], v[60:63], v[224:227]
ds_read_b64_tr_b16 a[214:215], v6 offset:62464
v_add_f32 v24, v24, v29
v_cvt_pk_bf16_f32 v200, v200, v201
v_cvt_pk_bf16_f32 v201, v202, v203
v_xor_b32 v0, 96, v0
v_mfma_f32_16x16x32_bf16 v[224:227], a[196:199], v[48:51], v[224:227]
ds_write_b64 v0, v[200:201] offset:0
v_exp_f32 v30, v82
v_mfma_f32_16x16x32_bf16 v[228:231], a[192:195], v[64:67], v[228:231]
v_exp_f32 v31, v83
v_cvt_pk_bf16_f32 v204, v204, v205
v_cvt_pk_bf16_f32 v205, v206, v207
v_mfma_f32_16x16x32_bf16 v[228:231], a[196:199], v[52:55], v[228:231]
ds_write_b64 v0, v[204:205] offset:2048
v_cvt_pk_bf16_f32 v35, v30, v31
v_add_f32 v24, v24, v30
v_pk_mul_f32 v[224:225], v[224:225], v[14:15] op_sel_hi:[1,0]
v_pk_mul_f32 v[226:227], v[226:227], v[14:15] op_sel_hi:[1,0]
v_mfma_f32_16x16x32_bf16 v[232:235], a[200:203], v[56:59], v[232:235]
s_waitcnt lgkmcnt(4)
v_add_f32 v24, v24, v31
v_fma_f32 v84, v84, s24, v13
v_cvt_pk_bf16_f32 v208, v208, v209
v_cvt_pk_bf16_f32 v209, v210, v211
v_mfma_f32_16x16x32_bf16 v[232:235], a[204:207], v[44:47], v[232:235]
ds_write_b64 v0, v[208:209] offset:4096
v_exp_f32 v20, v84
v_pk_mul_f32 v[228:229], v[228:229], v[16:17] op_sel_hi:[1,0]
v_pk_mul_f32 v[230:231], v[230:231], v[16:17] op_sel_hi:[1,0]
PADJ_8:
s_cbranch_execz PADJ_12
v_mfma_f32_16x16x32_bf16 v[236:239], a[200:203], v[60:63], v[236:239]
v_fma_f32 v85, v85, s24, v13
v_fma_f32 v86, v86, s24, v13
v_cvt_pk_bf16_f32 v212, v212, v213
v_cvt_pk_bf16_f32 v213, v214, v215
v_xor_b32 v0, 32, v0
v_pk_mul_f32 v[232:233], v[232:233], v[12:13] op_sel_hi:[1,0]
v_pk_mul_f32 v[234:235], v[234:235], v[12:13] op_sel_hi:[1,0]
v_mfma_f32_16x16x32_bf16 v[236:239], a[204:207], v[48:51], v[236:239]
s_waitcnt vmcnt(18) lgkmcnt(3)
ds_write_b64 v0, v[212:213] offset:0
v_exp_f32 v21, v85
v_mfma_f32_16x16x32_bf16 v[240:243], a[200:203], v[64:67], v[240:243]
s_barrier
v_fma_f32 v87, v87, s24, v13
v_cvt_pk_bf16_f32 v216, v216, v217
v_cvt_pk_bf16_f32 v217, v218, v219
v_mfma_f32_16x16x32_bf16 v[240:243], a[204:207], v[52:55], v[240:243]
ds_read_b128 a[192:195], v1 offset:32768
ds_write_b64 v0, v[216:217] offset:2048
v_cvt_pk_bf16_f32 v38, v20, v21
v_pk_mul_f32 v[236:237], v[236:237], v[14:15] op_sel_hi:[1,0]
v_pk_mul_f32 v[238:239], v[238:239], v[14:15] op_sel_hi:[1,0]
v_mfma_f32_16x16x32_bf16 v[244:247], a[208:211], v[56:59], v[244:247]
ds_read_b128 a[196:199], v2 offset:32768
v_add_f32 v26, v26, v20
v_cvt_pk_bf16_f32 v220, v220, v221
v_cvt_pk_bf16_f32 v221, v222, v223
v_mfma_f32_16x16x32_bf16 v[244:247], a[212:215], v[44:47], v[244:247]
ds_read_b128 a[200:203], v1 offset:33792
ds_write_b64 v0, v[220:221] offset:4096
v_add_f32 v26, v26, v21
v_pk_mul_f32 v[240:241], v[240:241], v[16:17] op_sel_hi:[1,0]
v_pk_mul_f32 v[242:243], v[242:243], v[16:17] op_sel_hi:[1,0]
v_mfma_f32_16x16x32_bf16 v[248:251], a[208:211], v[60:63], v[248:251]
s_mov_b32 m0, s39
ds_read_b128 a[204:207], v2 offset:33792
v_fma_f32 v88, v88, s24, v15
v_accvgpr_read_b32 v200, a216
v_accvgpr_read_b32 v201, a217
v_accvgpr_read_b32 v202, a218
v_pk_mul_f32 v[200:201], v[200:201], v[12:13] op_sel_hi:[1,0]
v_pk_mul_f32 v[244:245], v[244:245], v[12:13] op_sel_hi:[1,0]
v_pk_mul_f32 v[246:247], v[246:247], v[12:13] op_sel_hi:[1,0]
v_mfma_f32_16x16x32_bf16 v[248:251], a[212:215], v[48:51], v[248:251]
s_addk_i32 s81, 2048
v_exp_f32 v28, v86
v_accvgpr_read_b32 v203, a219
v_cvt_pk_bf16_f32 v200, v200, v201
v_xor_b32 v0, 96, v0
v_pk_mul_f32 v[202:203], v[202:203], v[12:13] op_sel_hi:[1,0]
v_mfma_f32_16x16x32_bf16 v[252:255], a[208:211], v[64:67], v[252:255]
s_add_u32 s90, s81, s94
ds_read_b128 a[208:211], v1 offset:34816
v_add_f32 v26, v26, v28
v_cvt_pk_bf16_f32 v201, v202, v203
v_accvgpr_read_b32 v204, a220
v_accvgpr_read_b32 v205, a221
v_pk_mul_f32 v[204:205], v[204:205], v[14:15] op_sel_hi:[1,0]
v_pk_mul_f32 v[248:249], v[248:249], v[14:15] op_sel_hi:[1,0]
v_pk_mul_f32 v[250:251], v[250:251], v[14:15] op_sel_hi:[1,0]
v_mfma_f32_16x16x32_bf16 v[252:255], a[212:215], v[52:55], v[252:255]
s_waitcnt lgkmcnt(6)
ds_read_b128 a[212:215], v2 offset:34816
ds_write_b64 v0, v[200:201] offset:0
v_exp_f32 v29, v87
v_accvgpr_read_b32 v206, a222
v_accvgpr_read_b32 v207, a223
v_cvt_pk_bf16_f32 v204, v204, v205
v_pk_mul_f32 v[206:207], v[206:207], v[14:15] op_sel_hi:[1,0]
v_pk_mul_f32 v[252:253], v[252:253], v[16:17] op_sel_hi:[1,0]
v_pk_mul_f32 v[254:255], v[254:255], v[16:17] op_sel_hi:[1,0]
v_mfma_f32_16x16x32_bf16 v[44:47], a[192:195], a[96:99], 0
s_waitcnt lgkmcnt(6)
buffer_load_dwordx4 v7, s[16:19], s90 offen offset:0 nt lds
v_cvt_pk_bf16_f32 v205, v206, v207
v_accvgpr_read_b32 v208, a224
v_accvgpr_read_b32 v209, a225
v_pk_mul_f32 v[208:209], v[208:209], v[16:17] op_sel_hi:[1,0]
v_mfma_f32_16x16x32_bf16 v[44:47], a[196:199], a[108:111], v[44:47]
ds_write_b64 v0, v[204:205] offset:2048
v_exp_f32 v30, v88
v_accvgpr_read_b32 v210, a226
v_accvgpr_read_b32 v211, a227
v_cvt_pk_bf16_f32 v208, v208, v209
v_pk_mul_f32 v[210:211], v[210:211], v[16:17] op_sel_hi:[1,0]
v_mfma_f32_16x16x32_bf16 v[48:51], a[192:195], a[100:103], 0
v_cvt_pk_bf16_f32 v39, v28, v29
v_add_f32 v26, v26, v29
v_cvt_pk_bf16_f32 v209, v210, v211
v_accvgpr_read_b32 v212, a228
v_accvgpr_read_b32 v213, a229
v_pk_mul_f32 v[212:213], v[212:213], v[12:13] op_sel_hi:[1,0]
v_mfma_f32_16x16x32_bf16 v[48:51], a[196:199], a[112:115], v[48:51]
ds_write_b64 v0, v[208:209] offset:4096
v_fma_f32 v89, v89, s24, v15
v_accvgpr_read_b32 v214, a230
v_accvgpr_read_b32 v215, a231
v_cvt_pk_bf16_f32 v212, v212, v213
v_pk_mul_f32 v[214:215], v[214:215], v[12:13] op_sel_hi:[1,0]
v_mfma_f32_16x16x32_bf16 v[52:55], a[192:195], a[104:107], 0
s_add_u32 s91, s81, s95
ds_read_b128 a[192:195], v1 offset:35840
v_fma_f32 v90, v90, s24, v15
v_cvt_pk_bf16_f32 v213, v214, v215
v_xor_b32 v0, 32, v0
v_accvgpr_read_b32 v216, a232
v_mfma_f32_16x16x32_bf16 v[52:55], a[196:199], a[116:119], v[52:55]
s_waitcnt lgkmcnt(4)
ds_read_b128 a[196:199], v2 offset:35840
ds_write_b64 v0, v[212:213] offset:0
v_exp_f32 v31, v89
v_accvgpr_read_b32 v217, a233
v_accvgpr_read_b32 v218, a234
v_accvgpr_read_b32 v219, a235
v_pk_mul_f32 v[216:217], v[216:217], v[14:15] op_sel_hi:[1,0]
v_pk_mul_f32 v[218:219], v[218:219], v[14:15] op_sel_hi:[1,0]
v_mfma_f32_16x16x32_bf16 v[44:47], a[200:203], a[120:123], v[44:47]
buffer_load_dwordx4 v7, s[16:19], s91 offen offset:1024 nt lds
ds_read_b128 a[48:51], v9 offset:0
ds_read_b128 a[52:55], v9 offset:1024
v_cvt_pk_bf16_f32 v216, v216, v217
v_cvt_pk_bf16_f32 v217, v218, v219
v_accvgpr_read_b32 v220, a236
v_mfma_f32_16x16x32_bf16 v[44:47], a[204:207], a[132:135], v[44:47]
ds_write_b64 v0, v[216:217] offset:2048
v_exp_f32 v20, v90
v_accvgpr_read_b32 v221, a237
v_accvgpr_read_b32 v222, a238
v_accvgpr_read_b32 v223, a239
v_pk_mul_f32 v[220:221], v[220:221], v[16:17] op_sel_hi:[1,0]
v_pk_mul_f32 v[222:223], v[222:223], v[16:17] op_sel_hi:[1,0]
v_mfma_f32_16x16x32_bf16 v[48:51], a[200:203], a[124:127], v[48:51]
ds_read_b128 a[56:59], v9 offset:2048
ds_read_b128 a[60:63], v9 offset:3072
v_cvt_pk_bf16_f32 v220, v220, v221
v_cvt_pk_bf16_f32 v221, v222, v223
v_accvgpr_read_b32 v200, a240
v_mfma_f32_16x16x32_bf16 v[48:51], a[204:207], a[136:139], v[48:51]
ds_write_b64 v0, v[220:221] offset:4096
v_fma_f32 v91, v91, s24, v15
v_accvgpr_read_b32 v201, a241
v_accvgpr_read_b32 v202, a242
v_accvgpr_read_b32 v203, a243
v_pk_mul_f32 v[200:201], v[200:201], v[12:13] op_sel_hi:[1,0]
v_pk_mul_f32 v[202:203], v[202:203], v[12:13] op_sel_hi:[1,0]
v_mfma_f32_16x16x32_bf16 v[52:55], a[200:203], a[128:131], v[52:55]
ds_read_b128 a[200:203], v1 offset:40960
ds_read_b128 a[64:67], v9 offset:4096
ds_read_b128 a[68:71], v9 offset:5120
v_cvt_pk_bf16_f32 v200, v200, v201
v_cvt_pk_bf16_f32 v201, v202, v203
v_xor_b32 v0, 96, v0
v_mfma_f32_16x16x32_bf16 v[52:55], a[204:207], a[140:143], v[52:55]
ds_read_b128 a[204:207], v2 offset:40960
v_cvt_pk_bf16_f32 v42, v30, v31
v_accvgpr_read_b32 v204, a244
v_accvgpr_read_b32 v205, a245
v_accvgpr_read_b32 v206, a246
v_pk_mul_f32 v[204:205], v[204:205], v[14:15] op_sel_hi:[1,0]
v_mfma_f32_16x16x32_bf16 v[44:47], a[208:211], a[144:147], v[44:47]
s_addk_i32 s90, 2048
ds_write_b64 v0, v[200:201] offset:0
v_exp_f32 v21, v91
v_accvgpr_read_b32 v207, a247
v_cvt_pk_bf16_f32 v204, v204, v205
v_accvgpr_read_b32 v208, a248
v_pk_mul_f32 v[206:207], v[206:207], v[14:15] op_sel_hi:[1,0]
v_mfma_f32_16x16x32_bf16 v[44:47], a[212:215], a[156:159], v[44:47]
buffer_load_dwordx4 v7, s[16:19], s90 offen offset:2048 nt lds
v_cvt_pk_bf16_f32 v205, v206, v207
v_accvgpr_read_b32 v209, a249
v_accvgpr_read_b32 v210, a250
v_pk_mul_f32 v[208:209], v[208:209], v[16:17] op_sel_hi:[1,0]
v_mfma_f32_16x16x32_bf16 v[48:51], a[208:211], a[148:151], v[48:51]
ds_write_b64 v0, v[204:205] offset:2048
v_add_f32 v27, v27, v30
v_accvgpr_read_b32 v211, a251
v_cvt_pk_bf16_f32 v208, v208, v209
v_accvgpr_read_b32 v212, a252
v_pk_mul_f32 v[210:211], v[210:211], v[16:17] op_sel_hi:[1,0]
v_mfma_f32_16x16x32_bf16 v[48:51], a[212:215], a[160:163], v[48:51]
v_add_f32 v27, v27, v31
v_cvt_pk_bf16_f32 v43, v20, v21
v_cvt_pk_bf16_f32 v209, v210, v211
v_accvgpr_read_b32 v213, a253
v_accvgpr_read_b32 v214, a254
v_pk_mul_f32 v[212:213], v[212:213], v[12:13] op_sel_hi:[1,0]
v_mfma_f32_16x16x32_bf16 v[52:55], a[208:211], a[152:155], v[52:55]
ds_read_b128 a[208:211], v1 offset:41984
ds_write_b64 v0, v[208:209] offset:4096
v_add_f32 v27, v27, v20
v_accvgpr_read_b32 v215, a255
v_cvt_pk_bf16_f32 v212, v212, v213
v_xor_b32 v0, 32, v0
v_pk_mul_f32 v[214:215], v[214:215], v[12:13] op_sel_hi:[1,0]
v_mfma_f32_16x16x32_bf16 v[52:55], a[212:215], a[164:167], v[52:55]
s_waitcnt lgkmcnt(4)
ds_read_b128 a[212:215], v2 offset:41984
v_add_f32 v27, v27, v21
v_cvt_pk_bf16_f32 v213, v214, v215
v_cvt_pk_bf16_f32 v224, v224, v225
v_cvt_pk_bf16_f32 v225, v226, v227
v_mfma_f32_16x16x32_bf16 v[44:47], a[192:195], a[168:171], v[44:47]
ds_write_b64 v0, v[212:213] offset:0
v_max3_f32 v25, v24, v26, v27
v_cvt_pk_bf16_f32 v228, v228, v229
v_cvt_pk_bf16_f32 v229, v230, v231
v_mfma_f32_16x16x32_bf16 v[44:47], a[196:199], a[180:183], v[44:47]
s_addk_i32 s91, 2048
ds_write_b64 v0, v[224:225] offset:2048
v_cmp_lt_f32 vcc, s25, v25
v_mfma_f32_16x16x32_bf16 v[48:51], a[192:195], a[172:175], v[48:51]
buffer_load_dwordx4 v7, s[16:19], s91 offen offset:3072 nt lds
ds_write_b64 v0, v[228:229] offset:4096
v_cvt_pk_bf16_f32 v232, v232, v233
v_cvt_pk_bf16_f32 v233, v234, v235
v_xor_b32 v0, 96, v0
v_mfma_f32_16x16x32_bf16 v[48:51], a[196:199], a[184:187], v[48:51]
ds_write_b64 v0, v[232:233] offset:0
v_cvt_pk_bf16_f32 v236, v236, v237
s_cbranch_vccnz STUB_17
BACK_17:
v_mfma_f32_16x16x32_bf16 v[52:55], a[192:195], a[176:179], v[52:55]
ds_read_b128 a[192:195], v1 offset:43008
v_add_f32 v19, v19, v27
v_cvt_pk_bf16_f32 v237, v238, v239
v_mfma_f32_16x16x32_bf16 v[52:55], a[196:199], a[188:191], v[52:55]
ds_read_b128 a[196:199], v2 offset:43008
ds_write_b64 v0, v[236:237] offset:2048
v_add_f32 v17, v17, v24
v_mfma_f32_16x16x32_bf16 v[80:83], a[200:203], a[96:99], 0
v_add_f32 v18, v18, v26
v_fma_f32 v44, v44, s24, v11
v_cvt_pk_bf16_f32 v240, v240, v241
v_cvt_pk_bf16_f32 v241, v242, v243
v_mfma_f32_16x16x32_bf16 v[80:83], a[204:207], a[108:111], v[80:83]
ds_write_b64 v0, v[240:241] offset:4096
v_exp_f32 v28, v44
v_mfma_f32_16x16x32_bf16 v[84:87], a[200:203], a[100:103], 0
v_fma_f32 v45, v45, s24, v11
v_fma_f32 v46, v46, s24, v11
v_cvt_pk_bf16_f32 v244, v244, v245
v_cvt_pk_bf16_f32 v245, v246, v247
v_xor_b32 v0, 32, v0
v_mfma_f32_16x16x32_bf16 v[84:87], a[204:207], a[112:115], v[84:87]
s_mov_b32 m0, s33
ds_write_b64 v0, v[244:245] offset:0
v_exp_f32 v29, v45
v_mfma_f32_16x16x32_bf16 v[88:91], a[200:203], a[104:107], 0
s_add_u32 s90, s61, s92
ds_read_b128 a[200:203], v1 offset:44032
ds_read_b128 a[72:75], v9 offset:0
v_cvt_pk_bf16_f32 v248, v248, v249
v_cvt_pk_bf16_f32 v249, v250, v251
v_mfma_f32_16x16x32_bf16 v[88:91], a[204:207], a[116:119], v[88:91]
s_waitcnt lgkmcnt(5)
ds_read_b128 a[204:207], v2 offset:44032
ds_read_b128 a[76:79], v9 offset:1024
v_mfma_f32_16x16x32_bf16 v[80:83], a[208:211], a[120:123], v[80:83]
buffer_load_dwordx4 v7, s[12:15], s90 offen offset:0 nt lds
ds_write_b64 v0, v[248:249] offset:2048
v_exp_f32 v30, v46
v_cvt_pk_bf16_f32 v252, v252, v253
v_cvt_pk_bf16_f32 v253, v254, v255
v_mfma_f32_16x16x32_bf16 v[80:83], a[212:215], a[132:135], v[80:83]
ds_read_b128 a[80:83], v9 offset:2048
v_fma_f32 v47, v47, s24, v11
v_mfma_f32_16x16x32_bf16 v[84:87], a[208:211], a[124:127], v[84:87]
ds_read_b128 a[84:87], v9 offset:3072
v_cvt_pk_bf16_f32 v56, v28, v29
v_mfma_f32_16x16x32_bf16 v[84:87], a[212:215], a[136:139], v[84:87]
ds_write_b64 v0, v[252:253] offset:4096
v_exp_f32 v31, v47
v_mfma_f32_16x16x32_bf16 v[88:91], a[208:211], a[128:131], v[88:91]
ds_read_b64_tr_b16 a[208:209], v3 offset:0
ds_read_b128 a[88:91], v9 offset:4096
v_mfma_f32_16x16x32_bf16 v[88:91], a[212:215], a[140:143], v[88:91]
s_add_u32 s90, s61, s93
ds_read_b64_tr_b16 a[210:211], v3 offset:4096
v_add_f32 v24, v28, v29
v_mfma_f32_16x16x32_bf16 v[80:83], a[192:195], a[144:147], v[80:83]
buffer_load_dwordx4 v7, s[12:15], s90 offen offset:1024 nt lds
v_mfma_f32_16x16x32_bf16 v[80:83], a[196:199], a[156:159], v[80:83]
ds_read_b64_tr_b16 a[212:213], v3 offset:8192
ds_read_b128 a[92:95], v9 offset:5120
v_mfma_f32_16x16x32_bf16 v[84:87], a[192:195], a[148:151], v[84:87]
ds_read_b64_tr_b16 a[214:215], v3 offset:12288
v_cvt_pk_bf16_f32 v57, v30, v31
v_mfma_f32_16x16x32_bf16 v[84:87], a[196:199], a[160:163], v[84:87]
v_add_f32 v24, v24, v30
v_add_f32 v24, v24, v31
v_mfma_f32_16x16x32_bf16 v[88:91], a[192:195], a[152:155], v[88:91]
s_add_u32 s90, s61, s94
ds_read_b64_tr_b16 a[192:193], v4 offset:0
v_fma_f32 v48, v48, s24, v13
v_mfma_f32_16x16x32_bf16 v[88:91], a[196:199], a[164:167], v[88:91]
s_waitcnt lgkmcnt(4)
ds_read_b64_tr_b16 a[194:195], v4 offset:4096
v_fma_f32 v49, v49, s24, v13
v_mfma_f32_16x16x32_bf16 v[80:83], a[200:203], a[168:171], v[80:83]
buffer_load_dwordx4 v7, s[12:15], s90 offen offset:2048 nt lds
v_mfma_f32_16x16x32_bf16 v[80:83], a[204:207], a[180:183], v[80:83]
ds_read_b64_tr_b16 a[196:197], v4 offset:8192
v_fma_f32 v50, v50, s24, v13
v_mfma_f32_16x16x32_bf16 v[84:87], a[200:203], a[172:175], v[84:87]
ds_read_b64_tr_b16 a[198:199], v4 offset:12288
v_fma_f32 v51, v51, s24, v13
v_mfma_f32_16x16x32_bf16 v[84:87], a[204:207], a[184:187], v[84:87]
v_exp_f32 v20, v48
v_mfma_f32_16x16x32_bf16 v[88:91], a[200:203], a[176:179], v[88:91]
ds_read_b64_tr_b16 a[200:201], v5 offset:0
v_fma_f32 v52, v52, s24, v15
v_mfma_f32_16x16x32_bf16 v[88:91], a[204:207], a[188:191], v[88:91]
ds_read_b64_tr_b16 a[202:203], v5 offset:4096
v_fma_f32 v53, v53, s24, v15
v_mfma_f32_16x16x32_bf16 v[104:107], a[208:211], v[68:71], 0
s_waitcnt lgkmcnt(4)
v_exp_f32 v21, v49
v_mfma_f32_16x16x32_bf16 v[104:107], a[212:215], v[32:35], v[104:107]
ds_read_b64_tr_b16 a[204:205], v5 offset:8192
v_cvt_pk_bf16_f32 v60, v20, v21
v_mfma_f32_16x16x32_bf16 v[108:111], a[208:211], v[72:75], 0
s_add_u32 s90, s61, s95
ds_read_b64_tr_b16 a[206:207], v5 offset:12288
v_add_f32 v26, v20, v21
v_mfma_f32_16x16x32_bf16 v[108:111], a[212:215], v[36:39], v[108:111]
buffer_load_dwordx4 v7, s[12:15], s90 offen offset:3072 nt lds
v_mfma_f32_16x16x32_bf16 v[112:115], a[208:211], v[76:79], 0
ds_read_b64_tr_b16 a[208:209], v6 offset:0
v_fma_f32 v54, v54, s24, v15
v_mfma_f32_16x16x32_bf16 v[112:115], a[212:215], v[40:43], v[112:115]
ds_read_b64_tr_b16 a[210:211], v6 offset:4096
v_fma_f32 v55, v55, s24, v15
v_mfma_f32_16x16x32_bf16 v[116:119], a[192:195], v[68:71], 0
s_waitcnt lgkmcnt(4)
v_exp_f32 v28, v50
v_mfma_f32_16x16x32_bf16 v[116:119], a[196:199], v[32:35], v[116:119]
ds_read_b64_tr_b16 a[212:213], v6 offset:8192
v_add_f32 v26, v26, v28
v_mfma_f32_16x16x32_bf16 v[120:123], a[192:195], v[72:75], 0
s_add_u32 s89, s75, s84
ds_read_b64_tr_b16 a[214:215], v6 offset:12288
v_fma_f32 v80, v80, s24, v11
v_mfma_f32_16x16x32_bf16 v[120:123], a[196:199], v[36:39], v[120:123]
buffer_store_dwordx4 a[4:7], v8, s[20:23], s89 offen nt
v_mfma_f32_16x16x32_bf16 v[124:127], a[192:195], v[76:79], 0
ds_read_b64_tr_b16 a[192:193], v3 offset:1024
v_fma_f32 v81, v81, s24, v11
v_mfma_f32_16x16x32_bf16 v[124:127], a[196:199], v[40:43], v[124:127]
ds_read_b64_tr_b16 a[194:195], v3 offset:5120
v_fma_f32 v82, v82, s24, v11
v_mfma_f32_16x16x32_bf16 v[128:131], a[200:203], v[68:71], 0
s_waitcnt lgkmcnt(4)
v_exp_f32 v29, v51
v_mfma_f32_16x16x32_bf16 v[128:131], a[204:207], v[32:35], v[128:131]
ds_read_b64_tr_b16 a[196:197], v3 offset:9216
v_cvt_pk_bf16_f32 v61, v28, v29
v_mfma_f32_16x16x32_bf16 v[132:135], a[200:203], v[72:75], 0
ds_read_b64_tr_b16 a[198:199], v3 offset:13312
v_add_f32 v26, v26, v29
v_mfma_f32_16x16x32_bf16 v[132:135], a[204:207], v[36:39], v[132:135]
v_exp_f32 v30, v52
v_mfma_f32_16x16x32_bf16 v[136:139], a[200:203], v[76:79], 0
ds_read_b64_tr_b16 a[200:201], v4 offset:1024
v_fma_f32 v83, v83, s24, v11
v_mfma_f32_16x16x32_bf16 v[136:139], a[204:207], v[40:43], v[136:139]
s_add_u32 s89, s75, s85
ds_read_b64_tr_b16 a[202:203], v4 offset:5120
v_fma_f32 v84, v84, s24, v13
v_mfma_f32_16x16x32_bf16 v[140:143], a[208:211], v[68:71], 0
s_waitcnt lgkmcnt(4)
buffer_store_dwordx4 a[28:31], v8, s[20:23], s89 offen nt
v_mfma_f32_16x16x32_bf16 v[140:143], a[212:215], v[32:35], v[140:143]
ds_read_b64_tr_b16 a[204:205], v4 offset:9216
v_fma_f32 v85, v85, s24, v13
v_mfma_f32_16x16x32_bf16 v[144:147], a[208:211], v[72:75], 0
ds_read_b64_tr_b16 a[206:207], v4 offset:13312
v_fma_f32 v86, v86, s24, v13
v_mfma_f32_16x16x32_bf16 v[144:147], a[212:215], v[36:39], v[144:147]
v_exp_f32 v31, v53
v_mfma_f32_16x16x32_bf16 v[148:151], a[208:211], v[76:79], 0
ds_read_b64_tr_b16 a[208:209], v5 offset:1024
v_cvt_pk_bf16_f32 v64, v30, v31
v_mfma_f32_16x16x32_bf16 v[148:151], a[212:215], v[40:43], v[148:151]
s_add_u32 s89, s27, s84
ds_read_b64_tr_b16 a[210:211], v5 offset:5120
v_add_f32 v27, v30, v31
v_mfma_f32_16x16x32_bf16 v[152:155], a[192:195], v[68:71], 0
s_waitcnt lgkmcnt(4)
buffer_store_dwordx4 a[8:11], v8, s[20:23], s89 offen nt
v_mfma_f32_16x16x32_bf16 v[152:155], a[196:199], v[32:35], v[152:155]
ds_read_b64_tr_b16 a[212:213], v5 offset:9216
v_fma_f32 v87, v87, s24, v13
v_mfma_f32_16x16x32_bf16 v[156:159], a[192:195], v[72:75], 0
ds_read_b64_tr_b16 a[214:215], v5 offset:13312
v_fma_f32 v88, v88, s24, v15
v_mfma_f32_16x16x32_bf16 v[156:159], a[196:199], v[36:39], v[156:159]
v_exp_f32 v20, v54
v_mfma_f32_16x16x32_bf16 v[160:163], a[192:195], v[76:79], 0
ds_read_b64_tr_b16 a[192:193], v6 offset:1024
v_add_f32 v27, v27, v20
v_mfma_f32_16x16x32_bf16 v[160:163], a[196:199], v[40:43], v[160:163]
s_add_u32 s89, s27, s85
ds_read_b64_tr_b16 a[194:195], v6 offset:5120
v_fma_f32 v89, v89, s24, v15
v_mfma_f32_16x16x32_bf16 v[164:167], a[200:203], v[68:71], 0
s_waitcnt lgkmcnt(4)
buffer_store_dwordx4 a[32:35], v8, s[20:23], s89 offen nt
v_mfma_f32_16x16x32_bf16 v[164:167], a[204:207], v[32:35], v[164:167]
ds_read_b64_tr_b16 a[196:197], v6 offset:9216
v_fma_f32 v90, v90, s24, v15
v_mfma_f32_16x16x32_bf16 v[168:171], a[200:203], v[72:75], 0
ds_read_b64_tr_b16 a[198:199], v6 offset:13312
v_fma_f32 v91, v91, s24, v15
v_mfma_f32_16x16x32_bf16 v[168:171], a[204:207], v[36:39], v[168:171]
v_exp_f32 v21, v55
v_mfma_f32_16x16x32_bf16 v[172:175], a[200:203], v[76:79], 0
v_exp_f32 v28, v80
v_mfma_f32_16x16x32_bf16 v[172:175], a[204:207], v[40:43], v[172:175]
v_exp_f32 v29, v81
v_mfma_f32_16x16x32_bf16 v[176:179], a[208:211], v[68:71], 0
s_waitcnt lgkmcnt(2)
v_exp_f32 v30, v82
v_mfma_f32_16x16x32_bf16 v[176:179], a[212:215], v[32:35], v[176:179]
v_exp_f32 v31, v83
v_mfma_f32_16x16x32_bf16 v[180:183], a[208:211], v[72:75], 0
v_cvt_pk_bf16_f32 v65, v20, v21
v_add_f32 v27, v27, v21
v_mfma_f32_16x16x32_bf16 v[180:183], a[212:215], v[36:39], v[180:183]
s_waitcnt vmcnt(22) lgkmcnt(0)
v_exp_f32 v20, v84
v_mfma_f32_16x16x32_bf16 v[184:187], a[208:211], v[76:79], 0
s_barrier
v_cvt_pk_bf16_f32 v58, v28, v29
v_mfma_f32_16x16x32_bf16 v[184:187], a[212:215], v[40:43], v[184:187]
ds_read_b128 a[200:203], v1 offset:49152
v_add_f32 v24, v24, v28
v_mfma_f32_16x16x32_bf16 v[188:191], a[192:195], v[68:71], 0
ds_read_b128 a[204:207], v2 offset:49152
v_add_f32 v24, v24, v29
v_mfma_f32_16x16x32_bf16 v[188:191], a[196:199], v[32:35], v[188:191]
ds_read_b128 a[208:211], v1 offset:50176
v_cvt_pk_bf16_f32 v59, v30, v31
v_mfma_f32_16x16x32_bf16 v[192:195], a[192:195], v[72:75], 0
s_mov_b32 m0, s36
ds_read_b128 a[212:215], v2 offset:50176
v_add_f32 v24, v24, v30
v_mfma_f32_16x16x32_bf16 v[192:195], a[196:199], v[36:39], v[192:195]
s_bitcmp1_b32 s3, 1
s_cselect_b32 s81, s61, s60
v_add_f32 v24, v24, v31
v_mfma_f32_16x16x32_bf16 v[196:199], a[192:195], v[76:79], 0
s_add_u32 s90, s81, s92
ds_read_b128 a[192:195], v1 offset:51200
v_add_f32 v26, v26, v20
v_mfma_f32_16x16x32_bf16 v[196:199], a[196:199], v[40:43], v[196:199]
s_waitcnt lgkmcnt(4)
ds_read_b128 a[196:199], v2 offset:51200
v_mfma_f32_16x16x32_bf16 v[92:95], a[200:203], a[96:99], 0
s_waitcnt lgkmcnt(4)
buffer_load_dwordx4 v7, s[16:19], s90 offen offset:0 nt lds
v_mfma_f32_16x16x32_bf16 v[92:95], a[204:207], a[108:111], v[92:95]
v_exp_f32 v21, v85
v_mfma_f32_16x16x32_bf16 v[96:99], a[200:203], a[100:103], 0
v_exp_f32 v28, v86
v_mfma_f32_16x16x32_bf16 v[96:99], a[204:207], a[112:115], v[96:99]
v_exp_f32 v29, v87
v_mfma_f32_16x16x32_bf16 v[100:103], a[200:203], a[104:107], 0
ds_read_b128 a[200:203], v1 offset:52224
v_cvt_pk_bf16_f32 v62, v20, v21
v_mfma_f32_16x16x32_bf16 v[100:103], a[204:207], a[116:119], v[100:103]
s_waitcnt lgkmcnt(1)
ds_read_b128 a[204:207], v2 offset:52224
v_add_f32 v26, v26, v21
v_mfma_f32_16x16x32_bf16 v[92:95], a[208:211], a[120:123], v[92:95]
s_add_u32 s91, s81, s93
v_exp_f32 v30, v88
v_mfma_f32_16x16x32_bf16 v[92:95], a[212:215], a[132:135], v[92:95]
buffer_load_dwordx4 v7, s[16:19], s91 offen offset:1024 nt lds
v_mfma_f32_16x16x32_bf16 v[96:99], a[208:211], a[124:127], v[96:99]
v_exp_f32 v31, v89
v_mfma_f32_16x16x32_bf16 v[96:99], a[212:215], a[136:139], v[96:99]
v_exp_f32 v20, v90
v_mfma_f32_16x16x32_bf16 v[100:103], a[208:211], a[128:131], v[100:103]
ds_read_b128 a[208:211], v1 offset:57344
v_cvt_pk_bf16_f32 v63, v28, v29
v_mfma_f32_16x16x32_bf16 v[100:103], a[212:215], a[140:143], v[100:103]
ds_read_b128 a[212:215], v2 offset:57344
v_add_f32 v26, v26, v28
v_mfma_f32_16x16x32_bf16 v[92:95], a[192:195], a[144:147], v[92:95]
v_exp_f32 v21, v91
v_mfma_f32_16x16x32_bf16 v[92:95], a[196:199], a[156:159], v[92:95]
v_add_f32 v26, v26, v29
v_cvt_pk_bf16_f32 v66, v30, v31
v_mfma_f32_16x16x32_bf16 v[96:99], a[192:195], a[148:151], v[96:99]
v_add_f32 v27, v27, v30
v_add_f32 v27, v27, v31
v_mfma_f32_16x16x32_bf16 v[96:99], a[196:199], a[160:163], v[96:99]
v_cvt_pk_bf16_f32 v67, v20, v21
v_add_f32 v27, v27, v20
v_mfma_f32_16x16x32_bf16 v[100:103], a[192:195], a[152:155], v[100:103]
s_addk_i32 s90, 2048
ds_read_b128 a[192:195], v1 offset:58368
v_add_f32 v27, v27, v21
v_mfma_f32_16x16x32_bf16 v[100:103], a[196:199], a[164:167], v[100:103]
s_waitcnt lgkmcnt(1)
ds_read_b128 a[196:199], v2 offset:58368
v_max3_f32 v25, v24, v26, v27
v_mfma_f32_16x16x32_bf16 v[92:95], a[200:203], a[168:171], v[92:95]
buffer_load_dwordx4 v7, s[16:19], s90 offen offset:2048 nt lds
v_mfma_f32_16x16x32_bf16 v[92:95], a[204:207], a[180:183], v[92:95]
v_cmp_lt_f32 vcc, s25, v25
v_mfma_f32_16x16x32_bf16 v[96:99], a[200:203], a[172:175], v[96:99]
v_mfma_f32_16x16x32_bf16 v[96:99], a[204:207], a[184:187], v[96:99]
s_cbranch_vccnz STUB_18
BACK_18:
v_mfma_f32_16x16x32_bf16 v[100:103], a[200:203], a[176:179], v[100:103]
ds_read_b128 a[200:203], v1 offset:59392
v_add_f32 v19, v19, v27
v_mfma_f32_16x16x32_bf16 v[100:103], a[204:207], a[188:191], v[100:103]
ds_read_b128 a[204:207], v2 offset:59392
v_add_f32 v17, v17, v24
v_mfma_f32_16x16x32_bf16 v[80:83], a[208:211], a[96:99], 0
s_addk_i32 s91, 2048
v_add_f32 v18, v18, v26
v_fma_f32 v92, v92, s24, v11
v_mfma_f32_16x16x32_bf16 v[80:83], a[212:215], a[108:111], v[80:83]
buffer_load_dwordx4 v7, s[16:19], s91 offen offset:3072 nt lds
v_mfma_f32_16x16x32_bf16 v[84:87], a[208:211], a[100:103], 0
v_exp_f32 v28, v92
v_mfma_f32_16x16x32_bf16 v[84:87], a[212:215], a[112:115], v[84:87]
v_fma_f32 v93, v93, s24, v11
v_fma_f32 v94, v94, s24, v11
v_mfma_f32_16x16x32_bf16 v[88:91], a[208:211], a[104:107], 0
ds_read_b128 a[208:211], v1 offset:60416
v_fma_f32 v95, v95, s24, v11
v_mfma_f32_16x16x32_bf16 v[88:91], a[212:215], a[116:119], v[88:91]
s_waitcnt lgkmcnt(1)
ds_read_b128 a[212:215], v2 offset:60416
v_fma_f32 v96, v96, s24, v13
v_mfma_f32_16x16x32_bf16 v[80:83], a[192:195], a[120:123], v[80:83]
v_exp_f32 v29, v93
v_mfma_f32_16x16x32_bf16 v[80:83], a[196:199], a[132:135], v[80:83]
s_mov_b32 m0, s34
v_exp_f32 v30, v94
v_mfma_f32_16x16x32_bf16 v[84:87], a[192:195], a[124:127], v[84:87]
s_add_u32 s90, s62, s92
v_exp_f32 v31, v95
v_mfma_f32_16x16x32_bf16 v[84:87], a[196:199], a[136:139], v[84:87]
buffer_load_dwordx4 v7, s[12:15], s90 offen offset:0 nt lds
v_mfma_f32_16x16x32_bf16 v[88:91], a[192:195], a[128:131], v[88:91]
ds_read_b64_tr_b16 a[192:193], v3 offset:16384
v_cvt_pk_bf16_f32 v44, v28, v29
v_mfma_f32_16x16x32_bf16 v[88:91], a[196:199], a[140:143], v[88:91]
ds_read_b64_tr_b16 a[194:195], v3 offset:20480
v_add_f32 v24, v28, v29
v_mfma_f32_16x16x32_bf16 v[80:83], a[200:203], a[144:147], v[80:83]
v_exp_f32 v20, v96
v_mfma_f32_16x16x32_bf16 v[80:83], a[204:207], a[156:159], v[80:83]
ds_read_b64_tr_b16 a[196:197], v3 offset:24576
v_cvt_pk_bf16_f32 v45, v30, v31
v_mfma_f32_16x16x32_bf16 v[84:87], a[200:203], a[148:151], v[84:87]
ds_read_b64_tr_b16 a[198:199], v3 offset:28672
v_add_f32 v24, v24, v30
v_mfma_f32_16x16x32_bf16 v[84:87], a[204:207], a[160:163], v[84:87]
v_add_f32 v24, v24, v31
v_fma_f32 v97, v97, s24, v13
v_mfma_f32_16x16x32_bf16 v[88:91], a[200:203], a[152:155], v[88:91]
s_add_u32 s90, s62, s93
ds_read_b64_tr_b16 a[200:201], v4 offset:16384
v_fma_f32 v98, v98, s24, v13
v_mfma_f32_16x16x32_bf16 v[88:91], a[204:207], a[164:167], v[88:91]
s_waitcnt lgkmcnt(3)
ds_read_b64_tr_b16 a[202:203], v4 offset:20480
v_fma_f32 v99, v99, s24, v13
v_mfma_f32_16x16x32_bf16 v[80:83], a[208:211], a[168:171], v[80:83]
buffer_load_dwordx4 v7, s[12:15], s90 offen offset:1024 nt lds
v_mfma_f32_16x16x32_bf16 v[80:83], a[212:215], a[180:183], v[80:83]
PADJ_9:
s_cbranch_execz PADJ_13
ds_read_b64_tr_b16 a[204:205], v4 offset:24576
v_mfma_f32_16x16x32_bf16 v[84:87], a[208:211], a[172:175], v[84:87]
ds_read_b64_tr_b16 a[206:207], v4 offset:28672
v_fma_f32 v100, v100, s24, v15
v_mfma_f32_16x16x32_bf16 v[84:87], a[212:215], a[184:187], v[84:87]
v_exp_f32 v21, v97
v_mfma_f32_16x16x32_bf16 v[88:91], a[208:211], a[176:179], v[88:91]
ds_read_b64_tr_b16 a[208:209], v5 offset:16384
v_cvt_pk_bf16_f32 v48, v20, v21
v_mfma_f32_16x16x32_bf16 v[88:91], a[212:215], a[188:191], v[88:91]
ds_read_b64_tr_b16 a[210:211], v5 offset:20480
v_add_f32 v26, v20, v21
v_mfma_f32_16x16x32_bf16 v[200:203], a[192:195], v[68:71], 0
s_waitcnt lgkmcnt(4)
v_exp_f32 v28, v98
v_mfma_f32_16x16x32_bf16 v[200:203], a[196:199], v[32:35], v[200:203]
ds_read_b64_tr_b16 a[212:213], v5 offset:24576
v_add_f32 v26, v26, v28
v_mfma_f32_16x16x32_bf16 v[204:207], a[192:195], v[72:75], 0
s_add_u32 s90, s62, s94
ds_read_b64_tr_b16 a[214:215], v5 offset:28672
v_fma_f32 v101, v101, s24, v15
v_mfma_f32_16x16x32_bf16 v[204:207], a[196:199], v[36:39], v[204:207]
buffer_load_dwordx4 v7, s[12:15], s90 offen offset:2048 nt lds
v_mfma_f32_16x16x32_bf16 v[208:211], a[192:195], v[76:79], 0
ds_read_b64_tr_b16 a[192:193], v6 offset:16384
v_fma_f32 v102, v102, s24, v15
v_mfma_f32_16x16x32_bf16 v[208:211], a[196:199], v[40:43], v[208:211]
ds_read_b64_tr_b16 a[194:195], v6 offset:20480
v_fma_f32 v103, v103, s24, v15
v_mfma_f32_16x16x32_bf16 v[212:215], a[200:203], v[68:71], 0
s_waitcnt lgkmcnt(4)
v_exp_f32 v29, v99
v_mfma_f32_16x16x32_bf16 v[212:215], a[204:207], v[32:35], v[212:215]
ds_read_b64_tr_b16 a[196:197], v6 offset:24576
v_cvt_pk_bf16_f32 v49, v28, v29
v_mfma_f32_16x16x32_bf16 v[216:219], a[200:203], v[72:75], 0
ds_read_b64_tr_b16 a[198:199], v6 offset:28672
v_add_f32 v26, v26, v29
v_mfma_f32_16x16x32_bf16 v[216:219], a[204:207], v[36:39], v[216:219]
v_exp_f32 v30, v100
v_mfma_f32_16x16x32_bf16 v[220:223], a[200:203], v[76:79], 0
ds_read_b64_tr_b16 a[200:201], v3 offset:17408
v_fma_f32 v80, v80, s24, v11
v_mfma_f32_16x16x32_bf16 v[220:223], a[204:207], v[40:43], v[220:223]
s_add_u32 s90, s62, s95
ds_read_b64_tr_b16 a[202:203], v3 offset:21504
v_fma_f32 v81, v81, s24, v11
v_mfma_f32_16x16x32_bf16 a[216:219], a[208:211], v[68:71], 0
s_waitcnt lgkmcnt(4)
buffer_load_dwordx4 v7, s[12:15], s90 offen offset:3072 nt lds
v_mfma_f32_16x16x32_bf16 a[216:219], a[212:215], v[32:35], a[216:219]
ds_read_b64_tr_b16 a[204:205], v3 offset:25600
v_fma_f32 v82, v82, s24, v11
v_mfma_f32_16x16x32_bf16 a[220:223], a[208:211], v[72:75], 0
ds_read_b64_tr_b16 a[206:207], v3 offset:29696
v_fma_f32 v83, v83, s24, v11
v_mfma_f32_16x16x32_bf16 a[220:223], a[212:215], v[36:39], a[220:223]
v_exp_f32 v31, v101
v_mfma_f32_16x16x32_bf16 a[224:227], a[208:211], v[76:79], 0
ds_read_b64_tr_b16 a[208:209], v4 offset:17408
v_cvt_pk_bf16_f32 v52, v30, v31
v_mfma_f32_16x16x32_bf16 a[224:227], a[212:215], v[40:43], a[224:227]
ds_read_b64_tr_b16 a[210:211], v4 offset:21504
v_add_f32 v27, v30, v31
v_mfma_f32_16x16x32_bf16 a[228:231], a[192:195], v[68:71], 0
s_waitcnt lgkmcnt(4)
v_exp_f32 v20, v102
v_mfma_f32_16x16x32_bf16 a[228:231], a[196:199], v[32:35], a[228:231]
ds_read_b64_tr_b16 a[212:213], v4 offset:25600
v_add_f32 v27, v27, v20
v_mfma_f32_16x16x32_bf16 a[232:235], a[192:195], v[72:75], 0
s_add_u32 s89, s76, s84
ds_read_b64_tr_b16 a[214:215], v4 offset:29696
v_fma_f32 v84, v84, s24, v13
v_mfma_f32_16x16x32_bf16 a[232:235], a[196:199], v[36:39], a[232:235]
buffer_store_dwordx4 a[12:15], v8, s[20:23], s89 offen nt
v_mfma_f32_16x16x32_bf16 a[236:239], a[192:195], v[76:79], 0
ds_read_b64_tr_b16 a[192:193], v5 offset:17408
v_fma_f32 v85, v85, s24, v13
v_mfma_f32_16x16x32_bf16 a[236:239], a[196:199], v[40:43], a[236:239]
ds_read_b64_tr_b16 a[194:195], v5 offset:21504
v_fma_f32 v86, v86, s24, v13
v_mfma_f32_16x16x32_bf16 a[240:243], a[200:203], v[68:71], 0
s_waitcnt lgkmcnt(4)
v_exp_f32 v21, v103
v_mfma_f32_16x16x32_bf16 a[240:243], a[204:207], v[32:35], a[240:243]
ds_read_b64_tr_b16 a[196:197], v5 offset:25600
v_cvt_pk_bf16_f32 v53, v20, v21
v_mfma_f32_16x16x32_bf16 a[244:247], a[200:203], v[72:75], 0
ds_read_b64_tr_b16 a[198:199], v5 offset:29696
v_add_f32 v27, v27, v21
v_mfma_f32_16x16x32_bf16 a[244:247], a[204:207], v[36:39], a[244:247]
v_exp_f32 v28, v80
v_mfma_f32_16x16x32_bf16 a[248:251], a[200:203], v[76:79], 0
ds_read_b64_tr_b16 a[200:201], v6 offset:17408
v_add_f32 v24, v24, v28
v_mfma_f32_16x16x32_bf16 a[248:251], a[204:207], v[40:43], a[248:251]
s_add_u32 s89, s76, s85
ds_read_b64_tr_b16 a[202:203], v6 offset:21504
v_fma_f32 v87, v87, s24, v13
v_mfma_f32_16x16x32_bf16 a[252:255], a[208:211], v[68:71], 0
s_waitcnt lgkmcnt(4)
buffer_store_dwordx4 a[36:39], v8, s[20:23], s89 offen nt
v_mfma_f32_16x16x32_bf16 a[252:255], a[212:215], v[32:35], a[252:255]
ds_read_b64_tr_b16 a[204:205], v6 offset:25600
v_fma_f32 v88, v88, s24, v15
v_mfma_f32_16x16x32_bf16 v[224:227], a[208:211], v[72:75], 0
ds_read_b64_tr_b16 a[206:207], v6 offset:29696
v_fma_f32 v89, v89, s24, v15
v_mfma_f32_16x16x32_bf16 v[224:227], a[212:215], v[36:39], v[224:227]
v_exp_f32 v29, v81
v_mfma_f32_16x16x32_bf16 v[228:231], a[208:211], v[76:79], 0
v_exp_f32 v30, v82
v_mfma_f32_16x16x32_bf16 v[228:231], a[212:215], v[40:43], v[228:231]
v_exp_f32 v31, v83
v_mfma_f32_16x16x32_bf16 v[232:235], a[192:195], v[68:71], 0
s_waitcnt lgkmcnt(2)
v_exp_f32 v20, v84
v_mfma_f32_16x16x32_bf16 v[232:235], a[196:199], v[32:35], v[232:235]
v_exp_f32 v21, v85
v_mfma_f32_16x16x32_bf16 v[236:239], a[192:195], v[72:75], 0
v_cvt_pk_bf16_f32 v46, v28, v29
v_add_f32 v24, v24, v29
v_mfma_f32_16x16x32_bf16 v[236:239], a[196:199], v[36:39], v[236:239]
s_waitcnt vmcnt(24) lgkmcnt(0)
v_exp_f32 v28, v86
v_mfma_f32_16x16x32_bf16 v[240:243], a[192:195], v[76:79], 0
s_barrier
v_cvt_pk_bf16_f32 v47, v30, v31
v_mfma_f32_16x16x32_bf16 v[240:243], a[196:199], v[40:43], v[240:243]
ds_read_b128 a[208:211], v1 offset:0
v_add_f32 v24, v24, v30
v_mfma_f32_16x16x32_bf16 v[244:247], a[200:203], v[68:71], 0
ds_read_b128 a[212:215], v2 offset:0
v_add_f32 v24, v24, v31
v_mfma_f32_16x16x32_bf16 v[244:247], a[204:207], v[32:35], v[244:247]
ds_read_b128 a[192:195], v1 offset:1024
v_cvt_pk_bf16_f32 v50, v20, v21
v_mfma_f32_16x16x32_bf16 v[248:251], a[200:203], v[72:75], 0
s_mov_b32 m0, s37
ds_read_b128 a[196:199], v2 offset:1024
v_add_f32 v26, v26, v20
v_mfma_f32_16x16x32_bf16 v[248:251], a[204:207], v[36:39], v[248:251]
s_addk_i32 s81, 2048
v_exp_f32 v29, v87
v_mfma_f32_16x16x32_bf16 v[252:255], a[200:203], v[76:79], 0
s_add_u32 s90, s81, s94
ds_read_b128 a[200:203], v1 offset:2048
v_add_f32 v26, v26, v21
v_mfma_f32_16x16x32_bf16 v[252:255], a[204:207], v[40:43], v[252:255]
s_waitcnt lgkmcnt(4)
ds_read_b128 a[204:207], v2 offset:2048
v_cvt_pk_bf16_f32 v51, v28, v29
v_mfma_f32_16x16x32_bf16 v[32:35], a[208:211], a[96:99], 0
s_waitcnt lgkmcnt(4)
buffer_load_dwordx4 v7, s[16:19], s90 offen offset:0 nt lds
v_mfma_f32_16x16x32_bf16 v[32:35], a[212:215], a[108:111], v[32:35]
v_exp_f32 v30, v88
v_mfma_f32_16x16x32_bf16 v[36:39], a[208:211], a[100:103], 0
v_exp_f32 v31, v89
v_mfma_f32_16x16x32_bf16 v[36:39], a[212:215], a[112:115], v[36:39]
v_add_f32 v26, v26, v28
v_add_f32 v26, v26, v29
v_mfma_f32_16x16x32_bf16 v[40:43], a[208:211], a[104:107], 0
ds_read_b128 a[208:211], v1 offset:3072
v_fma_f32 v90, v90, s24, v15
v_mfma_f32_16x16x32_bf16 v[40:43], a[212:215], a[116:119], v[40:43]
s_waitcnt lgkmcnt(1)
ds_read_b128 a[212:215], v2 offset:3072
v_fma_f32 v91, v91, s24, v15
v_mfma_f32_16x16x32_bf16 v[32:35], a[192:195], a[120:123], v[32:35]
s_add_u32 s91, s81, s95
v_exp_f32 v20, v90
v_mfma_f32_16x16x32_bf16 v[32:35], a[196:199], a[132:135], v[32:35]
buffer_load_dwordx4 v7, s[16:19], s91 offen offset:1024 nt lds
v_mfma_f32_16x16x32_bf16 v[36:39], a[192:195], a[124:127], v[36:39]
v_exp_f32 v21, v91
v_mfma_f32_16x16x32_bf16 v[36:39], a[196:199], a[136:139], v[36:39]
v_cvt_pk_bf16_f32 v54, v30, v31
v_add_f32 v27, v27, v30
v_mfma_f32_16x16x32_bf16 v[40:43], a[192:195], a[128:131], v[40:43]
ds_read_b128 a[192:195], v1 offset:8192
v_add_f32 v27, v27, v31
v_mfma_f32_16x16x32_bf16 v[40:43], a[196:199], a[140:143], v[40:43]
ds_read_b128 a[196:199], v2 offset:8192
v_cvt_pk_bf16_f32 v55, v20, v21
v_mfma_f32_16x16x32_bf16 v[32:35], a[200:203], a[144:147], v[32:35]
v_add_f32 v27, v27, v20
v_add_f32 v27, v27, v21
v_mfma_f32_16x16x32_bf16 v[32:35], a[204:207], a[156:159], v[32:35]
v_max3_f32 v25, v24, v26, v27
v_cmp_lt_f32 vcc, s25, v25
v_mfma_f32_16x16x32_bf16 v[36:39], a[200:203], a[148:151], v[36:39]
v_mfma_f32_16x16x32_bf16 v[36:39], a[204:207], a[160:163], v[36:39]
v_mfma_f32_16x16x32_bf16 v[40:43], a[200:203], a[152:155], v[40:43]
s_addk_i32 s90, 2048
ds_read_b128 a[200:203], v1 offset:9216
v_mfma_f32_16x16x32_bf16 v[40:43], a[204:207], a[164:167], v[40:43]
s_waitcnt lgkmcnt(1)
ds_read_b128 a[204:207], v2 offset:9216
v_mfma_f32_16x16x32_bf16 v[32:35], a[208:211], a[168:171], v[32:35]
buffer_load_dwordx4 v7, s[16:19], s90 offen offset:2048 nt lds
v_mfma_f32_16x16x32_bf16 v[32:35], a[212:215], a[180:183], v[32:35]
v_mfma_f32_16x16x32_bf16 v[36:39], a[208:211], a[172:175], v[36:39]
v_mfma_f32_16x16x32_bf16 v[36:39], a[212:215], a[184:187], v[36:39]
s_cbranch_vccnz STUB_19
BACK_19:
v_mfma_f32_16x16x32_bf16 v[40:43], a[208:211], a[176:179], v[40:43]
ds_read_b128 a[208:211], v1 offset:10240
v_add_f32 v19, v19, v27
v_mfma_f32_16x16x32_bf16 v[40:43], a[212:215], a[188:191], v[40:43]
ds_read_b128 a[212:215], v2 offset:10240
v_add_f32 v17, v17, v24
v_mfma_f32_16x16x32_bf16 v[80:83], a[192:195], a[96:99], 0
s_addk_i32 s91, 2048
v_add_f32 v18, v18, v26
v_fma_f32 v32, v32, s24, v11
v_mfma_f32_16x16x32_bf16 v[80:83], a[196:199], a[108:111], v[80:83]
buffer_load_dwordx4 v7, s[16:19], s91 offen offset:3072 nt lds
v_mfma_f32_16x16x32_bf16 v[84:87], a[192:195], a[100:103], 0
v_exp_f32 v28, v32
v_mfma_f32_16x16x32_bf16 v[84:87], a[196:199], a[112:115], v[84:87]
v_fma_f32 v33, v33, s24, v11
v_fma_f32 v34, v34, s24, v11
v_mfma_f32_16x16x32_bf16 v[88:91], a[192:195], a[104:107], 0
ds_read_b128 a[192:195], v1 offset:11264
v_fma_f32 v35, v35, s24, v11
v_mfma_f32_16x16x32_bf16 v[88:91], a[196:199], a[116:119], v[88:91]
s_waitcnt lgkmcnt(1)
ds_read_b128 a[196:199], v2 offset:11264
v_fma_f32 v36, v36, s24, v13
v_mfma_f32_16x16x32_bf16 v[80:83], a[200:203], a[120:123], v[80:83]
v_exp_f32 v29, v33
v_mfma_f32_16x16x32_bf16 v[80:83], a[204:207], a[132:135], v[80:83]
s_mov_b32 m0, s35
v_exp_f32 v30, v34
v_mfma_f32_16x16x32_bf16 v[84:87], a[200:203], a[124:127], v[84:87]
s_add_u32 s90, s63, s92
v_exp_f32 v31, v35
v_mfma_f32_16x16x32_bf16 v[84:87], a[204:207], a[136:139], v[84:87]
buffer_load_dwordx4 v7, s[12:15], s90 offen offset:0 nt lds
v_mfma_f32_16x16x32_bf16 v[88:91], a[200:203], a[128:131], v[88:91]
ds_read_b64_tr_b16 a[200:201], v3 offset:32768
v_cvt_pk_bf16_f32 v68, v28, v29
v_mfma_f32_16x16x32_bf16 v[88:91], a[204:207], a[140:143], v[88:91]
ds_read_b64_tr_b16 a[202:203], v3 offset:36864
v_add_f32 v24, v28, v29
v_mfma_f32_16x16x32_bf16 v[80:83], a[208:211], a[144:147], v[80:83]
v_exp_f32 v20, v36
v_mfma_f32_16x16x32_bf16 v[80:83], a[212:215], a[156:159], v[80:83]
ds_read_b64_tr_b16 a[204:205], v3 offset:40960
v_cvt_pk_bf16_f32 v69, v30, v31
v_mfma_f32_16x16x32_bf16 v[84:87], a[208:211], a[148:151], v[84:87]
ds_read_b64_tr_b16 a[206:207], v3 offset:45056
v_add_f32 v24, v24, v30
v_mfma_f32_16x16x32_bf16 v[84:87], a[212:215], a[160:163], v[84:87]
v_add_f32 v24, v24, v31
v_fma_f32 v37, v37, s24, v13
v_mfma_f32_16x16x32_bf16 v[88:91], a[208:211], a[152:155], v[88:91]
s_add_u32 s90, s63, s93
ds_read_b64_tr_b16 a[208:209], v4 offset:32768
v_fma_f32 v38, v38, s24, v13
v_mfma_f32_16x16x32_bf16 v[88:91], a[212:215], a[164:167], v[88:91]
s_waitcnt lgkmcnt(3)
ds_read_b64_tr_b16 a[210:211], v4 offset:36864
v_fma_f32 v39, v39, s24, v13
v_mfma_f32_16x16x32_bf16 v[80:83], a[192:195], a[168:171], v[80:83]
buffer_load_dwordx4 v7, s[12:15], s90 offen offset:1024 nt lds
v_mfma_f32_16x16x32_bf16 v[80:83], a[196:199], a[180:183], v[80:83]
ds_read_b64_tr_b16 a[212:213], v4 offset:40960
v_fma_f32 v40, v40, s24, v15
v_mfma_f32_16x16x32_bf16 v[84:87], a[192:195], a[172:175], v[84:87]
ds_read_b64_tr_b16 a[214:215], v4 offset:45056
v_fma_f32 v41, v41, s24, v15
v_mfma_f32_16x16x32_bf16 v[84:87], a[196:199], a[184:187], v[84:87]
v_exp_f32 v21, v37
v_mfma_f32_16x16x32_bf16 v[88:91], a[192:195], a[176:179], v[88:91]
ds_read_b64_tr_b16 a[192:193], v5 offset:32768
v_cvt_pk_bf16_f32 v72, v20, v21
v_mfma_f32_16x16x32_bf16 v[88:91], a[196:199], a[188:191], v[88:91]
ds_read_b64_tr_b16 a[194:195], v5 offset:36864
v_add_f32 v26, v20, v21
v_mfma_f32_16x16x32_bf16 v[104:107], a[200:203], v[56:59], v[104:107]
s_waitcnt lgkmcnt(4)
v_exp_f32 v28, v38
v_mfma_f32_16x16x32_bf16 v[104:107], a[204:207], v[44:47], v[104:107]
ds_read_b64_tr_b16 a[196:197], v5 offset:40960
v_add_f32 v26, v26, v28
v_mfma_f32_16x16x32_bf16 v[108:111], a[200:203], v[60:63], v[108:111]
s_add_u32 s90, s63, s94
ds_read_b64_tr_b16 a[198:199], v5 offset:45056
v_fma_f32 v42, v42, s24, v15
v_mfma_f32_16x16x32_bf16 v[108:111], a[204:207], v[48:51], v[108:111]
buffer_load_dwordx4 v7, s[12:15], s90 offen offset:2048 nt lds
v_mfma_f32_16x16x32_bf16 v[112:115], a[200:203], v[64:67], v[112:115]
ds_read_b64_tr_b16 a[200:201], v6 offset:32768
v_fma_f32 v43, v43, s24, v15
v_mfma_f32_16x16x32_bf16 v[112:115], a[204:207], v[52:55], v[112:115]
ds_read_b64_tr_b16 a[202:203], v6 offset:36864
v_fma_f32 v80, v80, s24, v11
v_mfma_f32_16x16x32_bf16 v[116:119], a[208:211], v[56:59], v[116:119]
s_waitcnt lgkmcnt(4)
v_exp_f32 v29, v39
v_mfma_f32_16x16x32_bf16 v[116:119], a[212:215], v[44:47], v[116:119]
ds_read_b64_tr_b16 a[204:205], v6 offset:40960
v_cvt_pk_bf16_f32 v73, v28, v29
v_mfma_f32_16x16x32_bf16 v[120:123], a[208:211], v[60:63], v[120:123]
ds_read_b64_tr_b16 a[206:207], v6 offset:45056
v_add_f32 v26, v26, v29
v_mfma_f32_16x16x32_bf16 v[120:123], a[212:215], v[48:51], v[120:123]
v_exp_f32 v30, v40
v_mfma_f32_16x16x32_bf16 v[124:127], a[208:211], v[64:67], v[124:127]
ds_read_b64_tr_b16 a[208:209], v3 offset:33792
v_fma_f32 v81, v81, s24, v11
v_mfma_f32_16x16x32_bf16 v[124:127], a[212:215], v[52:55], v[124:127]
s_add_u32 s90, s63, s95
ds_read_b64_tr_b16 a[210:211], v3 offset:37888
v_fma_f32 v82, v82, s24, v11
v_mfma_f32_16x16x32_bf16 v[128:131], a[192:195], v[56:59], v[128:131]
s_waitcnt lgkmcnt(4)
buffer_load_dwordx4 v7, s[12:15], s90 offen offset:3072 nt lds
v_mfma_f32_16x16x32_bf16 v[128:131], a[196:199], v[44:47], v[128:131]
ds_read_b64_tr_b16 a[212:213], v3 offset:41984
v_fma_f32 v83, v83, s24, v11
v_mfma_f32_16x16x32_bf16 v[132:135], a[192:195], v[60:63], v[132:135]
ds_read_b64_tr_b16 a[214:215], v3 offset:46080
v_fma_f32 v84, v84, s24, v13
v_mfma_f32_16x16x32_bf16 v[132:135], a[196:199], v[48:51], v[132:135]
v_exp_f32 v31, v41
v_mfma_f32_16x16x32_bf16 v[136:139], a[192:195], v[64:67], v[136:139]
ds_read_b64_tr_b16 a[192:193], v4 offset:33792
v_cvt_pk_bf16_f32 v76, v30, v31
v_mfma_f32_16x16x32_bf16 v[136:139], a[196:199], v[52:55], v[136:139]
ds_read_b64_tr_b16 a[194:195], v4 offset:37888
v_add_f32 v27, v30, v31
v_mfma_f32_16x16x32_bf16 v[140:143], a[200:203], v[56:59], v[140:143]
s_waitcnt lgkmcnt(4)
v_exp_f32 v20, v42
v_mfma_f32_16x16x32_bf16 v[140:143], a[204:207], v[44:47], v[140:143]
ds_read_b64_tr_b16 a[196:197], v4 offset:41984
v_add_f32 v27, v27, v20
v_mfma_f32_16x16x32_bf16 v[144:147], a[200:203], v[60:63], v[144:147]
s_add_u32 s89, s28, s84
ds_read_b64_tr_b16 a[198:199], v4 offset:46080
v_fma_f32 v85, v85, s24, v13
v_mfma_f32_16x16x32_bf16 v[144:147], a[204:207], v[48:51], v[144:147]
buffer_store_dwordx4 a[16:19], v8, s[20:23], s89 offen nt
v_mfma_f32_16x16x32_bf16 v[148:151], a[200:203], v[64:67], v[148:151]
ds_read_b64_tr_b16 a[200:201], v5 offset:33792
v_fma_f32 v86, v86, s24, v13
v_mfma_f32_16x16x32_bf16 v[148:151], a[204:207], v[52:55], v[148:151]
ds_read_b64_tr_b16 a[202:203], v5 offset:37888
v_fma_f32 v87, v87, s24, v13
v_mfma_f32_16x16x32_bf16 v[152:155], a[208:211], v[56:59], v[152:155]
s_waitcnt lgkmcnt(4)
v_exp_f32 v21, v43
v_mfma_f32_16x16x32_bf16 v[152:155], a[212:215], v[44:47], v[152:155]
ds_read_b64_tr_b16 a[204:205], v5 offset:41984
v_cvt_pk_bf16_f32 v77, v20, v21
v_mfma_f32_16x16x32_bf16 v[156:159], a[208:211], v[60:63], v[156:159]
ds_read_b64_tr_b16 a[206:207], v5 offset:46080
v_add_f32 v27, v27, v21
v_mfma_f32_16x16x32_bf16 v[156:159], a[212:215], v[48:51], v[156:159]
v_exp_f32 v28, v80
v_mfma_f32_16x16x32_bf16 v[160:163], a[208:211], v[64:67], v[160:163]
ds_read_b64_tr_b16 a[208:209], v6 offset:33792
v_add_f32 v24, v24, v28
v_mfma_f32_16x16x32_bf16 v[160:163], a[212:215], v[52:55], v[160:163]
s_add_u32 s89, s28, s85
ds_read_b64_tr_b16 a[210:211], v6 offset:37888
v_fma_f32 v88, v88, s24, v15
v_mfma_f32_16x16x32_bf16 v[164:167], a[192:195], v[56:59], v[164:167]
s_waitcnt lgkmcnt(4)
buffer_store_dwordx4 a[40:43], v8, s[20:23], s89 offen nt
v_mfma_f32_16x16x32_bf16 v[164:167], a[196:199], v[44:47], v[164:167]
ds_read_b64_tr_b16 a[212:213], v6 offset:41984
v_fma_f32 v89, v89, s24, v15
v_mfma_f32_16x16x32_bf16 v[168:171], a[192:195], v[60:63], v[168:171]
ds_read_b64_tr_b16 a[214:215], v6 offset:46080
v_fma_f32 v90, v90, s24, v15
v_mfma_f32_16x16x32_bf16 v[168:171], a[196:199], v[48:51], v[168:171]
v_exp_f32 v29, v81
v_mfma_f32_16x16x32_bf16 v[172:175], a[192:195], v[64:67], v[172:175]
v_exp_f32 v30, v82
v_mfma_f32_16x16x32_bf16 v[172:175], a[196:199], v[52:55], v[172:175]
v_exp_f32 v31, v83
v_mfma_f32_16x16x32_bf16 v[176:179], a[200:203], v[56:59], v[176:179]
s_waitcnt lgkmcnt(2)
v_exp_f32 v20, v84
v_mfma_f32_16x16x32_bf16 v[176:179], a[204:207], v[44:47], v[176:179]
v_exp_f32 v21, v85
v_mfma_f32_16x16x32_bf16 v[180:183], a[200:203], v[60:63], v[180:183]
v_cvt_pk_bf16_f32 v70, v28, v29
v_add_f32 v24, v24, v29
v_mfma_f32_16x16x32_bf16 v[180:183], a[204:207], v[48:51], v[180:183]
s_waitcnt vmcnt(24) lgkmcnt(0)
v_exp_f32 v28, v86
v_mfma_f32_16x16x32_bf16 v[184:187], a[200:203], v[64:67], v[184:187]
s_barrier
v_cvt_pk_bf16_f32 v71, v30, v31
v_mfma_f32_16x16x32_bf16 v[184:187], a[204:207], v[52:55], v[184:187]
ds_read_b128 a[192:195], v1 offset:16384
v_add_f32 v24, v24, v30
v_mfma_f32_16x16x32_bf16 v[188:191], a[208:211], v[56:59], v[188:191]
ds_read_b128 a[196:199], v2 offset:16384
v_add_f32 v24, v24, v31
v_mfma_f32_16x16x32_bf16 v[188:191], a[212:215], v[44:47], v[188:191]
ds_read_b128 a[200:203], v1 offset:17408
v_cvt_pk_bf16_f32 v74, v20, v21
v_mfma_f32_16x16x32_bf16 v[192:195], a[208:211], v[60:63], v[192:195]
s_mov_b32 m0, s38
ds_read_b128 a[204:207], v2 offset:17408
v_add_f32 v26, v26, v20
v_mfma_f32_16x16x32_bf16 v[192:195], a[212:215], v[48:51], v[192:195]
s_bitcmp1_b32 s3, 1
s_cselect_b32 s81, s63, s62
v_add_f32 v26, v26, v21
v_mfma_f32_16x16x32_bf16 v[196:199], a[208:211], v[64:67], v[196:199]
s_add_u32 s90, s81, s92
ds_read_b128 a[208:211], v1 offset:18432
v_add_f32 v26, v26, v28
v_mfma_f32_16x16x32_bf16 v[196:199], a[212:215], v[52:55], v[196:199]
s_waitcnt lgkmcnt(4)
ds_read_b128 a[212:215], v2 offset:18432
v_fma_f32 v91, v91, s24, v15
v_mfma_f32_16x16x32_bf16 v[92:95], a[192:195], a[96:99], 0
s_waitcnt lgkmcnt(4)
buffer_load_dwordx4 v7, s[16:19], s90 offen offset:0 nt lds
v_mfma_f32_16x16x32_bf16 v[92:95], a[196:199], a[108:111], v[92:95]
v_exp_f32 v29, v87
v_mfma_f32_16x16x32_bf16 v[96:99], a[192:195], a[100:103], 0
v_exp_f32 v30, v88
v_mfma_f32_16x16x32_bf16 v[96:99], a[196:199], a[112:115], v[96:99]
v_exp_f32 v31, v89
v_mfma_f32_16x16x32_bf16 v[100:103], a[192:195], a[104:107], 0
ds_read_b128 a[192:195], v1 offset:19456
v_cvt_pk_bf16_f32 v75, v28, v29
v_mfma_f32_16x16x32_bf16 v[100:103], a[196:199], a[116:119], v[100:103]
s_waitcnt lgkmcnt(1)
ds_read_b128 a[196:199], v2 offset:19456
v_add_f32 v26, v26, v29
v_mfma_f32_16x16x32_bf16 v[92:95], a[200:203], a[120:123], v[92:95]
s_add_u32 s91, s81, s93
v_exp_f32 v20, v90
v_mfma_f32_16x16x32_bf16 v[92:95], a[204:207], a[132:135], v[92:95]
buffer_load_dwordx4 v7, s[16:19], s91 offen offset:1024 nt lds
v_mfma_f32_16x16x32_bf16 v[96:99], a[200:203], a[124:127], v[96:99]
v_exp_f32 v21, v91
v_mfma_f32_16x16x32_bf16 v[96:99], a[204:207], a[136:139], v[96:99]
v_cvt_pk_bf16_f32 v78, v30, v31
v_add_f32 v27, v27, v30
v_mfma_f32_16x16x32_bf16 v[100:103], a[200:203], a[128:131], v[100:103]
ds_read_b128 a[200:203], v1 offset:24576
v_add_f32 v27, v27, v31
v_mfma_f32_16x16x32_bf16 v[100:103], a[204:207], a[140:143], v[100:103]
ds_read_b128 a[204:207], v2 offset:24576
v_cvt_pk_bf16_f32 v79, v20, v21
v_mfma_f32_16x16x32_bf16 v[92:95], a[208:211], a[144:147], v[92:95]
v_add_f32 v27, v27, v20
v_add_f32 v27, v27, v21
v_mfma_f32_16x16x32_bf16 v[92:95], a[212:215], a[156:159], v[92:95]
v_max3_f32 v25, v24, v26, v27
v_cmp_lt_f32 vcc, s25, v25
v_mfma_f32_16x16x32_bf16 v[96:99], a[208:211], a[148:151], v[96:99]
v_mfma_f32_16x16x32_bf16 v[96:99], a[212:215], a[160:163], v[96:99]
v_mfma_f32_16x16x32_bf16 v[100:103], a[208:211], a[152:155], v[100:103]
s_addk_i32 s90, 2048
ds_read_b128 a[208:211], v1 offset:25600
v_mfma_f32_16x16x32_bf16 v[100:103], a[212:215], a[164:167], v[100:103]
s_waitcnt lgkmcnt(1)
ds_read_b128 a[212:215], v2 offset:25600
v_mfma_f32_16x16x32_bf16 v[92:95], a[192:195], a[168:171], v[92:95]
buffer_load_dwordx4 v7, s[16:19], s90 offen offset:2048 nt lds
v_mfma_f32_16x16x32_bf16 v[92:95], a[196:199], a[180:183], v[92:95]
v_mfma_f32_16x16x32_bf16 v[96:99], a[192:195], a[172:175], v[96:99]
v_mfma_f32_16x16x32_bf16 v[96:99], a[196:199], a[184:187], v[96:99]
s_cbranch_vccnz STUB_20
BACK_20:
v_mfma_f32_16x16x32_bf16 v[100:103], a[192:195], a[176:179], v[100:103]
ds_read_b128 a[192:195], v1 offset:26624
v_add_f32 v19, v19, v27
v_mfma_f32_16x16x32_bf16 v[100:103], a[196:199], a[188:191], v[100:103]
ds_read_b128 a[196:199], v2 offset:26624
v_add_f32 v17, v17, v24
v_mfma_f32_16x16x32_bf16 v[80:83], a[200:203], a[96:99], 0
s_addk_i32 s91, 2048
v_add_f32 v18, v18, v26
v_fma_f32 v92, v92, s24, v11
v_mfma_f32_16x16x32_bf16 v[80:83], a[204:207], a[108:111], v[80:83]
buffer_load_dwordx4 v7, s[16:19], s91 offen offset:3072 nt lds
v_mfma_f32_16x16x32_bf16 v[84:87], a[200:203], a[100:103], 0
v_exp_f32 v28, v92
v_mfma_f32_16x16x32_bf16 v[84:87], a[204:207], a[112:115], v[84:87]
v_fma_f32 v93, v93, s24, v11
v_fma_f32 v94, v94, s24, v11
v_mfma_f32_16x16x32_bf16 v[88:91], a[200:203], a[104:107], 0
ds_read_b128 a[200:203], v1 offset:27648
v_fma_f32 v95, v95, s24, v11
v_mfma_f32_16x16x32_bf16 v[88:91], a[204:207], a[116:119], v[88:91]
s_waitcnt lgkmcnt(1)
ds_read_b128 a[204:207], v2 offset:27648
v_fma_f32 v96, v96, s24, v13
v_mfma_f32_16x16x32_bf16 v[80:83], a[208:211], a[120:123], v[80:83]
v_exp_f32 v29, v93
v_mfma_f32_16x16x32_bf16 v[80:83], a[212:215], a[132:135], v[80:83]
s_mov_b32 m0, s32
v_exp_f32 v30, v94
v_mfma_f32_16x16x32_bf16 v[84:87], a[208:211], a[124:127], v[84:87]
s_add_u32 s90, s64, s92
v_exp_f32 v31, v95
v_mfma_f32_16x16x32_bf16 v[84:87], a[212:215], a[136:139], v[84:87]
buffer_load_dwordx4 v7, s[12:15], s90 offen offset:0 nt lds
v_mfma_f32_16x16x32_bf16 v[88:91], a[208:211], a[128:131], v[88:91]
ds_read_b64_tr_b16 a[208:209], v3 offset:49152
v_cvt_pk_bf16_f32 v32, v28, v29
v_mfma_f32_16x16x32_bf16 v[88:91], a[212:215], a[140:143], v[88:91]
ds_read_b64_tr_b16 a[210:211], v3 offset:53248
v_add_f32 v24, v28, v29
v_mfma_f32_16x16x32_bf16 v[80:83], a[192:195], a[144:147], v[80:83]
v_exp_f32 v20, v96
v_mfma_f32_16x16x32_bf16 v[80:83], a[196:199], a[156:159], v[80:83]
ds_read_b64_tr_b16 a[212:213], v3 offset:57344
v_cvt_pk_bf16_f32 v33, v30, v31
v_mfma_f32_16x16x32_bf16 v[84:87], a[192:195], a[148:151], v[84:87]
ds_read_b64_tr_b16 a[214:215], v3 offset:61440
v_add_f32 v24, v24, v30
v_mfma_f32_16x16x32_bf16 v[84:87], a[196:199], a[160:163], v[84:87]
v_add_f32 v24, v24, v31
v_fma_f32 v97, v97, s24, v13
v_mfma_f32_16x16x32_bf16 v[88:91], a[192:195], a[152:155], v[88:91]
s_add_u32 s90, s64, s93
ds_read_b64_tr_b16 a[192:193], v4 offset:49152
v_fma_f32 v98, v98, s24, v13
v_mfma_f32_16x16x32_bf16 v[88:91], a[196:199], a[164:167], v[88:91]
s_waitcnt lgkmcnt(3)
ds_read_b64_tr_b16 a[194:195], v4 offset:53248
v_fma_f32 v99, v99, s24, v13
v_mfma_f32_16x16x32_bf16 v[80:83], a[200:203], a[168:171], v[80:83]
buffer_load_dwordx4 v7, s[12:15], s90 offen offset:1024 nt lds
v_mfma_f32_16x16x32_bf16 v[80:83], a[204:207], a[180:183], v[80:83]
ds_read_b64_tr_b16 a[196:197], v4 offset:57344
v_fma_f32 v100, v100, s24, v15
v_mfma_f32_16x16x32_bf16 v[84:87], a[200:203], a[172:175], v[84:87]
ds_read_b64_tr_b16 a[198:199], v4 offset:61440
v_fma_f32 v101, v101, s24, v15
v_mfma_f32_16x16x32_bf16 v[84:87], a[204:207], a[184:187], v[84:87]
v_exp_f32 v21, v97
v_mfma_f32_16x16x32_bf16 v[88:91], a[200:203], a[176:179], v[88:91]
ds_read_b64_tr_b16 a[200:201], v5 offset:49152
v_cvt_pk_bf16_f32 v36, v20, v21
v_mfma_f32_16x16x32_bf16 v[88:91], a[204:207], a[188:191], v[88:91]
ds_read_b64_tr_b16 a[202:203], v5 offset:53248
v_add_f32 v26, v20, v21
v_mfma_f32_16x16x32_bf16 v[200:203], a[208:211], v[56:59], v[200:203]
s_waitcnt lgkmcnt(4)
v_exp_f32 v28, v98
v_mfma_f32_16x16x32_bf16 v[200:203], a[212:215], v[44:47], v[200:203]
ds_read_b64_tr_b16 a[204:205], v5 offset:57344
v_add_f32 v26, v26, v28
v_mfma_f32_16x16x32_bf16 v[204:207], a[208:211], v[60:63], v[204:207]
s_add_u32 s90, s64, s94
ds_read_b64_tr_b16 a[206:207], v5 offset:61440
v_fma_f32 v102, v102, s24, v15
v_mfma_f32_16x16x32_bf16 v[204:207], a[212:215], v[48:51], v[204:207]
buffer_load_dwordx4 v7, s[12:15], s90 offen offset:2048 nt lds
v_mfma_f32_16x16x32_bf16 v[208:211], a[208:211], v[64:67], v[208:211]
ds_read_b64_tr_b16 a[208:209], v6 offset:49152
v_fma_f32 v103, v103, s24, v15
v_mfma_f32_16x16x32_bf16 v[208:211], a[212:215], v[52:55], v[208:211]
ds_read_b64_tr_b16 a[210:211], v6 offset:53248
v_fma_f32 v80, v80, s24, v11
v_mfma_f32_16x16x32_bf16 v[212:215], a[192:195], v[56:59], v[212:215]
s_waitcnt lgkmcnt(4)
v_exp_f32 v29, v99
v_mfma_f32_16x16x32_bf16 v[212:215], a[196:199], v[44:47], v[212:215]
ds_read_b64_tr_b16 a[212:213], v6 offset:57344
v_cvt_pk_bf16_f32 v37, v28, v29
v_mfma_f32_16x16x32_bf16 v[216:219], a[192:195], v[60:63], v[216:219]
ds_read_b64_tr_b16 a[214:215], v6 offset:61440
v_add_f32 v26, v26, v29
v_mfma_f32_16x16x32_bf16 v[216:219], a[196:199], v[48:51], v[216:219]
v_exp_f32 v30, v100
v_mfma_f32_16x16x32_bf16 v[220:223], a[192:195], v[64:67], v[220:223]
ds_read_b64_tr_b16 a[192:193], v3 offset:50176
v_fma_f32 v81, v81, s24, v11
v_mfma_f32_16x16x32_bf16 v[220:223], a[196:199], v[52:55], v[220:223]
s_add_u32 s90, s64, s95
ds_read_b64_tr_b16 a[194:195], v3 offset:54272
v_fma_f32 v82, v82, s24, v11
v_mfma_f32_16x16x32_bf16 a[216:219], a[200:203], v[56:59], a[216:219]
s_waitcnt lgkmcnt(4)
buffer_load_dwordx4 v7, s[12:15], s90 offen offset:3072 nt lds
v_mfma_f32_16x16x32_bf16 a[216:219], a[204:207], v[44:47], a[216:219]
ds_read_b64_tr_b16 a[196:197], v3 offset:58368
v_fma_f32 v83, v83, s24, v11
v_mfma_f32_16x16x32_bf16 a[220:223], a[200:203], v[60:63], a[220:223]
ds_read_b64_tr_b16 a[198:199], v3 offset:62464
PADJ_10:
s_cbranch_execz PADJ_14
v_fma_f32 v84, v84, s24, v13
v_mfma_f32_16x16x32_bf16 a[220:223], a[204:207], v[48:51], a[220:223]
v_exp_f32 v31, v101
v_mfma_f32_16x16x32_bf16 a[224:227], a[200:203], v[64:67], a[224:227]
ds_read_b64_tr_b16 a[200:201], v4 offset:50176
v_cvt_pk_bf16_f32 v40, v30, v31
v_mfma_f32_16x16x32_bf16 a[224:227], a[204:207], v[52:55], a[224:227]
ds_read_b64_tr_b16 a[202:203], v4 offset:54272
v_add_f32 v27, v30, v31
v_mfma_f32_16x16x32_bf16 a[228:231], a[208:211], v[56:59], a[228:231]
s_waitcnt lgkmcnt(4)
v_exp_f32 v20, v102
v_mfma_f32_16x16x32_bf16 a[228:231], a[212:215], v[44:47], a[228:231]
ds_read_b64_tr_b16 a[204:205], v4 offset:58368
v_add_f32 v27, v27, v20
v_mfma_f32_16x16x32_bf16 a[232:235], a[208:211], v[60:63], a[232:235]
s_add_u32 s89, s77, s84
ds_read_b64_tr_b16 a[206:207], v4 offset:62464
v_fma_f32 v85, v85, s24, v13
v_mfma_f32_16x16x32_bf16 a[232:235], a[212:215], v[48:51], a[232:235]
buffer_store_dwordx4 a[20:23], v8, s[20:23], s89 offen nt
v_mfma_f32_16x16x32_bf16 a[236:239], a[208:211], v[64:67], a[236:239]
ds_read_b64_tr_b16 a[208:209], v5 offset:50176
v_fma_f32 v86, v86, s24, v13
v_mfma_f32_16x16x32_bf16 a[236:239], a[212:215], v[52:55], a[236:239]
ds_read_b64_tr_b16 a[210:211], v5 offset:54272
v_fma_f32 v87, v87, s24, v13
v_mfma_f32_16x16x32_bf16 a[240:243], a[192:195], v[56:59], a[240:243]
s_waitcnt lgkmcnt(4)
v_exp_f32 v21, v103
v_mfma_f32_16x16x32_bf16 a[240:243], a[196:199], v[44:47], a[240:243]
ds_read_b64_tr_b16 a[212:213], v5 offset:58368
v_cvt_pk_bf16_f32 v41, v20, v21
v_mfma_f32_16x16x32_bf16 a[244:247], a[192:195], v[60:63], a[244:247]
ds_read_b64_tr_b16 a[214:215], v5 offset:62464
v_add_f32 v27, v27, v21
v_mfma_f32_16x16x32_bf16 a[244:247], a[196:199], v[48:51], a[244:247]
v_exp_f32 v28, v80
v_mfma_f32_16x16x32_bf16 a[248:251], a[192:195], v[64:67], a[248:251]
ds_read_b64_tr_b16 a[192:193], v6 offset:50176
v_add_f32 v24, v24, v28
v_mfma_f32_16x16x32_bf16 a[248:251], a[196:199], v[52:55], a[248:251]
s_add_u32 s89, s77, s85
ds_read_b64_tr_b16 a[194:195], v6 offset:54272
v_fma_f32 v88, v88, s24, v15
v_mfma_f32_16x16x32_bf16 a[252:255], a[200:203], v[56:59], a[252:255]
s_waitcnt lgkmcnt(4)
buffer_store_dwordx4 a[44:47], v8, s[20:23], s89 offen nt
v_mfma_f32_16x16x32_bf16 a[252:255], a[204:207], v[44:47], a[252:255]
ds_read_b64_tr_b16 a[196:197], v6 offset:58368
v_fma_f32 v89, v89, s24, v15
v_mfma_f32_16x16x32_bf16 v[224:227], a[200:203], v[60:63], v[224:227]
ds_read_b64_tr_b16 a[198:199], v6 offset:62464
v_fma_f32 v90, v90, s24, v15
v_mfma_f32_16x16x32_bf16 v[224:227], a[204:207], v[48:51], v[224:227]
v_exp_f32 v29, v81
v_mfma_f32_16x16x32_bf16 v[228:231], a[200:203], v[64:67], v[228:231]
v_exp_f32 v30, v82
v_mfma_f32_16x16x32_bf16 v[228:231], a[204:207], v[52:55], v[228:231]
v_exp_f32 v31, v83
v_mfma_f32_16x16x32_bf16 v[232:235], a[208:211], v[56:59], v[232:235]
s_waitcnt lgkmcnt(2)
v_exp_f32 v20, v84
v_mfma_f32_16x16x32_bf16 v[232:235], a[212:215], v[44:47], v[232:235]
v_exp_f32 v21, v85
v_mfma_f32_16x16x32_bf16 v[236:239], a[208:211], v[60:63], v[236:239]
v_cvt_pk_bf16_f32 v34, v28, v29
v_add_f32 v24, v24, v29
v_mfma_f32_16x16x32_bf16 v[236:239], a[212:215], v[48:51], v[236:239]
s_waitcnt vmcnt(22) lgkmcnt(0)
v_exp_f32 v28, v86
v_mfma_f32_16x16x32_bf16 v[240:243], a[208:211], v[64:67], v[240:243]
s_barrier
v_cvt_pk_bf16_f32 v35, v30, v31
v_mfma_f32_16x16x32_bf16 v[240:243], a[212:215], v[52:55], v[240:243]
ds_read_b128 a[200:203], v1 offset:32768
v_add_f32 v24, v24, v30
v_mfma_f32_16x16x32_bf16 v[244:247], a[192:195], v[56:59], v[244:247]
ds_read_b128 a[204:207], v2 offset:32768
v_add_f32 v24, v24, v31
v_mfma_f32_16x16x32_bf16 v[244:247], a[196:199], v[44:47], v[244:247]
ds_read_b128 a[208:211], v1 offset:33792
v_cvt_pk_bf16_f32 v38, v20, v21
v_mfma_f32_16x16x32_bf16 v[248:251], a[192:195], v[60:63], v[248:251]
s_mov_b32 m0, s39
ds_read_b128 a[212:215], v2 offset:33792
v_add_f32 v26, v26, v20
v_mfma_f32_16x16x32_bf16 v[248:251], a[196:199], v[48:51], v[248:251]
s_addk_i32 s81, 2048
v_exp_f32 v29, v87
v_mfma_f32_16x16x32_bf16 v[252:255], a[192:195], v[64:67], v[252:255]
s_add_u32 s90, s81, s94
ds_read_b128 a[192:195], v1 offset:34816
v_add_f32 v26, v26, v21
v_mfma_f32_16x16x32_bf16 v[252:255], a[196:199], v[52:55], v[252:255]
s_waitcnt lgkmcnt(4)
ds_read_b128 a[196:199], v2 offset:34816
v_cvt_pk_bf16_f32 v39, v28, v29
v_mfma_f32_16x16x32_bf16 v[44:47], a[200:203], a[96:99], 0
s_waitcnt lgkmcnt(4)
buffer_load_dwordx4 v7, s[16:19], s90 offen offset:0 nt lds
v_mfma_f32_16x16x32_bf16 v[44:47], a[204:207], a[108:111], v[44:47]
v_exp_f32 v30, v88
v_mfma_f32_16x16x32_bf16 v[48:51], a[200:203], a[100:103], 0
v_exp_f32 v31, v89
v_mfma_f32_16x16x32_bf16 v[48:51], a[204:207], a[112:115], v[48:51]
v_exp_f32 v20, v90
v_mfma_f32_16x16x32_bf16 v[52:55], a[200:203], a[104:107], 0
ds_read_b128 a[200:203], v1 offset:35840
v_add_f32 v26, v26, v28
v_mfma_f32_16x16x32_bf16 v[52:55], a[204:207], a[116:119], v[52:55]
s_waitcnt lgkmcnt(1)
ds_read_b128 a[204:207], v2 offset:35840
v_add_f32 v26, v26, v29
v_mfma_f32_16x16x32_bf16 v[44:47], a[208:211], a[120:123], v[44:47]
s_add_u32 s91, s81, s95
v_fma_f32 v91, v91, s24, v15
v_cvt_pk_bf16_f32 v42, v30, v31
v_mfma_f32_16x16x32_bf16 v[44:47], a[212:215], a[132:135], v[44:47]
buffer_load_dwordx4 v7, s[16:19], s91 offen offset:1024 nt lds
v_mfma_f32_16x16x32_bf16 v[48:51], a[208:211], a[124:127], v[48:51]
v_exp_f32 v21, v91
v_mfma_f32_16x16x32_bf16 v[48:51], a[212:215], a[136:139], v[48:51]
v_add_f32 v27, v27, v30
v_add_f32 v27, v27, v31
v_mfma_f32_16x16x32_bf16 v[52:55], a[208:211], a[128:131], v[52:55]
ds_read_b128 a[208:211], v1 offset:40960
v_cvt_pk_bf16_f32 v43, v20, v21
v_mfma_f32_16x16x32_bf16 v[52:55], a[212:215], a[140:143], v[52:55]
ds_read_b128 a[212:215], v2 offset:40960
v_add_f32 v27, v27, v20
v_mfma_f32_16x16x32_bf16 v[44:47], a[192:195], a[144:147], v[44:47]
v_add_f32 v27, v27, v21
v_max3_f32 v25, v24, v26, v27
v_mfma_f32_16x16x32_bf16 v[44:47], a[196:199], a[156:159], v[44:47]
v_cmp_lt_f32 vcc, s25, v25
v_mfma_f32_16x16x32_bf16 v[48:51], a[192:195], a[148:151], v[48:51]
v_mfma_f32_16x16x32_bf16 v[48:51], a[196:199], a[160:163], v[48:51]
v_mfma_f32_16x16x32_bf16 v[52:55], a[192:195], a[152:155], v[52:55]
s_addk_i32 s90, 2048
ds_read_b128 a[192:195], v1 offset:41984
v_mfma_f32_16x16x32_bf16 v[52:55], a[196:199], a[164:167], v[52:55]
s_waitcnt lgkmcnt(1)
ds_read_b128 a[196:199], v2 offset:41984
v_mfma_f32_16x16x32_bf16 v[44:47], a[200:203], a[168:171], v[44:47]
buffer_load_dwordx4 v7, s[16:19], s90 offen offset:2048 nt lds
v_mfma_f32_16x16x32_bf16 v[44:47], a[204:207], a[180:183], v[44:47]
v_mfma_f32_16x16x32_bf16 v[48:51], a[200:203], a[172:175], v[48:51]
v_mfma_f32_16x16x32_bf16 v[48:51], a[204:207], a[184:187], v[48:51]
s_cbranch_vccnz STUB_21
BACK_21:
v_mfma_f32_16x16x32_bf16 v[52:55], a[200:203], a[176:179], v[52:55]
ds_read_b128 a[200:203], v1 offset:43008
v_add_f32 v19, v19, v27
v_mfma_f32_16x16x32_bf16 v[52:55], a[204:207], a[188:191], v[52:55]
ds_read_b128 a[204:207], v2 offset:43008
v_add_f32 v17, v17, v24
v_mfma_f32_16x16x32_bf16 v[80:83], a[208:211], a[96:99], 0
s_addk_i32 s91, 2048
v_add_f32 v18, v18, v26
v_fma_f32 v44, v44, s24, v11
v_mfma_f32_16x16x32_bf16 v[80:83], a[212:215], a[108:111], v[80:83]
buffer_load_dwordx4 v7, s[16:19], s91 offen offset:3072 nt lds
v_mfma_f32_16x16x32_bf16 v[84:87], a[208:211], a[100:103], 0
v_exp_f32 v28, v44
v_mfma_f32_16x16x32_bf16 v[84:87], a[212:215], a[112:115], v[84:87]
v_fma_f32 v45, v45, s24, v11
v_fma_f32 v46, v46, s24, v11
v_mfma_f32_16x16x32_bf16 v[88:91], a[208:211], a[104:107], 0
ds_read_b128 a[208:211], v1 offset:44032
v_fma_f32 v47, v47, s24, v11
v_mfma_f32_16x16x32_bf16 v[88:91], a[212:215], a[116:119], v[88:91]
s_waitcnt lgkmcnt(1)
ds_read_b128 a[212:215], v2 offset:44032
v_fma_f32 v48, v48, s24, v13
v_mfma_f32_16x16x32_bf16 v[80:83], a[192:195], a[120:123], v[80:83]
v_exp_f32 v29, v45
v_mfma_f32_16x16x32_bf16 v[80:83], a[196:199], a[132:135], v[80:83]
s_mov_b32 m0, s33
v_exp_f32 v30, v46
v_mfma_f32_16x16x32_bf16 v[84:87], a[192:195], a[124:127], v[84:87]
s_add_u32 s90, s65, s92
v_exp_f32 v31, v47
v_mfma_f32_16x16x32_bf16 v[84:87], a[196:199], a[136:139], v[84:87]
buffer_load_dwordx4 v7, s[12:15], s90 offen offset:0 nt lds
v_mfma_f32_16x16x32_bf16 v[88:91], a[192:195], a[128:131], v[88:91]
ds_read_b64_tr_b16 a[192:193], v3 offset:0
v_cvt_pk_bf16_f32 v56, v28, v29
v_mfma_f32_16x16x32_bf16 v[88:91], a[196:199], a[140:143], v[88:91]
ds_read_b64_tr_b16 a[194:195], v3 offset:4096
v_add_f32 v24, v28, v29
v_mfma_f32_16x16x32_bf16 v[80:83], a[200:203], a[144:147], v[80:83]
v_exp_f32 v20, v48
v_mfma_f32_16x16x32_bf16 v[80:83], a[204:207], a[156:159], v[80:83]
ds_read_b64_tr_b16 a[196:197], v3 offset:8192
v_cvt_pk_bf16_f32 v57, v30, v31
v_mfma_f32_16x16x32_bf16 v[84:87], a[200:203], a[148:151], v[84:87]
ds_read_b64_tr_b16 a[198:199], v3 offset:12288
v_add_f32 v24, v24, v30
v_mfma_f32_16x16x32_bf16 v[84:87], a[204:207], a[160:163], v[84:87]
v_add_f32 v24, v24, v31
v_fma_f32 v49, v49, s24, v13
v_mfma_f32_16x16x32_bf16 v[88:91], a[200:203], a[152:155], v[88:91]
s_add_u32 s90, s65, s93
ds_read_b64_tr_b16 a[200:201], v4 offset:0
v_fma_f32 v50, v50, s24, v13
v_mfma_f32_16x16x32_bf16 v[88:91], a[204:207], a[164:167], v[88:91]
s_waitcnt lgkmcnt(3)
ds_read_b64_tr_b16 a[202:203], v4 offset:4096
v_fma_f32 v51, v51, s24, v13
v_mfma_f32_16x16x32_bf16 v[80:83], a[208:211], a[168:171], v[80:83]
buffer_load_dwordx4 v7, s[12:15], s90 offen offset:1024 nt lds
v_mfma_f32_16x16x32_bf16 v[80:83], a[212:215], a[180:183], v[80:83]
ds_read_b64_tr_b16 a[204:205], v4 offset:8192
v_fma_f32 v52, v52, s24, v15
v_mfma_f32_16x16x32_bf16 v[84:87], a[208:211], a[172:175], v[84:87]
ds_read_b64_tr_b16 a[206:207], v4 offset:12288
v_fma_f32 v53, v53, s24, v15
v_mfma_f32_16x16x32_bf16 v[84:87], a[212:215], a[184:187], v[84:87]
v_exp_f32 v21, v49
v_mfma_f32_16x16x32_bf16 v[88:91], a[208:211], a[176:179], v[88:91]
ds_read_b64_tr_b16 a[208:209], v5 offset:0
v_cvt_pk_bf16_f32 v60, v20, v21
v_mfma_f32_16x16x32_bf16 v[88:91], a[212:215], a[188:191], v[88:91]
ds_read_b64_tr_b16 a[210:211], v5 offset:4096
v_add_f32 v26, v20, v21
v_mfma_f32_16x16x32_bf16 v[104:107], a[192:195], v[68:71], v[104:107]
s_waitcnt lgkmcnt(4)
v_exp_f32 v28, v50
v_mfma_f32_16x16x32_bf16 v[104:107], a[196:199], v[32:35], v[104:107]
ds_read_b64_tr_b16 a[212:213], v5 offset:8192
v_add_f32 v26, v26, v28
v_mfma_f32_16x16x32_bf16 v[108:111], a[192:195], v[72:75], v[108:111]
s_add_u32 s90, s65, s94
ds_read_b64_tr_b16 a[214:215], v5 offset:12288
v_fma_f32 v54, v54, s24, v15
v_mfma_f32_16x16x32_bf16 v[108:111], a[196:199], v[36:39], v[108:111]
buffer_load_dwordx4 v7, s[12:15], s90 offen offset:2048 nt lds
v_mfma_f32_16x16x32_bf16 v[112:115], a[192:195], v[76:79], v[112:115]
ds_read_b64_tr_b16 a[192:193], v6 offset:0
v_fma_f32 v55, v55, s24, v15
v_mfma_f32_16x16x32_bf16 v[112:115], a[196:199], v[40:43], v[112:115]
ds_read_b64_tr_b16 a[194:195], v6 offset:4096
v_fma_f32 v80, v80, s24, v11
v_mfma_f32_16x16x32_bf16 v[116:119], a[200:203], v[68:71], v[116:119]
s_waitcnt lgkmcnt(4)
v_exp_f32 v29, v51
v_mfma_f32_16x16x32_bf16 v[116:119], a[204:207], v[32:35], v[116:119]
ds_read_b64_tr_b16 a[196:197], v6 offset:8192
v_cvt_pk_bf16_f32 v61, v28, v29
v_mfma_f32_16x16x32_bf16 v[120:123], a[200:203], v[72:75], v[120:123]
ds_read_b64_tr_b16 a[198:199], v6 offset:12288
v_add_f32 v26, v26, v29
v_mfma_f32_16x16x32_bf16 v[120:123], a[204:207], v[36:39], v[120:123]
v_exp_f32 v30, v52
v_mfma_f32_16x16x32_bf16 v[124:127], a[200:203], v[76:79], v[124:127]
ds_read_b64_tr_b16 a[200:201], v3 offset:1024
v_fma_f32 v81, v81, s24, v11
v_mfma_f32_16x16x32_bf16 v[124:127], a[204:207], v[40:43], v[124:127]
s_add_u32 s90, s65, s95
ds_read_b64_tr_b16 a[202:203], v3 offset:5120
v_fma_f32 v82, v82, s24, v11
v_mfma_f32_16x16x32_bf16 v[128:131], a[208:211], v[68:71], v[128:131]
s_waitcnt lgkmcnt(4)
buffer_load_dwordx4 v7, s[12:15], s90 offen offset:3072 nt lds
v_mfma_f32_16x16x32_bf16 v[128:131], a[212:215], v[32:35], v[128:131]
ds_read_b64_tr_b16 a[204:205], v3 offset:9216
v_fma_f32 v83, v83, s24, v11
v_mfma_f32_16x16x32_bf16 v[132:135], a[208:211], v[72:75], v[132:135]
ds_read_b64_tr_b16 a[206:207], v3 offset:13312
v_fma_f32 v84, v84, s24, v13
v_mfma_f32_16x16x32_bf16 v[132:135], a[212:215], v[36:39], v[132:135]
v_exp_f32 v31, v53
v_mfma_f32_16x16x32_bf16 v[136:139], a[208:211], v[76:79], v[136:139]
ds_read_b64_tr_b16 a[208:209], v4 offset:1024
v_cvt_pk_bf16_f32 v64, v30, v31
v_mfma_f32_16x16x32_bf16 v[136:139], a[212:215], v[40:43], v[136:139]
ds_read_b64_tr_b16 a[210:211], v4 offset:5120
v_add_f32 v27, v30, v31
v_mfma_f32_16x16x32_bf16 v[140:143], a[192:195], v[68:71], v[140:143]
s_waitcnt lgkmcnt(4)
v_exp_f32 v20, v54
v_mfma_f32_16x16x32_bf16 v[140:143], a[196:199], v[32:35], v[140:143]
ds_read_b64_tr_b16 a[212:213], v4 offset:9216
v_add_f32 v27, v27, v20
v_mfma_f32_16x16x32_bf16 v[144:147], a[192:195], v[72:75], v[144:147]
s_add_u32 s89, s26, s86
ds_read_b64_tr_b16 a[214:215], v4 offset:13312
v_fma_f32 v85, v85, s24, v13
v_mfma_f32_16x16x32_bf16 v[144:147], a[196:199], v[36:39], v[144:147]
buffer_store_dwordx4 a[48:51], v8, s[20:23], s89 offen nt
v_mfma_f32_16x16x32_bf16 v[148:151], a[192:195], v[76:79], v[148:151]
ds_read_b64_tr_b16 a[192:193], v5 offset:1024
v_fma_f32 v86, v86, s24, v13
v_mfma_f32_16x16x32_bf16 v[148:151], a[196:199], v[40:43], v[148:151]
ds_read_b64_tr_b16 a[194:195], v5 offset:5120
v_fma_f32 v87, v87, s24, v13
v_mfma_f32_16x16x32_bf16 v[152:155], a[200:203], v[68:71], v[152:155]
s_waitcnt lgkmcnt(4)
v_exp_f32 v21, v55
v_mfma_f32_16x16x32_bf16 v[152:155], a[204:207], v[32:35], v[152:155]
ds_read_b64_tr_b16 a[196:197], v5 offset:9216
v_cvt_pk_bf16_f32 v65, v20, v21
v_mfma_f32_16x16x32_bf16 v[156:159], a[200:203], v[72:75], v[156:159]
ds_read_b64_tr_b16 a[198:199], v5 offset:13312
v_add_f32 v27, v27, v21
v_mfma_f32_16x16x32_bf16 v[156:159], a[204:207], v[36:39], v[156:159]
v_exp_f32 v28, v80
v_mfma_f32_16x16x32_bf16 v[160:163], a[200:203], v[76:79], v[160:163]
ds_read_b64_tr_b16 a[200:201], v6 offset:1024
v_add_f32 v24, v24, v28
v_mfma_f32_16x16x32_bf16 v[160:163], a[204:207], v[40:43], v[160:163]
s_add_u32 s89, s26, s87
ds_read_b64_tr_b16 a[202:203], v6 offset:5120
v_fma_f32 v88, v88, s24, v15
v_mfma_f32_16x16x32_bf16 v[164:167], a[208:211], v[68:71], v[164:167]
s_waitcnt lgkmcnt(4)
buffer_store_dwordx4 a[72:75], v8, s[20:23], s89 offen nt
v_mfma_f32_16x16x32_bf16 v[164:167], a[212:215], v[32:35], v[164:167]
ds_read_b64_tr_b16 a[204:205], v6 offset:9216
v_fma_f32 v89, v89, s24, v15
v_mfma_f32_16x16x32_bf16 v[168:171], a[208:211], v[72:75], v[168:171]
ds_read_b64_tr_b16 a[206:207], v6 offset:13312
v_fma_f32 v90, v90, s24, v15
v_mfma_f32_16x16x32_bf16 v[168:171], a[212:215], v[36:39], v[168:171]
v_exp_f32 v29, v81
v_mfma_f32_16x16x32_bf16 v[172:175], a[208:211], v[76:79], v[172:175]
v_exp_f32 v30, v82
v_mfma_f32_16x16x32_bf16 v[172:175], a[212:215], v[40:43], v[172:175]
v_exp_f32 v31, v83
v_mfma_f32_16x16x32_bf16 v[176:179], a[192:195], v[68:71], v[176:179]
s_waitcnt lgkmcnt(2)
v_exp_f32 v20, v84
v_mfma_f32_16x16x32_bf16 v[176:179], a[196:199], v[32:35], v[176:179]
v_exp_f32 v21, v85
v_mfma_f32_16x16x32_bf16 v[180:183], a[192:195], v[72:75], v[180:183]
v_cvt_pk_bf16_f32 v58, v28, v29
v_add_f32 v24, v24, v29
v_mfma_f32_16x16x32_bf16 v[180:183], a[196:199], v[36:39], v[180:183]
s_waitcnt vmcnt(22) lgkmcnt(0)
v_exp_f32 v28, v86
v_mfma_f32_16x16x32_bf16 v[184:187], a[192:195], v[76:79], v[184:187]
s_barrier
v_cvt_pk_bf16_f32 v59, v30, v31
v_mfma_f32_16x16x32_bf16 v[184:187], a[196:199], v[40:43], v[184:187]
ds_read_b128 a[208:211], v1 offset:49152
v_add_f32 v24, v24, v30
v_mfma_f32_16x16x32_bf16 v[188:191], a[200:203], v[68:71], v[188:191]
ds_read_b128 a[212:215], v2 offset:49152
v_add_f32 v24, v24, v31
v_mfma_f32_16x16x32_bf16 v[188:191], a[204:207], v[32:35], v[188:191]
ds_read_b128 a[192:195], v1 offset:50176
v_cvt_pk_bf16_f32 v62, v20, v21
v_mfma_f32_16x16x32_bf16 v[192:195], a[200:203], v[72:75], v[192:195]
s_mov_b32 m0, s36
ds_read_b128 a[196:199], v2 offset:50176
v_add_f32 v26, v26, v20
v_mfma_f32_16x16x32_bf16 v[192:195], a[204:207], v[36:39], v[192:195]
s_bitcmp1_b32 s3, 1
s_cselect_b32 s81, s65, s64
v_add_f32 v26, v26, v21
v_mfma_f32_16x16x32_bf16 v[196:199], a[200:203], v[76:79], v[196:199]
s_add_u32 s90, s81, s92
ds_read_b128 a[200:203], v1 offset:51200
v_add_f32 v26, v26, v28
v_mfma_f32_16x16x32_bf16 v[196:199], a[204:207], v[40:43], v[196:199]
s_waitcnt lgkmcnt(4)
ds_read_b128 a[204:207], v2 offset:51200
v_fma_f32 v91, v91, s24, v15
v_mfma_f32_16x16x32_bf16 v[92:95], a[208:211], a[96:99], 0
s_waitcnt lgkmcnt(4)
buffer_load_dwordx4 v7, s[16:19], s90 offen offset:0 nt lds
v_mfma_f32_16x16x32_bf16 v[92:95], a[212:215], a[108:111], v[92:95]
v_exp_f32 v29, v87
v_mfma_f32_16x16x32_bf16 v[96:99], a[208:211], a[100:103], 0
v_exp_f32 v30, v88
v_mfma_f32_16x16x32_bf16 v[96:99], a[212:215], a[112:115], v[96:99]
v_exp_f32 v31, v89
v_mfma_f32_16x16x32_bf16 v[100:103], a[208:211], a[104:107], 0
ds_read_b128 a[208:211], v1 offset:52224
v_cvt_pk_bf16_f32 v63, v28, v29
v_mfma_f32_16x16x32_bf16 v[100:103], a[212:215], a[116:119], v[100:103]
s_waitcnt lgkmcnt(1)
ds_read_b128 a[212:215], v2 offset:52224
v_add_f32 v26, v26, v29
v_mfma_f32_16x16x32_bf16 v[92:95], a[192:195], a[120:123], v[92:95]
s_add_u32 s91, s81, s93
v_exp_f32 v20, v90
v_mfma_f32_16x16x32_bf16 v[92:95], a[196:199], a[132:135], v[92:95]
buffer_load_dwordx4 v7, s[16:19], s91 offen offset:1024 nt lds
v_mfma_f32_16x16x32_bf16 v[96:99], a[192:195], a[124:127], v[96:99]
v_exp_f32 v21, v91
v_mfma_f32_16x16x32_bf16 v[96:99], a[196:199], a[136:139], v[96:99]
v_cvt_pk_bf16_f32 v66, v30, v31
v_add_f32 v27, v27, v30
v_mfma_f32_16x16x32_bf16 v[100:103], a[192:195], a[128:131], v[100:103]
ds_read_b128 a[192:195], v1 offset:57344
v_add_f32 v27, v27, v31
v_mfma_f32_16x16x32_bf16 v[100:103], a[196:199], a[140:143], v[100:103]
ds_read_b128 a[196:199], v2 offset:57344
v_cvt_pk_bf16_f32 v67, v20, v21
v_mfma_f32_16x16x32_bf16 v[92:95], a[200:203], a[144:147], v[92:95]
v_add_f32 v27, v27, v20
v_add_f32 v27, v27, v21
v_mfma_f32_16x16x32_bf16 v[92:95], a[204:207], a[156:159], v[92:95]
v_max3_f32 v25, v24, v26, v27
v_cmp_lt_f32 vcc, s25, v25
v_mfma_f32_16x16x32_bf16 v[96:99], a[200:203], a[148:151], v[96:99]
v_mfma_f32_16x16x32_bf16 v[96:99], a[204:207], a[160:163], v[96:99]
v_mfma_f32_16x16x32_bf16 v[100:103], a[200:203], a[152:155], v[100:103]
s_addk_i32 s90, 2048
ds_read_b128 a[200:203], v1 offset:58368
v_mfma_f32_16x16x32_bf16 v[100:103], a[204:207], a[164:167], v[100:103]
s_waitcnt lgkmcnt(1)
ds_read_b128 a[204:207], v2 offset:58368
v_mfma_f32_16x16x32_bf16 v[92:95], a[208:211], a[168:171], v[92:95]
buffer_load_dwordx4 v7, s[16:19], s90 offen offset:2048 nt lds
v_mfma_f32_16x16x32_bf16 v[92:95], a[212:215], a[180:183], v[92:95]
v_mfma_f32_16x16x32_bf16 v[96:99], a[208:211], a[172:175], v[96:99]
v_mfma_f32_16x16x32_bf16 v[96:99], a[212:215], a[184:187], v[96:99]
s_cbranch_vccnz STUB_22
BACK_22:
v_mfma_f32_16x16x32_bf16 v[100:103], a[208:211], a[176:179], v[100:103]
ds_read_b128 a[208:211], v1 offset:59392
v_add_f32 v19, v19, v27
v_mfma_f32_16x16x32_bf16 v[100:103], a[212:215], a[188:191], v[100:103]
ds_read_b128 a[212:215], v2 offset:59392
v_add_f32 v17, v17, v24
v_mfma_f32_16x16x32_bf16 v[80:83], a[192:195], a[96:99], 0
s_addk_i32 s91, 2048
v_add_f32 v18, v18, v26
v_fma_f32 v92, v92, s24, v11
v_mfma_f32_16x16x32_bf16 v[80:83], a[196:199], a[108:111], v[80:83]
buffer_load_dwordx4 v7, s[16:19], s91 offen offset:3072 nt lds
v_mfma_f32_16x16x32_bf16 v[84:87], a[192:195], a[100:103], 0
v_exp_f32 v28, v92
v_mfma_f32_16x16x32_bf16 v[84:87], a[196:199], a[112:115], v[84:87]
v_fma_f32 v93, v93, s24, v11
v_fma_f32 v94, v94, s24, v11
v_mfma_f32_16x16x32_bf16 v[88:91], a[192:195], a[104:107], 0
ds_read_b128 a[192:195], v1 offset:60416
v_fma_f32 v95, v95, s24, v11
v_mfma_f32_16x16x32_bf16 v[88:91], a[196:199], a[116:119], v[88:91]
s_waitcnt lgkmcnt(1)
ds_read_b128 a[196:199], v2 offset:60416
v_fma_f32 v96, v96, s24, v13
v_mfma_f32_16x16x32_bf16 v[80:83], a[200:203], a[120:123], v[80:83]
v_exp_f32 v29, v93
v_mfma_f32_16x16x32_bf16 v[80:83], a[204:207], a[132:135], v[80:83]
s_mov_b32 m0, s34
v_exp_f32 v30, v94
v_mfma_f32_16x16x32_bf16 v[84:87], a[200:203], a[124:127], v[84:87]
s_add_u32 s90, s66, s92
v_exp_f32 v31, v95
v_mfma_f32_16x16x32_bf16 v[84:87], a[204:207], a[136:139], v[84:87]
buffer_load_dwordx4 v7, s[12:15], s90 offen offset:0 nt lds
v_mfma_f32_16x16x32_bf16 v[88:91], a[200:203], a[128:131], v[88:91]
ds_read_b64_tr_b16 a[200:201], v3 offset:16384
v_cvt_pk_bf16_f32 v44, v28, v29
v_mfma_f32_16x16x32_bf16 v[88:91], a[204:207], a[140:143], v[88:91]
ds_read_b64_tr_b16 a[202:203], v3 offset:20480
v_add_f32 v24, v28, v29
v_mfma_f32_16x16x32_bf16 v[80:83], a[208:211], a[144:147], v[80:83]
v_exp_f32 v20, v96
v_mfma_f32_16x16x32_bf16 v[80:83], a[212:215], a[156:159], v[80:83]
ds_read_b64_tr_b16 a[204:205], v3 offset:24576
v_cvt_pk_bf16_f32 v45, v30, v31
v_mfma_f32_16x16x32_bf16 v[84:87], a[208:211], a[148:151], v[84:87]
ds_read_b64_tr_b16 a[206:207], v3 offset:28672
v_add_f32 v24, v24, v30
v_mfma_f32_16x16x32_bf16 v[84:87], a[212:215], a[160:163], v[84:87]
v_add_f32 v24, v24, v31
v_fma_f32 v97, v97, s24, v13
v_mfma_f32_16x16x32_bf16 v[88:91], a[208:211], a[152:155], v[88:91]
s_add_u32 s90, s66, s93
ds_read_b64_tr_b16 a[208:209], v4 offset:16384
v_fma_f32 v98, v98, s24, v13
v_mfma_f32_16x16x32_bf16 v[88:91], a[212:215], a[164:167], v[88:91]
s_waitcnt lgkmcnt(3)
ds_read_b64_tr_b16 a[210:211], v4 offset:20480
v_fma_f32 v99, v99, s24, v13
v_mfma_f32_16x16x32_bf16 v[80:83], a[192:195], a[168:171], v[80:83]
buffer_load_dwordx4 v7, s[12:15], s90 offen offset:1024 nt lds
v_mfma_f32_16x16x32_bf16 v[80:83], a[196:199], a[180:183], v[80:83]
ds_read_b64_tr_b16 a[212:213], v4 offset:24576
v_fma_f32 v100, v100, s24, v15
v_mfma_f32_16x16x32_bf16 v[84:87], a[192:195], a[172:175], v[84:87]
ds_read_b64_tr_b16 a[214:215], v4 offset:28672
v_fma_f32 v101, v101, s24, v15
v_mfma_f32_16x16x32_bf16 v[84:87], a[196:199], a[184:187], v[84:87]
v_exp_f32 v21, v97
v_mfma_f32_16x16x32_bf16 v[88:91], a[192:195], a[176:179], v[88:91]
ds_read_b64_tr_b16 a[192:193], v5 offset:16384
v_cvt_pk_bf16_f32 v48, v20, v21
v_mfma_f32_16x16x32_bf16 v[88:91], a[196:199], a[188:191], v[88:91]
ds_read_b64_tr_b16 a[194:195], v5 offset:20480
v_add_f32 v26, v20, v21
v_mfma_f32_16x16x32_bf16 v[200:203], a[200:203], v[68:71], v[200:203]
s_waitcnt lgkmcnt(4)
v_exp_f32 v28, v98
v_mfma_f32_16x16x32_bf16 v[200:203], a[204:207], v[32:35], v[200:203]
ds_read_b64_tr_b16 a[196:197], v5 offset:24576
v_add_f32 v26, v26, v28
v_mfma_f32_16x16x32_bf16 v[204:207], a[200:203], v[72:75], v[204:207]
s_add_u32 s90, s66, s94
ds_read_b64_tr_b16 a[198:199], v5 offset:28672
v_fma_f32 v102, v102, s24, v15
v_mfma_f32_16x16x32_bf16 v[204:207], a[204:207], v[36:39], v[204:207]
buffer_load_dwordx4 v7, s[12:15], s90 offen offset:2048 nt lds
v_mfma_f32_16x16x32_bf16 v[208:211], a[200:203], v[76:79], v[208:211]
ds_read_b64_tr_b16 a[200:201], v6 offset:16384
v_fma_f32 v103, v103, s24, v15
v_mfma_f32_16x16x32_bf16 v[208:211], a[204:207], v[40:43], v[208:211]
ds_read_b64_tr_b16 a[202:203], v6 offset:20480
v_fma_f32 v80, v80, s24, v11
v_mfma_f32_16x16x32_bf16 v[212:215], a[208:211], v[68:71], v[212:215]
s_waitcnt lgkmcnt(4)
v_exp_f32 v29, v99
v_mfma_f32_16x16x32_bf16 v[212:215], a[212:215], v[32:35], v[212:215]
ds_read_b64_tr_b16 a[204:205], v6 offset:24576
v_cvt_pk_bf16_f32 v49, v28, v29
v_mfma_f32_16x16x32_bf16 v[216:219], a[208:211], v[72:75], v[216:219]
ds_read_b64_tr_b16 a[206:207], v6 offset:28672
v_add_f32 v26, v26, v29
v_mfma_f32_16x16x32_bf16 v[216:219], a[212:215], v[36:39], v[216:219]
v_exp_f32 v30, v100
v_mfma_f32_16x16x32_bf16 v[220:223], a[208:211], v[76:79], v[220:223]
ds_read_b64_tr_b16 a[208:209], v3 offset:17408
v_fma_f32 v81, v81, s24, v11
v_mfma_f32_16x16x32_bf16 v[220:223], a[212:215], v[40:43], v[220:223]
s_add_u32 s90, s66, s95
ds_read_b64_tr_b16 a[210:211], v3 offset:21504
v_fma_f32 v82, v82, s24, v11
v_mfma_f32_16x16x32_bf16 a[216:219], a[192:195], v[68:71], a[216:219]
s_waitcnt lgkmcnt(4)
buffer_load_dwordx4 v7, s[12:15], s90 offen offset:3072 nt lds
v_mfma_f32_16x16x32_bf16 a[216:219], a[196:199], v[32:35], a[216:219]
ds_read_b64_tr_b16 a[212:213], v3 offset:25600
v_fma_f32 v83, v83, s24, v11
v_mfma_f32_16x16x32_bf16 a[220:223], a[192:195], v[72:75], a[220:223]
ds_read_b64_tr_b16 a[214:215], v3 offset:29696
v_fma_f32 v84, v84, s24, v13
v_mfma_f32_16x16x32_bf16 a[220:223], a[196:199], v[36:39], a[220:223]
v_exp_f32 v31, v101
v_mfma_f32_16x16x32_bf16 a[224:227], a[192:195], v[76:79], a[224:227]
ds_read_b64_tr_b16 a[192:193], v4 offset:17408
v_cvt_pk_bf16_f32 v52, v30, v31
v_mfma_f32_16x16x32_bf16 a[224:227], a[196:199], v[40:43], a[224:227]
ds_read_b64_tr_b16 a[194:195], v4 offset:21504
v_add_f32 v27, v30, v31
v_mfma_f32_16x16x32_bf16 a[228:231], a[200:203], v[68:71], a[228:231]
s_waitcnt lgkmcnt(4)
v_exp_f32 v20, v102
v_mfma_f32_16x16x32_bf16 a[228:231], a[204:207], v[32:35], a[228:231]
ds_read_b64_tr_b16 a[196:197], v4 offset:25600
v_add_f32 v27, v27, v20
v_mfma_f32_16x16x32_bf16 a[232:235], a[200:203], v[72:75], a[232:235]
s_add_u32 s89, s75, s86
ds_read_b64_tr_b16 a[198:199], v4 offset:29696
v_fma_f32 v85, v85, s24, v13
v_mfma_f32_16x16x32_bf16 a[232:235], a[204:207], v[36:39], a[232:235]
buffer_store_dwordx4 a[52:55], v8, s[20:23], s89 offen nt
v_mfma_f32_16x16x32_bf16 a[236:239], a[200:203], v[76:79], a[236:239]
ds_read_b64_tr_b16 a[200:201], v5 offset:17408
v_fma_f32 v86, v86, s24, v13
v_mfma_f32_16x16x32_bf16 a[236:239], a[204:207], v[40:43], a[236:239]
ds_read_b64_tr_b16 a[202:203], v5 offset:21504
v_fma_f32 v87, v87, s24, v13
v_mfma_f32_16x16x32_bf16 a[240:243], a[208:211], v[68:71], a[240:243]
s_waitcnt lgkmcnt(4)
v_exp_f32 v21, v103
v_mfma_f32_16x16x32_bf16 a[240:243], a[212:215], v[32:35], a[240:243]
ds_read_b64_tr_b16 a[204:205], v5 offset:25600
v_cvt_pk_bf16_f32 v53, v20, v21
v_mfma_f32_16x16x32_bf16 a[244:247], a[208:211], v[72:75], a[244:247]
ds_read_b64_tr_b16 a[206:207], v5 offset:29696
v_add_f32 v27, v27, v21
v_mfma_f32_16x16x32_bf16 a[244:247], a[212:215], v[36:39], a[244:247]
v_exp_f32 v28, v80
v_mfma_f32_16x16x32_bf16 a[248:251], a[208:211], v[76:79], a[248:251]
ds_read_b64_tr_b16 a[208:209], v6 offset:17408
v_add_f32 v24, v24, v28
v_mfma_f32_16x16x32_bf16 a[248:251], a[212:215], v[40:43], a[248:251]
s_add_u32 s89, s75, s87
ds_read_b64_tr_b16 a[210:211], v6 offset:21504
v_fma_f32 v88, v88, s24, v15
v_mfma_f32_16x16x32_bf16 a[252:255], a[192:195], v[68:71], a[252:255]
s_waitcnt lgkmcnt(4)
buffer_store_dwordx4 a[76:79], v8, s[20:23], s89 offen nt
v_mfma_f32_16x16x32_bf16 a[252:255], a[196:199], v[32:35], a[252:255]
ds_read_b64_tr_b16 a[212:213], v6 offset:25600
v_fma_f32 v89, v89, s24, v15
v_mfma_f32_16x16x32_bf16 v[224:227], a[192:195], v[72:75], v[224:227]
ds_read_b64_tr_b16 a[214:215], v6 offset:29696
v_fma_f32 v90, v90, s24, v15
v_mfma_f32_16x16x32_bf16 v[224:227], a[196:199], v[36:39], v[224:227]
v_exp_f32 v29, v81
v_mfma_f32_16x16x32_bf16 v[228:231], a[192:195], v[76:79], v[228:231]
v_exp_f32 v30, v82
PADJ_11:
s_cbranch_execz PADJ_15
v_mfma_f32_16x16x32_bf16 v[228:231], a[196:199], v[40:43], v[228:231]
v_exp_f32 v31, v83
v_mfma_f32_16x16x32_bf16 v[232:235], a[200:203], v[68:71], v[232:235]
s_waitcnt lgkmcnt(2)
v_exp_f32 v20, v84
v_mfma_f32_16x16x32_bf16 v[232:235], a[204:207], v[32:35], v[232:235]
v_exp_f32 v21, v85
v_mfma_f32_16x16x32_bf16 v[236:239], a[200:203], v[72:75], v[236:239]
v_cvt_pk_bf16_f32 v46, v28, v29
v_add_f32 v24, v24, v29
v_mfma_f32_16x16x32_bf16 v[236:239], a[204:207], v[36:39], v[236:239]
s_waitcnt vmcnt(22) lgkmcnt(0)
v_exp_f32 v28, v86
v_mfma_f32_16x16x32_bf16 v[240:243], a[200:203], v[76:79], v[240:243]
s_barrier
v_cvt_pk_bf16_f32 v47, v30, v31
v_mfma_f32_16x16x32_bf16 v[240:243], a[204:207], v[40:43], v[240:243]
ds_read_b128 a[192:195], v1 offset:0
v_add_f32 v24, v24, v30
v_mfma_f32_16x16x32_bf16 v[244:247], a[208:211], v[68:71], v[244:247]
ds_read_b128 a[196:199], v2 offset:0
v_add_f32 v24, v24, v31
v_mfma_f32_16x16x32_bf16 v[244:247], a[212:215], v[32:35], v[244:247]
ds_read_b128 a[200:203], v1 offset:1024
v_cvt_pk_bf16_f32 v50, v20, v21
v_mfma_f32_16x16x32_bf16 v[248:251], a[208:211], v[72:75], v[248:251]
s_mov_b32 m0, s37
ds_read_b128 a[204:207], v2 offset:1024
v_add_f32 v26, v26, v20
v_mfma_f32_16x16x32_bf16 v[248:251], a[212:215], v[36:39], v[248:251]
s_addk_i32 s81, 2048
v_exp_f32 v29, v87
v_mfma_f32_16x16x32_bf16 v[252:255], a[208:211], v[76:79], v[252:255]
s_add_u32 s90, s81, s94
ds_read_b128 a[208:211], v1 offset:2048
v_add_f32 v26, v26, v21
v_mfma_f32_16x16x32_bf16 v[252:255], a[212:215], v[40:43], v[252:255]
s_waitcnt lgkmcnt(4)
ds_read_b128 a[212:215], v2 offset:2048
v_cvt_pk_bf16_f32 v51, v28, v29
v_mfma_f32_16x16x32_bf16 v[32:35], a[192:195], a[96:99], 0
s_waitcnt lgkmcnt(4)
buffer_load_dwordx4 v7, s[16:19], s90 offen offset:0 nt lds
v_mfma_f32_16x16x32_bf16 v[32:35], a[196:199], a[108:111], v[32:35]
v_exp_f32 v30, v88
v_mfma_f32_16x16x32_bf16 v[36:39], a[192:195], a[100:103], 0
v_exp_f32 v31, v89
v_mfma_f32_16x16x32_bf16 v[36:39], a[196:199], a[112:115], v[36:39]
v_exp_f32 v20, v90
v_mfma_f32_16x16x32_bf16 v[40:43], a[192:195], a[104:107], 0
ds_read_b128 a[192:195], v1 offset:3072
v_add_f32 v26, v26, v28
v_mfma_f32_16x16x32_bf16 v[40:43], a[196:199], a[116:119], v[40:43]
s_waitcnt lgkmcnt(1)
ds_read_b128 a[196:199], v2 offset:3072
v_add_f32 v26, v26, v29
v_mfma_f32_16x16x32_bf16 v[32:35], a[200:203], a[120:123], v[32:35]
s_add_u32 s91, s81, s95
v_fma_f32 v91, v91, s24, v15
v_cvt_pk_bf16_f32 v54, v30, v31
v_mfma_f32_16x16x32_bf16 v[32:35], a[204:207], a[132:135], v[32:35]
buffer_load_dwordx4 v7, s[16:19], s91 offen offset:1024 nt lds
v_mfma_f32_16x16x32_bf16 v[36:39], a[200:203], a[124:127], v[36:39]
v_exp_f32 v21, v91
v_mfma_f32_16x16x32_bf16 v[36:39], a[204:207], a[136:139], v[36:39]
v_add_f32 v27, v27, v30
v_add_f32 v27, v27, v31
v_mfma_f32_16x16x32_bf16 v[40:43], a[200:203], a[128:131], v[40:43]
ds_read_b128 a[200:203], v1 offset:8192
v_cvt_pk_bf16_f32 v55, v20, v21
v_mfma_f32_16x16x32_bf16 v[40:43], a[204:207], a[140:143], v[40:43]
ds_read_b128 a[204:207], v2 offset:8192
v_add_f32 v27, v27, v20
v_mfma_f32_16x16x32_bf16 v[32:35], a[208:211], a[144:147], v[32:35]
v_add_f32 v27, v27, v21
v_max3_f32 v25, v24, v26, v27
v_mfma_f32_16x16x32_bf16 v[32:35], a[212:215], a[156:159], v[32:35]
v_cmp_lt_f32 vcc, s25, v25
v_mfma_f32_16x16x32_bf16 v[36:39], a[208:211], a[148:151], v[36:39]
v_mfma_f32_16x16x32_bf16 v[36:39], a[212:215], a[160:163], v[36:39]
v_mfma_f32_16x16x32_bf16 v[40:43], a[208:211], a[152:155], v[40:43]
s_addk_i32 s90, 2048
ds_read_b128 a[208:211], v1 offset:9216
v_mfma_f32_16x16x32_bf16 v[40:43], a[212:215], a[164:167], v[40:43]
s_waitcnt lgkmcnt(1)
ds_read_b128 a[212:215], v2 offset:9216
v_mfma_f32_16x16x32_bf16 v[32:35], a[192:195], a[168:171], v[32:35]
buffer_load_dwordx4 v7, s[16:19], s90 offen offset:2048 nt lds
v_mfma_f32_16x16x32_bf16 v[32:35], a[196:199], a[180:183], v[32:35]
v_mfma_f32_16x16x32_bf16 v[36:39], a[192:195], a[172:175], v[36:39]
v_mfma_f32_16x16x32_bf16 v[36:39], a[196:199], a[184:187], v[36:39]
s_cbranch_vccnz STUB_23
BACK_23:
v_mfma_f32_16x16x32_bf16 v[40:43], a[192:195], a[176:179], v[40:43]
ds_read_b128 a[192:195], v1 offset:10240
v_add_f32 v19, v19, v27
v_mfma_f32_16x16x32_bf16 v[40:43], a[196:199], a[188:191], v[40:43]
ds_read_b128 a[196:199], v2 offset:10240
v_add_f32 v17, v17, v24
v_mfma_f32_16x16x32_bf16 v[80:83], a[200:203], a[96:99], 0
s_addk_i32 s91, 2048
v_add_f32 v18, v18, v26
v_fma_f32 v32, v32, s24, v11
v_mfma_f32_16x16x32_bf16 v[80:83], a[204:207], a[108:111], v[80:83]
buffer_load_dwordx4 v7, s[16:19], s91 offen offset:3072 nt lds
v_mfma_f32_16x16x32_bf16 v[84:87], a[200:203], a[100:103], 0
v_exp_f32 v28, v32
v_mfma_f32_16x16x32_bf16 v[84:87], a[204:207], a[112:115], v[84:87]
v_fma_f32 v33, v33, s24, v11
v_fma_f32 v34, v34, s24, v11
v_mfma_f32_16x16x32_bf16 v[88:91], a[200:203], a[104:107], 0
ds_read_b128 a[200:203], v1 offset:11264
v_fma_f32 v35, v35, s24, v11
v_mfma_f32_16x16x32_bf16 v[88:91], a[204:207], a[116:119], v[88:91]
s_waitcnt lgkmcnt(1)
ds_read_b128 a[204:207], v2 offset:11264
v_fma_f32 v36, v36, s24, v13
v_mfma_f32_16x16x32_bf16 v[80:83], a[208:211], a[120:123], v[80:83]
v_exp_f32 v29, v33
v_mfma_f32_16x16x32_bf16 v[80:83], a[212:215], a[132:135], v[80:83]
s_mov_b32 m0, s35
v_exp_f32 v30, v34
v_mfma_f32_16x16x32_bf16 v[84:87], a[208:211], a[124:127], v[84:87]
s_add_u32 s90, s67, s92
v_exp_f32 v31, v35
v_mfma_f32_16x16x32_bf16 v[84:87], a[212:215], a[136:139], v[84:87]
buffer_load_dwordx4 v7, s[12:15], s90 offen offset:0 nt lds
v_mfma_f32_16x16x32_bf16 v[88:91], a[208:211], a[128:131], v[88:91]
ds_read_b64_tr_b16 a[208:209], v3 offset:32768
v_cvt_pk_bf16_f32 v68, v28, v29
v_mfma_f32_16x16x32_bf16 v[88:91], a[212:215], a[140:143], v[88:91]
ds_read_b64_tr_b16 a[210:211], v3 offset:36864
v_add_f32 v24, v28, v29
v_mfma_f32_16x16x32_bf16 v[80:83], a[192:195], a[144:147], v[80:83]
v_exp_f32 v20, v36
v_mfma_f32_16x16x32_bf16 v[80:83], a[196:199], a[156:159], v[80:83]
ds_read_b64_tr_b16 a[212:213], v3 offset:40960
v_cvt_pk_bf16_f32 v69, v30, v31
v_mfma_f32_16x16x32_bf16 v[84:87], a[192:195], a[148:151], v[84:87]
ds_read_b64_tr_b16 a[214:215], v3 offset:45056
v_add_f32 v24, v24, v30
v_mfma_f32_16x16x32_bf16 v[84:87], a[196:199], a[160:163], v[84:87]
v_add_f32 v24, v24, v31
v_fma_f32 v37, v37, s24, v13
v_mfma_f32_16x16x32_bf16 v[88:91], a[192:195], a[152:155], v[88:91]
s_add_u32 s90, s67, s93
ds_read_b64_tr_b16 a[192:193], v4 offset:32768
v_fma_f32 v38, v38, s24, v13
v_mfma_f32_16x16x32_bf16 v[88:91], a[196:199], a[164:167], v[88:91]
s_waitcnt lgkmcnt(3)
ds_read_b64_tr_b16 a[194:195], v4 offset:36864
v_fma_f32 v39, v39, s24, v13
v_mfma_f32_16x16x32_bf16 v[80:83], a[200:203], a[168:171], v[80:83]
buffer_load_dwordx4 v7, s[12:15], s90 offen offset:1024 nt lds
v_mfma_f32_16x16x32_bf16 v[80:83], a[204:207], a[180:183], v[80:83]
ds_read_b64_tr_b16 a[196:197], v4 offset:40960
v_fma_f32 v40, v40, s24, v15
v_mfma_f32_16x16x32_bf16 v[84:87], a[200:203], a[172:175], v[84:87]
ds_read_b64_tr_b16 a[198:199], v4 offset:45056
v_fma_f32 v41, v41, s24, v15
v_mfma_f32_16x16x32_bf16 v[84:87], a[204:207], a[184:187], v[84:87]
v_exp_f32 v21, v37
v_mfma_f32_16x16x32_bf16 v[88:91], a[200:203], a[176:179], v[88:91]
ds_read_b64_tr_b16 a[200:201], v5 offset:32768
v_cvt_pk_bf16_f32 v72, v20, v21
v_mfma_f32_16x16x32_bf16 v[88:91], a[204:207], a[188:191], v[88:91]
ds_read_b64_tr_b16 a[202:203], v5 offset:36864
v_add_f32 v26, v20, v21
v_mfma_f32_16x16x32_bf16 v[104:107], a[208:211], v[56:59], v[104:107]
s_waitcnt lgkmcnt(4)
v_exp_f32 v28, v38
v_mfma_f32_16x16x32_bf16 v[104:107], a[212:215], v[44:47], v[104:107]
ds_read_b64_tr_b16 a[204:205], v5 offset:40960
v_add_f32 v26, v26, v28
v_mfma_f32_16x16x32_bf16 v[108:111], a[208:211], v[60:63], v[108:111]
s_add_u32 s90, s67, s94
ds_read_b64_tr_b16 a[206:207], v5 offset:45056
v_fma_f32 v42, v42, s24, v15
v_mfma_f32_16x16x32_bf16 v[108:111], a[212:215], v[48:51], v[108:111]
buffer_load_dwordx4 v7, s[12:15], s90 offen offset:2048 nt lds
v_mfma_f32_16x16x32_bf16 v[112:115], a[208:211], v[64:67], v[112:115]
ds_read_b64_tr_b16 a[208:209], v6 offset:32768
v_fma_f32 v43, v43, s24, v15
v_mfma_f32_16x16x32_bf16 v[112:115], a[212:215], v[52:55], v[112:115]
ds_read_b64_tr_b16 a[210:211], v6 offset:36864
v_fma_f32 v80, v80, s24, v11
v_mfma_f32_16x16x32_bf16 v[116:119], a[192:195], v[56:59], v[116:119]
s_waitcnt lgkmcnt(4)
v_exp_f32 v29, v39
v_mfma_f32_16x16x32_bf16 v[116:119], a[196:199], v[44:47], v[116:119]
ds_read_b64_tr_b16 a[212:213], v6 offset:40960
v_cvt_pk_bf16_f32 v73, v28, v29
v_mfma_f32_16x16x32_bf16 v[120:123], a[192:195], v[60:63], v[120:123]
ds_read_b64_tr_b16 a[214:215], v6 offset:45056
v_add_f32 v26, v26, v29
v_mfma_f32_16x16x32_bf16 v[120:123], a[196:199], v[48:51], v[120:123]
v_exp_f32 v30, v40
v_mfma_f32_16x16x32_bf16 v[124:127], a[192:195], v[64:67], v[124:127]
ds_read_b64_tr_b16 a[192:193], v3 offset:33792
v_fma_f32 v81, v81, s24, v11
v_mfma_f32_16x16x32_bf16 v[124:127], a[196:199], v[52:55], v[124:127]
s_add_u32 s90, s67, s95
ds_read_b64_tr_b16 a[194:195], v3 offset:37888
v_fma_f32 v82, v82, s24, v11
v_mfma_f32_16x16x32_bf16 v[128:131], a[200:203], v[56:59], v[128:131]
s_waitcnt lgkmcnt(4)
buffer_load_dwordx4 v7, s[12:15], s90 offen offset:3072 nt lds
v_mfma_f32_16x16x32_bf16 v[128:131], a[204:207], v[44:47], v[128:131]
ds_read_b64_tr_b16 a[196:197], v3 offset:41984
v_fma_f32 v83, v83, s24, v11
v_mfma_f32_16x16x32_bf16 v[132:135], a[200:203], v[60:63], v[132:135]
ds_read_b64_tr_b16 a[198:199], v3 offset:46080
v_fma_f32 v84, v84, s24, v13
v_mfma_f32_16x16x32_bf16 v[132:135], a[204:207], v[48:51], v[132:135]
v_exp_f32 v31, v41
v_mfma_f32_16x16x32_bf16 v[136:139], a[200:203], v[64:67], v[136:139]
ds_read_b64_tr_b16 a[200:201], v4 offset:33792
v_cvt_pk_bf16_f32 v76, v30, v31
v_mfma_f32_16x16x32_bf16 v[136:139], a[204:207], v[52:55], v[136:139]
ds_read_b64_tr_b16 a[202:203], v4 offset:37888
v_add_f32 v27, v30, v31
v_mfma_f32_16x16x32_bf16 v[140:143], a[208:211], v[56:59], v[140:143]
s_waitcnt lgkmcnt(4)
v_exp_f32 v20, v42
v_mfma_f32_16x16x32_bf16 v[140:143], a[212:215], v[44:47], v[140:143]
ds_read_b64_tr_b16 a[204:205], v4 offset:41984
v_add_f32 v27, v27, v20
v_mfma_f32_16x16x32_bf16 v[144:147], a[208:211], v[60:63], v[144:147]
s_add_u32 s89, s27, s86
ds_read_b64_tr_b16 a[206:207], v4 offset:46080
v_fma_f32 v85, v85, s24, v13
v_mfma_f32_16x16x32_bf16 v[144:147], a[212:215], v[48:51], v[144:147]
buffer_store_dwordx4 a[56:59], v8, s[20:23], s89 offen nt
v_mfma_f32_16x16x32_bf16 v[148:151], a[208:211], v[64:67], v[148:151]
ds_read_b64_tr_b16 a[208:209], v5 offset:33792
v_fma_f32 v86, v86, s24, v13
v_mfma_f32_16x16x32_bf16 v[148:151], a[212:215], v[52:55], v[148:151]
ds_read_b64_tr_b16 a[210:211], v5 offset:37888
v_fma_f32 v87, v87, s24, v13
v_mfma_f32_16x16x32_bf16 v[152:155], a[192:195], v[56:59], v[152:155]
s_waitcnt lgkmcnt(4)
v_exp_f32 v21, v43
v_mfma_f32_16x16x32_bf16 v[152:155], a[196:199], v[44:47], v[152:155]
ds_read_b64_tr_b16 a[212:213], v5 offset:41984
v_cvt_pk_bf16_f32 v77, v20, v21
v_mfma_f32_16x16x32_bf16 v[156:159], a[192:195], v[60:63], v[156:159]
ds_read_b64_tr_b16 a[214:215], v5 offset:46080
v_add_f32 v27, v27, v21
v_mfma_f32_16x16x32_bf16 v[156:159], a[196:199], v[48:51], v[156:159]
v_exp_f32 v28, v80
v_mfma_f32_16x16x32_bf16 v[160:163], a[192:195], v[64:67], v[160:163]
ds_read_b64_tr_b16 a[192:193], v6 offset:33792
v_add_f32 v24, v24, v28
v_mfma_f32_16x16x32_bf16 v[160:163], a[196:199], v[52:55], v[160:163]
s_add_u32 s89, s27, s87
ds_read_b64_tr_b16 a[194:195], v6 offset:37888
v_fma_f32 v88, v88, s24, v15
v_mfma_f32_16x16x32_bf16 v[164:167], a[200:203], v[56:59], v[164:167]
s_waitcnt lgkmcnt(4)
buffer_store_dwordx4 a[80:83], v8, s[20:23], s89 offen nt
v_mfma_f32_16x16x32_bf16 v[164:167], a[204:207], v[44:47], v[164:167]
ds_read_b64_tr_b16 a[196:197], v6 offset:41984
v_fma_f32 v89, v89, s24, v15
v_mfma_f32_16x16x32_bf16 v[168:171], a[200:203], v[60:63], v[168:171]
ds_read_b64_tr_b16 a[198:199], v6 offset:46080
v_fma_f32 v90, v90, s24, v15
v_mfma_f32_16x16x32_bf16 v[168:171], a[204:207], v[48:51], v[168:171]
v_exp_f32 v29, v81
v_mfma_f32_16x16x32_bf16 v[172:175], a[200:203], v[64:67], v[172:175]
v_exp_f32 v30, v82
v_mfma_f32_16x16x32_bf16 v[172:175], a[204:207], v[52:55], v[172:175]
v_exp_f32 v31, v83
v_mfma_f32_16x16x32_bf16 v[176:179], a[208:211], v[56:59], v[176:179]
s_waitcnt lgkmcnt(2)
v_exp_f32 v20, v84
v_mfma_f32_16x16x32_bf16 v[176:179], a[212:215], v[44:47], v[176:179]
v_exp_f32 v21, v85
v_mfma_f32_16x16x32_bf16 v[180:183], a[208:211], v[60:63], v[180:183]
v_cvt_pk_bf16_f32 v70, v28, v29
v_add_f32 v24, v24, v29
v_mfma_f32_16x16x32_bf16 v[180:183], a[212:215], v[48:51], v[180:183]
s_waitcnt vmcnt(22) lgkmcnt(0)
v_exp_f32 v28, v86
v_mfma_f32_16x16x32_bf16 v[184:187], a[208:211], v[64:67], v[184:187]
s_barrier
v_cvt_pk_bf16_f32 v71, v30, v31
v_mfma_f32_16x16x32_bf16 v[184:187], a[212:215], v[52:55], v[184:187]
ds_read_b128 a[200:203], v1 offset:16384
v_add_f32 v24, v24, v30
v_mfma_f32_16x16x32_bf16 v[188:191], a[192:195], v[56:59], v[188:191]
ds_read_b128 a[204:207], v2 offset:16384
v_add_f32 v24, v24, v31
v_mfma_f32_16x16x32_bf16 v[188:191], a[196:199], v[44:47], v[188:191]
ds_read_b128 a[208:211], v1 offset:17408
v_cvt_pk_bf16_f32 v74, v20, v21
v_mfma_f32_16x16x32_bf16 v[192:195], a[192:195], v[60:63], v[192:195]
s_mov_b32 m0, s38
ds_read_b128 a[212:215], v2 offset:17408
v_add_f32 v26, v26, v20
v_mfma_f32_16x16x32_bf16 v[192:195], a[196:199], v[48:51], v[192:195]
s_bitcmp1_b32 s3, 1
s_cselect_b32 s81, s67, s66
v_add_f32 v26, v26, v21
v_mfma_f32_16x16x32_bf16 v[196:199], a[192:195], v[64:67], v[196:199]
s_add_u32 s90, s81, s92
ds_read_b128 a[192:195], v1 offset:18432
v_add_f32 v26, v26, v28
v_mfma_f32_16x16x32_bf16 v[196:199], a[196:199], v[52:55], v[196:199]
s_waitcnt lgkmcnt(4)
ds_read_b128 a[196:199], v2 offset:18432
v_fma_f32 v91, v91, s24, v15
v_mfma_f32_16x16x32_bf16 v[92:95], a[200:203], a[96:99], 0
s_waitcnt lgkmcnt(4)
buffer_load_dwordx4 v7, s[16:19], s90 offen offset:0 nt lds
v_mfma_f32_16x16x32_bf16 v[92:95], a[204:207], a[108:111], v[92:95]
v_exp_f32 v29, v87
v_mfma_f32_16x16x32_bf16 v[96:99], a[200:203], a[100:103], 0
v_exp_f32 v30, v88
v_mfma_f32_16x16x32_bf16 v[96:99], a[204:207], a[112:115], v[96:99]
v_exp_f32 v31, v89
v_mfma_f32_16x16x32_bf16 v[100:103], a[200:203], a[104:107], 0
ds_read_b128 a[200:203], v1 offset:19456
v_cvt_pk_bf16_f32 v75, v28, v29
v_mfma_f32_16x16x32_bf16 v[100:103], a[204:207], a[116:119], v[100:103]
s_waitcnt lgkmcnt(1)
ds_read_b128 a[204:207], v2 offset:19456
v_add_f32 v26, v26, v29
v_mfma_f32_16x16x32_bf16 v[92:95], a[208:211], a[120:123], v[92:95]
s_add_u32 s91, s81, s93
v_exp_f32 v20, v90
v_mfma_f32_16x16x32_bf16 v[92:95], a[212:215], a[132:135], v[92:95]
buffer_load_dwordx4 v7, s[16:19], s91 offen offset:1024 nt lds
v_mfma_f32_16x16x32_bf16 v[96:99], a[208:211], a[124:127], v[96:99]
v_exp_f32 v21, v91
v_mfma_f32_16x16x32_bf16 v[96:99], a[212:215], a[136:139], v[96:99]
v_cvt_pk_bf16_f32 v78, v30, v31
v_add_f32 v27, v27, v30
v_mfma_f32_16x16x32_bf16 v[100:103], a[208:211], a[128:131], v[100:103]
ds_read_b128 a[208:211], v1 offset:24576
v_add_f32 v27, v27, v31
v_mfma_f32_16x16x32_bf16 v[100:103], a[212:215], a[140:143], v[100:103]
ds_read_b128 a[212:215], v2 offset:24576
v_cvt_pk_bf16_f32 v79, v20, v21
v_mfma_f32_16x16x32_bf16 v[92:95], a[192:195], a[144:147], v[92:95]
v_add_f32 v27, v27, v20
v_add_f32 v27, v27, v21
v_mfma_f32_16x16x32_bf16 v[92:95], a[196:199], a[156:159], v[92:95]
v_max3_f32 v25, v24, v26, v27
v_cmp_lt_f32 vcc, s25, v25
v_mfma_f32_16x16x32_bf16 v[96:99], a[192:195], a[148:151], v[96:99]
v_mfma_f32_16x16x32_bf16 v[96:99], a[196:199], a[160:163], v[96:99]
v_mfma_f32_16x16x32_bf16 v[100:103], a[192:195], a[152:155], v[100:103]
s_addk_i32 s90, 2048
ds_read_b128 a[192:195], v1 offset:25600
v_mfma_f32_16x16x32_bf16 v[100:103], a[196:199], a[164:167], v[100:103]
s_waitcnt lgkmcnt(1)
ds_read_b128 a[196:199], v2 offset:25600
v_mfma_f32_16x16x32_bf16 v[92:95], a[200:203], a[168:171], v[92:95]
buffer_load_dwordx4 v7, s[16:19], s90 offen offset:2048 nt lds
v_mfma_f32_16x16x32_bf16 v[92:95], a[204:207], a[180:183], v[92:95]
v_mfma_f32_16x16x32_bf16 v[96:99], a[200:203], a[172:175], v[96:99]
v_mfma_f32_16x16x32_bf16 v[96:99], a[204:207], a[184:187], v[96:99]
s_cbranch_vccnz STUB_24
BACK_24:
v_mfma_f32_16x16x32_bf16 v[100:103], a[200:203], a[176:179], v[100:103]
ds_read_b128 a[200:203], v1 offset:26624
v_add_f32 v19, v19, v27
v_mfma_f32_16x16x32_bf16 v[100:103], a[204:207], a[188:191], v[100:103]
ds_read_b128 a[204:207], v2 offset:26624
v_add_f32 v17, v17, v24
v_mfma_f32_16x16x32_bf16 v[80:83], a[208:211], a[96:99], 0
s_addk_i32 s91, 2048
v_add_f32 v18, v18, v26
v_fma_f32 v92, v92, s24, v11
v_mfma_f32_16x16x32_bf16 v[80:83], a[212:215], a[108:111], v[80:83]
buffer_load_dwordx4 v7, s[16:19], s91 offen offset:3072 nt lds
v_mfma_f32_16x16x32_bf16 v[84:87], a[208:211], a[100:103], 0
v_exp_f32 v28, v92
v_mfma_f32_16x16x32_bf16 v[84:87], a[212:215], a[112:115], v[84:87]
v_fma_f32 v93, v93, s24, v11
v_fma_f32 v94, v94, s24, v11
v_mfma_f32_16x16x32_bf16 v[88:91], a[208:211], a[104:107], 0
ds_read_b128 a[208:211], v1 offset:27648
v_fma_f32 v95, v95, s24, v11
v_mfma_f32_16x16x32_bf16 v[88:91], a[212:215], a[116:119], v[88:91]
s_waitcnt lgkmcnt(1)
ds_read_b128 a[212:215], v2 offset:27648
v_fma_f32 v96, v96, s24, v13
v_mfma_f32_16x16x32_bf16 v[80:83], a[192:195], a[120:123], v[80:83]
v_exp_f32 v29, v93
v_mfma_f32_16x16x32_bf16 v[80:83], a[196:199], a[132:135], v[80:83]
s_mov_b32 m0, s32
v_exp_f32 v30, v94
v_mfma_f32_16x16x32_bf16 v[84:87], a[192:195], a[124:127], v[84:87]
s_add_u32 s90, s68, s92
v_exp_f32 v31, v95
v_mfma_f32_16x16x32_bf16 v[84:87], a[196:199], a[136:139], v[84:87]
buffer_load_dwordx4 v7, s[12:15], s90 offen offset:0 nt lds
v_mfma_f32_16x16x32_bf16 v[88:91], a[192:195], a[128:131], v[88:91]
ds_read_b64_tr_b16 a[192:193], v3 offset:49152
v_cvt_pk_bf16_f32 v32, v28, v29
v_mfma_f32_16x16x32_bf16 v[88:91], a[196:199], a[140:143], v[88:91]
ds_read_b64_tr_b16 a[194:195], v3 offset:53248
v_add_f32 v24, v28, v29
v_mfma_f32_16x16x32_bf16 v[80:83], a[200:203], a[144:147], v[80:83]
v_exp_f32 v20, v96
v_mfma_f32_16x16x32_bf16 v[80:83], a[204:207], a[156:159], v[80:83]
ds_read_b64_tr_b16 a[196:197], v3 offset:57344
v_cvt_pk_bf16_f32 v33, v30, v31
v_mfma_f32_16x16x32_bf16 v[84:87], a[200:203], a[148:151], v[84:87]
ds_read_b64_tr_b16 a[198:199], v3 offset:61440
v_add_f32 v24, v24, v30
v_mfma_f32_16x16x32_bf16 v[84:87], a[204:207], a[160:163], v[84:87]
v_add_f32 v24, v24, v31
v_fma_f32 v97, v97, s24, v13
v_mfma_f32_16x16x32_bf16 v[88:91], a[200:203], a[152:155], v[88:91]
s_add_u32 s90, s68, s93
ds_read_b64_tr_b16 a[200:201], v4 offset:49152
v_fma_f32 v98, v98, s24, v13
v_mfma_f32_16x16x32_bf16 v[88:91], a[204:207], a[164:167], v[88:91]
s_waitcnt lgkmcnt(3)
ds_read_b64_tr_b16 a[202:203], v4 offset:53248
v_fma_f32 v99, v99, s24, v13
v_mfma_f32_16x16x32_bf16 v[80:83], a[208:211], a[168:171], v[80:83]
buffer_load_dwordx4 v7, s[12:15], s90 offen offset:1024 nt lds
v_mfma_f32_16x16x32_bf16 v[80:83], a[212:215], a[180:183], v[80:83]
ds_read_b64_tr_b16 a[204:205], v4 offset:57344
v_fma_f32 v100, v100, s24, v15
v_mfma_f32_16x16x32_bf16 v[84:87], a[208:211], a[172:175], v[84:87]
ds_read_b64_tr_b16 a[206:207], v4 offset:61440
v_fma_f32 v101, v101, s24, v15
v_mfma_f32_16x16x32_bf16 v[84:87], a[212:215], a[184:187], v[84:87]
v_exp_f32 v21, v97
v_mfma_f32_16x16x32_bf16 v[88:91], a[208:211], a[176:179], v[88:91]
ds_read_b64_tr_b16 a[208:209], v5 offset:49152
v_cvt_pk_bf16_f32 v36, v20, v21
v_mfma_f32_16x16x32_bf16 v[88:91], a[212:215], a[188:191], v[88:91]
ds_read_b64_tr_b16 a[210:211], v5 offset:53248
v_add_f32 v26, v20, v21
v_mfma_f32_16x16x32_bf16 v[200:203], a[192:195], v[56:59], v[200:203]
s_waitcnt lgkmcnt(4)
v_exp_f32 v28, v98
v_mfma_f32_16x16x32_bf16 v[200:203], a[196:199], v[44:47], v[200:203]
ds_read_b64_tr_b16 a[212:213], v5 offset:57344
v_add_f32 v26, v26, v28
v_mfma_f32_16x16x32_bf16 v[204:207], a[192:195], v[60:63], v[204:207]
s_add_u32 s90, s68, s94
ds_read_b64_tr_b16 a[214:215], v5 offset:61440
v_fma_f32 v102, v102, s24, v15
v_mfma_f32_16x16x32_bf16 v[204:207], a[196:199], v[48:51], v[204:207]
buffer_load_dwordx4 v7, s[12:15], s90 offen offset:2048 nt lds
v_mfma_f32_16x16x32_bf16 v[208:211], a[192:195], v[64:67], v[208:211]
ds_read_b64_tr_b16 a[192:193], v6 offset:49152
v_fma_f32 v103, v103, s24, v15
v_mfma_f32_16x16x32_bf16 v[208:211], a[196:199], v[52:55], v[208:211]
ds_read_b64_tr_b16 a[194:195], v6 offset:53248
v_fma_f32 v80, v80, s24, v11
v_mfma_f32_16x16x32_bf16 v[212:215], a[200:203], v[56:59], v[212:215]
s_waitcnt lgkmcnt(4)
v_exp_f32 v29, v99
v_mfma_f32_16x16x32_bf16 v[212:215], a[204:207], v[44:47], v[212:215]
ds_read_b64_tr_b16 a[196:197], v6 offset:57344
v_cvt_pk_bf16_f32 v37, v28, v29
v_mfma_f32_16x16x32_bf16 v[216:219], a[200:203], v[60:63], v[216:219]
ds_read_b64_tr_b16 a[198:199], v6 offset:61440
v_add_f32 v26, v26, v29
v_mfma_f32_16x16x32_bf16 v[216:219], a[204:207], v[48:51], v[216:219]
v_exp_f32 v30, v100
v_mfma_f32_16x16x32_bf16 v[220:223], a[200:203], v[64:67], v[220:223]
ds_read_b64_tr_b16 a[200:201], v3 offset:50176
v_fma_f32 v81, v81, s24, v11
v_mfma_f32_16x16x32_bf16 v[220:223], a[204:207], v[52:55], v[220:223]
s_add_u32 s90, s68, s95
ds_read_b64_tr_b16 a[202:203], v3 offset:54272
v_fma_f32 v82, v82, s24, v11
v_mfma_f32_16x16x32_bf16 a[216:219], a[208:211], v[56:59], a[216:219]
s_waitcnt lgkmcnt(4)
buffer_load_dwordx4 v7, s[12:15], s90 offen offset:3072 nt lds
v_mfma_f32_16x16x32_bf16 a[216:219], a[212:215], v[44:47], a[216:219]
ds_read_b64_tr_b16 a[204:205], v3 offset:58368
v_fma_f32 v83, v83, s24, v11
v_mfma_f32_16x16x32_bf16 a[220:223], a[208:211], v[60:63], a[220:223]
ds_read_b64_tr_b16 a[206:207], v3 offset:62464
v_fma_f32 v84, v84, s24, v13
v_mfma_f32_16x16x32_bf16 a[220:223], a[212:215], v[48:51], a[220:223]
v_exp_f32 v31, v101
v_mfma_f32_16x16x32_bf16 a[224:227], a[208:211], v[64:67], a[224:227]
ds_read_b64_tr_b16 a[208:209], v4 offset:50176
v_cvt_pk_bf16_f32 v40, v30, v31
v_mfma_f32_16x16x32_bf16 a[224:227], a[212:215], v[52:55], a[224:227]
ds_read_b64_tr_b16 a[210:211], v4 offset:54272
v_add_f32 v27, v30, v31
v_mfma_f32_16x16x32_bf16 a[228:231], a[192:195], v[56:59], a[228:231]
s_waitcnt lgkmcnt(4)
v_exp_f32 v20, v102
v_mfma_f32_16x16x32_bf16 a[228:231], a[196:199], v[44:47], a[228:231]
ds_read_b64_tr_b16 a[212:213], v4 offset:58368
v_add_f32 v27, v27, v20
v_mfma_f32_16x16x32_bf16 a[232:235], a[192:195], v[60:63], a[232:235]
s_add_u32 s89, s76, s86
ds_read_b64_tr_b16 a[214:215], v4 offset:62464
v_fma_f32 v85, v85, s24, v13
v_mfma_f32_16x16x32_bf16 a[232:235], a[196:199], v[48:51], a[232:235]
buffer_store_dwordx4 a[60:63], v8, s[20:23], s89 offen nt
v_mfma_f32_16x16x32_bf16 a[236:239], a[192:195], v[64:67], a[236:239]
ds_read_b64_tr_b16 a[192:193], v5 offset:50176
v_fma_f32 v86, v86, s24, v13
v_mfma_f32_16x16x32_bf16 a[236:239], a[196:199], v[52:55], a[236:239]
ds_read_b64_tr_b16 a[194:195], v5 offset:54272
v_fma_f32 v87, v87, s24, v13
v_mfma_f32_16x16x32_bf16 a[240:243], a[200:203], v[56:59], a[240:243]
s_waitcnt lgkmcnt(4)
v_exp_f32 v21, v103
v_mfma_f32_16x16x32_bf16 a[240:243], a[204:207], v[44:47], a[240:243]
ds_read_b64_tr_b16 a[196:197], v5 offset:58368
v_cvt_pk_bf16_f32 v41, v20, v21
v_mfma_f32_16x16x32_bf16 a[244:247], a[200:203], v[60:63], a[244:247]
ds_read_b64_tr_b16 a[198:199], v5 offset:62464
v_add_f32 v27, v27, v21
v_mfma_f32_16x16x32_bf16 a[244:247], a[204:207], v[48:51], a[244:247]
v_exp_f32 v28, v80
v_mfma_f32_16x16x32_bf16 a[248:251], a[200:203], v[64:67], a[248:251]
ds_read_b64_tr_b16 a[200:201], v6 offset:50176
v_add_f32 v24, v24, v28
v_mfma_f32_16x16x32_bf16 a[248:251], a[204:207], v[52:55], a[248:251]
s_add_u32 s89, s76, s87
ds_read_b64_tr_b16 a[202:203], v6 offset:54272
v_fma_f32 v88, v88, s24, v15
v_mfma_f32_16x16x32_bf16 a[252:255], a[208:211], v[56:59], a[252:255]
s_waitcnt lgkmcnt(4)
buffer_store_dwordx4 a[84:87], v8, s[20:23], s89 offen nt
v_mfma_f32_16x16x32_bf16 a[252:255], a[212:215], v[44:47], a[252:255]
ds_read_b64_tr_b16 a[204:205], v6 offset:58368
v_fma_f32 v89, v89, s24, v15
v_mfma_f32_16x16x32_bf16 v[224:227], a[208:211], v[60:63], v[224:227]
ds_read_b64_tr_b16 a[206:207], v6 offset:62464
v_fma_f32 v90, v90, s24, v15
v_mfma_f32_16x16x32_bf16 v[224:227], a[212:215], v[48:51], v[224:227]
v_exp_f32 v29, v81
v_mfma_f32_16x16x32_bf16 v[228:231], a[208:211], v[64:67], v[228:231]
v_exp_f32 v30, v82
v_mfma_f32_16x16x32_bf16 v[228:231], a[212:215], v[52:55], v[228:231]
v_exp_f32 v31, v83
v_mfma_f32_16x16x32_bf16 v[232:235], a[192:195], v[56:59], v[232:235]
s_waitcnt lgkmcnt(2)
v_exp_f32 v20, v84
v_mfma_f32_16x16x32_bf16 v[232:235], a[196:199], v[44:47], v[232:235]
v_exp_f32 v21, v85
v_mfma_f32_16x16x32_bf16 v[236:239], a[192:195], v[60:63], v[236:239]
v_cvt_pk_bf16_f32 v34, v28, v29
v_add_f32 v24, v24, v29
v_mfma_f32_16x16x32_bf16 v[236:239], a[196:199], v[48:51], v[236:239]
s_waitcnt vmcnt(22) lgkmcnt(0)
v_exp_f32 v28, v86
v_mfma_f32_16x16x32_bf16 v[240:243], a[192:195], v[64:67], v[240:243]
s_barrier
v_cvt_pk_bf16_f32 v35, v30, v31
v_mfma_f32_16x16x32_bf16 v[240:243], a[196:199], v[52:55], v[240:243]
ds_read_b128 a[208:211], v1 offset:32768
v_add_f32 v24, v24, v30
v_mfma_f32_16x16x32_bf16 v[244:247], a[200:203], v[56:59], v[244:247]
ds_read_b128 a[212:215], v2 offset:32768
v_add_f32 v24, v24, v31
v_mfma_f32_16x16x32_bf16 v[244:247], a[204:207], v[44:47], v[244:247]
ds_read_b128 a[192:195], v1 offset:33792
v_cvt_pk_bf16_f32 v38, v20, v21
v_mfma_f32_16x16x32_bf16 v[248:251], a[200:203], v[60:63], v[248:251]
s_mov_b32 m0, s39
ds_read_b128 a[196:199], v2 offset:33792
v_add_f32 v26, v26, v20
v_mfma_f32_16x16x32_bf16 v[248:251], a[204:207], v[48:51], v[248:251]
s_addk_i32 s81, 2048
v_exp_f32 v29, v87
v_mfma_f32_16x16x32_bf16 v[252:255], a[200:203], v[64:67], v[252:255]
s_add_u32 s90, s81, s94
ds_read_b128 a[200:203], v1 offset:34816
v_add_f32 v26, v26, v21
v_mfma_f32_16x16x32_bf16 v[252:255], a[204:207], v[52:55], v[252:255]
s_waitcnt lgkmcnt(4)
ds_read_b128 a[204:207], v2 offset:34816
v_cvt_pk_bf16_f32 v39, v28, v29
v_mfma_f32_16x16x32_bf16 v[44:47], a[208:211], a[96:99], 0
s_waitcnt lgkmcnt(4)
buffer_load_dwordx4 v7, s[16:19], s90 offen offset:0 nt lds
v_mfma_f32_16x16x32_bf16 v[44:47], a[212:215], a[108:111], v[44:47]
v_exp_f32 v30, v88
v_mfma_f32_16x16x32_bf16 v[48:51], a[208:211], a[100:103], 0
v_exp_f32 v31, v89
v_mfma_f32_16x16x32_bf16 v[48:51], a[212:215], a[112:115], v[48:51]
v_exp_f32 v20, v90
v_mfma_f32_16x16x32_bf16 v[52:55], a[208:211], a[104:107], 0
ds_read_b128 a[208:211], v1 offset:35840
v_add_f32 v26, v26, v28
v_mfma_f32_16x16x32_bf16 v[52:55], a[212:215], a[116:119], v[52:55]
s_waitcnt lgkmcnt(1)
ds_read_b128 a[212:215], v2 offset:35840
v_add_f32 v26, v26, v29
v_mfma_f32_16x16x32_bf16 v[44:47], a[192:195], a[120:123], v[44:47]
s_add_u32 s91, s81, s95
v_fma_f32 v91, v91, s24, v15
v_cvt_pk_bf16_f32 v42, v30, v31
v_mfma_f32_16x16x32_bf16 v[44:47], a[196:199], a[132:135], v[44:47]
buffer_load_dwordx4 v7, s[16:19], s91 offen offset:1024 nt lds
v_mfma_f32_16x16x32_bf16 v[48:51], a[192:195], a[124:127], v[48:51]
v_exp_f32 v21, v91
PADJ_12:
s_cbranch_execz PADJ_16
v_mfma_f32_16x16x32_bf16 v[48:51], a[196:199], a[136:139], v[48:51]
v_add_f32 v27, v27, v30
v_add_f32 v27, v27, v31
v_mfma_f32_16x16x32_bf16 v[52:55], a[192:195], a[128:131], v[52:55]
ds_read_b128 a[192:195], v1 offset:40960
v_cvt_pk_bf16_f32 v43, v20, v21
v_mfma_f32_16x16x32_bf16 v[52:55], a[196:199], a[140:143], v[52:55]
ds_read_b128 a[196:199], v2 offset:40960
v_add_f32 v27, v27, v20
v_mfma_f32_16x16x32_bf16 v[44:47], a[200:203], a[144:147], v[44:47]
v_add_f32 v27, v27, v21
v_max3_f32 v25, v24, v26, v27
v_mfma_f32_16x16x32_bf16 v[44:47], a[204:207], a[156:159], v[44:47]
v_cmp_lt_f32 vcc, s25, v25
v_mfma_f32_16x16x32_bf16 v[48:51], a[200:203], a[148:151], v[48:51]
v_mfma_f32_16x16x32_bf16 v[48:51], a[204:207], a[160:163], v[48:51]
v_mfma_f32_16x16x32_bf16 v[52:55], a[200:203], a[152:155], v[52:55]
s_addk_i32 s90, 2048
ds_read_b128 a[200:203], v1 offset:41984
v_mfma_f32_16x16x32_bf16 v[52:55], a[204:207], a[164:167], v[52:55]
s_waitcnt lgkmcnt(1)
ds_read_b128 a[204:207], v2 offset:41984
v_mfma_f32_16x16x32_bf16 v[44:47], a[208:211], a[168:171], v[44:47]
buffer_load_dwordx4 v7, s[16:19], s90 offen offset:2048 nt lds
v_mfma_f32_16x16x32_bf16 v[44:47], a[212:215], a[180:183], v[44:47]
v_mfma_f32_16x16x32_bf16 v[48:51], a[208:211], a[172:175], v[48:51]
v_mfma_f32_16x16x32_bf16 v[48:51], a[212:215], a[184:187], v[48:51]
s_cbranch_vccnz STUB_25
BACK_25:
v_mfma_f32_16x16x32_bf16 v[52:55], a[208:211], a[176:179], v[52:55]
ds_read_b128 a[208:211], v1 offset:43008
v_add_f32 v19, v19, v27
v_mfma_f32_16x16x32_bf16 v[52:55], a[212:215], a[188:191], v[52:55]
ds_read_b128 a[212:215], v2 offset:43008
v_add_f32 v17, v17, v24
v_mfma_f32_16x16x32_bf16 v[80:83], a[192:195], a[96:99], 0
s_addk_i32 s91, 2048
v_add_f32 v18, v18, v26
v_fma_f32 v44, v44, s24, v11
v_mfma_f32_16x16x32_bf16 v[80:83], a[196:199], a[108:111], v[80:83]
buffer_load_dwordx4 v7, s[16:19], s91 offen offset:3072 nt lds
v_mfma_f32_16x16x32_bf16 v[84:87], a[192:195], a[100:103], 0
v_exp_f32 v28, v44
v_mfma_f32_16x16x32_bf16 v[84:87], a[196:199], a[112:115], v[84:87]
v_fma_f32 v45, v45, s24, v11
v_fma_f32 v46, v46, s24, v11
v_mfma_f32_16x16x32_bf16 v[88:91], a[192:195], a[104:107], 0
ds_read_b128 a[192:195], v1 offset:44032
v_fma_f32 v47, v47, s24, v11
v_mfma_f32_16x16x32_bf16 v[88:91], a[196:199], a[116:119], v[88:91]
s_waitcnt lgkmcnt(1)
ds_read_b128 a[196:199], v2 offset:44032
v_fma_f32 v48, v48, s24, v13
v_mfma_f32_16x16x32_bf16 v[80:83], a[200:203], a[120:123], v[80:83]
v_exp_f32 v29, v45
v_mfma_f32_16x16x32_bf16 v[80:83], a[204:207], a[132:135], v[80:83]
s_mov_b32 m0, s33
v_exp_f32 v30, v46
v_mfma_f32_16x16x32_bf16 v[84:87], a[200:203], a[124:127], v[84:87]
s_add_u32 s90, s69, s92
v_exp_f32 v31, v47
v_mfma_f32_16x16x32_bf16 v[84:87], a[204:207], a[136:139], v[84:87]
buffer_load_dwordx4 v7, s[12:15], s90 offen offset:0 nt lds
v_mfma_f32_16x16x32_bf16 v[88:91], a[200:203], a[128:131], v[88:91]
ds_read_b64_tr_b16 a[200:201], v3 offset:0
v_cvt_pk_bf16_f32 v56, v28, v29
v_mfma_f32_16x16x32_bf16 v[88:91], a[204:207], a[140:143], v[88:91]
ds_read_b64_tr_b16 a[202:203], v3 offset:4096
v_add_f32 v24, v28, v29
v_mfma_f32_16x16x32_bf16 v[80:83], a[208:211], a[144:147], v[80:83]
v_exp_f32 v20, v48
v_mfma_f32_16x16x32_bf16 v[80:83], a[212:215], a[156:159], v[80:83]
ds_read_b64_tr_b16 a[204:205], v3 offset:8192
v_cvt_pk_bf16_f32 v57, v30, v31
v_mfma_f32_16x16x32_bf16 v[84:87], a[208:211], a[148:151], v[84:87]
ds_read_b64_tr_b16 a[206:207], v3 offset:12288
v_add_f32 v24, v24, v30
v_mfma_f32_16x16x32_bf16 v[84:87], a[212:215], a[160:163], v[84:87]
v_add_f32 v24, v24, v31
v_fma_f32 v49, v49, s24, v13
v_mfma_f32_16x16x32_bf16 v[88:91], a[208:211], a[152:155], v[88:91]
s_add_u32 s90, s69, s93
ds_read_b64_tr_b16 a[208:209], v4 offset:0
v_fma_f32 v50, v50, s24, v13
v_mfma_f32_16x16x32_bf16 v[88:91], a[212:215], a[164:167], v[88:91]
s_waitcnt lgkmcnt(3)
ds_read_b64_tr_b16 a[210:211], v4 offset:4096
v_fma_f32 v51, v51, s24, v13
v_mfma_f32_16x16x32_bf16 v[80:83], a[192:195], a[168:171], v[80:83]
buffer_load_dwordx4 v7, s[12:15], s90 offen offset:1024 nt lds
v_mfma_f32_16x16x32_bf16 v[80:83], a[196:199], a[180:183], v[80:83]
ds_read_b64_tr_b16 a[212:213], v4 offset:8192
v_fma_f32 v52, v52, s24, v15
v_mfma_f32_16x16x32_bf16 v[84:87], a[192:195], a[172:175], v[84:87]
ds_read_b64_tr_b16 a[214:215], v4 offset:12288
v_fma_f32 v53, v53, s24, v15
v_mfma_f32_16x16x32_bf16 v[84:87], a[196:199], a[184:187], v[84:87]
v_exp_f32 v21, v49
v_mfma_f32_16x16x32_bf16 v[88:91], a[192:195], a[176:179], v[88:91]
ds_read_b64_tr_b16 a[192:193], v5 offset:0
v_cvt_pk_bf16_f32 v60, v20, v21
v_mfma_f32_16x16x32_bf16 v[88:91], a[196:199], a[188:191], v[88:91]
ds_read_b64_tr_b16 a[194:195], v5 offset:4096
v_add_f32 v26, v20, v21
v_mfma_f32_16x16x32_bf16 v[104:107], a[200:203], v[68:71], v[104:107]
s_waitcnt lgkmcnt(4)
v_exp_f32 v28, v50
v_mfma_f32_16x16x32_bf16 v[104:107], a[204:207], v[32:35], v[104:107]
ds_read_b64_tr_b16 a[196:197], v5 offset:8192
v_add_f32 v26, v26, v28
v_mfma_f32_16x16x32_bf16 v[108:111], a[200:203], v[72:75], v[108:111]
s_add_u32 s90, s69, s94
ds_read_b64_tr_b16 a[198:199], v5 offset:12288
v_fma_f32 v54, v54, s24, v15
v_mfma_f32_16x16x32_bf16 v[108:111], a[204:207], v[36:39], v[108:111]
buffer_load_dwordx4 v7, s[12:15], s90 offen offset:2048 nt lds
v_mfma_f32_16x16x32_bf16 v[112:115], a[200:203], v[76:79], v[112:115]
ds_read_b64_tr_b16 a[200:201], v6 offset:0
v_fma_f32 v55, v55, s24, v15
v_mfma_f32_16x16x32_bf16 v[112:115], a[204:207], v[40:43], v[112:115]
ds_read_b64_tr_b16 a[202:203], v6 offset:4096
v_fma_f32 v80, v80, s24, v11
v_mfma_f32_16x16x32_bf16 v[116:119], a[208:211], v[68:71], v[116:119]
s_waitcnt lgkmcnt(4)
v_exp_f32 v29, v51
v_mfma_f32_16x16x32_bf16 v[116:119], a[212:215], v[32:35], v[116:119]
ds_read_b64_tr_b16 a[204:205], v6 offset:8192
v_cvt_pk_bf16_f32 v61, v28, v29
v_mfma_f32_16x16x32_bf16 v[120:123], a[208:211], v[72:75], v[120:123]
ds_read_b64_tr_b16 a[206:207], v6 offset:12288
v_add_f32 v26, v26, v29
v_mfma_f32_16x16x32_bf16 v[120:123], a[212:215], v[36:39], v[120:123]
v_exp_f32 v30, v52
v_mfma_f32_16x16x32_bf16 v[124:127], a[208:211], v[76:79], v[124:127]
ds_read_b64_tr_b16 a[208:209], v3 offset:1024
v_fma_f32 v81, v81, s24, v11
v_mfma_f32_16x16x32_bf16 v[124:127], a[212:215], v[40:43], v[124:127]
s_add_u32 s90, s69, s95
ds_read_b64_tr_b16 a[210:211], v3 offset:5120
v_fma_f32 v82, v82, s24, v11
v_mfma_f32_16x16x32_bf16 v[128:131], a[192:195], v[68:71], v[128:131]
s_waitcnt lgkmcnt(4)
buffer_load_dwordx4 v7, s[12:15], s90 offen offset:3072 nt lds
v_mfma_f32_16x16x32_bf16 v[128:131], a[196:199], v[32:35], v[128:131]
ds_read_b64_tr_b16 a[212:213], v3 offset:9216
v_fma_f32 v83, v83, s24, v11
v_mfma_f32_16x16x32_bf16 v[132:135], a[192:195], v[72:75], v[132:135]
ds_read_b64_tr_b16 a[214:215], v3 offset:13312
v_fma_f32 v84, v84, s24, v13
v_mfma_f32_16x16x32_bf16 v[132:135], a[196:199], v[36:39], v[132:135]
v_exp_f32 v31, v53
v_mfma_f32_16x16x32_bf16 v[136:139], a[192:195], v[76:79], v[136:139]
ds_read_b64_tr_b16 a[192:193], v4 offset:1024
v_cvt_pk_bf16_f32 v64, v30, v31
v_mfma_f32_16x16x32_bf16 v[136:139], a[196:199], v[40:43], v[136:139]
ds_read_b64_tr_b16 a[194:195], v4 offset:5120
v_add_f32 v27, v30, v31
v_mfma_f32_16x16x32_bf16 v[140:143], a[200:203], v[68:71], v[140:143]
s_waitcnt lgkmcnt(4)
v_exp_f32 v20, v54
v_mfma_f32_16x16x32_bf16 v[140:143], a[204:207], v[32:35], v[140:143]
ds_read_b64_tr_b16 a[196:197], v4 offset:9216
v_add_f32 v27, v27, v20
v_mfma_f32_16x16x32_bf16 v[144:147], a[200:203], v[72:75], v[144:147]
s_add_u32 s89, s28, s86
ds_read_b64_tr_b16 a[198:199], v4 offset:13312
v_fma_f32 v85, v85, s24, v13
v_mfma_f32_16x16x32_bf16 v[144:147], a[204:207], v[36:39], v[144:147]
buffer_store_dwordx4 a[64:67], v8, s[20:23], s89 offen nt
v_mfma_f32_16x16x32_bf16 v[148:151], a[200:203], v[76:79], v[148:151]
ds_read_b64_tr_b16 a[200:201], v5 offset:1024
v_fma_f32 v86, v86, s24, v13
v_mfma_f32_16x16x32_bf16 v[148:151], a[204:207], v[40:43], v[148:151]
ds_read_b64_tr_b16 a[202:203], v5 offset:5120
v_fma_f32 v87, v87, s24, v13
v_mfma_f32_16x16x32_bf16 v[152:155], a[208:211], v[68:71], v[152:155]
s_waitcnt lgkmcnt(4)
v_exp_f32 v21, v55
v_mfma_f32_16x16x32_bf16 v[152:155], a[212:215], v[32:35], v[152:155]
ds_read_b64_tr_b16 a[204:205], v5 offset:9216
v_cvt_pk_bf16_f32 v65, v20, v21
v_mfma_f32_16x16x32_bf16 v[156:159], a[208:211], v[72:75], v[156:159]
ds_read_b64_tr_b16 a[206:207], v5 offset:13312
v_add_f32 v27, v27, v21
v_mfma_f32_16x16x32_bf16 v[156:159], a[212:215], v[36:39], v[156:159]
v_exp_f32 v28, v80
v_mfma_f32_16x16x32_bf16 v[160:163], a[208:211], v[76:79], v[160:163]
ds_read_b64_tr_b16 a[208:209], v6 offset:1024
v_add_f32 v24, v24, v28
v_mfma_f32_16x16x32_bf16 v[160:163], a[212:215], v[40:43], v[160:163]
s_add_u32 s89, s28, s87
ds_read_b64_tr_b16 a[210:211], v6 offset:5120
v_fma_f32 v88, v88, s24, v15
v_mfma_f32_16x16x32_bf16 v[164:167], a[192:195], v[68:71], v[164:167]
s_waitcnt lgkmcnt(4)
buffer_store_dwordx4 a[88:91], v8, s[20:23], s89 offen nt
v_mfma_f32_16x16x32_bf16 v[164:167], a[196:199], v[32:35], v[164:167]
ds_read_b64_tr_b16 a[212:213], v6 offset:9216
v_fma_f32 v89, v89, s24, v15
v_mfma_f32_16x16x32_bf16 v[168:171], a[192:195], v[72:75], v[168:171]
ds_read_b64_tr_b16 a[214:215], v6 offset:13312
v_fma_f32 v90, v90, s24, v15
v_mfma_f32_16x16x32_bf16 v[168:171], a[196:199], v[36:39], v[168:171]
v_exp_f32 v29, v81
v_mfma_f32_16x16x32_bf16 v[172:175], a[192:195], v[76:79], v[172:175]
v_exp_f32 v30, v82
v_mfma_f32_16x16x32_bf16 v[172:175], a[196:199], v[40:43], v[172:175]
v_exp_f32 v31, v83
v_mfma_f32_16x16x32_bf16 v[176:179], a[200:203], v[68:71], v[176:179]
s_waitcnt lgkmcnt(2)
v_exp_f32 v20, v84
v_mfma_f32_16x16x32_bf16 v[176:179], a[204:207], v[32:35], v[176:179]
v_exp_f32 v21, v85
v_mfma_f32_16x16x32_bf16 v[180:183], a[200:203], v[72:75], v[180:183]
v_cvt_pk_bf16_f32 v58, v28, v29
v_add_f32 v24, v24, v29
v_mfma_f32_16x16x32_bf16 v[180:183], a[204:207], v[36:39], v[180:183]
s_waitcnt vmcnt(22) lgkmcnt(0)
v_exp_f32 v28, v86
v_mfma_f32_16x16x32_bf16 v[184:187], a[200:203], v[76:79], v[184:187]
s_barrier
v_cvt_pk_bf16_f32 v59, v30, v31
v_mfma_f32_16x16x32_bf16 v[184:187], a[204:207], v[40:43], v[184:187]
ds_read_b128 a[192:195], v1 offset:49152
v_add_f32 v24, v24, v30
v_mfma_f32_16x16x32_bf16 v[188:191], a[208:211], v[68:71], v[188:191]
ds_read_b128 a[196:199], v2 offset:49152
v_add_f32 v24, v24, v31
v_mfma_f32_16x16x32_bf16 v[188:191], a[212:215], v[32:35], v[188:191]
ds_read_b128 a[200:203], v1 offset:50176
v_cvt_pk_bf16_f32 v62, v20, v21
v_mfma_f32_16x16x32_bf16 v[192:195], a[208:211], v[72:75], v[192:195]
s_mov_b32 m0, s36
ds_read_b128 a[204:207], v2 offset:50176
v_add_f32 v26, v26, v20
v_mfma_f32_16x16x32_bf16 v[192:195], a[212:215], v[36:39], v[192:195]
s_bitcmp1_b32 s3, 1
s_cselect_b32 s81, s69, s68
v_add_f32 v26, v26, v21
v_mfma_f32_16x16x32_bf16 v[196:199], a[208:211], v[76:79], v[196:199]
s_add_u32 s90, s81, s92
ds_read_b128 a[208:211], v1 offset:51200
v_add_f32 v26, v26, v28
v_mfma_f32_16x16x32_bf16 v[196:199], a[212:215], v[40:43], v[196:199]
s_waitcnt lgkmcnt(4)
ds_read_b128 a[212:215], v2 offset:51200
v_fma_f32 v91, v91, s24, v15
v_mfma_f32_16x16x32_bf16 v[92:95], a[192:195], a[96:99], 0
s_waitcnt lgkmcnt(4)
buffer_load_dwordx4 v7, s[16:19], s90 offen offset:0 nt lds
v_mfma_f32_16x16x32_bf16 v[92:95], a[196:199], a[108:111], v[92:95]
v_exp_f32 v29, v87
v_mfma_f32_16x16x32_bf16 v[96:99], a[192:195], a[100:103], 0
v_exp_f32 v30, v88
v_mfma_f32_16x16x32_bf16 v[96:99], a[196:199], a[112:115], v[96:99]
v_exp_f32 v31, v89
v_mfma_f32_16x16x32_bf16 v[100:103], a[192:195], a[104:107], 0
ds_read_b128 a[192:195], v1 offset:52224
v_cvt_pk_bf16_f32 v63, v28, v29
v_mfma_f32_16x16x32_bf16 v[100:103], a[196:199], a[116:119], v[100:103]
s_waitcnt lgkmcnt(1)
ds_read_b128 a[196:199], v2 offset:52224
v_add_f32 v26, v26, v29
v_mfma_f32_16x16x32_bf16 v[92:95], a[200:203], a[120:123], v[92:95]
s_add_u32 s91, s81, s93
v_exp_f32 v20, v90
v_mfma_f32_16x16x32_bf16 v[92:95], a[204:207], a[132:135], v[92:95]
buffer_load_dwordx4 v7, s[16:19], s91 offen offset:1024 nt lds
v_mfma_f32_16x16x32_bf16 v[96:99], a[200:203], a[124:127], v[96:99]
v_exp_f32 v21, v91
v_mfma_f32_16x16x32_bf16 v[96:99], a[204:207], a[136:139], v[96:99]
v_cvt_pk_bf16_f32 v66, v30, v31
v_add_f32 v27, v27, v30
v_mfma_f32_16x16x32_bf16 v[100:103], a[200:203], a[128:131], v[100:103]
ds_read_b128 a[200:203], v1 offset:57344
v_add_f32 v27, v27, v31
v_mfma_f32_16x16x32_bf16 v[100:103], a[204:207], a[140:143], v[100:103]
ds_read_b128 a[204:207], v2 offset:57344
v_cvt_pk_bf16_f32 v67, v20, v21
v_mfma_f32_16x16x32_bf16 v[92:95], a[208:211], a[144:147], v[92:95]
v_add_f32 v27, v27, v20
v_add_f32 v27, v27, v21
v_mfma_f32_16x16x32_bf16 v[92:95], a[212:215], a[156:159], v[92:95]
v_max3_f32 v25, v24, v26, v27
v_cmp_lt_f32 vcc, s25, v25
v_mfma_f32_16x16x32_bf16 v[96:99], a[208:211], a[148:151], v[96:99]
v_mfma_f32_16x16x32_bf16 v[96:99], a[212:215], a[160:163], v[96:99]
v_mfma_f32_16x16x32_bf16 v[100:103], a[208:211], a[152:155], v[100:103]
s_addk_i32 s90, 2048
ds_read_b128 a[208:211], v1 offset:58368
v_mfma_f32_16x16x32_bf16 v[100:103], a[212:215], a[164:167], v[100:103]
s_waitcnt lgkmcnt(1)
ds_read_b128 a[212:215], v2 offset:58368
v_mfma_f32_16x16x32_bf16 v[92:95], a[192:195], a[168:171], v[92:95]
buffer_load_dwordx4 v7, s[16:19], s90 offen offset:2048 nt lds
v_mfma_f32_16x16x32_bf16 v[92:95], a[196:199], a[180:183], v[92:95]
v_mfma_f32_16x16x32_bf16 v[96:99], a[192:195], a[172:175], v[96:99]
v_mfma_f32_16x16x32_bf16 v[96:99], a[196:199], a[184:187], v[96:99]
s_cbranch_vccnz STUB_26
BACK_26:
v_mfma_f32_16x16x32_bf16 v[100:103], a[192:195], a[176:179], v[100:103]
ds_read_b128 a[192:195], v1 offset:59392
v_add_f32 v19, v19, v27
v_mfma_f32_16x16x32_bf16 v[100:103], a[196:199], a[188:191], v[100:103]
ds_read_b128 a[196:199], v2 offset:59392
v_add_f32 v17, v17, v24
v_mfma_f32_16x16x32_bf16 v[80:83], a[200:203], a[96:99], 0
s_addk_i32 s91, 2048
v_add_f32 v18, v18, v26
v_accvgpr_write_b32 a0, v56
v_mfma_f32_16x16x32_bf16 v[80:83], a[204:207], a[108:111], v[80:83]
buffer_load_dwordx4 v7, s[16:19], s91 offen offset:3072 nt lds
v_mfma_f32_16x16x32_bf16 v[84:87], a[200:203], a[100:103], 0
v_accvgpr_write_b32 a1, v57
v_accvgpr_write_b32 a2, v58
v_mfma_f32_16x16x32_bf16 v[84:87], a[204:207], a[112:115], v[84:87]
v_accvgpr_write_b32 a3, v59
v_accvgpr_write_b32 a4, v60
v_mfma_f32_16x16x32_bf16 v[88:91], a[200:203], a[104:107], 0
ds_read_b128 a[200:203], v1 offset:60416
v_accvgpr_write_b32 a5, v61
v_mfma_f32_16x16x32_bf16 v[88:91], a[204:207], a[116:119], v[88:91]
s_waitcnt lgkmcnt(1)
ds_read_b128 a[204:207], v2 offset:60416
v_accvgpr_write_b32 a6, v62
v_mfma_f32_16x16x32_bf16 v[80:83], a[208:211], a[120:123], v[80:83]
v_accvgpr_write_b32 a7, v63
v_accvgpr_write_b32 a8, v64
v_mfma_f32_16x16x32_bf16 v[80:83], a[212:215], a[132:135], v[80:83]
s_mov_b32 m0, s34
v_accvgpr_write_b32 a9, v65
v_accvgpr_write_b32 a10, v66
v_mfma_f32_16x16x32_bf16 v[84:87], a[208:211], a[124:127], v[84:87]
s_add_u32 s90, s70, s92
v_accvgpr_write_b32 a11, v67
v_fma_f32 v92, v92, s24, v11
v_mfma_f32_16x16x32_bf16 v[84:87], a[212:215], a[136:139], v[84:87]
buffer_load_dwordx4 v7, s[12:15], s90 offen offset:0 nt lds
v_mfma_f32_16x16x32_bf16 v[88:91], a[208:211], a[128:131], v[88:91]
ds_read_b64_tr_b16 a[208:209], v3 offset:16384
v_fma_f32 v93, v93, s24, v11
v_mfma_f32_16x16x32_bf16 v[88:91], a[212:215], a[140:143], v[88:91]
ds_read_b64_tr_b16 a[210:211], v3 offset:20480
v_fma_f32 v94, v94, s24, v11
v_mfma_f32_16x16x32_bf16 v[80:83], a[192:195], a[144:147], v[80:83]
v_exp_f32 v28, v92
v_mfma_f32_16x16x32_bf16 v[80:83], a[196:199], a[156:159], v[80:83]
ds_read_b64_tr_b16 a[212:213], v3 offset:24576
v_fma_f32 v95, v95, s24, v11
v_mfma_f32_16x16x32_bf16 v[84:87], a[192:195], a[148:151], v[84:87]
ds_read_b64_tr_b16 a[214:215], v3 offset:28672
v_fma_f32 v96, v96, s24, v13
v_exp_f32 v29, v93
v_mfma_f32_16x16x32_bf16 v[84:87], a[196:199], a[160:163], v[84:87]
v_exp_f32 v30, v94
v_mfma_f32_16x16x32_bf16 v[88:91], a[192:195], a[152:155], v[88:91]
s_add_u32 s90, s70, s93
ds_read_b64_tr_b16 a[192:193], v4 offset:16384
v_cvt_pk_bf16_f32 v44, v28, v29
v_mfma_f32_16x16x32_bf16 v[88:91], a[196:199], a[164:167], v[88:91]
s_waitcnt lgkmcnt(3)
ds_read_b64_tr_b16 a[194:195], v4 offset:20480
v_add_f32 v24, v28, v29
v_mfma_f32_16x16x32_bf16 v[80:83], a[200:203], a[168:171], v[80:83]
buffer_load_dwordx4 v7, s[12:15], s90 offen offset:1024 nt lds
v_mfma_f32_16x16x32_bf16 v[80:83], a[204:207], a[180:183], v[80:83]
ds_read_b64_tr_b16 a[196:197], v4 offset:24576
v_add_f32 v24, v24, v30
v_mfma_f32_16x16x32_bf16 v[84:87], a[200:203], a[172:175], v[84:87]
ds_read_b64_tr_b16 a[198:199], v4 offset:28672
v_fma_f32 v97, v97, s24, v13
v_mfma_f32_16x16x32_bf16 v[84:87], a[204:207], a[184:187], v[84:87]
v_exp_f32 v31, v95
v_mfma_f32_16x16x32_bf16 v[88:91], a[200:203], a[176:179], v[88:91]
ds_read_b64_tr_b16 a[200:201], v5 offset:16384
v_cvt_pk_bf16_f32 v45, v30, v31
v_mfma_f32_16x16x32_bf16 v[88:91], a[204:207], a[188:191], v[88:91]
ds_read_b64_tr_b16 a[202:203], v5 offset:20480
v_add_f32 v24, v24, v31
v_mfma_f32_16x16x32_bf16 v[200:203], a[208:211], v[68:71], v[200:203]
s_waitcnt lgkmcnt(4)
v_exp_f32 v20, v96
v_mfma_f32_16x16x32_bf16 v[200:203], a[212:215], v[32:35], v[200:203]
ds_read_b64_tr_b16 a[204:205], v5 offset:24576
v_fma_f32 v98, v98, s24, v13
v_mfma_f32_16x16x32_bf16 v[204:207], a[208:211], v[72:75], v[204:207]
s_add_u32 s90, s70, s94
ds_read_b64_tr_b16 a[206:207], v5 offset:28672
v_fma_f32 v99, v99, s24, v13
v_mfma_f32_16x16x32_bf16 v[204:207], a[212:215], v[36:39], v[204:207]
buffer_load_dwordx4 v7, s[12:15], s90 offen offset:2048 nt lds
v_mfma_f32_16x16x32_bf16 v[208:211], a[208:211], v[76:79], v[208:211]
ds_read_b64_tr_b16 a[208:209], v6 offset:16384
v_fma_f32 v100, v100, s24, v15
v_mfma_f32_16x16x32_bf16 v[208:211], a[212:215], v[40:43], v[208:211]
ds_read_b64_tr_b16 a[210:211], v6 offset:20480
v_fma_f32 v101, v101, s24, v15
v_mfma_f32_16x16x32_bf16 v[212:215], a[192:195], v[68:71], v[212:215]
s_waitcnt lgkmcnt(4)
v_exp_f32 v21, v97
v_mfma_f32_16x16x32_bf16 v[212:215], a[196:199], v[32:35], v[212:215]
ds_read_b64_tr_b16 a[212:213], v6 offset:24576
v_cvt_pk_bf16_f32 v48, v20, v21
v_mfma_f32_16x16x32_bf16 v[216:219], a[192:195], v[72:75], v[216:219]
ds_read_b64_tr_b16 a[214:215], v6 offset:28672
v_add_f32 v26, v20, v21
v_mfma_f32_16x16x32_bf16 v[216:219], a[196:199], v[36:39], v[216:219]
v_exp_f32 v28, v98
v_mfma_f32_16x16x32_bf16 v[220:223], a[192:195], v[76:79], v[220:223]
ds_read_b64_tr_b16 a[192:193], v3 offset:17408
v_add_f32 v26, v26, v28
v_mfma_f32_16x16x32_bf16 v[220:223], a[196:199], v[40:43], v[220:223]
s_add_u32 s90, s70, s95
ds_read_b64_tr_b16 a[194:195], v3 offset:21504
v_fma_f32 v102, v102, s24, v15
v_mfma_f32_16x16x32_bf16 a[216:219], a[200:203], v[68:71], a[216:219]
s_waitcnt lgkmcnt(4)
buffer_load_dwordx4 v7, s[12:15], s90 offen offset:3072 nt lds
v_mfma_f32_16x16x32_bf16 a[216:219], a[204:207], v[32:35], a[216:219]
ds_read_b64_tr_b16 a[196:197], v3 offset:25600
v_fma_f32 v103, v103, s24, v15
v_mfma_f32_16x16x32_bf16 a[220:223], a[200:203], v[72:75], a[220:223]
ds_read_b64_tr_b16 a[198:199], v3 offset:29696
v_fma_f32 v80, v80, s24, v11
v_mfma_f32_16x16x32_bf16 a[220:223], a[204:207], v[36:39], a[220:223]
v_exp_f32 v29, v99
v_mfma_f32_16x16x32_bf16 a[224:227], a[200:203], v[76:79], a[224:227]
ds_read_b64_tr_b16 a[200:201], v4 offset:17408
v_cvt_pk_bf16_f32 v49, v28, v29
v_mfma_f32_16x16x32_bf16 a[224:227], a[204:207], v[40:43], a[224:227]
ds_read_b64_tr_b16 a[202:203], v4 offset:21504
v_add_f32 v26, v26, v29
v_mfma_f32_16x16x32_bf16 a[228:231], a[208:211], v[68:71], a[228:231]
s_waitcnt lgkmcnt(4)
v_exp_f32 v30, v100
v_mfma_f32_16x16x32_bf16 a[228:231], a[212:215], v[32:35], a[228:231]
ds_read_b64_tr_b16 a[204:205], v4 offset:25600
v_fma_f32 v81, v81, s24, v11
v_mfma_f32_16x16x32_bf16 a[232:235], a[208:211], v[72:75], a[232:235]
s_add_u32 s89, s77, s86
ds_read_b64_tr_b16 a[206:207], v4 offset:29696
v_fma_f32 v82, v82, s24, v11
v_mfma_f32_16x16x32_bf16 a[232:235], a[212:215], v[36:39], a[232:235]
buffer_store_dwordx4 a[68:71], v8, s[20:23], s89 offen nt
v_mfma_f32_16x16x32_bf16 a[236:239], a[208:211], v[76:79], a[236:239]
ds_read_b64_tr_b16 a[208:209], v5 offset:17408
v_fma_f32 v83, v83, s24, v11
v_mfma_f32_16x16x32_bf16 a[236:239], a[212:215], v[40:43], a[236:239]
ds_read_b64_tr_b16 a[210:211], v5 offset:21504
v_fma_f32 v84, v84, s24, v13
v_mfma_f32_16x16x32_bf16 a[240:243], a[192:195], v[68:71], a[240:243]
s_waitcnt lgkmcnt(4)
v_exp_f32 v31, v101
v_mfma_f32_16x16x32_bf16 a[240:243], a[196:199], v[32:35], a[240:243]
ds_read_b64_tr_b16 a[212:213], v5 offset:25600
v_cvt_pk_bf16_f32 v52, v30, v31
v_mfma_f32_16x16x32_bf16 a[244:247], a[192:195], v[72:75], a[244:247]
ds_read_b64_tr_b16 a[214:215], v5 offset:29696
v_add_f32 v27, v30, v31
v_mfma_f32_16x16x32_bf16 a[244:247], a[196:199], v[36:39], a[244:247]
v_exp_f32 v20, v102
v_exp_f32 v21, v103
v_mfma_f32_16x16x32_bf16 a[248:251], a[192:195], v[76:79], a[248:251]
ds_read_b64_tr_b16 a[192:193], v6 offset:17408
v_cvt_pk_bf16_f32 v53, v20, v21
v_mfma_f32_16x16x32_bf16 a[248:251], a[196:199], v[40:43], a[248:251]
s_add_u32 s89, s77, s87
ds_read_b64_tr_b16 a[194:195], v6 offset:21504
v_add_f32 v27, v27, v20
v_mfma_f32_16x16x32_bf16 a[252:255], a[200:203], v[68:71], a[252:255]
s_waitcnt lgkmcnt(4)
buffer_store_dwordx4 a[92:95], v8, s[20:23], s89 offen nt
v_mfma_f32_16x16x32_bf16 a[252:255], a[204:207], v[32:35], a[252:255]
ds_read_b64_tr_b16 a[196:197], v6 offset:25600
v_add_f32 v27, v27, v21
v_mfma_f32_16x16x32_bf16 v[224:227], a[200:203], v[72:75], v[224:227]
ds_read_b64_tr_b16 a[198:199], v6 offset:29696
v_fma_f32 v85, v85, s24, v13
v_mfma_f32_16x16x32_bf16 v[224:227], a[204:207], v[36:39], v[224:227]
v_exp_f32 v28, v80
v_mfma_f32_16x16x32_bf16 v[228:231], a[200:203], v[76:79], v[228:231]
v_exp_f32 v29, v81
v_mfma_f32_16x16x32_bf16 v[228:231], a[204:207], v[40:43], v[228:231]
v_exp_f32 v30, v82
v_mfma_f32_16x16x32_bf16 v[232:235], a[208:211], v[68:71], v[232:235]
s_waitcnt lgkmcnt(2)
v_exp_f32 v31, v83
v_mfma_f32_16x16x32_bf16 v[232:235], a[212:215], v[32:35], v[232:235]
v_exp_f32 v20, v84
v_mfma_f32_16x16x32_bf16 v[236:239], a[208:211], v[72:75], v[236:239]
v_exp_f32 v21, v85
v_mfma_f32_16x16x32_bf16 v[236:239], a[212:215], v[36:39], v[236:239]
s_waitcnt vmcnt(22) lgkmcnt(0)
v_cvt_pk_bf16_f32 v46, v28, v29
v_add_f32 v24, v24, v28
v_mfma_f32_16x16x32_bf16 v[240:243], a[208:211], v[76:79], v[240:243]
s_barrier
v_add_f32 v24, v24, v29
v_mfma_f32_16x16x32_bf16 v[240:243], a[212:215], v[40:43], v[240:243]
ds_read_b128 a[200:203], v1 offset:0
v_cvt_pk_bf16_f32 v47, v30, v31
v_mfma_f32_16x16x32_bf16 v[244:247], a[192:195], v[68:71], v[244:247]
ds_read_b128 a[204:207], v2 offset:0
v_add_f32 v24, v24, v30
v_mfma_f32_16x16x32_bf16 v[244:247], a[196:199], v[32:35], v[244:247]
ds_read_b128 a[208:211], v1 offset:1024
v_add_f32 v24, v24, v31
v_mfma_f32_16x16x32_bf16 v[248:251], a[192:195], v[72:75], v[248:251]
s_mov_b32 m0, s37
ds_read_b128 a[212:215], v2 offset:1024
v_fma_f32 v86, v86, s24, v13
v_mfma_f32_16x16x32_bf16 v[248:251], a[196:199], v[36:39], v[248:251]
s_addk_i32 s81, 2048
v_exp_f32 v28, v86
v_mfma_f32_16x16x32_bf16 v[252:255], a[192:195], v[76:79], v[252:255]
s_add_u32 s90, s81, s94
ds_read_b128 a[192:195], v1 offset:2048
v_fma_f32 v87, v87, s24, v13
v_mfma_f32_16x16x32_bf16 v[252:255], a[196:199], v[40:43], v[252:255]
s_waitcnt lgkmcnt(4)
ds_read_b128 a[196:199], v2 offset:2048
v_cvt_pk_bf16_f32 v50, v20, v21
v_mfma_f32_16x16x32_bf16 v[32:35], a[200:203], a[96:99], 0
s_waitcnt lgkmcnt(4)
buffer_load_dwordx4 v7, s[16:19], s90 offen offset:0 nt lds
v_mfma_f32_16x16x32_bf16 v[32:35], a[204:207], a[108:111], v[32:35]
v_exp_f32 v29, v87
v_mfma_f32_16x16x32_bf16 v[36:39], a[200:203], a[100:103], 0
s_add_u32 s91, s81, s95
v_add_f32 v26, v26, v20
v_add_f32 v26, v26, v21
v_mfma_f32_16x16x32_bf16 v[36:39], a[204:207], a[112:115], v[36:39]
buffer_load_dwordx4 v7, s[16:19], s91 offen offset:1024 nt lds
v_mfma_f32_16x16x32_bf16 v[40:43], a[200:203], a[104:107], 0
ds_read_b128 a[200:203], v1 offset:3072
v_cvt_pk_bf16_f32 v51, v28, v29
v_mfma_f32_16x16x32_bf16 v[40:43], a[204:207], a[116:119], v[40:43]
s_waitcnt lgkmcnt(1)
ds_read_b128 a[204:207], v2 offset:3072
v_add_f32 v26, v26, v28
v_mfma_f32_16x16x32_bf16 v[32:35], a[208:211], a[120:123], v[32:35]
v_add_f32 v26, v26, v29
v_fma_f32 v88, v88, s24, v15
v_mfma_f32_16x16x32_bf16 v[32:35], a[212:215], a[132:135], v[32:35]
s_addk_i32 s90, 2048
v_exp_f32 v30, v88
v_mfma_f32_16x16x32_bf16 v[36:39], a[208:211], a[124:127], v[36:39]
buffer_load_dwordx4 v7, s[16:19], s90 offen offset:2048 nt lds
v_mfma_f32_16x16x32_bf16 v[36:39], a[212:215], a[136:139], v[36:39]
v_fma_f32 v89, v89, s24, v15
v_fma_f32 v90, v90, s24, v15
v_mfma_f32_16x16x32_bf16 v[40:43], a[208:211], a[128:131], v[40:43]
ds_read_b128 a[208:211], v1 offset:8192
v_fma_f32 v91, v91, s24, v15
v_mfma_f32_16x16x32_bf16 v[40:43], a[212:215], a[140:143], v[40:43]
ds_read_b128 a[212:215], v2 offset:8192
v_add_f32 v27, v27, v30
v_mfma_f32_16x16x32_bf16 v[32:35], a[192:195], a[144:147], v[32:35]
s_addk_i32 s91, 2048
v_exp_f32 v31, v89
v_mfma_f32_16x16x32_bf16 v[32:35], a[196:199], a[156:159], v[32:35]
buffer_load_dwordx4 v7, s[16:19], s91 offen offset:3072 nt lds
v_cvt_pk_bf16_f32 v54, v30, v31
v_mfma_f32_16x16x32_bf16 v[36:39], a[192:195], a[148:151], v[36:39]
v_exp_f32 v20, v90
v_mfma_f32_16x16x32_bf16 v[36:39], a[196:199], a[160:163], v[36:39]
s_mov_b32 m0, s35
v_exp_f32 v21, v91
v_mfma_f32_16x16x32_bf16 v[40:43], a[192:195], a[152:155], v[40:43]
s_add_u32 s90, s71, s92
ds_read_b128 a[192:195], v1 offset:9216
v_add_f32 v27, v27, v31
v_mfma_f32_16x16x32_bf16 v[40:43], a[196:199], a[164:167], v[40:43]
s_waitcnt lgkmcnt(1)
ds_read_b128 a[196:199], v2 offset:9216
v_cvt_pk_bf16_f32 v55, v20, v21
v_mfma_f32_16x16x32_bf16 v[32:35], a[200:203], a[168:171], v[32:35]
buffer_load_dwordx4 v7, s[12:15], s90 offen offset:0 nt lds
v_mfma_f32_16x16x32_bf16 v[32:35], a[204:207], a[180:183], v[32:35]
v_add_f32 v27, v27, v20
v_add_f32 v27, v27, v21
v_mfma_f32_16x16x32_bf16 v[36:39], a[200:203], a[172:175], v[36:39]
v_max3_f32 v25, v24, v26, v27
v_cmp_lt_f32 vcc, s25, v25
v_mfma_f32_16x16x32_bf16 v[36:39], a[204:207], a[184:187], v[36:39]
s_cbranch_vccnz STUB_27
BACK_27:
v_mfma_f32_16x16x32_bf16 v[40:43], a[200:203], a[176:179], v[40:43]
ds_read_b128 a[200:203], v1 offset:10240
v_add_f32 v19, v19, v27
v_add_f32 v17, v17, v24
v_add_f32 v18, v18, v26
v_mfma_f32_16x16x32_bf16 v[40:43], a[204:207], a[188:191], v[40:43]
s_add_u32 s90, s71, s93
ds_read_b128 a[204:207], v2 offset:10240
v_accvgpr_write_b32 a12, v44
v_accvgpr_write_b32 a13, v45
v_mfma_f32_16x16x32_bf16 v[68:71], a[208:211], a[96:99], 0
buffer_load_dwordx4 v7, s[12:15], s90 offen offset:1024 nt lds
v_accvgpr_write_b32 a14, v46
v_accvgpr_write_b32 a15, v47
PADJ_13:
s_cbranch_execz PADJ_17
v_mfma_f32_16x16x32_bf16 v[68:71], a[212:215], a[108:111], v[68:71]
v_accvgpr_write_b32 a16, v48
v_accvgpr_write_b32 a17, v49
v_accvgpr_write_b32 a18, v50
v_mfma_f32_16x16x32_bf16 v[72:75], a[208:211], a[100:103], 0
v_accvgpr_write_b32 a19, v51
v_accvgpr_write_b32 a20, v52
v_accvgpr_write_b32 a21, v53
v_mfma_f32_16x16x32_bf16 v[72:75], a[212:215], a[112:115], v[72:75]
v_accvgpr_write_b32 a22, v54
v_accvgpr_write_b32 a23, v55
v_fma_f32 v32, v32, s24, v11
v_mfma_f32_16x16x32_bf16 v[76:79], a[208:211], a[104:107], 0
s_add_u32 s90, s71, s94
ds_read_b128 a[208:211], v1 offset:11264
v_fma_f32 v33, v33, s24, v11
v_fma_f32 v34, v34, s24, v11
v_fma_f32 v35, v35, s24, v11
v_mfma_f32_16x16x32_bf16 v[76:79], a[212:215], a[116:119], v[76:79]
s_waitcnt lgkmcnt(1)
ds_read_b128 a[212:215], v2 offset:11264
v_fma_f32 v36, v36, s24, v13
v_exp_f32 v28, v32
v_mfma_f32_16x16x32_bf16 v[68:71], a[192:195], a[120:123], v[68:71]
buffer_load_dwordx4 v7, s[12:15], s90 offen offset:2048 nt lds
v_mfma_f32_16x16x32_bf16 v[68:71], a[196:199], a[132:135], v[68:71]
v_exp_f32 v29, v33
v_exp_f32 v30, v34
v_mfma_f32_16x16x32_bf16 v[72:75], a[192:195], a[124:127], v[72:75]
s_add_u32 s90, s71, s95
v_exp_f32 v31, v35
v_mfma_f32_16x16x32_bf16 v[72:75], a[196:199], a[136:139], v[72:75]
buffer_load_dwordx4 v7, s[12:15], s90 offen offset:3072 nt lds
v_cvt_pk_bf16_f32 v56, v28, v29
v_add_f32 v24, v28, v29
v_mfma_f32_16x16x32_bf16 v[76:79], a[192:195], a[128:131], v[76:79]
v_exp_f32 v20, v36
v_cvt_pk_bf16_f32 v57, v30, v31
v_mfma_f32_16x16x32_bf16 v[76:79], a[196:199], a[140:143], v[76:79]
v_add_f32 v24, v24, v30
v_add_f32 v24, v24, v31
v_fma_f32 v37, v37, s24, v13
v_mfma_f32_16x16x32_bf16 v[68:71], a[200:203], a[144:147], v[68:71]
v_exp_f32 v21, v37
v_fma_f32 v38, v38, s24, v13
v_mfma_f32_16x16x32_bf16 v[68:71], a[204:207], a[156:159], v[68:71]
v_exp_f32 v28, v38
v_fma_f32 v39, v39, s24, v13
v_cvt_pk_bf16_f32 v60, v20, v21
v_mfma_f32_16x16x32_bf16 v[72:75], a[200:203], a[148:151], v[72:75]
v_exp_f32 v29, v39
v_add_f32 v26, v20, v21
v_mfma_f32_16x16x32_bf16 v[72:75], a[204:207], a[160:163], v[72:75]
s_waitcnt vmcnt(20) lgkmcnt(0)
v_cvt_pk_bf16_f32 v61, v28, v29
v_add_f32 v26, v26, v28
v_fma_f32 v40, v40, s24, v15
v_mfma_f32_16x16x32_bf16 v[76:79], a[200:203], a[152:155], v[76:79]
s_barrier
v_add_f32 v26, v26, v29
v_fma_f32 v41, v41, s24, v15
v_mfma_f32_16x16x32_bf16 v[76:79], a[204:207], a[164:167], v[76:79]
ds_read_b128 a[192:195], v1 offset:16384
v_fma_f32 v42, v42, s24, v15
v_fma_f32 v43, v43, s24, v15
v_exp_f32 v30, v40
v_mfma_f32_16x16x32_bf16 v[68:71], a[208:211], a[168:171], v[68:71]
ds_read_b128 a[196:199], v2 offset:16384
v_mfma_f32_16x16x32_bf16 v[68:71], a[212:215], a[180:183], v[68:71]
ds_read_b128 a[200:203], v1 offset:17408
v_exp_f32 v31, v41
v_mfma_f32_16x16x32_bf16 v[72:75], a[208:211], a[172:175], v[72:75]
s_mov_b32 m0, s32
ds_read_b128 a[204:207], v2 offset:17408
v_cvt_pk_bf16_f32 v64, v30, v31
v_add_f32 v27, v30, v31
v_mfma_f32_16x16x32_bf16 v[72:75], a[212:215], a[184:187], v[72:75]
s_bitcmp1_b32 s3, 1
s_cselect_b32 s81, s71, s70
v_fma_f32 v68, v68, s24, v11
v_exp_f32 v20, v42
v_mfma_f32_16x16x32_bf16 v[76:79], a[208:211], a[176:179], v[76:79]
s_add_u32 s90, s81, s92
ds_read_b128 a[208:211], v1 offset:18432
v_add_f32 v27, v27, v20
v_mfma_f32_16x16x32_bf16 v[76:79], a[212:215], a[188:191], v[76:79]
s_waitcnt lgkmcnt(4)
ds_read_b128 a[212:215], v2 offset:18432
v_fma_f32 v69, v69, s24, v11
v_exp_f32 v21, v43
v_mfma_f32_16x16x32_bf16 v[80:83], a[192:195], a[96:99], 0
s_waitcnt lgkmcnt(4)
buffer_load_dwordx4 v7, s[16:19], s90 offen offset:0 nt lds
v_cvt_pk_bf16_f32 v65, v20, v21
v_mfma_f32_16x16x32_bf16 v[80:83], a[196:199], a[108:111], v[80:83]
v_exp_f32 v28, v68
v_add_f32 v27, v27, v21
v_mfma_f32_16x16x32_bf16 v[84:87], a[192:195], a[100:103], 0
v_exp_f32 v29, v69
v_fma_f32 v70, v70, s24, v11
v_fma_f32 v71, v71, s24, v11
v_mfma_f32_16x16x32_bf16 v[84:87], a[196:199], a[112:115], v[84:87]
v_exp_f32 v30, v70
v_cvt_pk_bf16_f32 v58, v28, v29
v_mfma_f32_16x16x32_bf16 v[88:91], a[192:195], a[104:107], 0
ds_read_b128 a[192:195], v1 offset:19456
v_add_f32 v24, v24, v28
v_exp_f32 v31, v71
v_mfma_f32_16x16x32_bf16 v[88:91], a[196:199], a[116:119], v[88:91]
s_waitcnt lgkmcnt(1)
ds_read_b128 a[196:199], v2 offset:19456
v_add_f32 v24, v24, v29
v_cvt_pk_bf16_f32 v59, v30, v31
v_mfma_f32_16x16x32_bf16 v[80:83], a[200:203], a[120:123], v[80:83]
v_add_f32 v24, v24, v30
v_add_f32 v24, v24, v31
v_fma_f32 v72, v72, s24, v13
v_mfma_f32_16x16x32_bf16 v[80:83], a[204:207], a[132:135], v[80:83]
s_add_u32 s91, s81, s93
v_exp_f32 v20, v72
v_fma_f32 v73, v73, s24, v13
v_fma_f32 v74, v74, s24, v13
v_mfma_f32_16x16x32_bf16 v[84:87], a[200:203], a[124:127], v[84:87]
buffer_load_dwordx4 v7, s[16:19], s91 offen offset:1024 nt lds
v_fma_f32 v75, v75, s24, v13
v_mfma_f32_16x16x32_bf16 v[84:87], a[204:207], a[136:139], v[84:87]
v_exp_f32 v21, v73
v_add_f32 v26, v26, v20
v_cvt_pk_bf16_f32 v62, v20, v21
v_mfma_f32_16x16x32_bf16 v[88:91], a[200:203], a[128:131], v[88:91]
ds_read_b128 a[200:203], v1 offset:24576
v_add_f32 v26, v26, v21
v_exp_f32 v28, v74
v_mfma_f32_16x16x32_bf16 v[88:91], a[204:207], a[140:143], v[88:91]
ds_read_b128 a[204:207], v2 offset:24576
v_add_f32 v26, v26, v28
v_mfma_f32_16x16x32_bf16 v[80:83], a[208:211], a[144:147], v[80:83]
v_exp_f32 v29, v75
v_fma_f32 v76, v76, s24, v15
v_cvt_pk_bf16_f32 v63, v28, v29
v_mfma_f32_16x16x32_bf16 v[80:83], a[212:215], a[156:159], v[80:83]
v_exp_f32 v30, v76
v_add_f32 v26, v26, v29
v_mfma_f32_16x16x32_bf16 v[84:87], a[208:211], a[148:151], v[84:87]
v_fma_f32 v77, v77, s24, v15
v_fma_f32 v78, v78, s24, v15
v_fma_f32 v79, v79, s24, v15
v_mfma_f32_16x16x32_bf16 v[84:87], a[212:215], a[160:163], v[84:87]
v_exp_f32 v31, v77
v_add_f32 v27, v27, v30
v_cvt_pk_bf16_f32 v66, v30, v31
v_mfma_f32_16x16x32_bf16 v[88:91], a[208:211], a[152:155], v[88:91]
s_addk_i32 s90, 2048
ds_read_b128 a[208:211], v1 offset:25600
v_add_f32 v27, v27, v31
v_exp_f32 v20, v78
v_mfma_f32_16x16x32_bf16 v[88:91], a[212:215], a[164:167], v[88:91]
s_waitcnt lgkmcnt(1)
ds_read_b128 a[212:215], v2 offset:25600
v_add_f32 v27, v27, v20
v_mfma_f32_16x16x32_bf16 v[80:83], a[192:195], a[168:171], v[80:83]
buffer_load_dwordx4 v7, s[16:19], s90 offen offset:2048 nt lds
v_exp_f32 v21, v79
v_mfma_f32_16x16x32_bf16 v[80:83], a[196:199], a[180:183], v[80:83]
v_cvt_pk_bf16_f32 v67, v20, v21
v_add_f32 v27, v27, v21
v_mfma_f32_16x16x32_bf16 v[84:87], a[192:195], a[172:175], v[84:87]
v_max3_f32 v25, v24, v26, v27
v_cmp_lt_f32 vcc, s25, v25
v_mfma_f32_16x16x32_bf16 v[84:87], a[196:199], a[184:187], v[84:87]
s_cbranch_vccnz STUB_28
BACK_28:
v_mfma_f32_16x16x32_bf16 v[88:91], a[192:195], a[176:179], v[88:91]
ds_read_b128 a[192:195], v1 offset:26624
v_add_f32 v19, v19, v27
v_add_f32 v17, v17, v24
v_mfma_f32_16x16x32_bf16 v[88:91], a[196:199], a[188:191], v[88:91]
ds_read_b128 a[196:199], v2 offset:26624
v_add_f32 v18, v18, v26
v_fma_f32 v80, v80, s24, v11
v_mfma_f32_16x16x32_bf16 v[44:47], a[200:203], a[96:99], 0
v_exp_f32 v28, v80
v_fma_f32 v81, v81, s24, v11
v_mfma_f32_16x16x32_bf16 v[44:47], a[204:207], a[108:111], v[44:47]
v_exp_f32 v29, v81
v_fma_f32 v82, v82, s24, v11
v_mfma_f32_16x16x32_bf16 v[48:51], a[200:203], a[100:103], 0
v_exp_f32 v30, v82
v_fma_f32 v83, v83, s24, v11
v_mfma_f32_16x16x32_bf16 v[48:51], a[204:207], a[112:115], v[48:51]
v_exp_f32 v31, v83
v_cvt_pk_bf16_f32 v32, v28, v29
v_mfma_f32_16x16x32_bf16 v[52:55], a[200:203], a[104:107], 0
s_addk_i32 s91, 2048
ds_read_b128 a[200:203], v1 offset:27648
v_add_f32 v24, v28, v29
v_cvt_pk_bf16_f32 v33, v30, v31
v_mfma_f32_16x16x32_bf16 v[52:55], a[204:207], a[116:119], v[52:55]
s_waitcnt lgkmcnt(1)
ds_read_b128 a[204:207], v2 offset:27648
v_add_f32 v24, v24, v30
v_fma_f32 v84, v84, s24, v13
v_mfma_f32_16x16x32_bf16 v[44:47], a[208:211], a[120:123], v[44:47]
buffer_load_dwordx4 v7, s[16:19], s91 offen offset:3072 nt lds
v_add_f32 v24, v24, v31
v_mfma_f32_16x16x32_bf16 v[44:47], a[212:215], a[132:135], v[44:47]
v_exp_f32 v20, v84
v_mfma_f32_16x16x32_bf16 v[48:51], a[208:211], a[124:127], v[48:51]
v_fma_f32 v85, v85, s24, v13
v_fma_f32 v86, v86, s24, v13
v_fma_f32 v87, v87, s24, v13
v_mfma_f32_16x16x32_bf16 v[48:51], a[212:215], a[136:139], v[48:51]
v_exp_f32 v21, v85
v_exp_f32 v28, v86
v_mfma_f32_16x16x32_bf16 v[52:55], a[208:211], a[128:131], v[52:55]
v_exp_f32 v29, v87
v_mfma_f32_16x16x32_bf16 v[52:55], a[212:215], a[140:143], v[52:55]
v_cvt_pk_bf16_f32 v36, v20, v21
v_add_f32 v26, v20, v21
v_cvt_pk_bf16_f32 v37, v28, v29
v_mfma_f32_16x16x32_bf16 v[44:47], a[192:195], a[144:147], v[44:47]
v_add_f32 v26, v26, v28
v_add_f32 v26, v26, v29
v_fma_f32 v88, v88, s24, v15
v_mfma_f32_16x16x32_bf16 v[44:47], a[196:199], a[156:159], v[44:47]
v_exp_f32 v30, v88
v_fma_f32 v89, v89, s24, v15
v_mfma_f32_16x16x32_bf16 v[48:51], a[192:195], a[148:151], v[48:51]
v_exp_f32 v31, v89
v_fma_f32 v90, v90, s24, v15
v_mfma_f32_16x16x32_bf16 v[48:51], a[196:199], a[160:163], v[48:51]
s_waitcnt vmcnt(14) lgkmcnt(0)
v_exp_f32 v20, v90
v_fma_f32 v91, v91, s24, v15
v_mfma_f32_16x16x32_bf16 v[52:55], a[192:195], a[152:155], v[52:55]
s_barrier
v_cvt_pk_bf16_f32 v40, v30, v31
v_mfma_f32_16x16x32_bf16 v[52:55], a[196:199], a[164:167], v[52:55]
ds_read_b128 a[208:211], v1 offset:32768
v_add_f32 v27, v30, v31
v_exp_f32 v21, v91
v_mfma_f32_16x16x32_bf16 v[44:47], a[200:203], a[168:171], v[44:47]
ds_read_b128 a[212:215], v2 offset:32768
v_cvt_pk_bf16_f32 v41, v20, v21
v_mfma_f32_16x16x32_bf16 v[44:47], a[204:207], a[180:183], v[44:47]
ds_read_b128 a[192:195], v1 offset:33792
v_add_f32 v27, v27, v20
v_mfma_f32_16x16x32_bf16 v[48:51], a[200:203], a[172:175], v[48:51]
s_mov_b32 m0, s33
ds_read_b128 a[196:199], v2 offset:33792
v_add_f32 v27, v27, v21
v_mfma_f32_16x16x32_bf16 v[48:51], a[204:207], a[184:187], v[48:51]
s_addk_i32 s81, 2048
v_fma_f32 v44, v44, s24, v11
v_fma_f32 v45, v45, s24, v11
v_fma_f32 v46, v46, s24, v11
v_fma_f32 v47, v47, s24, v11
v_exp_f32 v28, v44
v_mfma_f32_16x16x32_bf16 v[52:55], a[200:203], a[176:179], v[52:55]
s_add_u32 s90, s81, s94
ds_read_b128 a[200:203], v1 offset:34816
v_add_f32 v24, v24, v28
v_mfma_f32_16x16x32_bf16 v[52:55], a[204:207], a[188:191], v[52:55]
s_waitcnt lgkmcnt(4)
ds_read_b128 a[204:207], v2 offset:34816
v_fma_f32 v48, v48, s24, v13
v_exp_f32 v29, v45
v_mfma_f32_16x16x32_bf16 v[68:71], a[208:211], a[96:99], 0
s_waitcnt lgkmcnt(4)
buffer_load_dwordx4 v7, s[16:19], s90 offen offset:0 nt lds
v_mfma_f32_16x16x32_bf16 v[68:71], a[212:215], a[108:111], v[68:71]
v_exp_f32 v30, v46
v_cvt_pk_bf16_f32 v34, v28, v29
v_mfma_f32_16x16x32_bf16 v[72:75], a[208:211], a[100:103], 0
v_exp_f32 v31, v47
v_add_f32 v24, v24, v29
v_mfma_f32_16x16x32_bf16 v[72:75], a[212:215], a[112:115], v[72:75]
v_exp_f32 v20, v48
v_mfma_f32_16x16x32_bf16 v[76:79], a[208:211], a[104:107], 0
ds_read_b128 a[208:211], v1 offset:35840
v_cvt_pk_bf16_f32 v35, v30, v31
v_add_f32 v24, v24, v30
v_mfma_f32_16x16x32_bf16 v[76:79], a[212:215], a[116:119], v[76:79]
s_waitcnt lgkmcnt(1)
ds_read_b128 a[212:215], v2 offset:35840
v_add_f32 v24, v24, v31
v_fma_f32 v49, v49, s24, v13
v_mfma_f32_16x16x32_bf16 v[68:71], a[192:195], a[120:123], v[68:71]
v_exp_f32 v21, v49
v_fma_f32 v50, v50, s24, v13
v_mfma_f32_16x16x32_bf16 v[68:71], a[196:199], a[132:135], v[68:71]
s_add_u32 s91, s81, s95
v_exp_f32 v28, v50
v_fma_f32 v51, v51, s24, v13
v_mfma_f32_16x16x32_bf16 v[72:75], a[192:195], a[124:127], v[72:75]
buffer_load_dwordx4 v7, s[16:19], s91 offen offset:1024 nt lds
v_cvt_pk_bf16_f32 v38, v20, v21
v_mfma_f32_16x16x32_bf16 v[72:75], a[196:199], a[136:139], v[72:75]
v_exp_f32 v29, v51
v_add_f32 v26, v26, v20
v_mfma_f32_16x16x32_bf16 v[76:79], a[192:195], a[128:131], v[76:79]
ds_read_b128 a[192:195], v1 offset:40960
v_add_f32 v26, v26, v21
v_cvt_pk_bf16_f32 v39, v28, v29
v_mfma_f32_16x16x32_bf16 v[76:79], a[196:199], a[140:143], v[76:79]
ds_read_b128 a[196:199], v2 offset:40960
v_add_f32 v26, v26, v28
v_fma_f32 v52, v52, s24, v15
v_mfma_f32_16x16x32_bf16 v[68:71], a[200:203], a[144:147], v[68:71]
v_exp_f32 v30, v52
v_add_f32 v26, v26, v29
v_mfma_f32_16x16x32_bf16 v[68:71], a[204:207], a[156:159], v[68:71]
v_fma_f32 v53, v53, s24, v15
v_fma_f32 v54, v54, s24, v15
v_mfma_f32_16x16x32_bf16 v[72:75], a[200:203], a[148:151], v[72:75]
v_exp_f32 v31, v53
v_fma_f32 v55, v55, s24, v15
v_mfma_f32_16x16x32_bf16 v[72:75], a[204:207], a[160:163], v[72:75]
v_exp_f32 v20, v54
v_cvt_pk_bf16_f32 v42, v30, v31
v_mfma_f32_16x16x32_bf16 v[76:79], a[200:203], a[152:155], v[76:79]
s_addk_i32 s90, 2048
ds_read_b128 a[200:203], v1 offset:41984
v_add_f32 v27, v27, v30
v_exp_f32 v21, v55
v_mfma_f32_16x16x32_bf16 v[76:79], a[204:207], a[164:167], v[76:79]
s_waitcnt lgkmcnt(1)
ds_read_b128 a[204:207], v2 offset:41984
v_add_f32 v27, v27, v31
v_mfma_f32_16x16x32_bf16 v[68:71], a[208:211], a[168:171], v[68:71]
buffer_load_dwordx4 v7, s[16:19], s90 offen offset:2048 nt lds
v_cvt_pk_bf16_f32 v43, v20, v21
v_mfma_f32_16x16x32_bf16 v[68:71], a[212:215], a[180:183], v[68:71]
v_add_f32 v27, v27, v20
v_add_f32 v27, v27, v21
v_mfma_f32_16x16x32_bf16 v[72:75], a[208:211], a[172:175], v[72:75]
v_max3_f32 v25, v24, v26, v27
v_cmp_lt_f32 vcc, s25, v25
v_mfma_f32_16x16x32_bf16 v[72:75], a[212:215], a[184:187], v[72:75]
s_cbranch_vccnz STUB_29
BACK_29:
v_mfma_f32_16x16x32_bf16 v[76:79], a[208:211], a[176:179], v[76:79]
ds_read_b128 a[208:211], v1 offset:43008
v_add_f32 v19, v19, v27
v_add_f32 v17, v17, v24
v_mfma_f32_16x16x32_bf16 v[76:79], a[212:215], a[188:191], v[76:79]
ds_read_b128 a[212:215], v2 offset:43008
v_add_f32 v18, v18, v26
v_fma_f32 v68, v68, s24, v11
v_mfma_f32_16x16x32_bf16 v[80:83], a[192:195], a[96:99], 0
v_exp_f32 v28, v68
v_fma_f32 v69, v69, s24, v11
v_mfma_f32_16x16x32_bf16 v[80:83], a[196:199], a[108:111], v[80:83]
v_exp_f32 v29, v69
v_mfma_f32_16x16x32_bf16 v[84:87], a[192:195], a[100:103], 0
v_fma_f32 v70, v70, s24, v11
v_fma_f32 v71, v71, s24, v11
v_cvt_pk_bf16_f32 v44, v28, v29
v_mfma_f32_16x16x32_bf16 v[84:87], a[196:199], a[112:115], v[84:87]
v_exp_f32 v30, v70
v_add_f32 v24, v28, v29
v_mfma_f32_16x16x32_bf16 v[88:91], a[192:195], a[104:107], 0
s_addk_i32 s91, 2048
ds_read_b128 a[192:195], v1 offset:44032
v_add_f32 v24, v24, v30
v_exp_f32 v31, v71
v_mfma_f32_16x16x32_bf16 v[88:91], a[196:199], a[116:119], v[88:91]
s_waitcnt lgkmcnt(1)
ds_read_b128 a[196:199], v2 offset:44032
v_cvt_pk_bf16_f32 v45, v30, v31
v_mfma_f32_16x16x32_bf16 v[80:83], a[200:203], a[120:123], v[80:83]
buffer_load_dwordx4 v7, s[16:19], s91 offen offset:3072 nt lds
v_mfma_f32_16x16x32_bf16 v[80:83], a[204:207], a[132:135], v[80:83]
v_add_f32 v24, v24, v31
v_fma_f32 v72, v72, s24, v13
v_fma_f32 v73, v73, s24, v13
v_mfma_f32_16x16x32_bf16 v[84:87], a[200:203], a[124:127], v[84:87]
v_exp_f32 v20, v72
v_fma_f32 v74, v74, s24, v13
v_mfma_f32_16x16x32_bf16 v[84:87], a[204:207], a[136:139], v[84:87]
v_exp_f32 v21, v73
v_mfma_f32_16x16x32_bf16 v[88:91], a[200:203], a[128:131], v[88:91]
v_exp_f32 v28, v74
v_fma_f32 v75, v75, s24, v13
v_mfma_f32_16x16x32_bf16 v[88:91], a[204:207], a[140:143], v[88:91]
v_exp_f32 v29, v75
v_cvt_pk_bf16_f32 v48, v20, v21
v_mfma_f32_16x16x32_bf16 v[80:83], a[208:211], a[144:147], v[80:83]
v_add_f32 v26, v20, v21
v_cvt_pk_bf16_f32 v49, v28, v29
v_add_f32 v26, v26, v28
v_mfma_f32_16x16x32_bf16 v[80:83], a[212:215], a[156:159], v[80:83]
v_add_f32 v26, v26, v29
v_fma_f32 v76, v76, s24, v15
v_fma_f32 v77, v77, s24, v15
v_mfma_f32_16x16x32_bf16 v[84:87], a[208:211], a[148:151], v[84:87]
v_exp_f32 v30, v76
v_mfma_f32_16x16x32_bf16 v[84:87], a[212:215], a[160:163], v[84:87]
s_waitcnt vmcnt(8) lgkmcnt(0)
v_exp_f32 v31, v77
v_fma_f32 v78, v78, s24, v15
v_mfma_f32_16x16x32_bf16 v[88:91], a[208:211], a[152:155], v[88:91]
s_barrier
v_fma_f32 v79, v79, s24, v15
v_cvt_pk_bf16_f32 v52, v30, v31
v_mfma_f32_16x16x32_bf16 v[88:91], a[212:215], a[164:167], v[88:91]
ds_read_b128 a[200:203], v1 offset:49152
v_add_f32 v27, v30, v31
v_exp_f32 v20, v78
v_mfma_f32_16x16x32_bf16 v[80:83], a[192:195], a[168:171], v[80:83]
ds_read_b128 a[204:207], v2 offset:49152
v_add_f32 v27, v27, v20
v_mfma_f32_16x16x32_bf16 v[80:83], a[196:199], a[180:183], v[80:83]
ds_read_b128 a[208:211], v1 offset:50176
v_mfma_f32_16x16x32_bf16 v[84:87], a[192:195], a[172:175], v[84:87]
ds_read_b128 a[212:215], v2 offset:50176
v_exp_f32 v21, v79
v_mfma_f32_16x16x32_bf16 v[84:87], a[196:199], a[184:187], v[84:87]
v_cvt_pk_bf16_f32 v53, v20, v21
v_add_f32 v27, v27, v21
v_mfma_f32_16x16x32_bf16 v[88:91], a[192:195], a[176:179], v[88:91]
ds_read_b128 a[192:195], v1 offset:51200
v_fma_f32 v80, v80, s24, v11
v_fma_f32 v81, v81, s24, v11
v_mfma_f32_16x16x32_bf16 v[88:91], a[196:199], a[188:191], v[88:91]
s_waitcnt lgkmcnt(4)
ds_read_b128 a[196:199], v2 offset:51200
v_fma_f32 v82, v82, s24, v11
v_fma_f32 v83, v83, s24, v11
v_mfma_f32_16x16x32_bf16 v[92:95], a[200:203], a[96:99], 0
s_waitcnt lgkmcnt(4)
v_exp_f32 v28, v80
v_mfma_f32_16x16x32_bf16 v[92:95], a[204:207], a[108:111], v[92:95]
v_exp_f32 v29, v81
v_add_f32 v24, v24, v28
v_mfma_f32_16x16x32_bf16 v[96:99], a[200:203], a[100:103], 0
v_exp_f32 v30, v82
v_cvt_pk_bf16_f32 v46, v28, v29
v_mfma_f32_16x16x32_bf16 v[96:99], a[204:207], a[112:115], v[96:99]
v_exp_f32 v31, v83
v_add_f32 v24, v24, v29
v_mfma_f32_16x16x32_bf16 v[100:103], a[200:203], a[104:107], 0
ds_read_b128 a[200:203], v1 offset:52224
v_cvt_pk_bf16_f32 v47, v30, v31
v_add_f32 v24, v24, v30
v_mfma_f32_16x16x32_bf16 v[100:103], a[204:207], a[116:119], v[100:103]
s_waitcnt lgkmcnt(1)
ds_read_b128 a[204:207], v2 offset:52224
v_add_f32 v24, v24, v31
v_fma_f32 v84, v84, s24, v13
v_mfma_f32_16x16x32_bf16 v[92:95], a[208:211], a[120:123], v[92:95]
v_exp_f32 v20, v84
v_fma_f32 v85, v85, s24, v13
v_mfma_f32_16x16x32_bf16 v[92:95], a[212:215], a[132:135], v[92:95]
v_exp_f32 v21, v85
v_mfma_f32_16x16x32_bf16 v[96:99], a[208:211], a[124:127], v[96:99]
v_fma_f32 v86, v86, s24, v13
v_fma_f32 v87, v87, s24, v13
v_cvt_pk_bf16_f32 v50, v20, v21
v_mfma_f32_16x16x32_bf16 v[96:99], a[212:215], a[136:139], v[96:99]
v_exp_f32 v28, v86
v_add_f32 v26, v26, v20
v_mfma_f32_16x16x32_bf16 v[100:103], a[208:211], a[128:131], v[100:103]
ds_read_b128 a[208:211], v1 offset:57344
v_add_f32 v26, v26, v21
v_exp_f32 v29, v87
v_mfma_f32_16x16x32_bf16 v[100:103], a[212:215], a[140:143], v[100:103]
ds_read_b128 a[212:215], v2 offset:57344
v_cvt_pk_bf16_f32 v51, v28, v29
v_mfma_f32_16x16x32_bf16 v[92:95], a[192:195], a[144:147], v[92:95]
v_add_f32 v26, v26, v28
v_add_f32 v26, v26, v29
v_fma_f32 v88, v88, s24, v15
v_mfma_f32_16x16x32_bf16 v[92:95], a[196:199], a[156:159], v[92:95]
v_exp_f32 v30, v88
v_fma_f32 v89, v89, s24, v15
v_mfma_f32_16x16x32_bf16 v[96:99], a[192:195], a[148:151], v[96:99]
v_exp_f32 v31, v89
v_mfma_f32_16x16x32_bf16 v[96:99], a[196:199], a[160:163], v[96:99]
v_fma_f32 v90, v90, s24, v15
v_fma_f32 v91, v91, s24, v15
v_cvt_pk_bf16_f32 v54, v30, v31
v_mfma_f32_16x16x32_bf16 v[100:103], a[192:195], a[152:155], v[100:103]
ds_read_b128 a[192:195], v1 offset:58368
v_add_f32 v27, v27, v30
v_exp_f32 v20, v90
v_mfma_f32_16x16x32_bf16 v[100:103], a[196:199], a[164:167], v[100:103]
s_waitcnt lgkmcnt(1)
ds_read_b128 a[196:199], v2 offset:58368
v_add_f32 v27, v27, v31
v_mfma_f32_16x16x32_bf16 v[92:95], a[200:203], a[168:171], v[92:95]
v_exp_f32 v21, v91
v_add_f32 v27, v27, v20
v_mfma_f32_16x16x32_bf16 v[92:95], a[204:207], a[180:183], v[92:95]
v_cvt_pk_bf16_f32 v55, v20, v21
v_add_f32 v27, v27, v21
v_mfma_f32_16x16x32_bf16 v[96:99], a[200:203], a[172:175], v[96:99]
v_max3_f32 v25, v24, v26, v27
v_cmp_lt_f32 vcc, s25, v25
v_mfma_f32_16x16x32_bf16 v[96:99], a[204:207], a[184:187], v[96:99]
s_cbranch_vccnz STUB_30
BACK_30:
v_mfma_f32_16x16x32_bf16 v[100:103], a[200:203], a[176:179], v[100:103]
ds_read_b128 a[200:203], v1 offset:59392
v_add_f32 v19, v19, v27
v_add_f32 v17, v17, v24
v_mfma_f32_16x16x32_bf16 v[100:103], a[204:207], a[188:191], v[100:103]
s_waitcnt vmcnt(4)
ds_read_b128 a[204:207], v2 offset:59392
v_add_f32 v18, v18, v26
v_fma_f32 v92, v92, s24, v11
v_mfma_f32_16x16x32_bf16 v[80:83], a[208:211], a[96:99], 0
s_barrier
v_fma_f32 v93, v93, s24, v11
v_fma_f32 v94, v94, s24, v11
v_mfma_f32_16x16x32_bf16 v[80:83], a[212:215], a[108:111], v[80:83]
v_exp_f32 v28, v92
v_fma_f32 v95, v95, s24, v11
v_mfma_f32_16x16x32_bf16 v[84:87], a[208:211], a[100:103], 0
v_exp_f32 v29, v93
v_exp_f32 v30, v94
v_mfma_f32_16x16x32_bf16 v[84:87], a[212:215], a[112:115], v[84:87]
v_exp_f32 v31, v95
v_mfma_f32_16x16x32_bf16 v[88:91], a[208:211], a[104:107], 0
ds_read_b128 a[208:211], v1 offset:60416
v_cvt_pk_bf16_f32 v68, v28, v29
v_add_f32 v24, v28, v29
v_mfma_f32_16x16x32_bf16 v[88:91], a[212:215], a[116:119], v[88:91]
s_waitcnt lgkmcnt(1)
ds_read_b128 a[212:215], v2 offset:60416
v_cvt_pk_bf16_f32 v69, v30, v31
v_add_f32 v24, v24, v30
v_mfma_f32_16x16x32_bf16 v[80:83], a[192:195], a[120:123], v[80:83]
v_add_f32 v24, v24, v31
v_fma_f32 v96, v96, s24, v13
v_fma_f32 v97, v97, s24, v13
v_mfma_f32_16x16x32_bf16 v[80:83], a[196:199], a[132:135], v[80:83]
v_exp_f32 v20, v96
v_fma_f32 v98, v98, s24, v13
v_mfma_f32_16x16x32_bf16 v[84:87], a[192:195], a[124:127], v[84:87]
v_exp_f32 v21, v97
v_fma_f32 v99, v99, s24, v13
v_mfma_f32_16x16x32_bf16 v[84:87], a[196:199], a[136:139], v[84:87]
v_exp_f32 v28, v98
v_cvt_pk_bf16_f32 v72, v20, v21
v_mfma_f32_16x16x32_bf16 v[88:91], a[192:195], a[128:131], v[88:91]
ds_read_b64_tr_b16 a[192:193], v3 offset:32768
v_add_f32 v26, v20, v21
v_exp_f32 v29, v99
v_mfma_f32_16x16x32_bf16 v[88:91], a[196:199], a[140:143], v[88:91]
ds_read_b64_tr_b16 a[194:195], v3 offset:36864
v_cvt_pk_bf16_f32 v73, v28, v29
v_mfma_f32_16x16x32_bf16 v[80:83], a[200:203], a[144:147], v[80:83]
v_add_f32 v26, v26, v28
v_add_f32 v26, v26, v29
v_fma_f32 v100, v100, s24, v15
v_mfma_f32_16x16x32_bf16 v[80:83], a[204:207], a[156:159], v[80:83]
ds_read_b64_tr_b16 a[196:197], v3 offset:40960
v_fma_f32 v101, v101, s24, v15
v_fma_f32 v102, v102, s24, v15
v_mfma_f32_16x16x32_bf16 v[84:87], a[200:203], a[148:151], v[84:87]
ds_read_b64_tr_b16 a[198:199], v3 offset:45056
v_fma_f32 v103, v103, s24, v15
v_exp_f32 v30, v100
v_mfma_f32_16x16x32_bf16 v[84:87], a[204:207], a[160:163], v[84:87]
v_exp_f32 v31, v101
v_mfma_f32_16x16x32_bf16 v[88:91], a[200:203], a[152:155], v[88:91]
ds_read_b64_tr_b16 a[200:201], v4 offset:32768
v_cvt_pk_bf16_f32 v76, v30, v31
v_add_f32 v27, v30, v31
v_mfma_f32_16x16x32_bf16 v[88:91], a[204:207], a[164:167], v[88:91]
s_waitcnt lgkmcnt(3)
ds_read_b64_tr_b16 a[202:203], v4 offset:36864
v_subrev_u32 v22, 65536, v3
v_exp_f32 v20, v102
v_mfma_f32_16x16x32_bf16 v[80:83], a[208:211], a[168:171], v[80:83]
v_exp_f32 v21, v103
v_mfma_f32_16x16x32_bf16 v[80:83], a[212:215], a[180:183], v[80:83]
ds_read_b64_tr_b16 a[204:205], v4 offset:40960
v_cvt_pk_bf16_f32 v77, v20, v21
v_add_f32 v27, v27, v20
v_mfma_f32_16x16x32_bf16 v[84:87], a[208:211], a[172:175], v[84:87]
ds_read_b64_tr_b16 a[206:207], v4 offset:45056
v_add_f32 v27, v27, v21
v_subrev_u32 v23, 65536, v4
v_mfma_f32_16x16x32_bf16 v[84:87], a[212:215], a[184:187], v[84:87]
v_fma_f32 v80, v80, s24, v11
v_fma_f32 v81, v81, s24, v11
v_fma_f32 v82, v82, s24, v11
v_fma_f32 v83, v83, s24, v11
v_mfma_f32_16x16x32_bf16 v[88:91], a[208:211], a[176:179], v[88:91]
ds_read_b64_tr_b16 a[208:209], v5 offset:32768
v_exp_f32 v28, v80
v_mfma_f32_16x16x32_bf16 v[88:91], a[212:215], a[188:191], v[88:91]
ds_read_b64_tr_b16 a[210:211], v5 offset:36864
v_add_f32 v24, v24, v28
v_mfma_f32_16x16x32_bf16 v[104:107], a[192:195], a[0:3], v[104:107]
s_waitcnt lgkmcnt(4)
v_exp_f32 v29, v81
v_exp_f32 v30, v82
v_mfma_f32_16x16x32_bf16 v[104:107], a[196:199], a[12:15], v[104:107]
ds_read_b64_tr_b16 a[212:213], v5 offset:40960
v_cvt_pk_bf16_f32 v70, v28, v29
v_mfma_f32_16x16x32_bf16 v[108:111], a[192:195], a[4:7], v[108:111]
ds_read_b64_tr_b16 a[214:215], v5 offset:45056
v_add_f32 v24, v24, v29
v_exp_f32 v31, v83
v_mfma_f32_16x16x32_bf16 v[108:111], a[196:199], a[16:19], v[108:111]
v_cvt_pk_bf16_f32 v71, v30, v31
v_add_f32 v24, v24, v30
v_mfma_f32_16x16x32_bf16 v[112:115], a[192:195], a[8:11], v[112:115]
ds_read_b64_tr_b16 a[192:193], v6 offset:32768
v_add_f32 v24, v24, v31
v_fma_f32 v84, v84, s24, v13
v_mfma_f32_16x16x32_bf16 v[112:115], a[196:199], a[20:23], v[112:115]
ds_read_b64_tr_b16 a[194:195], v6 offset:36864
v_fma_f32 v85, v85, s24, v13
v_fma_f32 v86, v86, s24, v13
v_mfma_f32_16x16x32_bf16 v[116:119], a[200:203], a[0:3], v[116:119]
s_waitcnt lgkmcnt(4)
v_exp_f32 v20, v84
v_fma_f32 v87, v87, s24, v13
v_exp_f32 v21, v85
v_mfma_f32_16x16x32_bf16 v[116:119], a[204:207], a[12:15], v[116:119]
ds_read_b64_tr_b16 a[196:197], v6 offset:40960
v_cvt_pk_bf16_f32 v74, v20, v21
PADJ_14:
s_cbranch_execz PADJ_18
v_mfma_f32_16x16x32_bf16 v[120:123], a[200:203], a[4:7], v[120:123]
ds_read_b64_tr_b16 a[198:199], v6 offset:45056
v_add_f32 v26, v26, v20
v_exp_f32 v28, v86
v_mfma_f32_16x16x32_bf16 v[120:123], a[204:207], a[16:19], v[120:123]
v_exp_f32 v29, v87
v_mfma_f32_16x16x32_bf16 v[124:127], a[200:203], a[8:11], v[124:127]
ds_read_b64_tr_b16 a[200:201], v3 offset:0
v_add_f32 v26, v26, v21
v_cvt_pk_bf16_f32 v75, v28, v29
v_mfma_f32_16x16x32_bf16 v[124:127], a[204:207], a[20:23], v[124:127]
ds_read_b64_tr_b16 a[202:203], v3 offset:4096
v_add_f32 v26, v26, v28
v_fma_f32 v88, v88, s24, v15
v_mfma_f32_16x16x32_bf16 v[128:131], a[208:211], a[0:3], v[128:131]
s_waitcnt lgkmcnt(4)
v_exp_f32 v30, v88
v_add_f32 v26, v26, v29
v_mfma_f32_16x16x32_bf16 v[128:131], a[212:215], a[12:15], v[128:131]
ds_read_b64_tr_b16 a[204:205], v3 offset:8192
v_fma_f32 v89, v89, s24, v15
v_fma_f32 v90, v90, s24, v15
v_mfma_f32_16x16x32_bf16 v[132:135], a[208:211], a[4:7], v[132:135]
ds_read_b64_tr_b16 a[206:207], v3 offset:12288
v_fma_f32 v91, v91, s24, v15
v_exp_f32 v31, v89
v_mfma_f32_16x16x32_bf16 v[132:135], a[212:215], a[16:19], v[132:135]
v_exp_f32 v20, v90
v_mfma_f32_16x16x32_bf16 v[136:139], a[208:211], a[8:11], v[136:139]
ds_read_b64_tr_b16 a[208:209], v4 offset:0
v_cvt_pk_bf16_f32 v78, v30, v31
v_add_f32 v27, v27, v30
v_exp_f32 v21, v91
v_mfma_f32_16x16x32_bf16 v[136:139], a[212:215], a[20:23], v[136:139]
ds_read_b64_tr_b16 a[210:211], v4 offset:4096
v_add_f32 v27, v27, v31
v_mfma_f32_16x16x32_bf16 v[140:143], a[192:195], a[0:3], v[140:143]
s_waitcnt lgkmcnt(4)
v_cvt_pk_bf16_f32 v79, v20, v21
v_add_f32 v27, v27, v20
v_mfma_f32_16x16x32_bf16 v[140:143], a[196:199], a[12:15], v[140:143]
ds_read_b64_tr_b16 a[212:213], v4 offset:8192
v_add_f32 v27, v27, v21
v_subrev_u32 v1, 65536, v5
v_mfma_f32_16x16x32_bf16 v[144:147], a[192:195], a[4:7], v[144:147]
ds_read_b64_tr_b16 a[214:215], v4 offset:12288
v_max3_f32 v25, v24, v26, v27
v_subrev_u32 v2, 65536, v6
v_mfma_f32_16x16x32_bf16 v[144:147], a[196:199], a[16:19], v[144:147]
v_cmp_lt_f32 vcc, s25, v25
s_nop 0
s_cbranch_vccnz STUB_31
BACK_31:
v_mfma_f32_16x16x32_bf16 v[148:151], a[192:195], a[8:11], v[148:151]
ds_read_b64_tr_b16 a[192:193], v5 offset:0
v_add_f32 v16, v19, v27
v_mfma_f32_16x16x32_bf16 v[148:151], a[196:199], a[20:23], v[148:151]
ds_read_b64_tr_b16 a[194:195], v5 offset:4096
v_add_f32 v12, v17, v24
v_mfma_f32_16x16x32_bf16 v[104:107], a[200:203], v[56:59], v[104:107]
s_waitcnt lgkmcnt(4)
v_add_f32 v14, v18, v26
v_mov_b32 v21, v16
v_mfma_f32_16x16x32_bf16 v[104:107], a[204:207], v[32:35], v[104:107]
ds_read_b64_tr_b16 a[196:197], v5 offset:8192
v_mov_b32 v31, v12
v_mfma_f32_16x16x32_bf16 v[108:111], a[200:203], v[60:63], v[108:111]
ds_read_b64_tr_b16 a[198:199], v5 offset:12288
v_mov_b32 v20, v14
v_mfma_f32_16x16x32_bf16 v[108:111], a[204:207], v[36:39], v[108:111]
v_permlane16_swap_b32 v16, v21
v_mfma_f32_16x16x32_bf16 v[112:115], a[200:203], v[64:67], v[112:115]
ds_read_b64_tr_b16 a[200:201], v6 offset:0
v_add_f32 v16, v16, v21
v_mfma_f32_16x16x32_bf16 v[112:115], a[204:207], v[40:43], v[112:115]
ds_read_b64_tr_b16 a[202:203], v6 offset:4096
v_mov_b32 v21, v16
v_mfma_f32_16x16x32_bf16 v[116:119], a[208:211], v[56:59], v[116:119]
s_waitcnt lgkmcnt(4)
v_permlane16_swap_b32 v12, v31
v_mfma_f32_16x16x32_bf16 v[116:119], a[212:215], v[32:35], v[116:119]
ds_read_b64_tr_b16 a[204:205], v6 offset:8192
v_add_f32 v12, v12, v31
v_mfma_f32_16x16x32_bf16 v[120:123], a[208:211], v[60:63], v[120:123]
ds_read_b64_tr_b16 a[206:207], v6 offset:12288
v_mov_b32 v31, v12
v_mfma_f32_16x16x32_bf16 v[120:123], a[212:215], v[36:39], v[120:123]
v_permlane16_swap_b32 v14, v20
v_mfma_f32_16x16x32_bf16 v[124:127], a[208:211], v[64:67], v[124:127]
ds_read_b64_tr_b16 a[208:209], v22 offset:0
v_add_f32 v14, v14, v20
v_mfma_f32_16x16x32_bf16 v[124:127], a[212:215], v[40:43], v[124:127]
ds_read_b64_tr_b16 a[210:211], v22 offset:4096
v_mov_b32 v20, v14
v_mfma_f32_16x16x32_bf16 v[128:131], a[192:195], v[56:59], v[128:131]
s_waitcnt lgkmcnt(4)
v_permlane32_swap_b32 v16, v21
v_mfma_f32_16x16x32_bf16 v[128:131], a[196:199], v[32:35], v[128:131]
ds_read_b64_tr_b16 a[212:213], v22 offset:8192
v_add_f32 v16, v16, v21
v_mfma_f32_16x16x32_bf16 v[132:135], a[192:195], v[60:63], v[132:135]
ds_read_b64_tr_b16 a[214:215], v22 offset:12288
v_mfma_f32_16x16x32_bf16 v[132:135], a[196:199], v[36:39], v[132:135]
v_permlane32_swap_b32 v12, v31
v_mfma_f32_16x16x32_bf16 v[136:139], a[192:195], v[64:67], v[136:139]
ds_read_b64_tr_b16 a[192:193], v23 offset:0
v_add_f32 v12, v12, v31
v_mfma_f32_16x16x32_bf16 v[136:139], a[196:199], v[40:43], v[136:139]
ds_read_b64_tr_b16 a[194:195], v23 offset:4096
v_mfma_f32_16x16x32_bf16 v[140:143], a[200:203], v[56:59], v[140:143]
s_waitcnt lgkmcnt(4)
v_permlane32_swap_b32 v14, v20
v_mfma_f32_16x16x32_bf16 v[140:143], a[204:207], v[32:35], v[140:143]
ds_read_b64_tr_b16 a[196:197], v23 offset:8192
v_add_f32 v14, v14, v20
v_mfma_f32_16x16x32_bf16 v[144:147], a[200:203], v[60:63], v[144:147]
ds_read_b64_tr_b16 a[198:199], v23 offset:12288
v_mfma_f32_16x16x32_bf16 v[144:147], a[204:207], v[36:39], v[144:147]
v_rcp_f32 v16, v16
v_mfma_f32_16x16x32_bf16 v[148:151], a[200:203], v[64:67], v[148:151]
ds_read_b64_tr_b16 a[200:201], v1 offset:0
v_mfma_f32_16x16x32_bf16 v[148:151], a[204:207], v[40:43], v[148:151]
ds_read_b64_tr_b16 a[202:203], v1 offset:4096
v_mfma_f32_16x16x32_bf16 v[104:107], a[208:211], v[44:47], v[104:107]
s_waitcnt lgkmcnt(4)
v_rcp_f32 v12, v12
v_mfma_f32_16x16x32_bf16 v[104:107], a[212:215], v[68:71], v[104:107]
ds_read_b64_tr_b16 a[204:205], v1 offset:8192
v_xor_b32 v0, 96, v0
v_mfma_f32_16x16x32_bf16 v[108:111], a[208:211], v[48:51], v[108:111]
ds_read_b64_tr_b16 a[206:207], v1 offset:12288
v_mfma_f32_16x16x32_bf16 v[108:111], a[212:215], v[72:75], v[108:111]
v_rcp_f32 v14, v14
v_mfma_f32_16x16x32_bf16 v[112:115], a[208:211], v[52:55], v[112:115]
ds_read_b64_tr_b16 a[208:209], v2 offset:0
v_mul_f32 v104, v104, v12
v_mfma_f32_16x16x32_bf16 v[112:115], a[212:215], v[76:79], v[112:115]
ds_read_b64_tr_b16 a[210:211], v2 offset:4096
v_mul_f32 v105, v105, v12
v_mfma_f32_16x16x32_bf16 v[116:119], a[192:195], v[44:47], v[116:119]
s_waitcnt lgkmcnt(4)
v_cvt_pk_bf16_f32 v104, v104, v105
v_mul_f32 v106, v106, v12
v_mfma_f32_16x16x32_bf16 v[116:119], a[196:199], v[68:71], v[116:119]
ds_read_b64_tr_b16 a[212:213], v2 offset:8192
v_mul_f32 v107, v107, v12
v_mfma_f32_16x16x32_bf16 v[120:123], a[192:195], v[48:51], v[120:123]
ds_read_b64_tr_b16 a[214:215], v2 offset:12288
v_cvt_pk_bf16_f32 v105, v106, v107
v_mfma_f32_16x16x32_bf16 v[120:123], a[196:199], v[72:75], v[120:123]
ds_write_b64 v0, v[104:105] offset:0
v_mfma_f32_16x16x32_bf16 v[124:127], a[192:195], v[52:55], v[124:127]
ds_read_b64_tr_b16 a[192:193], v3 offset:33792
v_mfma_f32_16x16x32_bf16 v[124:127], a[196:199], v[76:79], v[124:127]
ds_read_b64_tr_b16 a[194:195], v3 offset:37888
v_mul_f32 v108, v108, v14
v_mfma_f32_16x16x32_bf16 v[128:131], a[200:203], v[44:47], v[128:131]
s_waitcnt lgkmcnt(5)
v_mul_f32 v109, v109, v14
v_mul_f32 v110, v110, v14
v_mfma_f32_16x16x32_bf16 v[128:131], a[204:207], v[68:71], v[128:131]
ds_read_b64_tr_b16 a[196:197], v3 offset:41984
v_mul_f32 v111, v111, v14
v_mfma_f32_16x16x32_bf16 v[132:135], a[200:203], v[48:51], v[132:135]
ds_read_b64_tr_b16 a[198:199], v3 offset:46080
v_cvt_pk_bf16_f32 v108, v108, v109
v_mfma_f32_16x16x32_bf16 v[132:135], a[204:207], v[72:75], v[132:135]
v_cvt_pk_bf16_f32 v109, v110, v111
v_mul_f32 v112, v112, v16
v_mfma_f32_16x16x32_bf16 v[136:139], a[200:203], v[52:55], v[136:139]
ds_read_b64_tr_b16 a[200:201], v3 offset:1024
v_mul_f32 v113, v113, v16
v_mfma_f32_16x16x32_bf16 v[136:139], a[204:207], v[76:79], v[136:139]
ds_read_b64_tr_b16 a[202:203], v3 offset:5120
v_cvt_pk_bf16_f32 v112, v112, v113
v_mfma_f32_16x16x32_bf16 v[140:143], a[208:211], v[44:47], v[140:143]
s_waitcnt lgkmcnt(4)
ds_write_b64 v0, v[108:109] offset:2048
v_mfma_f32_16x16x32_bf16 v[140:143], a[212:215], v[68:71], v[140:143]
ds_read_b64_tr_b16 a[204:205], v3 offset:9216
v_mfma_f32_16x16x32_bf16 v[144:147], a[208:211], v[48:51], v[144:147]
ds_read_b64_tr_b16 a[206:207], v3 offset:13312
v_mul_f32 v114, v114, v16
v_mfma_f32_16x16x32_bf16 v[144:147], a[212:215], v[72:75], v[144:147]
v_mul_f32 v115, v115, v16
v_mul_f32 v116, v116, v12
v_mfma_f32_16x16x32_bf16 v[148:151], a[208:211], v[52:55], v[148:151]
ds_read_b64_tr_b16 a[208:209], v22 offset:1024
v_cvt_pk_bf16_f32 v113, v114, v115
v_mfma_f32_16x16x32_bf16 v[148:151], a[212:215], v[76:79], v[148:151]
ds_read_b64_tr_b16 a[210:211], v22 offset:5120
v_mul_f32 v117, v117, v12
v_mfma_f32_16x16x32_bf16 v[152:155], a[192:195], a[0:3], v[152:155]
s_waitcnt lgkmcnt(5)
ds_write_b64 v0, v[112:113] offset:4096
v_cvt_pk_bf16_f32 v116, v116, v117
v_mfma_f32_16x16x32_bf16 v[152:155], a[196:199], a[12:15], v[152:155]
ds_read_b64_tr_b16 a[212:213], v22 offset:9216
v_xor_b32 v0, 32, v0
v_mfma_f32_16x16x32_bf16 v[156:159], a[192:195], a[4:7], v[156:159]
ds_read_b64_tr_b16 a[214:215], v22 offset:13312
v_mul_f32 v118, v118, v12
v_mfma_f32_16x16x32_bf16 v[156:159], a[196:199], a[16:19], v[156:159]
v_mul_f32 v119, v119, v12
v_mul_f32 v120, v120, v14
v_mfma_f32_16x16x32_bf16 v[160:163], a[192:195], a[8:11], v[160:163]
ds_read_b64_tr_b16 a[192:193], v4 offset:33792
v_cvt_pk_bf16_f32 v117, v118, v119
v_mfma_f32_16x16x32_bf16 v[160:163], a[196:199], a[20:23], v[160:163]
ds_read_b64_tr_b16 a[194:195], v4 offset:37888
v_mul_f32 v121, v121, v14
v_mfma_f32_16x16x32_bf16 v[152:155], a[200:203], v[56:59], v[152:155]
s_waitcnt lgkmcnt(5)
ds_write_b64 v0, v[116:117] offset:0
v_cvt_pk_bf16_f32 v120, v120, v121
v_mfma_f32_16x16x32_bf16 v[152:155], a[204:207], v[32:35], v[152:155]
ds_read_b64_tr_b16 a[196:197], v4 offset:41984
v_mul_f32 v122, v122, v14
v_mfma_f32_16x16x32_bf16 v[156:159], a[200:203], v[60:63], v[156:159]
ds_read_b64_tr_b16 a[198:199], v4 offset:46080
v_mul_f32 v123, v123, v14
v_mfma_f32_16x16x32_bf16 v[156:159], a[204:207], v[36:39], v[156:159]
v_cvt_pk_bf16_f32 v121, v122, v123
v_mul_f32 v124, v124, v16
v_mfma_f32_16x16x32_bf16 v[160:163], a[200:203], v[64:67], v[160:163]
ds_read_b64_tr_b16 a[200:201], v4 offset:1024
ds_write_b64 v0, v[120:121] offset:2048
v_mul_f32 v125, v125, v16
v_pk_mul_f32 v[126:127], v[126:127], v[16:17] op_sel_hi:[1,0]
v_pk_mul_f32 v[128:129], v[128:129], v[12:13] op_sel_hi:[1,0]
v_pk_mul_f32 v[130:131], v[130:131], v[12:13] op_sel_hi:[1,0]
v_pk_mul_f32 v[132:133], v[132:133], v[14:15] op_sel_hi:[1,0]
v_pk_mul_f32 v[134:135], v[134:135], v[14:15] op_sel_hi:[1,0]
v_pk_mul_f32 v[136:137], v[136:137], v[16:17] op_sel_hi:[1,0]
v_mfma_f32_16x16x32_bf16 v[160:163], a[204:207], v[40:43], v[160:163]
ds_read_b64_tr_b16 a[202:203], v4 offset:5120
v_cvt_pk_bf16_f32 v124, v124, v125
v_mfma_f32_16x16x32_bf16 v[152:155], a[208:211], v[44:47], v[152:155]
s_waitcnt lgkmcnt(6)
v_cvt_pk_bf16_f32 v125, v126, v127
v_cvt_pk_bf16_f32 v128, v128, v129
v_mfma_f32_16x16x32_bf16 v[152:155], a[212:215], v[68:71], v[152:155]
ds_read_b64_tr_b16 a[204:205], v4 offset:9216
ds_write_b64 v0, v[124:125] offset:4096
v_cvt_pk_bf16_f32 v129, v130, v131
v_pk_mul_f32 v[138:139], v[138:139], v[16:17] op_sel_hi:[1,0]
v_pk_mul_f32 v[140:141], v[140:141], v[12:13] op_sel_hi:[1,0]
v_pk_mul_f32 v[142:143], v[142:143], v[12:13] op_sel_hi:[1,0]
v_pk_mul_f32 v[144:145], v[144:145], v[14:15] op_sel_hi:[1,0]
v_pk_mul_f32 v[146:147], v[146:147], v[14:15] op_sel_hi:[1,0]
v_pk_mul_f32 v[148:149], v[148:149], v[16:17] op_sel_hi:[1,0]
v_mfma_f32_16x16x32_bf16 v[156:159], a[208:211], v[48:51], v[156:159]
ds_read_b64_tr_b16 a[206:207], v4 offset:13312
v_xor_b32 v0, 96, v0
v_mfma_f32_16x16x32_bf16 v[156:159], a[212:215], v[72:75], v[156:159]
ds_write_b64 v0, v[128:129] offset:0
v_cvt_pk_bf16_f32 v132, v132, v133
v_mfma_f32_16x16x32_bf16 v[160:163], a[208:211], v[52:55], v[160:163]
ds_read_b64_tr_b16 a[208:209], v23 offset:1024
v_cvt_pk_bf16_f32 v133, v134, v135
v_mfma_f32_16x16x32_bf16 v[160:163], a[212:215], v[76:79], v[160:163]
ds_read_b64_tr_b16 a[210:211], v23 offset:5120
ds_write_b64 v0, v[132:133] offset:2048
v_cvt_pk_bf16_f32 v136, v136, v137
v_pk_mul_f32 v[150:151], v[150:151], v[16:17] op_sel_hi:[1,0]
v_pk_mul_f32 v[152:153], v[152:153], v[12:13] op_sel_hi:[1,0]
v_pk_mul_f32 v[154:155], v[154:155], v[12:13] op_sel_hi:[1,0]
v_pk_mul_f32 v[156:157], v[156:157], v[14:15] op_sel_hi:[1,0]
v_pk_mul_f32 v[158:159], v[158:159], v[14:15] op_sel_hi:[1,0]
v_pk_mul_f32 v[160:161], v[160:161], v[16:17] op_sel_hi:[1,0]
v_mfma_f32_16x16x32_bf16 v[164:167], a[192:195], a[0:3], v[164:167]
s_waitcnt lgkmcnt(7)
v_cvt_pk_bf16_f32 v137, v138, v139
v_cvt_pk_bf16_f32 v140, v140, v141
v_mfma_f32_16x16x32_bf16 v[164:167], a[196:199], a[12:15], v[164:167]
ds_read_b64_tr_b16 a[212:213], v23 offset:9216
ds_write_b64 v0, v[136:137] offset:4096
v_cvt_pk_bf16_f32 v141, v142, v143
v_pk_mul_f32 v[162:163], v[162:163], v[16:17] op_sel_hi:[1,0]
v_mfma_f32_16x16x32_bf16 v[168:171], a[192:195], a[4:7], v[168:171]
ds_read_b64_tr_b16 a[214:215], v23 offset:13312
v_xor_b32 v0, 32, v0
v_mfma_f32_16x16x32_bf16 v[168:171], a[196:199], a[16:19], v[168:171]
ds_write_b64 v0, v[140:141] offset:0
v_cvt_pk_bf16_f32 v144, v144, v145
v_mfma_f32_16x16x32_bf16 v[172:175], a[192:195], a[8:11], v[172:175]
ds_read_b64_tr_b16 a[192:193], v5 offset:33792
ds_read_b128 a[96:99], v9 offset:0
ds_read_b128 a[100:103], v9 offset:1024
v_mfma_f32_16x16x32_bf16 v[172:175], a[196:199], a[20:23], v[172:175]
ds_read_b64_tr_b16 a[194:195], v5 offset:37888
v_cvt_pk_bf16_f32 v145, v146, v147
v_mfma_f32_16x16x32_bf16 v[164:167], a[200:203], v[56:59], v[164:167]
s_waitcnt lgkmcnt(9)
ds_write_b64 v0, v[144:145] offset:2048
v_cvt_pk_bf16_f32 v148, v148, v149
v_mfma_f32_16x16x32_bf16 v[164:167], a[204:207], v[32:35], v[164:167]
ds_read_b64_tr_b16 a[196:197], v5 offset:41984
v_cvt_pk_bf16_f32 v149, v150, v151
v_mfma_f32_16x16x32_bf16 v[168:171], a[200:203], v[60:63], v[168:171]
ds_read_b64_tr_b16 a[198:199], v5 offset:46080
ds_read_b128 a[104:107], v9 offset:2048
v_mfma_f32_16x16x32_bf16 v[168:171], a[204:207], v[36:39], v[168:171]
v_cvt_pk_bf16_f32 v152, v152, v153
v_cvt_pk_bf16_f32 v153, v154, v155
v_mfma_f32_16x16x32_bf16 v[172:175], a[200:203], v[64:67], v[172:175]
ds_read_b64_tr_b16 a[200:201], v5 offset:1024
ds_read_b128 a[108:111], v9 offset:3072
v_mfma_f32_16x16x32_bf16 v[172:175], a[204:207], v[40:43], v[172:175]
ds_read_b64_tr_b16 a[202:203], v5 offset:5120
ds_write_b64 v0, v[148:149] offset:4096
v_xor_b32 v0, 96, v0
v_mfma_f32_16x16x32_bf16 v[164:167], a[208:211], v[44:47], v[164:167]
s_waitcnt lgkmcnt(8)
v_cvt_pk_bf16_f32 v156, v156, v157
v_cvt_pk_bf16_f32 v157, v158, v159
v_mfma_f32_16x16x32_bf16 v[164:167], a[212:215], v[68:71], v[164:167]
s_add_u32 s89, s29, s84
buffer_store_dwordx4 a[96:99], v8, s[20:23], s89 offen nt
ds_read_b64_tr_b16 a[204:205], v5 offset:9216
ds_read_b128 a[112:115], v9 offset:4096
ds_read_b128 a[116:119], v9 offset:5120
v_mfma_f32_16x16x32_bf16 v[168:171], a[208:211], v[48:51], v[168:171]
ds_read_b64_tr_b16 a[206:207], v5 offset:13312
v_cvt_pk_bf16_f32 v160, v160, v161
v_mfma_f32_16x16x32_bf16 v[168:171], a[212:215], v[72:75], v[168:171]
ds_write_b64 v0, v[152:153] offset:0
v_cvt_pk_bf16_f32 v161, v162, v163
v_mfma_f32_16x16x32_bf16 v[172:175], a[208:211], v[52:55], v[172:175]
ds_read_b64_tr_b16 a[208:209], v1 offset:1024
v_mul_f32 v164, v164, v12
v_mfma_f32_16x16x32_bf16 v[172:175], a[212:215], v[76:79], v[172:175]
ds_read_b64_tr_b16 a[210:211], v1 offset:5120
v_mul_f32 v165, v165, v12
v_mfma_f32_16x16x32_bf16 v[176:179], a[192:195], a[0:3], v[176:179]
s_waitcnt lgkmcnt(8)
ds_write_b64 v0, v[156:157] offset:2048
v_cvt_pk_bf16_f32 v164, v164, v165
v_mfma_f32_16x16x32_bf16 v[176:179], a[196:199], a[12:15], v[176:179]
ds_read_b64_tr_b16 a[212:213], v1 offset:9216
v_mul_f32 v166, v166, v12
v_mfma_f32_16x16x32_bf16 v[180:183], a[192:195], a[4:7], v[180:183]
ds_read_b64_tr_b16 a[214:215], v1 offset:13312
v_mul_f32 v167, v167, v12
v_mfma_f32_16x16x32_bf16 v[180:183], a[196:199], a[16:19], v[180:183]
s_add_u32 s89, s78, s84
buffer_store_dwordx4 a[100:103], v8, s[20:23], s89 offen nt
v_pk_mul_f32 v[168:169], v[168:169], v[14:15] op_sel_hi:[1,0]
v_pk_mul_f32 v[170:171], v[170:171], v[14:15] op_sel_hi:[1,0]
v_pk_mul_f32 v[172:173], v[172:173], v[16:17] op_sel_hi:[1,0]
v_pk_mul_f32 v[174:175], v[174:175], v[16:17] op_sel_hi:[1,0]
v_mfma_f32_16x16x32_bf16 v[184:187], a[192:195], a[8:11], v[184:187]
ds_read_b64_tr_b16 a[192:193], v6 offset:33792
v_cvt_pk_bf16_f32 v165, v166, v167
v_mfma_f32_16x16x32_bf16 v[184:187], a[196:199], a[20:23], v[184:187]
ds_read_b64_tr_b16 a[194:195], v6 offset:37888
v_cvt_pk_bf16_f32 v168, v168, v169
v_mfma_f32_16x16x32_bf16 v[176:179], a[200:203], v[56:59], v[176:179]
s_waitcnt lgkmcnt(5)
ds_write_b64 v0, v[160:161] offset:4096
v_xor_b32 v0, 32, v0
v_mfma_f32_16x16x32_bf16 v[176:179], a[204:207], v[32:35], v[176:179]
ds_read_b64_tr_b16 a[196:197], v6 offset:41984
v_cvt_pk_bf16_f32 v169, v170, v171
v_mfma_f32_16x16x32_bf16 v[180:183], a[200:203], v[60:63], v[180:183]
ds_read_b64_tr_b16 a[198:199], v6 offset:46080
v_cvt_pk_bf16_f32 v172, v172, v173
v_mfma_f32_16x16x32_bf16 v[180:183], a[204:207], v[36:39], v[180:183]
s_add_u32 s89, s30, s84
buffer_store_dwordx4 a[104:107], v8, s[20:23], s89 offen nt
v_mfma_f32_16x16x32_bf16 v[184:187], a[200:203], v[64:67], v[184:187]
ds_read_b64_tr_b16 a[200:201], v6 offset:1024
v_cvt_pk_bf16_f32 v173, v174, v175
v_mfma_f32_16x16x32_bf16 v[184:187], a[204:207], v[40:43], v[184:187]
s_waitcnt vmcnt(3) lgkmcnt(4)
ds_read_b64_tr_b16 a[202:203], v6 offset:5120
v_mfma_f32_16x16x32_bf16 v[176:179], a[208:211], v[44:47], v[176:179]
s_barrier
v_mfma_f32_16x16x32_bf16 v[176:179], a[212:215], v[68:71], v[176:179]
ds_read_b64_tr_b16 a[204:205], v6 offset:9216
v_mfma_f32_16x16x32_bf16 v[180:183], a[208:211], v[48:51], v[180:183]
ds_read_b64_tr_b16 a[206:207], v6 offset:13312
v_mfma_f32_16x16x32_bf16 v[180:183], a[212:215], v[72:75], v[180:183]
s_add_u32 s89, s79, s84
buffer_store_dwordx4 a[108:111], v8, s[20:23], s89 offen nt
v_mfma_f32_16x16x32_bf16 v[184:187], a[208:211], v[52:55], v[184:187]
ds_read_b64_tr_b16 a[208:209], v2 offset:1024
v_mfma_f32_16x16x32_bf16 v[184:187], a[212:215], v[76:79], v[184:187]
ds_read_b64_tr_b16 a[210:211], v2 offset:5120
v_mul_f32 v176, v176, v12
v_mfma_f32_16x16x32_bf16 v[188:191], a[192:195], a[0:3], v[188:191]
s_waitcnt lgkmcnt(4)
ds_write_b64 v0, v[164:165] offset:0
v_mul_f32 v177, v177, v12
v_mfma_f32_16x16x32_bf16 v[188:191], a[196:199], a[12:15], v[188:191]
ds_read_b64_tr_b16 a[212:213], v2 offset:9216
v_cvt_pk_bf16_f32 v176, v176, v177
v_mfma_f32_16x16x32_bf16 v[192:195], a[192:195], a[4:7], v[192:195]
ds_read_b64_tr_b16 a[214:215], v2 offset:13312
v_mul_f32 v178, v178, v12
v_mfma_f32_16x16x32_bf16 v[192:195], a[196:199], a[16:19], v[192:195]
s_add_u32 s89, s31, s84
buffer_store_dwordx4 a[112:115], v8, s[20:23], s89 offen nt
v_pk_mul_f32 v[180:181], v[180:181], v[14:15] op_sel_hi:[1,0]
v_pk_mul_f32 v[182:183], v[182:183], v[14:15] op_sel_hi:[1,0]
v_pk_mul_f32 v[184:185], v[184:185], v[16:17] op_sel_hi:[1,0]
v_pk_mul_f32 v[186:187], v[186:187], v[16:17] op_sel_hi:[1,0]
v_mfma_f32_16x16x32_bf16 v[196:199], a[192:195], a[8:11], v[196:199]
ds_read_b64_tr_b16 a[192:193], v3 offset:49152
ds_write_b64 v0, v[168:169] offset:2048
v_mul_f32 v179, v179, v12
v_mfma_f32_16x16x32_bf16 v[196:199], a[196:199], a[20:23], v[196:199]
ds_read_b64_tr_b16 a[194:195], v3 offset:53248
v_cvt_pk_bf16_f32 v177, v178, v179
v_mfma_f32_16x16x32_bf16 v[188:191], a[200:203], v[56:59], v[188:191]
s_waitcnt lgkmcnt(6)
ds_write_b64 v0, v[172:173] offset:4096
v_xor_b32 v0, 96, v0
v_mfma_f32_16x16x32_bf16 v[188:191], a[204:207], v[32:35], v[188:191]
ds_read_b64_tr_b16 a[196:197], v3 offset:57344
v_cvt_pk_bf16_f32 v180, v180, v181
v_mfma_f32_16x16x32_bf16 v[192:195], a[200:203], v[60:63], v[192:195]
ds_read_b64_tr_b16 a[198:199], v3 offset:61440
v_cvt_pk_bf16_f32 v181, v182, v183
v_mfma_f32_16x16x32_bf16 v[192:195], a[204:207], v[36:39], v[192:195]
s_add_u32 s89, s80, s84
buffer_store_dwordx4 a[116:119], v8, s[20:23], s89 offen nt
v_mfma_f32_16x16x32_bf16 v[196:199], a[200:203], v[64:67], v[196:199]
ds_read_b64_tr_b16 a[200:201], v3 offset:16384
v_cvt_pk_bf16_f32 v184, v184, v185
v_mfma_f32_16x16x32_bf16 v[196:199], a[204:207], v[40:43], v[196:199]
ds_read_b64_tr_b16 a[202:203], v3 offset:20480
v_cvt_pk_bf16_f32 v185, v186, v187
v_mfma_f32_16x16x32_bf16 v[188:191], a[208:211], v[44:47], v[188:191]
s_waitcnt lgkmcnt(5)
ds_write_b64 v0, v[176:177] offset:0
v_mfma_f32_16x16x32_bf16 v[188:191], a[212:215], v[68:71], v[188:191]
ds_read_b64_tr_b16 a[204:205], v3 offset:24576
v_mfma_f32_16x16x32_bf16 v[192:195], a[208:211], v[48:51], v[192:195]
ds_read_b64_tr_b16 a[206:207], v3 offset:28672
v_mfma_f32_16x16x32_bf16 v[192:195], a[212:215], v[72:75], v[192:195]
ds_write_b64 v0, v[180:181] offset:2048
v_mfma_f32_16x16x32_bf16 v[196:199], a[208:211], v[52:55], v[196:199]
ds_read_b64_tr_b16 a[208:209], v22 offset:16384
v_mfma_f32_16x16x32_bf16 v[196:199], a[212:215], v[76:79], v[196:199]
ds_read_b64_tr_b16 a[210:211], v22 offset:20480
v_mul_f32 v188, v188, v12
v_mfma_f32_16x16x32_bf16 v[200:203], a[192:195], a[0:3], v[200:203]
s_waitcnt lgkmcnt(6)
ds_write_b64 v0, v[184:185] offset:4096
v_mul_f32 v189, v189, v12
v_mfma_f32_16x16x32_bf16 v[200:203], a[196:199], a[12:15], v[200:203]
ds_read_b64_tr_b16 a[212:213], v22 offset:24576
v_cvt_pk_bf16_f32 v188, v188, v189
v_mfma_f32_16x16x32_bf16 v[204:207], a[192:195], a[4:7], v[204:207]
ds_read_b64_tr_b16 a[214:215], v22 offset:28672
v_xor_b32 v0, 32, v0
v_mfma_f32_16x16x32_bf16 v[204:207], a[196:199], a[16:19], v[204:207]
v_mul_f32 v190, v190, v12
v_mul_f32 v191, v191, v12
v_mfma_f32_16x16x32_bf16 v[208:211], a[192:195], a[8:11], v[208:211]
ds_read_b64_tr_b16 a[192:193], v4 offset:49152
v_cvt_pk_bf16_f32 v189, v190, v191
v_mfma_f32_16x16x32_bf16 v[208:211], a[196:199], a[20:23], v[208:211]
ds_read_b64_tr_b16 a[194:195], v4 offset:53248
v_mul_f32 v192, v192, v14
v_mfma_f32_16x16x32_bf16 v[200:203], a[200:203], v[56:59], v[200:203]
s_waitcnt lgkmcnt(5)
ds_write_b64 v0, v[188:189] offset:0
v_mul_f32 v193, v193, v14
v_mfma_f32_16x16x32_bf16 v[200:203], a[204:207], v[32:35], v[200:203]
ds_read_b64_tr_b16 a[196:197], v4 offset:57344
ds_read_b128 a[120:123], v9 offset:0
ds_read_b128 a[124:127], v9 offset:1024
v_mfma_f32_16x16x32_bf16 v[204:207], a[200:203], v[60:63], v[204:207]
ds_read_b64_tr_b16 a[198:199], v4 offset:61440
v_cvt_pk_bf16_f32 v192, v192, v193
v_mfma_f32_16x16x32_bf16 v[204:207], a[204:207], v[36:39], v[204:207]
v_mul_f32 v194, v194, v14
v_mul_f32 v195, v195, v14
v_mfma_f32_16x16x32_bf16 v[208:211], a[200:203], v[64:67], v[208:211]
ds_read_b64_tr_b16 a[200:201], v4 offset:16384
v_cvt_pk_bf16_f32 v193, v194, v195
v_mfma_f32_16x16x32_bf16 v[208:211], a[204:207], v[40:43], v[208:211]
ds_read_b64_tr_b16 a[202:203], v4 offset:20480
v_mul_f32 v196, v196, v16
v_mfma_f32_16x16x32_bf16 v[200:203], a[208:211], v[44:47], v[200:203]
s_waitcnt lgkmcnt(7)
ds_write_b64 v0, v[192:193] offset:2048
v_mul_f32 v197, v197, v16
v_mfma_f32_16x16x32_bf16 v[200:203], a[212:215], v[68:71], v[200:203]
ds_read_b64_tr_b16 a[204:205], v4 offset:24576
ds_read_b128 a[128:131], v9 offset:2048
ds_read_b128 a[132:135], v9 offset:3072
v_mfma_f32_16x16x32_bf16 v[204:207], a[208:211], v[48:51], v[204:207]
ds_read_b64_tr_b16 a[206:207], v4 offset:28672
v_cvt_pk_bf16_f32 v196, v196, v197
v_mfma_f32_16x16x32_bf16 v[204:207], a[212:215], v[72:75], v[204:207]
v_mul_f32 v198, v198, v16
v_mul_f32 v199, v199, v16
v_mfma_f32_16x16x32_bf16 v[208:211], a[208:211], v[52:55], v[208:211]
ds_read_b64_tr_b16 a[208:209], v23 offset:16384
v_cvt_pk_bf16_f32 v197, v198, v199
v_mfma_f32_16x16x32_bf16 v[208:211], a[212:215], v[76:79], v[208:211]
ds_read_b64_tr_b16 a[210:211], v23 offset:20480
v_mul_f32 v200, v200, v12
v_mfma_f32_16x16x32_bf16 v[212:215], a[192:195], a[0:3], v[212:215]
s_waitcnt lgkmcnt(7)
ds_write_b64 v0, v[196:197] offset:4096
v_mul_f32 v201, v201, v12
v_mfma_f32_16x16x32_bf16 v[212:215], a[196:199], a[12:15], v[212:215]
s_add_u32 s89, s29, s85
buffer_store_dwordx4 a[120:123], v8, s[20:23], s89 offen nt
ds_read_b64_tr_b16 a[212:213], v23 offset:24576
ds_read_b128 a[136:139], v9 offset:4096
ds_read_b128 a[140:143], v9 offset:5120
v_pk_mul_f32 v[202:203], v[202:203], v[12:13] op_sel_hi:[1,0]
v_pk_mul_f32 v[204:205], v[204:205], v[14:15] op_sel_hi:[1,0]
v_pk_mul_f32 v[206:207], v[206:207], v[14:15] op_sel_hi:[1,0]
v_pk_mul_f32 v[208:209], v[208:209], v[16:17] op_sel_hi:[1,0]
v_pk_mul_f32 v[210:211], v[210:211], v[16:17] op_sel_hi:[1,0]
v_mfma_f32_16x16x32_bf16 v[216:219], a[192:195], a[4:7], v[216:219]
ds_read_b64_tr_b16 a[214:215], v23 offset:28672
v_cvt_pk_bf16_f32 v200, v200, v201
v_mfma_f32_16x16x32_bf16 v[216:219], a[196:199], a[16:19], v[216:219]
v_cvt_pk_bf16_f32 v201, v202, v203
v_xor_b32 v0, 96, v0
v_mfma_f32_16x16x32_bf16 v[220:223], a[192:195], a[8:11], v[220:223]
ds_read_b64_tr_b16 a[192:193], v5 offset:49152
v_cvt_pk_bf16_f32 v204, v204, v205
v_mfma_f32_16x16x32_bf16 v[220:223], a[196:199], a[20:23], v[220:223]
ds_read_b64_tr_b16 a[194:195], v5 offset:53248
v_cvt_pk_bf16_f32 v205, v206, v207
v_mfma_f32_16x16x32_bf16 v[212:215], a[200:203], v[56:59], v[212:215]
s_waitcnt lgkmcnt(7)
ds_write_b64 v0, v[200:201] offset:0
v_cvt_pk_bf16_f32 v208, v208, v209
v_mfma_f32_16x16x32_bf16 v[212:215], a[204:207], v[32:35], v[212:215]
ds_read_b64_tr_b16 a[196:197], v5 offset:57344
v_cvt_pk_bf16_f32 v209, v210, v211
v_mfma_f32_16x16x32_bf16 v[216:219], a[200:203], v[60:63], v[216:219]
s_add_u32 s89, s78, s85
buffer_store_dwordx4 a[124:127], v8, s[20:23], s89 offen nt
ds_read_b64_tr_b16 a[198:199], v5 offset:61440
v_mfma_f32_16x16x32_bf16 v[216:219], a[204:207], v[36:39], v[216:219]
ds_write_b64 v0, v[204:205] offset:2048
v_mfma_f32_16x16x32_bf16 v[220:223], a[200:203], v[64:67], v[220:223]
ds_read_b64_tr_b16 a[200:201], v5 offset:16384
v_mfma_f32_16x16x32_bf16 v[220:223], a[204:207], v[40:43], v[220:223]
ds_read_b64_tr_b16 a[202:203], v5 offset:20480
v_mfma_f32_16x16x32_bf16 v[212:215], a[208:211], v[44:47], v[212:215]
s_waitcnt lgkmcnt(6)
ds_write_b64 v0, v[208:209] offset:4096
v_mfma_f32_16x16x32_bf16 v[212:215], a[212:215], v[68:71], v[212:215]
ds_read_b64_tr_b16 a[204:205], v5 offset:24576
v_mfma_f32_16x16x32_bf16 v[216:219], a[208:211], v[48:51], v[216:219]
ds_read_b64_tr_b16 a[206:207], v5 offset:28672
v_xor_b32 v0, 32, v0
v_mfma_f32_16x16x32_bf16 v[216:219], a[212:215], v[72:75], v[216:219]
s_add_u32 s89, s30, s85
buffer_store_dwordx4 a[128:131], v8, s[20:23], s89 offen nt
v_mfma_f32_16x16x32_bf16 v[220:223], a[208:211], v[52:55], v[220:223]
ds_read_b64_tr_b16 a[208:209], v1 offset:16384
v_mul_f32 v212, v212, v12
v_mfma_f32_16x16x32_bf16 v[220:223], a[212:215], v[76:79], v[220:223]
ds_read_b64_tr_b16 a[210:211], v1 offset:20480
v_mul_f32 v213, v213, v12
v_mfma_f32_16x16x32_bf16 a[216:219], a[192:195], a[0:3], a[216:219]
s_waitcnt lgkmcnt(5)
v_cvt_pk_bf16_f32 v212, v212, v213
v_mul_f32 v214, v214, v12
v_mfma_f32_16x16x32_bf16 a[216:219], a[196:199], a[12:15], a[216:219]
ds_read_b64_tr_b16 a[212:213], v1 offset:24576
v_mul_f32 v215, v215, v12
v_mfma_f32_16x16x32_bf16 a[220:223], a[192:195], a[4:7], a[220:223]
ds_read_b64_tr_b16 a[214:215], v1 offset:28672
v_cvt_pk_bf16_f32 v213, v214, v215
v_mfma_f32_16x16x32_bf16 a[220:223], a[196:199], a[16:19], a[220:223]
s_add_u32 s89, s79, s85
buffer_store_dwordx4 a[132:135], v8, s[20:23], s89 offen nt
PADJ_15:
s_cbranch_execz PADJ_19
v_pk_mul_f32 v[216:217], v[216:217], v[14:15] op_sel_hi:[1,0]
v_pk_mul_f32 v[218:219], v[218:219], v[14:15] op_sel_hi:[1,0]
v_pk_mul_f32 v[220:221], v[220:221], v[16:17] op_sel_hi:[1,0]
v_pk_mul_f32 v[222:223], v[222:223], v[16:17] op_sel_hi:[1,0]
v_mfma_f32_16x16x32_bf16 a[224:227], a[192:195], a[8:11], a[224:227]
ds_read_b64_tr_b16 a[192:193], v6 offset:49152
v_cvt_pk_bf16_f32 v216, v216, v217
v_mfma_f32_16x16x32_bf16 a[224:227], a[196:199], a[20:23], a[224:227]
ds_read_b64_tr_b16 a[194:195], v6 offset:53248
v_cvt_pk_bf16_f32 v217, v218, v219
v_mfma_f32_16x16x32_bf16 a[216:219], a[200:203], v[56:59], a[216:219]
s_waitcnt lgkmcnt(4)
ds_write_b64 v0, v[212:213] offset:0
v_cvt_pk_bf16_f32 v220, v220, v221
v_mfma_f32_16x16x32_bf16 a[216:219], a[204:207], v[32:35], a[216:219]
ds_read_b64_tr_b16 a[196:197], v6 offset:57344
v_cvt_pk_bf16_f32 v221, v222, v223
v_mfma_f32_16x16x32_bf16 a[220:223], a[200:203], v[60:63], a[220:223]
ds_read_b64_tr_b16 a[198:199], v6 offset:61440
v_mfma_f32_16x16x32_bf16 a[220:223], a[204:207], v[36:39], a[220:223]
s_add_u32 s89, s31, s85
buffer_store_dwordx4 a[136:139], v8, s[20:23], s89 offen nt
v_mfma_f32_16x16x32_bf16 a[224:227], a[200:203], v[64:67], a[224:227]
ds_read_b64_tr_b16 a[200:201], v6 offset:16384
v_mfma_f32_16x16x32_bf16 a[224:227], a[204:207], v[40:43], a[224:227]
ds_read_b64_tr_b16 a[202:203], v6 offset:20480
v_mfma_f32_16x16x32_bf16 a[216:219], a[208:211], v[44:47], a[216:219]
s_waitcnt lgkmcnt(5)
ds_write_b64 v0, v[216:217] offset:2048
v_mfma_f32_16x16x32_bf16 a[216:219], a[212:215], v[68:71], a[216:219]
ds_read_b64_tr_b16 a[204:205], v6 offset:24576
v_mfma_f32_16x16x32_bf16 a[220:223], a[208:211], v[48:51], a[220:223]
ds_read_b64_tr_b16 a[206:207], v6 offset:28672
v_mfma_f32_16x16x32_bf16 a[220:223], a[212:215], v[72:75], a[220:223]
s_add_u32 s89, s80, s85
buffer_store_dwordx4 a[140:143], v8, s[20:23], s89 offen nt
v_mfma_f32_16x16x32_bf16 a[224:227], a[208:211], v[52:55], a[224:227]
ds_read_b64_tr_b16 a[208:209], v2 offset:16384
v_mfma_f32_16x16x32_bf16 a[224:227], a[212:215], v[76:79], a[224:227]
ds_read_b64_tr_b16 a[210:211], v2 offset:20480
v_accvgpr_read_b32 v200, a216
v_mfma_f32_16x16x32_bf16 a[228:231], a[192:195], a[0:3], a[228:231]
s_waitcnt lgkmcnt(5)
ds_write_b64 v0, v[220:221] offset:4096
v_accvgpr_read_b32 v201, a217
v_mfma_f32_16x16x32_bf16 a[228:231], a[196:199], a[12:15], a[228:231]
ds_read_b64_tr_b16 a[212:213], v2 offset:24576
v_accvgpr_read_b32 v202, a218
v_mfma_f32_16x16x32_bf16 a[232:235], a[192:195], a[4:7], a[232:235]
ds_read_b64_tr_b16 a[214:215], v2 offset:28672
v_accvgpr_read_b32 v203, a219
v_mfma_f32_16x16x32_bf16 a[232:235], a[196:199], a[16:19], a[232:235]
v_xor_b32 v0, 96, v0
v_accvgpr_read_b32 v204, a220
v_mfma_f32_16x16x32_bf16 a[236:239], a[192:195], a[8:11], a[236:239]
ds_read_b64_tr_b16 a[192:193], v3 offset:50176
v_accvgpr_read_b32 v205, a221
v_mfma_f32_16x16x32_bf16 a[236:239], a[196:199], a[20:23], a[236:239]
ds_read_b64_tr_b16 a[194:195], v3 offset:54272
v_accvgpr_read_b32 v206, a222
v_mfma_f32_16x16x32_bf16 a[228:231], a[200:203], v[56:59], a[228:231]
s_waitcnt lgkmcnt(5)
v_accvgpr_read_b32 v207, a223
v_accvgpr_read_b32 v208, a224
v_mfma_f32_16x16x32_bf16 a[228:231], a[204:207], v[32:35], a[228:231]
ds_read_b64_tr_b16 a[196:197], v3 offset:58368
v_accvgpr_read_b32 v209, a225
v_mfma_f32_16x16x32_bf16 a[232:235], a[200:203], v[60:63], a[232:235]
ds_read_b64_tr_b16 a[198:199], v3 offset:62464
v_accvgpr_read_b32 v210, a226
v_mfma_f32_16x16x32_bf16 a[232:235], a[204:207], v[36:39], a[232:235]
v_accvgpr_read_b32 v211, a227
v_mul_f32 v200, v200, v12
v_mfma_f32_16x16x32_bf16 a[236:239], a[200:203], v[64:67], a[236:239]
ds_read_b64_tr_b16 a[200:201], v3 offset:17408
v_mul_f32 v201, v201, v12
v_mfma_f32_16x16x32_bf16 a[236:239], a[204:207], v[40:43], a[236:239]
ds_read_b64_tr_b16 a[202:203], v3 offset:21504
v_cvt_pk_bf16_f32 v200, v200, v201
v_mfma_f32_16x16x32_bf16 a[228:231], a[208:211], v[44:47], a[228:231]
s_waitcnt lgkmcnt(4)
v_mul_f32 v202, v202, v12
v_mul_f32 v203, v203, v12
v_mfma_f32_16x16x32_bf16 a[228:231], a[212:215], v[68:71], a[228:231]
ds_read_b64_tr_b16 a[204:205], v3 offset:25600
v_cvt_pk_bf16_f32 v201, v202, v203
v_mfma_f32_16x16x32_bf16 a[232:235], a[208:211], v[48:51], a[232:235]
ds_read_b64_tr_b16 a[206:207], v3 offset:29696
v_mul_f32 v204, v204, v14
v_mfma_f32_16x16x32_bf16 a[232:235], a[212:215], v[72:75], a[232:235]
ds_write_b64 v0, v[200:201] offset:0
v_mul_f32 v205, v205, v14
v_mfma_f32_16x16x32_bf16 a[236:239], a[208:211], v[52:55], a[236:239]
ds_read_b64_tr_b16 a[208:209], v22 offset:17408
v_cvt_pk_bf16_f32 v204, v204, v205
v_mfma_f32_16x16x32_bf16 a[236:239], a[212:215], v[76:79], a[236:239]
ds_read_b64_tr_b16 a[210:211], v22 offset:21504
v_accvgpr_read_b32 v212, a228
v_mfma_f32_16x16x32_bf16 a[240:243], a[192:195], a[0:3], a[240:243]
s_waitcnt lgkmcnt(5)
v_accvgpr_read_b32 v213, a229
v_accvgpr_read_b32 v214, a230
v_mfma_f32_16x16x32_bf16 a[240:243], a[196:199], a[12:15], a[240:243]
ds_read_b64_tr_b16 a[212:213], v22 offset:25600
v_accvgpr_read_b32 v215, a231
v_mfma_f32_16x16x32_bf16 a[244:247], a[192:195], a[4:7], a[244:247]
ds_read_b64_tr_b16 a[214:215], v22 offset:29696
v_accvgpr_read_b32 v216, a232
v_mfma_f32_16x16x32_bf16 a[244:247], a[196:199], a[16:19], a[244:247]
v_accvgpr_read_b32 v217, a233
v_accvgpr_read_b32 v218, a234
v_mfma_f32_16x16x32_bf16 a[248:251], a[192:195], a[8:11], a[248:251]
ds_read_b64_tr_b16 a[192:193], v4 offset:50176
v_accvgpr_read_b32 v219, a235
v_accvgpr_read_b32 v220, a236
v_accvgpr_read_b32 v221, a237
v_accvgpr_read_b32 v222, a238
v_pk_mul_f32 v[206:207], v[206:207], v[14:15] op_sel_hi:[1,0]
v_pk_mul_f32 v[208:209], v[208:209], v[16:17] op_sel_hi:[1,0]
v_pk_mul_f32 v[210:211], v[210:211], v[16:17] op_sel_hi:[1,0]
v_pk_mul_f32 v[212:213], v[212:213], v[12:13] op_sel_hi:[1,0]
v_pk_mul_f32 v[214:215], v[214:215], v[12:13] op_sel_hi:[1,0]
v_pk_mul_f32 v[216:217], v[216:217], v[14:15] op_sel_hi:[1,0]
v_mfma_f32_16x16x32_bf16 a[248:251], a[196:199], a[20:23], a[248:251]
ds_read_b64_tr_b16 a[194:195], v4 offset:54272
v_cvt_pk_bf16_f32 v205, v206, v207
v_mfma_f32_16x16x32_bf16 a[240:243], a[200:203], v[56:59], a[240:243]
s_waitcnt lgkmcnt(4)
ds_write_b64 v0, v[204:205] offset:2048
v_cvt_pk_bf16_f32 v208, v208, v209
v_mfma_f32_16x16x32_bf16 a[240:243], a[204:207], v[32:35], a[240:243]
ds_read_b64_tr_b16 a[196:197], v4 offset:58368
v_cvt_pk_bf16_f32 v209, v210, v211
v_mfma_f32_16x16x32_bf16 a[244:247], a[200:203], v[60:63], a[244:247]
ds_read_b64_tr_b16 a[198:199], v4 offset:62464
ds_write_b64 v0, v[208:209] offset:4096
v_cvt_pk_bf16_f32 v212, v212, v213
v_pk_mul_f32 v[218:219], v[218:219], v[14:15] op_sel_hi:[1,0]
v_pk_mul_f32 v[220:221], v[220:221], v[16:17] op_sel_hi:[1,0]
v_mfma_f32_16x16x32_bf16 a[244:247], a[204:207], v[36:39], a[244:247]
v_cvt_pk_bf16_f32 v213, v214, v215
v_xor_b32 v0, 32, v0
v_mfma_f32_16x16x32_bf16 a[248:251], a[200:203], v[64:67], a[248:251]
ds_read_b64_tr_b16 a[200:201], v4 offset:17408
v_cvt_pk_bf16_f32 v216, v216, v217
v_mfma_f32_16x16x32_bf16 a[248:251], a[204:207], v[40:43], a[248:251]
ds_read_b64_tr_b16 a[202:203], v4 offset:21504
v_cvt_pk_bf16_f32 v217, v218, v219
v_mfma_f32_16x16x32_bf16 a[240:243], a[208:211], v[44:47], a[240:243]
s_waitcnt lgkmcnt(6)
ds_write_b64 v0, v[212:213] offset:0
v_accvgpr_read_b32 v223, a239
v_mfma_f32_16x16x32_bf16 a[240:243], a[212:215], v[68:71], a[240:243]
ds_read_b64_tr_b16 a[204:205], v4 offset:25600
ds_read_b128 a[144:147], v9 offset:0
ds_read_b128 a[148:151], v9 offset:1024
v_mfma_f32_16x16x32_bf16 a[244:247], a[208:211], v[48:51], a[244:247]
ds_read_b64_tr_b16 a[206:207], v4 offset:29696
v_cvt_pk_bf16_f32 v220, v220, v221
v_mfma_f32_16x16x32_bf16 a[244:247], a[212:215], v[72:75], a[244:247]
ds_write_b64 v0, v[216:217] offset:2048
v_accvgpr_read_b32 v200, a240
v_mfma_f32_16x16x32_bf16 a[248:251], a[208:211], v[52:55], a[248:251]
ds_read_b64_tr_b16 a[208:209], v23 offset:17408
v_accvgpr_read_b32 v201, a241
v_mfma_f32_16x16x32_bf16 a[248:251], a[212:215], v[76:79], a[248:251]
ds_read_b64_tr_b16 a[210:211], v23 offset:21504
ds_read_b128 a[152:155], v9 offset:2048
v_mfma_f32_16x16x32_bf16 a[252:255], a[192:195], a[0:3], a[252:255]
s_waitcnt lgkmcnt(9)
v_accvgpr_read_b32 v202, a242
v_accvgpr_read_b32 v203, a243
v_mfma_f32_16x16x32_bf16 a[252:255], a[196:199], a[12:15], a[252:255]
ds_read_b64_tr_b16 a[212:213], v23 offset:25600
ds_read_b128 a[156:159], v9 offset:3072
v_mfma_f32_16x16x32_bf16 v[224:227], a[192:195], a[4:7], v[224:227]
ds_read_b64_tr_b16 a[214:215], v23 offset:29696
v_accvgpr_read_b32 v204, a244
v_mfma_f32_16x16x32_bf16 v[224:227], a[196:199], a[16:19], v[224:227]
v_accvgpr_read_b32 v205, a245
v_accvgpr_read_b32 v206, a246
v_mfma_f32_16x16x32_bf16 v[228:231], a[192:195], a[8:11], v[228:231]
ds_read_b64_tr_b16 a[192:193], v5 offset:50176
v_accvgpr_read_b32 v207, a247
v_mfma_f32_16x16x32_bf16 v[228:231], a[196:199], a[20:23], v[228:231]
ds_read_b64_tr_b16 a[194:195], v5 offset:54272
v_accvgpr_read_b32 v208, a248
v_mfma_f32_16x16x32_bf16 a[252:255], a[200:203], v[56:59], a[252:255]
s_waitcnt lgkmcnt(6)
v_accvgpr_read_b32 v209, a249
v_accvgpr_read_b32 v210, a250
v_mfma_f32_16x16x32_bf16 a[252:255], a[204:207], v[32:35], a[252:255]
s_add_u32 s89, s29, s86
buffer_store_dwordx4 a[144:147], v8, s[20:23], s89 offen nt
ds_read_b64_tr_b16 a[196:197], v5 offset:58368
v_pk_mul_f32 v[222:223], v[222:223], v[16:17] op_sel_hi:[1,0]
v_pk_mul_f32 v[200:201], v[200:201], v[12:13] op_sel_hi:[1,0]
v_pk_mul_f32 v[202:203], v[202:203], v[12:13] op_sel_hi:[1,0]
v_pk_mul_f32 v[204:205], v[204:205], v[14:15] op_sel_hi:[1,0]
v_pk_mul_f32 v[206:207], v[206:207], v[14:15] op_sel_hi:[1,0]
v_pk_mul_f32 v[208:209], v[208:209], v[16:17] op_sel_hi:[1,0]
v_mfma_f32_16x16x32_bf16 v[224:227], a[200:203], v[60:63], v[224:227]
ds_read_b64_tr_b16 a[198:199], v5 offset:62464
v_cvt_pk_bf16_f32 v221, v222, v223
v_mfma_f32_16x16x32_bf16 v[224:227], a[204:207], v[36:39], v[224:227]
ds_write_b64 v0, v[220:221] offset:4096
v_cvt_pk_bf16_f32 v200, v200, v201
v_mfma_f32_16x16x32_bf16 v[228:231], a[200:203], v[64:67], v[228:231]
ds_read_b64_tr_b16 a[200:201], v5 offset:17408
ds_read_b128 a[160:163], v9 offset:4096
ds_read_b128 a[164:167], v9 offset:5120
v_mfma_f32_16x16x32_bf16 v[228:231], a[204:207], v[40:43], v[228:231]
ds_read_b64_tr_b16 a[202:203], v5 offset:21504
v_cvt_pk_bf16_f32 v201, v202, v203
v_mfma_f32_16x16x32_bf16 a[252:255], a[208:211], v[44:47], a[252:255]
s_waitcnt lgkmcnt(7)
v_xor_b32 v0, 96, v0
v_cvt_pk_bf16_f32 v204, v204, v205
v_mfma_f32_16x16x32_bf16 a[252:255], a[212:215], v[68:71], a[252:255]
ds_read_b64_tr_b16 a[204:205], v5 offset:25600
v_cvt_pk_bf16_f32 v205, v206, v207
v_mfma_f32_16x16x32_bf16 v[224:227], a[208:211], v[48:51], v[224:227]
s_add_u32 s89, s78, s86
buffer_store_dwordx4 a[148:151], v8, s[20:23], s89 offen nt
ds_read_b64_tr_b16 a[206:207], v5 offset:29696
v_mfma_f32_16x16x32_bf16 v[224:227], a[212:215], v[72:75], v[224:227]
ds_write_b64 v0, v[200:201] offset:0
v_accvgpr_read_b32 v211, a251
v_mfma_f32_16x16x32_bf16 v[228:231], a[208:211], v[52:55], v[228:231]
ds_read_b64_tr_b16 a[208:209], v1 offset:17408
v_cvt_pk_bf16_f32 v208, v208, v209
v_mfma_f32_16x16x32_bf16 v[228:231], a[212:215], v[76:79], v[228:231]
ds_read_b64_tr_b16 a[210:211], v1 offset:21504
v_accvgpr_read_b32 v212, a252
v_mfma_f32_16x16x32_bf16 v[232:235], a[192:195], a[0:3], v[232:235]
s_waitcnt lgkmcnt(5)
ds_write_b64 v0, v[204:205] offset:2048
v_accvgpr_read_b32 v213, a253
v_mfma_f32_16x16x32_bf16 v[232:235], a[196:199], a[12:15], v[232:235]
ds_read_b64_tr_b16 a[212:213], v1 offset:25600
v_accvgpr_read_b32 v214, a254
v_mfma_f32_16x16x32_bf16 v[236:239], a[192:195], a[4:7], v[236:239]
ds_read_b64_tr_b16 a[214:215], v1 offset:29696
v_accvgpr_read_b32 v215, a255
v_mfma_f32_16x16x32_bf16 v[236:239], a[196:199], a[16:19], v[236:239]
s_add_u32 s89, s30, s86
buffer_store_dwordx4 a[152:155], v8, s[20:23], s89 offen nt
v_pk_mul_f32 v[210:211], v[210:211], v[16:17] op_sel_hi:[1,0]
v_pk_mul_f32 v[212:213], v[212:213], v[12:13] op_sel_hi:[1,0]
v_pk_mul_f32 v[214:215], v[214:215], v[12:13] op_sel_hi:[1,0]
v_pk_mul_f32 v[224:225], v[224:225], v[14:15] op_sel_hi:[1,0]
v_pk_mul_f32 v[226:227], v[226:227], v[14:15] op_sel_hi:[1,0]
v_pk_mul_f32 v[228:229], v[228:229], v[16:17] op_sel_hi:[1,0]
v_mfma_f32_16x16x32_bf16 v[240:243], a[192:195], a[8:11], v[240:243]
ds_read_b64_tr_b16 a[192:193], v6 offset:50176
v_cvt_pk_bf16_f32 v209, v210, v211
v_mfma_f32_16x16x32_bf16 v[240:243], a[196:199], a[20:23], v[240:243]
ds_read_b64_tr_b16 a[194:195], v6 offset:54272
v_cvt_pk_bf16_f32 v212, v212, v213
v_mfma_f32_16x16x32_bf16 v[232:235], a[200:203], v[56:59], v[232:235]
s_waitcnt lgkmcnt(5)
ds_write_b64 v0, v[208:209] offset:4096
v_cvt_pk_bf16_f32 v213, v214, v215
v_mfma_f32_16x16x32_bf16 v[232:235], a[204:207], v[32:35], v[232:235]
ds_read_b64_tr_b16 a[196:197], v6 offset:58368
v_xor_b32 v0, 32, v0
v_mfma_f32_16x16x32_bf16 v[236:239], a[200:203], v[60:63], v[236:239]
ds_read_b64_tr_b16 a[198:199], v6 offset:62464
v_cvt_pk_bf16_f32 v224, v224, v225
v_mfma_f32_16x16x32_bf16 v[236:239], a[204:207], v[36:39], v[236:239]
s_add_u32 s89, s79, s86
buffer_store_dwordx4 a[156:159], v8, s[20:23], s89 offen nt
v_pk_mul_f32 v[230:231], v[230:231], v[16:17] op_sel_hi:[1,0]
v_mfma_f32_16x16x32_bf16 v[240:243], a[200:203], v[64:67], v[240:243]
ds_read_b64_tr_b16 a[200:201], v6 offset:17408
v_cvt_pk_bf16_f32 v225, v226, v227
v_mfma_f32_16x16x32_bf16 v[240:243], a[204:207], v[40:43], v[240:243]
ds_read_b64_tr_b16 a[202:203], v6 offset:21504
v_cvt_pk_bf16_f32 v228, v228, v229
v_mfma_f32_16x16x32_bf16 v[232:235], a[208:211], v[44:47], v[232:235]
s_waitcnt lgkmcnt(5)
ds_write_b64 v0, v[212:213] offset:0
v_cvt_pk_bf16_f32 v229, v230, v231
v_mfma_f32_16x16x32_bf16 v[232:235], a[212:215], v[68:71], v[232:235]
ds_read_b64_tr_b16 a[204:205], v6 offset:25600
v_mfma_f32_16x16x32_bf16 v[236:239], a[208:211], v[48:51], v[236:239]
ds_read_b64_tr_b16 a[206:207], v6 offset:29696
v_mfma_f32_16x16x32_bf16 v[236:239], a[212:215], v[72:75], v[236:239]
s_add_u32 s89, s31, s86
buffer_store_dwordx4 a[160:163], v8, s[20:23], s89 offen nt
v_mfma_f32_16x16x32_bf16 v[240:243], a[208:211], v[52:55], v[240:243]
ds_read_b64_tr_b16 a[208:209], v2 offset:17408
v_mfma_f32_16x16x32_bf16 v[240:243], a[212:215], v[76:79], v[240:243]
ds_read_b64_tr_b16 a[210:211], v2 offset:21504
v_mul_f32 v232, v232, v12
v_mfma_f32_16x16x32_bf16 v[244:247], a[192:195], a[0:3], v[244:247]
s_waitcnt lgkmcnt(5)
ds_write_b64 v0, v[224:225] offset:2048
v_mul_f32 v233, v233, v12
v_mfma_f32_16x16x32_bf16 v[244:247], a[196:199], a[12:15], v[244:247]
ds_read_b64_tr_b16 a[212:213], v2 offset:25600
v_cvt_pk_bf16_f32 v232, v232, v233
v_mfma_f32_16x16x32_bf16 v[248:251], a[192:195], a[4:7], v[248:251]
ds_read_b64_tr_b16 a[214:215], v2 offset:29696
v_mul_f32 v234, v234, v12
v_mfma_f32_16x16x32_bf16 v[248:251], a[196:199], a[16:19], v[248:251]
s_add_u32 s89, s80, s86
buffer_store_dwordx4 a[164:167], v8, s[20:23], s89 offen nt
v_pk_mul_f32 v[236:237], v[236:237], v[14:15] op_sel_hi:[1,0]
v_pk_mul_f32 v[238:239], v[238:239], v[14:15] op_sel_hi:[1,0]
v_pk_mul_f32 v[240:241], v[240:241], v[16:17] op_sel_hi:[1,0]
v_pk_mul_f32 v[242:243], v[242:243], v[16:17] op_sel_hi:[1,0]
v_mfma_f32_16x16x32_bf16 v[252:255], a[192:195], a[8:11], v[252:255]
ds_write_b64 v0, v[228:229] offset:4096
v_mul_f32 v235, v235, v12
v_mfma_f32_16x16x32_bf16 v[252:255], a[196:199], a[20:23], v[252:255]
v_cvt_pk_bf16_f32 v233, v234, v235
v_xor_b32 v0, 96, v0
v_mfma_f32_16x16x32_bf16 v[244:247], a[200:203], v[56:59], v[244:247]
s_waitcnt lgkmcnt(4)
ds_write_b64 v0, v[232:233] offset:0
v_cvt_pk_bf16_f32 v236, v236, v237
v_mfma_f32_16x16x32_bf16 v[244:247], a[204:207], v[32:35], v[244:247]
v_cvt_pk_bf16_f32 v237, v238, v239
v_cvt_pk_bf16_f32 v240, v240, v241
v_mfma_f32_16x16x32_bf16 v[248:251], a[200:203], v[60:63], v[248:251]
ds_write_b64 v0, v[236:237] offset:2048
v_cvt_pk_bf16_f32 v241, v242, v243
v_mfma_f32_16x16x32_bf16 v[248:251], a[204:207], v[36:39], v[248:251]
ds_write_b64 v0, v[240:241] offset:4096
v_mfma_f32_16x16x32_bf16 v[252:255], a[200:203], v[64:67], v[252:255]
v_mfma_f32_16x16x32_bf16 v[252:255], a[204:207], v[40:43], v[252:255]
v_mfma_f32_16x16x32_bf16 v[244:247], a[208:211], v[44:47], v[244:247]
s_waitcnt lgkmcnt(4)
v_mfma_f32_16x16x32_bf16 v[244:247], a[212:215], v[68:71], v[244:247]
v_xor_b32 v0, 32, v0
v_mfma_f32_16x16x32_bf16 v[248:251], a[208:211], v[48:51], v[248:251]
v_mfma_f32_16x16x32_bf16 v[248:251], a[212:215], v[72:75], v[248:251]
v_mfma_f32_16x16x32_bf16 v[252:255], a[208:211], v[52:55], v[252:255]
v_mfma_f32_16x16x32_bf16 v[252:255], a[212:215], v[76:79], v[252:255]
s_nop 2
v_pk_mul_f32 v[244:245], v[244:245], v[12:13] op_sel_hi:[1,0]
v_pk_mul_f32 v[246:247], v[246:247], v[12:13] op_sel_hi:[1,0]
v_cvt_pk_bf16_f32 v244, v244, v245
v_cvt_pk_bf16_f32 v245, v246, v247
v_pk_mul_f32 v[248:249], v[248:249], v[14:15] op_sel_hi:[1,0]
v_pk_mul_f32 v[250:251], v[250:251], v[14:15] op_sel_hi:[1,0]
v_cvt_pk_bf16_f32 v248, v248, v249
v_cvt_pk_bf16_f32 v249, v250, v251
v_pk_mul_f32 v[252:253], v[252:253], v[16:17] op_sel_hi:[1,0]
v_pk_mul_f32 v[254:255], v[254:255], v[16:17] op_sel_hi:[1,0]
v_cvt_pk_bf16_f32 v252, v252, v253
v_cvt_pk_bf16_f32 v253, v254, v255
ds_write_b64 v0, v[244:245] offset:0
ds_write_b64 v0, v[248:249] offset:2048
ds_read_b128 a[168:171], v9 offset:0
ds_read_b128 a[172:175], v9 offset:1024
ds_read_b128 a[176:179], v9 offset:2048
ds_read_b128 a[180:183], v9 offset:3072
ds_write_b64 v0, v[252:253] offset:4096
ds_read_b128 a[184:187], v9 offset:4096
ds_read_b128 a[188:191], v9 offset:5120
s_waitcnt lgkmcnt(6)
s_add_u32 s89, s29, s87
buffer_store_dwordx4 a[168:171], v8, s[20:23], s89 offen nt
s_waitcnt lgkmcnt(5)
s_add_u32 s89, s78, s87
buffer_store_dwordx4 a[172:175], v8, s[20:23], s89 offen nt
s_waitcnt lgkmcnt(4)
s_add_u32 s89, s30, s87
buffer_store_dwordx4 a[176:179], v8, s[20:23], s89 offen nt
s_waitcnt lgkmcnt(3)
s_add_u32 s89, s79, s87
buffer_store_dwordx4 a[180:183], v8, s[20:23], s89 offen nt
s_waitcnt lgkmcnt(1)
s_add_u32 s89, s31, s87
buffer_store_dwordx4 a[184:187], v8, s[20:23], s89 offen nt
s_waitcnt lgkmcnt(0)
s_add_u32 s89, s80, s87
buffer_store_dwordx4 a[188:191], v8, s[20:23], s89 offen nt
END:
s_endpgm
PADJ_16:
PADJ_17:
PADJ_18:
PADJ_19:
HOPEND:
s_setpc_b64 s[72:73]
STUB_2:
s_call_b64 s[72:73], RARE_0
s_branch BACK_2
STUB_3:
s_call_b64 s[72:73], RARE_1
s_branch BACK_3
STUB_4:
s_call_b64 s[72:73], RARE_2
s_branch BACK_4
STUB_5:
s_call_b64 s[72:73], RARE_3
s_branch BACK_5
STUB_6:
s_call_b64 s[72:73], RARE_4
s_branch BACK_6
STUB_7:
s_call_b64 s[72:73], RARE_5
s_branch BACK_7
STUB_8:
s_call_b64 s[72:73], RARE_6
s_branch BACK_8
STUB_9:
s_call_b64 s[72:73], RARE_7
s_branch BACK_9
STUB_10:
s_call_b64 s[72:73], RARE_8
s_branch BACK_10
STUB_11:
s_call_b64 s[72:73], RARE_5
s_branch BACK_11
STUB_12:
s_call_b64 s[72:73], RARE_6
s_branch BACK_12
STUB_13:
s_call_b64 s[72:73], RARE_7
s_branch BACK_13
STUB_14:
s_call_b64 s[72:73], RARE_8
s_branch BACK_14
STUB_15:
s_call_b64 s[72:73], RARE_5
s_branch BACK_15
STUB_16:
s_call_b64 s[72:73], RARE_9
s_branch BACK_16
STUB_17:
s_call_b64 s[72:73], RARE_10
s_branch BACK_17
STUB_18:
s_call_b64 s[72:73], RARE_11
s_branch BACK_18
STUB_19:
s_call_b64 s[72:73], RARE_5
s_branch BACK_19
STUB_20:
s_call_b64 s[72:73], RARE_6
s_branch BACK_20
STUB_21:
s_call_b64 s[72:73], RARE_7
s_branch BACK_21
STUB_22:
s_call_b64 s[72:73], RARE_8
s_branch BACK_22
STUB_23:
s_call_b64 s[72:73], RARE_5
s_branch BACK_23
STUB_24:
s_call_b64 s[72:73], RARE_6
s_branch BACK_24
STUB_25:
s_call_b64 s[72:73], RARE_7
s_branch BACK_25
STUB_26:
s_call_b64 s[72:73], RARE_8
s_branch BACK_26
STUB_27:
s_call_b64 s[72:73], RARE_12
s_branch BACK_27
STUB_28:
s_call_b64 s[72:73], RARE_13
s_branch BACK_28
STUB_29:
s_call_b64 s[72:73], RARE_14
s_branch BACK_29
STUB_30:
s_call_b64 s[72:73], RARE_15
s_branch BACK_30
STUB_31:
s_call_b64 s[72:73], RARE_16
s_branch BACK_31
RARE_0:
s_nop 7
v_max3_f32 v31, v44, v45, v46
v_max3_f32 v31, v31, v47, v68
v_max3_f32 v31, v31, v69, v70
v_max3_f32 v31, v31, v71, 0
v_mov_b32 v30, v31
s_nop 1
v_permlane16_swap_b32 v31, v30
s_nop 1
v_max_f32 v31, v31, v30
v_mov_b32 v30, v31
s_nop 1
v_permlane32_swap_b32 v31, v30
s_nop 1
v_max_f32 v31, v31, v30
v_sub_f32 v11, v11, v31
v_sub_f32 v44, v44, v31
v_sub_f32 v68, v68, v31
v_sub_f32 v45, v45, v31
v_sub_f32 v69, v69, v31
v_sub_f32 v46, v46, v31
v_sub_f32 v70, v70, v31
v_sub_f32 v47, v47, v31
v_sub_f32 v71, v71, v31
v_exp_f32 v28, v44
s_nop 0
v_exp_f32 v29, v45
s_nop 0
v_cvt_pk_bf16_f32 v56, v28, v29
v_add_f32 v24, v28, v29
v_exp_f32 v28, v46
s_nop 0
v_exp_f32 v29, v47
s_nop 0
v_cvt_pk_bf16_f32 v57, v28, v29
v_add_f32 v24, v24, v28
v_add_f32 v24, v24, v29
v_exp_f32 v28, v68
s_nop 0
v_exp_f32 v29, v69
s_nop 0
v_cvt_pk_bf16_f32 v58, v28, v29
v_add_f32 v24, v24, v28
v_add_f32 v24, v24, v29
v_exp_f32 v28, v70
s_nop 0
v_exp_f32 v29, v71
s_nop 0
v_cvt_pk_bf16_f32 v59, v28, v29
v_add_f32 v24, v24, v28
v_add_f32 v24, v24, v29
v_exp_f32_e64 v25, -v31
s_nop 1
v_mul_f32 v17, v17, v25
s_call_b64 s[0:1], OSC_0
v_max3_f32 v31, v48, v49, v50
v_max3_f32 v31, v31, v51, v72
v_max3_f32 v31, v31, v73, v74
v_max3_f32 v31, v31, v75, 0
v_mov_b32 v30, v31
s_nop 1
v_permlane16_swap_b32 v31, v30
s_nop 1
v_max_f32 v31, v31, v30
v_mov_b32 v30, v31
s_nop 1
v_permlane32_swap_b32 v31, v30
s_nop 1
v_max_f32 v31, v31, v30
v_sub_f32 v13, v13, v31
v_sub_f32 v48, v48, v31
v_sub_f32 v72, v72, v31
v_sub_f32 v49, v49, v31
v_sub_f32 v73, v73, v31
v_sub_f32 v50, v50, v31
v_sub_f32 v74, v74, v31
v_sub_f32 v51, v51, v31
v_sub_f32 v75, v75, v31
v_exp_f32 v28, v48
s_nop 0
v_exp_f32 v29, v49
s_nop 0
v_cvt_pk_bf16_f32 v60, v28, v29
v_add_f32 v26, v28, v29
v_exp_f32 v28, v50
s_nop 0
v_exp_f32 v29, v51
s_nop 0
v_cvt_pk_bf16_f32 v61, v28, v29
v_add_f32 v26, v26, v28
v_add_f32 v26, v26, v29
v_exp_f32 v28, v72
s_nop 0
v_exp_f32 v29, v73
s_nop 0
v_cvt_pk_bf16_f32 v62, v28, v29
v_add_f32 v26, v26, v28
v_add_f32 v26, v26, v29
v_exp_f32 v28, v74
s_nop 0
v_exp_f32 v29, v75
s_nop 0
v_cvt_pk_bf16_f32 v63, v28, v29
v_add_f32 v26, v26, v28
v_add_f32 v26, v26, v29
v_exp_f32_e64 v25, -v31
s_nop 1
v_mul_f32 v18, v18, v25
s_call_b64 s[0:1], OSC_1
v_max3_f32 v31, v52, v53, v54
v_max3_f32 v31, v31, v55, v76
v_max3_f32 v31, v31, v77, v78
v_max3_f32 v31, v31, v79, 0
v_mov_b32 v30, v31
s_nop 1
v_permlane16_swap_b32 v31, v30
s_nop 1
v_max_f32 v31, v31, v30
v_mov_b32 v30, v31
s_nop 1
v_permlane32_swap_b32 v31, v30
s_nop 1
v_max_f32 v31, v31, v30
v_sub_f32 v15, v15, v31
v_sub_f32 v52, v52, v31
v_sub_f32 v76, v76, v31
v_sub_f32 v53, v53, v31
v_sub_f32 v77, v77, v31
v_sub_f32 v54, v54, v31
v_sub_f32 v78, v78, v31
v_sub_f32 v55, v55, v31
v_sub_f32 v79, v79, v31
v_exp_f32 v28, v52
s_nop 0
v_exp_f32 v29, v53
s_nop 0
v_cvt_pk_bf16_f32 v64, v28, v29
v_add_f32 v27, v28, v29
v_exp_f32 v28, v54
s_nop 0
v_exp_f32 v29, v55
s_nop 0
v_cvt_pk_bf16_f32 v65, v28, v29
v_add_f32 v27, v27, v28
v_add_f32 v27, v27, v29
v_exp_f32 v28, v76
s_nop 0
v_exp_f32 v29, v77
s_nop 0
v_cvt_pk_bf16_f32 v66, v28, v29
v_add_f32 v27, v27, v28
v_add_f32 v27, v27, v29
v_exp_f32 v28, v78
s_nop 0
v_exp_f32 v29, v79
s_nop 0
v_cvt_pk_bf16_f32 v67, v28, v29
v_add_f32 v27, v27, v28
v_add_f32 v27, v27, v29
v_exp_f32_e64 v25, -v31
s_nop 1
v_mul_f32 v19, v19, v25
s_call_b64 s[0:1], OSC_2
s_nop 3
s_nop 7
s_nop 3
s_setpc_b64 s[72:73]
RARE_1:
s_nop 7
v_max3_f32 v31, v32, v33, v34
v_max3_f32 v31, v31, v35, v68
v_max3_f32 v31, v31, v69, v70
v_max3_f32 v31, v31, v71, 0
v_mov_b32 v30, v31
s_nop 1
v_permlane16_swap_b32 v31, v30
s_nop 1
v_max_f32 v31, v31, v30
v_mov_b32 v30, v31
s_nop 1
v_permlane32_swap_b32 v31, v30
s_nop 1
v_max_f32 v31, v31, v30
v_sub_f32 v11, v11, v31
v_sub_f32 v32, v32, v31
v_sub_f32 v68, v68, v31
v_sub_f32 v33, v33, v31
v_sub_f32 v69, v69, v31
v_sub_f32 v34, v34, v31
v_sub_f32 v70, v70, v31
v_sub_f32 v35, v35, v31
v_sub_f32 v71, v71, v31
v_exp_f32 v28, v32
s_nop 0
v_exp_f32 v29, v33
s_nop 0
v_cvt_pk_bf16_f32 v44, v28, v29
v_add_f32 v24, v28, v29
v_exp_f32 v28, v34
s_nop 0
v_exp_f32 v29, v35
s_nop 0
v_cvt_pk_bf16_f32 v45, v28, v29
v_add_f32 v24, v24, v28
v_add_f32 v24, v24, v29
v_exp_f32 v28, v68
s_nop 0
v_exp_f32 v29, v69
s_nop 0
v_cvt_pk_bf16_f32 v46, v28, v29
v_add_f32 v24, v24, v28
v_add_f32 v24, v24, v29
v_exp_f32 v28, v70
s_nop 0
v_exp_f32 v29, v71
s_nop 0
v_cvt_pk_bf16_f32 v47, v28, v29
v_add_f32 v24, v24, v28
v_add_f32 v24, v24, v29
v_exp_f32_e64 v25, -v31
s_nop 1
v_mul_f32 v17, v17, v25
v_lshlrev_b32 v28, 16, v56
v_and_b32 v29, 0xffff0000, v56
v_mul_f32 v28, v28, v25
v_mul_f32 v29, v29, v25
v_cvt_pk_bf16_f32 v56, v28, v29
v_lshlrev_b32 v28, 16, v57
v_and_b32 v29, 0xffff0000, v57
v_mul_f32 v28, v28, v25
v_mul_f32 v29, v29, v25
v_cvt_pk_bf16_f32 v57, v28, v29
v_lshlrev_b32 v28, 16, v58
v_and_b32 v29, 0xffff0000, v58
v_mul_f32 v28, v28, v25
v_mul_f32 v29, v29, v25
v_cvt_pk_bf16_f32 v58, v28, v29
v_lshlrev_b32 v28, 16, v59
v_and_b32 v29, 0xffff0000, v59
v_mul_f32 v28, v28, v25
v_mul_f32 v29, v29, v25
v_cvt_pk_bf16_f32 v59, v28, v29
s_call_b64 s[0:1], OSC_0
v_max3_f32 v31, v36, v37, v38
v_max3_f32 v31, v31, v39, v72
v_max3_f32 v31, v31, v73, v74
v_max3_f32 v31, v31, v75, 0
v_mov_b32 v30, v31
s_nop 1
v_permlane16_swap_b32 v31, v30
s_nop 1
v_max_f32 v31, v31, v30
v_mov_b32 v30, v31
s_nop 1
v_permlane32_swap_b32 v31, v30
s_nop 1
v_max_f32 v31, v31, v30
v_sub_f32 v13, v13, v31
v_sub_f32 v36, v36, v31
v_sub_f32 v72, v72, v31
v_sub_f32 v37, v37, v31
v_sub_f32 v73, v73, v31
v_sub_f32 v38, v38, v31
v_sub_f32 v74, v74, v31
v_sub_f32 v39, v39, v31
v_sub_f32 v75, v75, v31
v_exp_f32 v28, v36
s_nop 0
v_exp_f32 v29, v37
s_nop 0
v_cvt_pk_bf16_f32 v48, v28, v29
v_add_f32 v26, v28, v29
v_exp_f32 v28, v38
s_nop 0
v_exp_f32 v29, v39
s_nop 0
v_cvt_pk_bf16_f32 v49, v28, v29
v_add_f32 v26, v26, v28
v_add_f32 v26, v26, v29
v_exp_f32 v28, v72
s_nop 0
v_exp_f32 v29, v73
s_nop 0
v_cvt_pk_bf16_f32 v50, v28, v29
v_add_f32 v26, v26, v28
v_add_f32 v26, v26, v29
v_exp_f32 v28, v74
s_nop 0
v_exp_f32 v29, v75
s_nop 0
v_cvt_pk_bf16_f32 v51, v28, v29
v_add_f32 v26, v26, v28
v_add_f32 v26, v26, v29
v_exp_f32_e64 v25, -v31
s_nop 1
v_mul_f32 v18, v18, v25
v_lshlrev_b32 v28, 16, v60
v_and_b32 v29, 0xffff0000, v60
v_mul_f32 v28, v28, v25
v_mul_f32 v29, v29, v25
v_cvt_pk_bf16_f32 v60, v28, v29
v_lshlrev_b32 v28, 16, v61
v_and_b32 v29, 0xffff0000, v61
v_mul_f32 v28, v28, v25
v_mul_f32 v29, v29, v25
v_cvt_pk_bf16_f32 v61, v28, v29
v_lshlrev_b32 v28, 16, v62
v_and_b32 v29, 0xffff0000, v62
v_mul_f32 v28, v28, v25
v_mul_f32 v29, v29, v25
v_cvt_pk_bf16_f32 v62, v28, v29
v_lshlrev_b32 v28, 16, v63
v_and_b32 v29, 0xffff0000, v63
v_mul_f32 v28, v28, v25
v_mul_f32 v29, v29, v25
v_cvt_pk_bf16_f32 v63, v28, v29
s_call_b64 s[0:1], OSC_1
v_max3_f32 v31, v40, v41, v42
v_max3_f32 v31, v31, v43, v76
v_max3_f32 v31, v31, v77, v78
v_max3_f32 v31, v31, v79, 0
v_mov_b32 v30, v31
s_nop 1
v_permlane16_swap_b32 v31, v30
s_nop 1
v_max_f32 v31, v31, v30
v_mov_b32 v30, v31
s_nop 1
v_permlane32_swap_b32 v31, v30
s_nop 1
v_max_f32 v31, v31, v30
v_sub_f32 v15, v15, v31
v_sub_f32 v40, v40, v31
v_sub_f32 v76, v76, v31
v_sub_f32 v41, v41, v31
v_sub_f32 v77, v77, v31
v_sub_f32 v42, v42, v31
v_sub_f32 v78, v78, v31
v_sub_f32 v43, v43, v31
v_sub_f32 v79, v79, v31
v_exp_f32 v28, v40
s_nop 0
v_exp_f32 v29, v41
s_nop 0
v_cvt_pk_bf16_f32 v52, v28, v29
v_add_f32 v27, v28, v29
v_exp_f32 v28, v42
s_nop 0
v_exp_f32 v29, v43
s_nop 0
v_cvt_pk_bf16_f32 v53, v28, v29
v_add_f32 v27, v27, v28
v_add_f32 v27, v27, v29
v_exp_f32 v28, v76
s_nop 0
v_exp_f32 v29, v77
s_nop 0
v_cvt_pk_bf16_f32 v54, v28, v29
v_add_f32 v27, v27, v28
v_add_f32 v27, v27, v29
v_exp_f32 v28, v78
s_nop 0
v_exp_f32 v29, v79
s_nop 0
v_cvt_pk_bf16_f32 v55, v28, v29
v_add_f32 v27, v27, v28
v_add_f32 v27, v27, v29
v_exp_f32_e64 v25, -v31
s_nop 1
v_mul_f32 v19, v19, v25
v_lshlrev_b32 v28, 16, v64
v_and_b32 v29, 0xffff0000, v64
v_mul_f32 v28, v28, v25
v_mul_f32 v29, v29, v25
v_cvt_pk_bf16_f32 v64, v28, v29
v_lshlrev_b32 v28, 16, v65
v_and_b32 v29, 0xffff0000, v65
v_mul_f32 v28, v28, v25
v_mul_f32 v29, v29, v25
v_cvt_pk_bf16_f32 v65, v28, v29
v_lshlrev_b32 v28, 16, v66
v_and_b32 v29, 0xffff0000, v66
v_mul_f32 v28, v28, v25
v_mul_f32 v29, v29, v25
v_cvt_pk_bf16_f32 v66, v28, v29
v_lshlrev_b32 v28, 16, v67
v_and_b32 v29, 0xffff0000, v67
v_mul_f32 v28, v28, v25
v_mul_f32 v29, v29, v25
v_cvt_pk_bf16_f32 v67, v28, v29
s_call_b64 s[0:1], OSC_2
s_nop 3
s_nop 7
s_nop 3
s_setpc_b64 s[72:73]
RARE_2:
s_nop 7
v_max3_f32 v31, v80, v81, v82
v_max3_f32 v31, v31, v83, v68
v_max3_f32 v31, v31, v69, v70
v_max3_f32 v31, v31, v71, 0
v_mov_b32 v30, v31
s_nop 1
v_permlane16_swap_b32 v31, v30
s_nop 1
v_max_f32 v31, v31, v30
v_mov_b32 v30, v31
s_nop 1
v_permlane32_swap_b32 v31, v30
s_nop 1
v_max_f32 v31, v31, v30
v_sub_f32 v11, v11, v31
v_sub_f32 v80, v80, v31
v_sub_f32 v68, v68, v31
v_sub_f32 v81, v81, v31
v_sub_f32 v69, v69, v31
v_sub_f32 v82, v82, v31
v_sub_f32 v70, v70, v31
v_sub_f32 v83, v83, v31
v_sub_f32 v71, v71, v31
v_exp_f32 v28, v80
s_nop 0
v_exp_f32 v29, v81
s_nop 0
v_cvt_pk_bf16_f32 v32, v28, v29
v_add_f32 v24, v28, v29
v_exp_f32 v28, v82
s_nop 0
v_exp_f32 v29, v83
s_nop 0
v_cvt_pk_bf16_f32 v33, v28, v29
v_add_f32 v24, v24, v28
v_add_f32 v24, v24, v29
v_exp_f32 v28, v68
s_nop 0
v_exp_f32 v29, v69
s_nop 0
v_cvt_pk_bf16_f32 v34, v28, v29
v_add_f32 v24, v24, v28
v_add_f32 v24, v24, v29
v_exp_f32 v28, v70
s_nop 0
v_exp_f32 v29, v71
s_nop 0
v_cvt_pk_bf16_f32 v35, v28, v29
v_add_f32 v24, v24, v28
v_add_f32 v24, v24, v29
v_exp_f32_e64 v25, -v31
s_nop 1
v_mul_f32 v17, v17, v25
v_lshlrev_b32 v28, 16, v56
v_and_b32 v29, 0xffff0000, v56
v_mul_f32 v28, v28, v25
v_mul_f32 v29, v29, v25
v_cvt_pk_bf16_f32 v56, v28, v29
v_lshlrev_b32 v28, 16, v57
v_and_b32 v29, 0xffff0000, v57
v_mul_f32 v28, v28, v25
v_mul_f32 v29, v29, v25
v_cvt_pk_bf16_f32 v57, v28, v29
v_lshlrev_b32 v28, 16, v58
v_and_b32 v29, 0xffff0000, v58
v_mul_f32 v28, v28, v25
v_mul_f32 v29, v29, v25
v_cvt_pk_bf16_f32 v58, v28, v29
v_lshlrev_b32 v28, 16, v59
v_and_b32 v29, 0xffff0000, v59
v_mul_f32 v28, v28, v25
v_mul_f32 v29, v29, v25
v_cvt_pk_bf16_f32 v59, v28, v29
v_lshlrev_b32 v28, 16, v44
v_and_b32 v29, 0xffff0000, v44
v_mul_f32 v28, v28, v25
v_mul_f32 v29, v29, v25
v_cvt_pk_bf16_f32 v44, v28, v29
v_lshlrev_b32 v28, 16, v45
v_and_b32 v29, 0xffff0000, v45
v_mul_f32 v28, v28, v25
v_mul_f32 v29, v29, v25
v_cvt_pk_bf16_f32 v45, v28, v29
v_lshlrev_b32 v28, 16, v46
v_and_b32 v29, 0xffff0000, v46
v_mul_f32 v28, v28, v25
v_mul_f32 v29, v29, v25
v_cvt_pk_bf16_f32 v46, v28, v29
v_lshlrev_b32 v28, 16, v47
v_and_b32 v29, 0xffff0000, v47
v_mul_f32 v28, v28, v25
v_mul_f32 v29, v29, v25
v_cvt_pk_bf16_f32 v47, v28, v29
s_call_b64 s[0:1], OSC_0
v_max3_f32 v31, v84, v85, v86
v_max3_f32 v31, v31, v87, v72
v_max3_f32 v31, v31, v73, v74
v_max3_f32 v31, v31, v75, 0
v_mov_b32 v30, v31
s_nop 1
v_permlane16_swap_b32 v31, v30
s_nop 1
v_max_f32 v31, v31, v30
v_mov_b32 v30, v31
s_nop 1
v_permlane32_swap_b32 v31, v30
s_nop 1
v_max_f32 v31, v31, v30
v_sub_f32 v13, v13, v31
v_sub_f32 v84, v84, v31
v_sub_f32 v72, v72, v31
v_sub_f32 v85, v85, v31
v_sub_f32 v73, v73, v31
v_sub_f32 v86, v86, v31
v_sub_f32 v74, v74, v31
v_sub_f32 v87, v87, v31
v_sub_f32 v75, v75, v31
v_exp_f32 v28, v84
s_nop 0
v_exp_f32 v29, v85
s_nop 0
v_cvt_pk_bf16_f32 v36, v28, v29
v_add_f32 v26, v28, v29
v_exp_f32 v28, v86
s_nop 0
v_exp_f32 v29, v87
s_nop 0
v_cvt_pk_bf16_f32 v37, v28, v29
v_add_f32 v26, v26, v28
v_add_f32 v26, v26, v29
v_exp_f32 v28, v72
s_nop 0
v_exp_f32 v29, v73
s_nop 0
v_cvt_pk_bf16_f32 v38, v28, v29
v_add_f32 v26, v26, v28
v_add_f32 v26, v26, v29
v_exp_f32 v28, v74
s_nop 0
v_exp_f32 v29, v75
s_nop 0
v_cvt_pk_bf16_f32 v39, v28, v29
v_add_f32 v26, v26, v28
v_add_f32 v26, v26, v29
v_exp_f32_e64 v25, -v31
s_nop 1
v_mul_f32 v18, v18, v25
v_lshlrev_b32 v28, 16, v60
v_and_b32 v29, 0xffff0000, v60
v_mul_f32 v28, v28, v25
v_mul_f32 v29, v29, v25
v_cvt_pk_bf16_f32 v60, v28, v29
v_lshlrev_b32 v28, 16, v61
v_and_b32 v29, 0xffff0000, v61
v_mul_f32 v28, v28, v25
v_mul_f32 v29, v29, v25
v_cvt_pk_bf16_f32 v61, v28, v29
v_lshlrev_b32 v28, 16, v62
v_and_b32 v29, 0xffff0000, v62
v_mul_f32 v28, v28, v25
v_mul_f32 v29, v29, v25
v_cvt_pk_bf16_f32 v62, v28, v29
v_lshlrev_b32 v28, 16, v63
v_and_b32 v29, 0xffff0000, v63
v_mul_f32 v28, v28, v25
v_mul_f32 v29, v29, v25
v_cvt_pk_bf16_f32 v63, v28, v29
v_lshlrev_b32 v28, 16, v48
v_and_b32 v29, 0xffff0000, v48
v_mul_f32 v28, v28, v25
v_mul_f32 v29, v29, v25
v_cvt_pk_bf16_f32 v48, v28, v29
v_lshlrev_b32 v28, 16, v49
v_and_b32 v29, 0xffff0000, v49
v_mul_f32 v28, v28, v25
v_mul_f32 v29, v29, v25
v_cvt_pk_bf16_f32 v49, v28, v29
v_lshlrev_b32 v28, 16, v50
v_and_b32 v29, 0xffff0000, v50
v_mul_f32 v28, v28, v25
v_mul_f32 v29, v29, v25
v_cvt_pk_bf16_f32 v50, v28, v29
v_lshlrev_b32 v28, 16, v51
v_and_b32 v29, 0xffff0000, v51
v_mul_f32 v28, v28, v25
v_mul_f32 v29, v29, v25
v_cvt_pk_bf16_f32 v51, v28, v29
s_call_b64 s[0:1], OSC_1
v_max3_f32 v31, v88, v89, v90
v_max3_f32 v31, v31, v91, v76
v_max3_f32 v31, v31, v77, v78
v_max3_f32 v31, v31, v79, 0
v_mov_b32 v30, v31
s_nop 1
v_permlane16_swap_b32 v31, v30
s_nop 1
v_max_f32 v31, v31, v30
v_mov_b32 v30, v31
s_nop 1
v_permlane32_swap_b32 v31, v30
s_nop 1
v_max_f32 v31, v31, v30
v_sub_f32 v15, v15, v31
v_sub_f32 v88, v88, v31
v_sub_f32 v76, v76, v31
v_sub_f32 v89, v89, v31
v_sub_f32 v77, v77, v31
v_sub_f32 v90, v90, v31
v_sub_f32 v78, v78, v31
v_sub_f32 v91, v91, v31
v_sub_f32 v79, v79, v31
v_exp_f32 v28, v88
s_nop 0
v_exp_f32 v29, v89
s_nop 0
v_cvt_pk_bf16_f32 v40, v28, v29
v_add_f32 v27, v28, v29
v_exp_f32 v28, v90
s_nop 0
v_exp_f32 v29, v91
s_nop 0
v_cvt_pk_bf16_f32 v41, v28, v29
v_add_f32 v27, v27, v28
v_add_f32 v27, v27, v29
v_exp_f32 v28, v76
s_nop 0
v_exp_f32 v29, v77
s_nop 0
v_cvt_pk_bf16_f32 v42, v28, v29
v_add_f32 v27, v27, v28
v_add_f32 v27, v27, v29
v_exp_f32 v28, v78
s_nop 0
v_exp_f32 v29, v79
s_nop 0
v_cvt_pk_bf16_f32 v43, v28, v29
v_add_f32 v27, v27, v28
v_add_f32 v27, v27, v29
v_exp_f32_e64 v25, -v31
s_nop 1
v_mul_f32 v19, v19, v25
v_lshlrev_b32 v28, 16, v64
v_and_b32 v29, 0xffff0000, v64
v_mul_f32 v28, v28, v25
v_mul_f32 v29, v29, v25
v_cvt_pk_bf16_f32 v64, v28, v29
v_lshlrev_b32 v28, 16, v65
v_and_b32 v29, 0xffff0000, v65
v_mul_f32 v28, v28, v25
v_mul_f32 v29, v29, v25
v_cvt_pk_bf16_f32 v65, v28, v29
v_lshlrev_b32 v28, 16, v66
v_and_b32 v29, 0xffff0000, v66
v_mul_f32 v28, v28, v25
v_mul_f32 v29, v29, v25
v_cvt_pk_bf16_f32 v66, v28, v29
v_lshlrev_b32 v28, 16, v67
v_and_b32 v29, 0xffff0000, v67
v_mul_f32 v28, v28, v25
v_mul_f32 v29, v29, v25
v_cvt_pk_bf16_f32 v67, v28, v29
v_lshlrev_b32 v28, 16, v52
v_and_b32 v29, 0xffff0000, v52
v_mul_f32 v28, v28, v25
v_mul_f32 v29, v29, v25
v_cvt_pk_bf16_f32 v52, v28, v29
v_lshlrev_b32 v28, 16, v53
v_and_b32 v29, 0xffff0000, v53
v_mul_f32 v28, v28, v25
v_mul_f32 v29, v29, v25
v_cvt_pk_bf16_f32 v53, v28, v29
v_lshlrev_b32 v28, 16, v54
v_and_b32 v29, 0xffff0000, v54
v_mul_f32 v28, v28, v25
v_mul_f32 v29, v29, v25
v_cvt_pk_bf16_f32 v54, v28, v29
v_lshlrev_b32 v28, 16, v55
v_and_b32 v29, 0xffff0000, v55
v_mul_f32 v28, v28, v25
v_mul_f32 v29, v29, v25
v_cvt_pk_bf16_f32 v55, v28, v29
s_call_b64 s[0:1], OSC_2
s_nop 3
s_nop 7
s_nop 3
s_setpc_b64 s[72:73]
RARE_3:
s_nop 7
v_max3_f32 v31, v92, v93, v94
v_max3_f32 v31, v31, v95, v80
v_max3_f32 v31, v31, v81, v82
v_max3_f32 v31, v31, v83, 0
v_mov_b32 v30, v31
s_nop 1
v_permlane16_swap_b32 v31, v30
s_nop 1
v_max_f32 v31, v31, v30
v_mov_b32 v30, v31
s_nop 1
v_permlane32_swap_b32 v31, v30
s_nop 1
v_max_f32 v31, v31, v30
v_sub_f32 v11, v11, v31
v_sub_f32 v92, v92, v31
v_sub_f32 v80, v80, v31
v_sub_f32 v93, v93, v31
v_sub_f32 v81, v81, v31
v_sub_f32 v94, v94, v31
v_sub_f32 v82, v82, v31
v_sub_f32 v95, v95, v31
v_sub_f32 v83, v83, v31
v_exp_f32 v28, v92
s_nop 0
v_exp_f32 v29, v93
s_nop 0
v_cvt_pk_bf16_f32 v68, v28, v29
v_add_f32 v24, v28, v29
v_exp_f32 v28, v94
s_nop 0
v_exp_f32 v29, v95
s_nop 0
v_cvt_pk_bf16_f32 v69, v28, v29
v_add_f32 v24, v24, v28
v_add_f32 v24, v24, v29
v_exp_f32 v28, v80
s_nop 0
v_exp_f32 v29, v81
s_nop 0
v_cvt_pk_bf16_f32 v70, v28, v29
v_add_f32 v24, v24, v28
v_add_f32 v24, v24, v29
v_exp_f32 v28, v82
s_nop 0
v_exp_f32 v29, v83
s_nop 0
v_cvt_pk_bf16_f32 v71, v28, v29
v_add_f32 v24, v24, v28
v_add_f32 v24, v24, v29
v_exp_f32_e64 v25, -v31
s_nop 1
v_mul_f32 v17, v17, v25
v_lshlrev_b32 v28, 16, v32
v_and_b32 v29, 0xffff0000, v32
v_mul_f32 v28, v28, v25
v_mul_f32 v29, v29, v25
v_cvt_pk_bf16_f32 v32, v28, v29
v_lshlrev_b32 v28, 16, v33
v_and_b32 v29, 0xffff0000, v33
v_mul_f32 v28, v28, v25
v_mul_f32 v29, v29, v25
v_cvt_pk_bf16_f32 v33, v28, v29
v_lshlrev_b32 v28, 16, v34
v_and_b32 v29, 0xffff0000, v34
v_mul_f32 v28, v28, v25
v_mul_f32 v29, v29, v25
v_cvt_pk_bf16_f32 v34, v28, v29
v_lshlrev_b32 v28, 16, v35
v_and_b32 v29, 0xffff0000, v35
v_mul_f32 v28, v28, v25
v_mul_f32 v29, v29, v25
v_cvt_pk_bf16_f32 v35, v28, v29
s_call_b64 s[0:1], OSC_0
v_max3_f32 v31, v96, v97, v98
v_max3_f32 v31, v31, v99, v84
v_max3_f32 v31, v31, v85, v86
v_max3_f32 v31, v31, v87, 0
v_mov_b32 v30, v31
s_nop 1
v_permlane16_swap_b32 v31, v30
s_nop 1
v_max_f32 v31, v31, v30
v_mov_b32 v30, v31
s_nop 1
v_permlane32_swap_b32 v31, v30
s_nop 1
v_max_f32 v31, v31, v30
v_sub_f32 v13, v13, v31
v_sub_f32 v96, v96, v31
v_sub_f32 v84, v84, v31
v_sub_f32 v97, v97, v31
v_sub_f32 v85, v85, v31
v_sub_f32 v98, v98, v31
v_sub_f32 v86, v86, v31
v_sub_f32 v99, v99, v31
v_sub_f32 v87, v87, v31
v_exp_f32 v28, v96
s_nop 0
v_exp_f32 v29, v97
s_nop 0
v_cvt_pk_bf16_f32 v72, v28, v29
v_add_f32 v26, v28, v29
v_exp_f32 v28, v98
s_nop 0
v_exp_f32 v29, v99
s_nop 0
v_cvt_pk_bf16_f32 v73, v28, v29
v_add_f32 v26, v26, v28
v_add_f32 v26, v26, v29
v_exp_f32 v28, v84
s_nop 0
v_exp_f32 v29, v85
s_nop 0
v_cvt_pk_bf16_f32 v74, v28, v29
v_add_f32 v26, v26, v28
v_add_f32 v26, v26, v29
v_exp_f32 v28, v86
s_nop 0
v_exp_f32 v29, v87
s_nop 0
v_cvt_pk_bf16_f32 v75, v28, v29
v_add_f32 v26, v26, v28
v_add_f32 v26, v26, v29
v_exp_f32_e64 v25, -v31
s_nop 1
v_mul_f32 v18, v18, v25
v_lshlrev_b32 v28, 16, v36
v_and_b32 v29, 0xffff0000, v36
v_mul_f32 v28, v28, v25
v_mul_f32 v29, v29, v25
v_cvt_pk_bf16_f32 v36, v28, v29
v_lshlrev_b32 v28, 16, v37
v_and_b32 v29, 0xffff0000, v37
v_mul_f32 v28, v28, v25
v_mul_f32 v29, v29, v25
v_cvt_pk_bf16_f32 v37, v28, v29
v_lshlrev_b32 v28, 16, v38
v_and_b32 v29, 0xffff0000, v38
v_mul_f32 v28, v28, v25
v_mul_f32 v29, v29, v25
v_cvt_pk_bf16_f32 v38, v28, v29
v_lshlrev_b32 v28, 16, v39
v_and_b32 v29, 0xffff0000, v39
v_mul_f32 v28, v28, v25
v_mul_f32 v29, v29, v25
v_cvt_pk_bf16_f32 v39, v28, v29
s_call_b64 s[0:1], OSC_1
v_max3_f32 v31, v100, v101, v102
v_max3_f32 v31, v31, v103, v88
v_max3_f32 v31, v31, v89, v90
v_max3_f32 v31, v31, v91, 0
v_mov_b32 v30, v31
s_nop 1
v_permlane16_swap_b32 v31, v30
s_nop 1
v_max_f32 v31, v31, v30
v_mov_b32 v30, v31
s_nop 1
v_permlane32_swap_b32 v31, v30
s_nop 1
v_max_f32 v31, v31, v30
v_sub_f32 v15, v15, v31
v_sub_f32 v100, v100, v31
v_sub_f32 v88, v88, v31
v_sub_f32 v101, v101, v31
v_sub_f32 v89, v89, v31
v_sub_f32 v102, v102, v31
v_sub_f32 v90, v90, v31
v_sub_f32 v103, v103, v31
v_sub_f32 v91, v91, v31
v_exp_f32 v28, v100
s_nop 0
v_exp_f32 v29, v101
s_nop 0
v_cvt_pk_bf16_f32 v76, v28, v29
v_add_f32 v27, v28, v29
v_exp_f32 v28, v102
s_nop 0
v_exp_f32 v29, v103
s_nop 0
v_cvt_pk_bf16_f32 v77, v28, v29
v_add_f32 v27, v27, v28
v_add_f32 v27, v27, v29
v_exp_f32 v28, v88
s_nop 0
v_exp_f32 v29, v89
s_nop 0
v_cvt_pk_bf16_f32 v78, v28, v29
v_add_f32 v27, v27, v28
v_add_f32 v27, v27, v29
v_exp_f32 v28, v90
s_nop 0
v_exp_f32 v29, v91
s_nop 0
v_cvt_pk_bf16_f32 v79, v28, v29
v_add_f32 v27, v27, v28
v_add_f32 v27, v27, v29
v_exp_f32_e64 v25, -v31
s_nop 1
v_mul_f32 v19, v19, v25
v_lshlrev_b32 v28, 16, v40
v_and_b32 v29, 0xffff0000, v40
v_mul_f32 v28, v28, v25
v_mul_f32 v29, v29, v25
v_cvt_pk_bf16_f32 v40, v28, v29
v_lshlrev_b32 v28, 16, v41
v_and_b32 v29, 0xffff0000, v41
v_mul_f32 v28, v28, v25
v_mul_f32 v29, v29, v25
v_cvt_pk_bf16_f32 v41, v28, v29
v_lshlrev_b32 v28, 16, v42
v_and_b32 v29, 0xffff0000, v42
v_mul_f32 v28, v28, v25
v_mul_f32 v29, v29, v25
v_cvt_pk_bf16_f32 v42, v28, v29
v_lshlrev_b32 v28, 16, v43
v_and_b32 v29, 0xffff0000, v43
v_mul_f32 v28, v28, v25
v_mul_f32 v29, v29, v25
v_cvt_pk_bf16_f32 v43, v28, v29
s_call_b64 s[0:1], OSC_2
s_nop 3
s_nop 7
s_nop 3
s_setpc_b64 s[72:73]
RARE_4:
s_nop 7
v_max3_f32 v31, v44, v45, v46
v_max3_f32 v31, v31, v47, v80
v_max3_f32 v31, v31, v81, v82
v_max3_f32 v31, v31, v83, 0
v_mov_b32 v30, v31
s_nop 1
v_permlane16_swap_b32 v31, v30
s_nop 1
v_max_f32 v31, v31, v30
v_mov_b32 v30, v31
s_nop 1
v_permlane32_swap_b32 v31, v30
s_nop 1
v_max_f32 v31, v31, v30
v_sub_f32 v11, v11, v31
v_sub_f32 v44, v44, v31
v_sub_f32 v80, v80, v31
v_sub_f32 v45, v45, v31
v_sub_f32 v81, v81, v31
v_sub_f32 v46, v46, v31
v_sub_f32 v82, v82, v31
v_sub_f32 v47, v47, v31
v_sub_f32 v83, v83, v31
v_exp_f32 v28, v44
s_nop 0
v_exp_f32 v29, v45
s_nop 0
v_cvt_pk_bf16_f32 v56, v28, v29
v_add_f32 v24, v28, v29
v_exp_f32 v28, v46
s_nop 0
v_exp_f32 v29, v47
s_nop 0
v_cvt_pk_bf16_f32 v57, v28, v29
v_add_f32 v24, v24, v28
v_add_f32 v24, v24, v29
v_exp_f32 v28, v80
s_nop 0
v_exp_f32 v29, v81
s_nop 0
v_cvt_pk_bf16_f32 v58, v28, v29
v_add_f32 v24, v24, v28
v_add_f32 v24, v24, v29
v_exp_f32 v28, v82
s_nop 0
v_exp_f32 v29, v83
s_nop 0
v_cvt_pk_bf16_f32 v59, v28, v29
v_add_f32 v24, v24, v28
v_add_f32 v24, v24, v29
v_exp_f32_e64 v25, -v31
s_nop 1
v_mul_f32 v17, v17, v25
v_lshlrev_b32 v28, 16, v32
v_and_b32 v29, 0xffff0000, v32
v_mul_f32 v28, v28, v25
v_mul_f32 v29, v29, v25
v_cvt_pk_bf16_f32 v32, v28, v29
v_lshlrev_b32 v28, 16, v33
v_and_b32 v29, 0xffff0000, v33
v_mul_f32 v28, v28, v25
v_mul_f32 v29, v29, v25
v_cvt_pk_bf16_f32 v33, v28, v29
v_lshlrev_b32 v28, 16, v34
v_and_b32 v29, 0xffff0000, v34
v_mul_f32 v28, v28, v25
v_mul_f32 v29, v29, v25
v_cvt_pk_bf16_f32 v34, v28, v29
v_lshlrev_b32 v28, 16, v35
v_and_b32 v29, 0xffff0000, v35
v_mul_f32 v28, v28, v25
v_mul_f32 v29, v29, v25
v_cvt_pk_bf16_f32 v35, v28, v29
v_lshlrev_b32 v28, 16, v68
v_and_b32 v29, 0xffff0000, v68
v_mul_f32 v28, v28, v25
v_mul_f32 v29, v29, v25
v_cvt_pk_bf16_f32 v68, v28, v29
v_lshlrev_b32 v28, 16, v69
v_and_b32 v29, 0xffff0000, v69
v_mul_f32 v28, v28, v25
v_mul_f32 v29, v29, v25
v_cvt_pk_bf16_f32 v69, v28, v29
v_lshlrev_b32 v28, 16, v70
v_and_b32 v29, 0xffff0000, v70
v_mul_f32 v28, v28, v25
v_mul_f32 v29, v29, v25
v_cvt_pk_bf16_f32 v70, v28, v29
v_lshlrev_b32 v28, 16, v71
v_and_b32 v29, 0xffff0000, v71
v_mul_f32 v28, v28, v25
v_mul_f32 v29, v29, v25
v_cvt_pk_bf16_f32 v71, v28, v29
s_call_b64 s[0:1], OSC_0
v_max3_f32 v31, v48, v49, v50
v_max3_f32 v31, v31, v51, v84
v_max3_f32 v31, v31, v85, v86
v_max3_f32 v31, v31, v87, 0
v_mov_b32 v30, v31
s_nop 1
v_permlane16_swap_b32 v31, v30
s_nop 1
v_max_f32 v31, v31, v30
v_mov_b32 v30, v31
s_nop 1
v_permlane32_swap_b32 v31, v30
s_nop 1
v_max_f32 v31, v31, v30
v_sub_f32 v13, v13, v31
v_sub_f32 v48, v48, v31
v_sub_f32 v84, v84, v31
v_sub_f32 v49, v49, v31
v_sub_f32 v85, v85, v31
v_sub_f32 v50, v50, v31
v_sub_f32 v86, v86, v31
v_sub_f32 v51, v51, v31
v_sub_f32 v87, v87, v31
v_exp_f32 v28, v48
s_nop 0
v_exp_f32 v29, v49
s_nop 0
v_cvt_pk_bf16_f32 v60, v28, v29
v_add_f32 v26, v28, v29
v_exp_f32 v28, v50
s_nop 0
v_exp_f32 v29, v51
s_nop 0
v_cvt_pk_bf16_f32 v61, v28, v29
v_add_f32 v26, v26, v28
v_add_f32 v26, v26, v29
v_exp_f32 v28, v84
s_nop 0
v_exp_f32 v29, v85
s_nop 0
v_cvt_pk_bf16_f32 v62, v28, v29
v_add_f32 v26, v26, v28
v_add_f32 v26, v26, v29
v_exp_f32 v28, v86
s_nop 0
v_exp_f32 v29, v87
s_nop 0
v_cvt_pk_bf16_f32 v63, v28, v29
v_add_f32 v26, v26, v28
v_add_f32 v26, v26, v29
v_exp_f32_e64 v25, -v31
s_nop 1
v_mul_f32 v18, v18, v25
v_lshlrev_b32 v28, 16, v36
v_and_b32 v29, 0xffff0000, v36
v_mul_f32 v28, v28, v25
v_mul_f32 v29, v29, v25
v_cvt_pk_bf16_f32 v36, v28, v29
v_lshlrev_b32 v28, 16, v37
v_and_b32 v29, 0xffff0000, v37
v_mul_f32 v28, v28, v25
v_mul_f32 v29, v29, v25
v_cvt_pk_bf16_f32 v37, v28, v29
v_lshlrev_b32 v28, 16, v38
v_and_b32 v29, 0xffff0000, v38
v_mul_f32 v28, v28, v25
v_mul_f32 v29, v29, v25
v_cvt_pk_bf16_f32 v38, v28, v29
v_lshlrev_b32 v28, 16, v39
v_and_b32 v29, 0xffff0000, v39
v_mul_f32 v28, v28, v25
v_mul_f32 v29, v29, v25
v_cvt_pk_bf16_f32 v39, v28, v29
v_lshlrev_b32 v28, 16, v72
v_and_b32 v29, 0xffff0000, v72
v_mul_f32 v28, v28, v25
v_mul_f32 v29, v29, v25
v_cvt_pk_bf16_f32 v72, v28, v29
v_lshlrev_b32 v28, 16, v73
v_and_b32 v29, 0xffff0000, v73
v_mul_f32 v28, v28, v25
v_mul_f32 v29, v29, v25
v_cvt_pk_bf16_f32 v73, v28, v29
v_lshlrev_b32 v28, 16, v74
v_and_b32 v29, 0xffff0000, v74
v_mul_f32 v28, v28, v25
v_mul_f32 v29, v29, v25
v_cvt_pk_bf16_f32 v74, v28, v29
v_lshlrev_b32 v28, 16, v75
v_and_b32 v29, 0xffff0000, v75
v_mul_f32 v28, v28, v25
v_mul_f32 v29, v29, v25
v_cvt_pk_bf16_f32 v75, v28, v29
s_call_b64 s[0:1], OSC_1
v_max3_f32 v31, v52, v53, v54
v_max3_f32 v31, v31, v55, v88
v_max3_f32 v31, v31, v89, v90
v_max3_f32 v31, v31, v91, 0
v_mov_b32 v30, v31
s_nop 1
v_permlane16_swap_b32 v31, v30
s_nop 1
v_max_f32 v31, v31, v30
v_mov_b32 v30, v31
s_nop 1
v_permlane32_swap_b32 v31, v30
s_nop 1
v_max_f32 v31, v31, v30
v_sub_f32 v15, v15, v31
v_sub_f32 v52, v52, v31
v_sub_f32 v88, v88, v31
v_sub_f32 v53, v53, v31
v_sub_f32 v89, v89, v31
v_sub_f32 v54, v54, v31
v_sub_f32 v90, v90, v31
v_sub_f32 v55, v55, v31
v_sub_f32 v91, v91, v31
v_exp_f32 v28, v52
s_nop 0
v_exp_f32 v29, v53
s_nop 0
v_cvt_pk_bf16_f32 v64, v28, v29
v_add_f32 v27, v28, v29
v_exp_f32 v28, v54
s_nop 0
v_exp_f32 v29, v55
s_nop 0
v_cvt_pk_bf16_f32 v65, v28, v29
v_add_f32 v27, v27, v28
v_add_f32 v27, v27, v29
v_exp_f32 v28, v88
s_nop 0
v_exp_f32 v29, v89
s_nop 0
v_cvt_pk_bf16_f32 v66, v28, v29
v_add_f32 v27, v27, v28
v_add_f32 v27, v27, v29
v_exp_f32 v28, v90
s_nop 0
v_exp_f32 v29, v91
s_nop 0
v_cvt_pk_bf16_f32 v67, v28, v29
v_add_f32 v27, v27, v28
v_add_f32 v27, v27, v29
v_exp_f32_e64 v25, -v31
s_nop 1
v_mul_f32 v19, v19, v25
v_lshlrev_b32 v28, 16, v40
v_and_b32 v29, 0xffff0000, v40
v_mul_f32 v28, v28, v25
v_mul_f32 v29, v29, v25
v_cvt_pk_bf16_f32 v40, v28, v29
v_lshlrev_b32 v28, 16, v41
v_and_b32 v29, 0xffff0000, v41
v_mul_f32 v28, v28, v25
v_mul_f32 v29, v29, v25
v_cvt_pk_bf16_f32 v41, v28, v29
v_lshlrev_b32 v28, 16, v42
v_and_b32 v29, 0xffff0000, v42
v_mul_f32 v28, v28, v25
v_mul_f32 v29, v29, v25
v_cvt_pk_bf16_f32 v42, v28, v29
v_lshlrev_b32 v28, 16, v43
v_and_b32 v29, 0xffff0000, v43
v_mul_f32 v28, v28, v25
v_mul_f32 v29, v29, v25
v_cvt_pk_bf16_f32 v43, v28, v29
v_lshlrev_b32 v28, 16, v76
v_and_b32 v29, 0xffff0000, v76
v_mul_f32 v28, v28, v25
v_mul_f32 v29, v29, v25
v_cvt_pk_bf16_f32 v76, v28, v29
v_lshlrev_b32 v28, 16, v77
v_and_b32 v29, 0xffff0000, v77
v_mul_f32 v28, v28, v25
v_mul_f32 v29, v29, v25
v_cvt_pk_bf16_f32 v77, v28, v29
v_lshlrev_b32 v28, 16, v78
v_and_b32 v29, 0xffff0000, v78
v_mul_f32 v28, v28, v25
v_mul_f32 v29, v29, v25
v_cvt_pk_bf16_f32 v78, v28, v29
v_lshlrev_b32 v28, 16, v79
v_and_b32 v29, 0xffff0000, v79
v_mul_f32 v28, v28, v25
v_mul_f32 v29, v29, v25
v_cvt_pk_bf16_f32 v79, v28, v29
s_call_b64 s[0:1], OSC_2
s_nop 3
s_nop 7
s_nop 3
s_setpc_b64 s[72:73]
RARE_5:
s_nop 7
v_max3_f32 v31, v92, v93, v94
v_max3_f32 v31, v31, v95, v80
v_max3_f32 v31, v31, v81, v82
v_max3_f32 v31, v31, v83, 0
v_mov_b32 v30, v31
s_nop 1
v_permlane16_swap_b32 v31, v30
s_nop 1
v_max_f32 v31, v31, v30
v_mov_b32 v30, v31
s_nop 1
v_permlane32_swap_b32 v31, v30
s_nop 1
v_max_f32 v31, v31, v30
v_sub_f32 v11, v11, v31
v_sub_f32 v92, v92, v31
v_sub_f32 v80, v80, v31
v_sub_f32 v93, v93, v31
v_sub_f32 v81, v81, v31
v_sub_f32 v94, v94, v31
v_sub_f32 v82, v82, v31
v_sub_f32 v95, v95, v31
v_sub_f32 v83, v83, v31
v_exp_f32 v28, v92
s_nop 0
v_exp_f32 v29, v93
s_nop 0
v_cvt_pk_bf16_f32 v44, v28, v29
v_add_f32 v24, v28, v29
v_exp_f32 v28, v94
s_nop 0
v_exp_f32 v29, v95
s_nop 0
v_cvt_pk_bf16_f32 v45, v28, v29
v_add_f32 v24, v24, v28
v_add_f32 v24, v24, v29
v_exp_f32 v28, v80
s_nop 0
v_exp_f32 v29, v81
s_nop 0
v_cvt_pk_bf16_f32 v46, v28, v29
v_add_f32 v24, v24, v28
v_add_f32 v24, v24, v29
v_exp_f32 v28, v82
s_nop 0
v_exp_f32 v29, v83
s_nop 0
v_cvt_pk_bf16_f32 v47, v28, v29
v_add_f32 v24, v24, v28
v_add_f32 v24, v24, v29
v_exp_f32_e64 v25, -v31
s_nop 1
v_mul_f32 v17, v17, v25
v_lshlrev_b32 v28, 16, v56
v_and_b32 v29, 0xffff0000, v56
v_mul_f32 v28, v28, v25
v_mul_f32 v29, v29, v25
v_cvt_pk_bf16_f32 v56, v28, v29
v_lshlrev_b32 v28, 16, v57
v_and_b32 v29, 0xffff0000, v57
v_mul_f32 v28, v28, v25
v_mul_f32 v29, v29, v25
v_cvt_pk_bf16_f32 v57, v28, v29
v_lshlrev_b32 v28, 16, v58
v_and_b32 v29, 0xffff0000, v58
v_mul_f32 v28, v28, v25
v_mul_f32 v29, v29, v25
v_cvt_pk_bf16_f32 v58, v28, v29
v_lshlrev_b32 v28, 16, v59
v_and_b32 v29, 0xffff0000, v59
v_mul_f32 v28, v28, v25
v_mul_f32 v29, v29, v25
v_cvt_pk_bf16_f32 v59, v28, v29
s_call_b64 s[0:1], OSC_0
v_max3_f32 v31, v96, v97, v98
v_max3_f32 v31, v31, v99, v84
v_max3_f32 v31, v31, v85, v86
v_max3_f32 v31, v31, v87, 0
v_mov_b32 v30, v31
s_nop 1
v_permlane16_swap_b32 v31, v30
s_nop 1
v_max_f32 v31, v31, v30
v_mov_b32 v30, v31
s_nop 1
v_permlane32_swap_b32 v31, v30
s_nop 1
v_max_f32 v31, v31, v30
v_sub_f32 v13, v13, v31
v_sub_f32 v96, v96, v31
v_sub_f32 v84, v84, v31
v_sub_f32 v97, v97, v31
v_sub_f32 v85, v85, v31
v_sub_f32 v98, v98, v31
v_sub_f32 v86, v86, v31
v_sub_f32 v99, v99, v31
v_sub_f32 v87, v87, v31
v_exp_f32 v28, v96
s_nop 0
v_exp_f32 v29, v97
s_nop 0
v_cvt_pk_bf16_f32 v48, v28, v29
v_add_f32 v26, v28, v29
v_exp_f32 v28, v98
s_nop 0
v_exp_f32 v29, v99
s_nop 0
v_cvt_pk_bf16_f32 v49, v28, v29
v_add_f32 v26, v26, v28
v_add_f32 v26, v26, v29
v_exp_f32 v28, v84
s_nop 0
v_exp_f32 v29, v85
s_nop 0
v_cvt_pk_bf16_f32 v50, v28, v29
v_add_f32 v26, v26, v28
v_add_f32 v26, v26, v29
v_exp_f32 v28, v86
s_nop 0
v_exp_f32 v29, v87
s_nop 0
v_cvt_pk_bf16_f32 v51, v28, v29
v_add_f32 v26, v26, v28
v_add_f32 v26, v26, v29
v_exp_f32_e64 v25, -v31
s_nop 1
v_mul_f32 v18, v18, v25
v_lshlrev_b32 v28, 16, v60
v_and_b32 v29, 0xffff0000, v60
v_mul_f32 v28, v28, v25
v_mul_f32 v29, v29, v25
v_cvt_pk_bf16_f32 v60, v28, v29
v_lshlrev_b32 v28, 16, v61
v_and_b32 v29, 0xffff0000, v61
v_mul_f32 v28, v28, v25
v_mul_f32 v29, v29, v25
v_cvt_pk_bf16_f32 v61, v28, v29
v_lshlrev_b32 v28, 16, v62
v_and_b32 v29, 0xffff0000, v62
v_mul_f32 v28, v28, v25
v_mul_f32 v29, v29, v25
v_cvt_pk_bf16_f32 v62, v28, v29
v_lshlrev_b32 v28, 16, v63
v_and_b32 v29, 0xffff0000, v63
v_mul_f32 v28, v28, v25
v_mul_f32 v29, v29, v25
v_cvt_pk_bf16_f32 v63, v28, v29
s_call_b64 s[0:1], OSC_1
v_max3_f32 v31, v100, v101, v102
v_max3_f32 v31, v31, v103, v88
v_max3_f32 v31, v31, v89, v90
v_max3_f32 v31, v31, v91, 0
v_mov_b32 v30, v31
s_nop 1
v_permlane16_swap_b32 v31, v30
s_nop 1
v_max_f32 v31, v31, v30
v_mov_b32 v30, v31
s_nop 1
v_permlane32_swap_b32 v31, v30
s_nop 1
v_max_f32 v31, v31, v30
v_sub_f32 v15, v15, v31
v_sub_f32 v100, v100, v31
v_sub_f32 v88, v88, v31
v_sub_f32 v101, v101, v31
v_sub_f32 v89, v89, v31
v_sub_f32 v102, v102, v31
v_sub_f32 v90, v90, v31
v_sub_f32 v103, v103, v31
v_sub_f32 v91, v91, v31
v_exp_f32 v28, v100
s_nop 0
v_exp_f32 v29, v101
s_nop 0
v_cvt_pk_bf16_f32 v52, v28, v29
v_add_f32 v27, v28, v29
v_exp_f32 v28, v102
s_nop 0
v_exp_f32 v29, v103
s_nop 0
v_cvt_pk_bf16_f32 v53, v28, v29
v_add_f32 v27, v27, v28
v_add_f32 v27, v27, v29
v_exp_f32 v28, v88
s_nop 0
v_exp_f32 v29, v89
s_nop 0
v_cvt_pk_bf16_f32 v54, v28, v29
v_add_f32 v27, v27, v28
v_add_f32 v27, v27, v29
v_exp_f32 v28, v90
s_nop 0
v_exp_f32 v29, v91
s_nop 0
v_cvt_pk_bf16_f32 v55, v28, v29
v_add_f32 v27, v27, v28
v_add_f32 v27, v27, v29
v_exp_f32_e64 v25, -v31
s_nop 1
v_mul_f32 v19, v19, v25
v_lshlrev_b32 v28, 16, v64
v_and_b32 v29, 0xffff0000, v64
v_mul_f32 v28, v28, v25
v_mul_f32 v29, v29, v25
v_cvt_pk_bf16_f32 v64, v28, v29
v_lshlrev_b32 v28, 16, v65
v_and_b32 v29, 0xffff0000, v65
v_mul_f32 v28, v28, v25
v_mul_f32 v29, v29, v25
v_cvt_pk_bf16_f32 v65, v28, v29
v_lshlrev_b32 v28, 16, v66
v_and_b32 v29, 0xffff0000, v66
v_mul_f32 v28, v28, v25
v_mul_f32 v29, v29, v25
v_cvt_pk_bf16_f32 v66, v28, v29
v_lshlrev_b32 v28, 16, v67
v_and_b32 v29, 0xffff0000, v67
v_mul_f32 v28, v28, v25
v_mul_f32 v29, v29, v25
v_cvt_pk_bf16_f32 v67, v28, v29
s_call_b64 s[0:1], OSC_2
s_nop 3
s_nop 7
s_nop 3
s_setpc_b64 s[72:73]
RARE_6:
s_nop 7
v_max3_f32 v31, v32, v33, v34
v_max3_f32 v31, v31, v35, v80
v_max3_f32 v31, v31, v81, v82
v_max3_f32 v31, v31, v83, 0
v_mov_b32 v30, v31
s_nop 1
v_permlane16_swap_b32 v31, v30
s_nop 1
v_max_f32 v31, v31, v30
v_mov_b32 v30, v31
s_nop 1
v_permlane32_swap_b32 v31, v30
s_nop 1
v_max_f32 v31, v31, v30
v_sub_f32 v11, v11, v31
v_sub_f32 v32, v32, v31
v_sub_f32 v80, v80, v31
v_sub_f32 v33, v33, v31
v_sub_f32 v81, v81, v31
v_sub_f32 v34, v34, v31
v_sub_f32 v82, v82, v31
v_sub_f32 v35, v35, v31
v_sub_f32 v83, v83, v31
v_exp_f32 v28, v32
s_nop 0
v_exp_f32 v29, v33
s_nop 0
v_cvt_pk_bf16_f32 v68, v28, v29
v_add_f32 v24, v28, v29
v_exp_f32 v28, v34
s_nop 0
v_exp_f32 v29, v35
s_nop 0
v_cvt_pk_bf16_f32 v69, v28, v29
v_add_f32 v24, v24, v28
v_add_f32 v24, v24, v29
v_exp_f32 v28, v80
s_nop 0
v_exp_f32 v29, v81
s_nop 0
v_cvt_pk_bf16_f32 v70, v28, v29
v_add_f32 v24, v24, v28
v_add_f32 v24, v24, v29
v_exp_f32 v28, v82
s_nop 0
v_exp_f32 v29, v83
s_nop 0
v_cvt_pk_bf16_f32 v71, v28, v29
v_add_f32 v24, v24, v28
v_add_f32 v24, v24, v29
v_exp_f32_e64 v25, -v31
s_nop 1
v_mul_f32 v17, v17, v25
v_lshlrev_b32 v28, 16, v56
v_and_b32 v29, 0xffff0000, v56
v_mul_f32 v28, v28, v25
v_mul_f32 v29, v29, v25
v_cvt_pk_bf16_f32 v56, v28, v29
v_lshlrev_b32 v28, 16, v57
v_and_b32 v29, 0xffff0000, v57
v_mul_f32 v28, v28, v25
v_mul_f32 v29, v29, v25
v_cvt_pk_bf16_f32 v57, v28, v29
v_lshlrev_b32 v28, 16, v58
v_and_b32 v29, 0xffff0000, v58
v_mul_f32 v28, v28, v25
v_mul_f32 v29, v29, v25
v_cvt_pk_bf16_f32 v58, v28, v29
v_lshlrev_b32 v28, 16, v59
v_and_b32 v29, 0xffff0000, v59
v_mul_f32 v28, v28, v25
v_mul_f32 v29, v29, v25
v_cvt_pk_bf16_f32 v59, v28, v29
v_lshlrev_b32 v28, 16, v44
v_and_b32 v29, 0xffff0000, v44
v_mul_f32 v28, v28, v25
v_mul_f32 v29, v29, v25
v_cvt_pk_bf16_f32 v44, v28, v29
v_lshlrev_b32 v28, 16, v45
v_and_b32 v29, 0xffff0000, v45
v_mul_f32 v28, v28, v25
v_mul_f32 v29, v29, v25
v_cvt_pk_bf16_f32 v45, v28, v29
v_lshlrev_b32 v28, 16, v46
v_and_b32 v29, 0xffff0000, v46
v_mul_f32 v28, v28, v25
v_mul_f32 v29, v29, v25
v_cvt_pk_bf16_f32 v46, v28, v29
v_lshlrev_b32 v28, 16, v47
v_and_b32 v29, 0xffff0000, v47
v_mul_f32 v28, v28, v25
v_mul_f32 v29, v29, v25
v_cvt_pk_bf16_f32 v47, v28, v29
s_call_b64 s[0:1], OSC_0
v_max3_f32 v31, v36, v37, v38
v_max3_f32 v31, v31, v39, v84
v_max3_f32 v31, v31, v85, v86
v_max3_f32 v31, v31, v87, 0
v_mov_b32 v30, v31
s_nop 1
v_permlane16_swap_b32 v31, v30
s_nop 1
v_max_f32 v31, v31, v30
v_mov_b32 v30, v31
s_nop 1
v_permlane32_swap_b32 v31, v30
s_nop 1
v_max_f32 v31, v31, v30
v_sub_f32 v13, v13, v31
v_sub_f32 v36, v36, v31
v_sub_f32 v84, v84, v31
v_sub_f32 v37, v37, v31
v_sub_f32 v85, v85, v31
v_sub_f32 v38, v38, v31
v_sub_f32 v86, v86, v31
v_sub_f32 v39, v39, v31
v_sub_f32 v87, v87, v31
v_exp_f32 v28, v36
s_nop 0
v_exp_f32 v29, v37
s_nop 0
v_cvt_pk_bf16_f32 v72, v28, v29
v_add_f32 v26, v28, v29
v_exp_f32 v28, v38
s_nop 0
v_exp_f32 v29, v39
s_nop 0
v_cvt_pk_bf16_f32 v73, v28, v29
v_add_f32 v26, v26, v28
v_add_f32 v26, v26, v29
v_exp_f32 v28, v84
s_nop 0
v_exp_f32 v29, v85
s_nop 0
v_cvt_pk_bf16_f32 v74, v28, v29
v_add_f32 v26, v26, v28
v_add_f32 v26, v26, v29
v_exp_f32 v28, v86
s_nop 0
v_exp_f32 v29, v87
s_nop 0
v_cvt_pk_bf16_f32 v75, v28, v29
v_add_f32 v26, v26, v28
v_add_f32 v26, v26, v29
v_exp_f32_e64 v25, -v31
s_nop 1
v_mul_f32 v18, v18, v25
v_lshlrev_b32 v28, 16, v60
v_and_b32 v29, 0xffff0000, v60
v_mul_f32 v28, v28, v25
v_mul_f32 v29, v29, v25
v_cvt_pk_bf16_f32 v60, v28, v29
v_lshlrev_b32 v28, 16, v61
v_and_b32 v29, 0xffff0000, v61
v_mul_f32 v28, v28, v25
v_mul_f32 v29, v29, v25
v_cvt_pk_bf16_f32 v61, v28, v29
v_lshlrev_b32 v28, 16, v62
v_and_b32 v29, 0xffff0000, v62
v_mul_f32 v28, v28, v25
v_mul_f32 v29, v29, v25
v_cvt_pk_bf16_f32 v62, v28, v29
v_lshlrev_b32 v28, 16, v63
v_and_b32 v29, 0xffff0000, v63
v_mul_f32 v28, v28, v25
v_mul_f32 v29, v29, v25
v_cvt_pk_bf16_f32 v63, v28, v29
v_lshlrev_b32 v28, 16, v48
v_and_b32 v29, 0xffff0000, v48
v_mul_f32 v28, v28, v25
v_mul_f32 v29, v29, v25
v_cvt_pk_bf16_f32 v48, v28, v29
v_lshlrev_b32 v28, 16, v49
v_and_b32 v29, 0xffff0000, v49
v_mul_f32 v28, v28, v25
v_mul_f32 v29, v29, v25
v_cvt_pk_bf16_f32 v49, v28, v29
v_lshlrev_b32 v28, 16, v50
v_and_b32 v29, 0xffff0000, v50
v_mul_f32 v28, v28, v25
v_mul_f32 v29, v29, v25
v_cvt_pk_bf16_f32 v50, v28, v29
v_lshlrev_b32 v28, 16, v51
v_and_b32 v29, 0xffff0000, v51
v_mul_f32 v28, v28, v25
v_mul_f32 v29, v29, v25
v_cvt_pk_bf16_f32 v51, v28, v29
s_call_b64 s[0:1], OSC_1
v_max3_f32 v31, v40, v41, v42
v_max3_f32 v31, v31, v43, v88
v_max3_f32 v31, v31, v89, v90
v_max3_f32 v31, v31, v91, 0
v_mov_b32 v30, v31
s_nop 1
v_permlane16_swap_b32 v31, v30
s_nop 1
v_max_f32 v31, v31, v30
v_mov_b32 v30, v31
s_nop 1
v_permlane32_swap_b32 v31, v30
s_nop 1
v_max_f32 v31, v31, v30
v_sub_f32 v15, v15, v31
v_sub_f32 v40, v40, v31
v_sub_f32 v88, v88, v31
v_sub_f32 v41, v41, v31
v_sub_f32 v89, v89, v31
v_sub_f32 v42, v42, v31
v_sub_f32 v90, v90, v31
v_sub_f32 v43, v43, v31
v_sub_f32 v91, v91, v31
v_exp_f32 v28, v40
s_nop 0
v_exp_f32 v29, v41
s_nop 0
v_cvt_pk_bf16_f32 v76, v28, v29
v_add_f32 v27, v28, v29
v_exp_f32 v28, v42
s_nop 0
v_exp_f32 v29, v43
s_nop 0
v_cvt_pk_bf16_f32 v77, v28, v29
v_add_f32 v27, v27, v28
v_add_f32 v27, v27, v29
v_exp_f32 v28, v88
s_nop 0
v_exp_f32 v29, v89
s_nop 0
v_cvt_pk_bf16_f32 v78, v28, v29
v_add_f32 v27, v27, v28
v_add_f32 v27, v27, v29
v_exp_f32 v28, v90
s_nop 0
v_exp_f32 v29, v91
s_nop 0
v_cvt_pk_bf16_f32 v79, v28, v29
v_add_f32 v27, v27, v28
v_add_f32 v27, v27, v29
v_exp_f32_e64 v25, -v31
s_nop 1
v_mul_f32 v19, v19, v25
v_lshlrev_b32 v28, 16, v64
v_and_b32 v29, 0xffff0000, v64
v_mul_f32 v28, v28, v25
v_mul_f32 v29, v29, v25
v_cvt_pk_bf16_f32 v64, v28, v29
v_lshlrev_b32 v28, 16, v65
v_and_b32 v29, 0xffff0000, v65
v_mul_f32 v28, v28, v25
v_mul_f32 v29, v29, v25
v_cvt_pk_bf16_f32 v65, v28, v29
v_lshlrev_b32 v28, 16, v66
v_and_b32 v29, 0xffff0000, v66
v_mul_f32 v28, v28, v25
v_mul_f32 v29, v29, v25
v_cvt_pk_bf16_f32 v66, v28, v29
v_lshlrev_b32 v28, 16, v67
v_and_b32 v29, 0xffff0000, v67
v_mul_f32 v28, v28, v25
v_mul_f32 v29, v29, v25
v_cvt_pk_bf16_f32 v67, v28, v29
v_lshlrev_b32 v28, 16, v52
v_and_b32 v29, 0xffff0000, v52
v_mul_f32 v28, v28, v25
v_mul_f32 v29, v29, v25
v_cvt_pk_bf16_f32 v52, v28, v29
v_lshlrev_b32 v28, 16, v53
v_and_b32 v29, 0xffff0000, v53
v_mul_f32 v28, v28, v25
v_mul_f32 v29, v29, v25
v_cvt_pk_bf16_f32 v53, v28, v29
v_lshlrev_b32 v28, 16, v54
v_and_b32 v29, 0xffff0000, v54
v_mul_f32 v28, v28, v25
v_mul_f32 v29, v29, v25
v_cvt_pk_bf16_f32 v54, v28, v29
v_lshlrev_b32 v28, 16, v55
v_and_b32 v29, 0xffff0000, v55
v_mul_f32 v28, v28, v25
v_mul_f32 v29, v29, v25
v_cvt_pk_bf16_f32 v55, v28, v29
s_call_b64 s[0:1], OSC_2
s_nop 3
s_nop 7
s_nop 3
s_setpc_b64 s[72:73]
RARE_7:
s_nop 7
v_max3_f32 v31, v92, v93, v94
v_max3_f32 v31, v31, v95, v80
v_max3_f32 v31, v31, v81, v82
v_max3_f32 v31, v31, v83, 0
v_mov_b32 v30, v31
s_nop 1
v_permlane16_swap_b32 v31, v30
s_nop 1
v_max_f32 v31, v31, v30
v_mov_b32 v30, v31
s_nop 1
v_permlane32_swap_b32 v31, v30
s_nop 1
v_max_f32 v31, v31, v30
v_sub_f32 v11, v11, v31
v_sub_f32 v92, v92, v31
v_sub_f32 v80, v80, v31
v_sub_f32 v93, v93, v31
v_sub_f32 v81, v81, v31
v_sub_f32 v94, v94, v31
v_sub_f32 v82, v82, v31
v_sub_f32 v95, v95, v31
v_sub_f32 v83, v83, v31
v_exp_f32 v28, v92
s_nop 0
v_exp_f32 v29, v93
s_nop 0
v_cvt_pk_bf16_f32 v32, v28, v29
v_add_f32 v24, v28, v29
v_exp_f32 v28, v94
s_nop 0
v_exp_f32 v29, v95
s_nop 0
v_cvt_pk_bf16_f32 v33, v28, v29
v_add_f32 v24, v24, v28
v_add_f32 v24, v24, v29
v_exp_f32 v28, v80
s_nop 0
v_exp_f32 v29, v81
s_nop 0
v_cvt_pk_bf16_f32 v34, v28, v29
v_add_f32 v24, v24, v28
v_add_f32 v24, v24, v29
v_exp_f32 v28, v82
s_nop 0
v_exp_f32 v29, v83
s_nop 0
v_cvt_pk_bf16_f32 v35, v28, v29
v_add_f32 v24, v24, v28
v_add_f32 v24, v24, v29
v_exp_f32_e64 v25, -v31
s_nop 1
v_mul_f32 v17, v17, v25
v_lshlrev_b32 v28, 16, v68
v_and_b32 v29, 0xffff0000, v68
v_mul_f32 v28, v28, v25
v_mul_f32 v29, v29, v25
v_cvt_pk_bf16_f32 v68, v28, v29
v_lshlrev_b32 v28, 16, v69
v_and_b32 v29, 0xffff0000, v69
v_mul_f32 v28, v28, v25
v_mul_f32 v29, v29, v25
v_cvt_pk_bf16_f32 v69, v28, v29
v_lshlrev_b32 v28, 16, v70
v_and_b32 v29, 0xffff0000, v70
v_mul_f32 v28, v28, v25
v_mul_f32 v29, v29, v25
v_cvt_pk_bf16_f32 v70, v28, v29
v_lshlrev_b32 v28, 16, v71
v_and_b32 v29, 0xffff0000, v71
v_mul_f32 v28, v28, v25
v_mul_f32 v29, v29, v25
v_cvt_pk_bf16_f32 v71, v28, v29
s_call_b64 s[0:1], OSC_0
v_max3_f32 v31, v96, v97, v98
v_max3_f32 v31, v31, v99, v84
v_max3_f32 v31, v31, v85, v86
v_max3_f32 v31, v31, v87, 0
v_mov_b32 v30, v31
s_nop 1
v_permlane16_swap_b32 v31, v30
s_nop 1
v_max_f32 v31, v31, v30
v_mov_b32 v30, v31
s_nop 1
v_permlane32_swap_b32 v31, v30
s_nop 1
v_max_f32 v31, v31, v30
v_sub_f32 v13, v13, v31
v_sub_f32 v96, v96, v31
v_sub_f32 v84, v84, v31
v_sub_f32 v97, v97, v31
v_sub_f32 v85, v85, v31
v_sub_f32 v98, v98, v31
v_sub_f32 v86, v86, v31
v_sub_f32 v99, v99, v31
v_sub_f32 v87, v87, v31
v_exp_f32 v28, v96
s_nop 0
v_exp_f32 v29, v97
s_nop 0
v_cvt_pk_bf16_f32 v36, v28, v29
v_add_f32 v26, v28, v29
v_exp_f32 v28, v98
s_nop 0
v_exp_f32 v29, v99
s_nop 0
v_cvt_pk_bf16_f32 v37, v28, v29
v_add_f32 v26, v26, v28
v_add_f32 v26, v26, v29
v_exp_f32 v28, v84
s_nop 0
v_exp_f32 v29, v85
s_nop 0
v_cvt_pk_bf16_f32 v38, v28, v29
v_add_f32 v26, v26, v28
v_add_f32 v26, v26, v29
v_exp_f32 v28, v86
s_nop 0
v_exp_f32 v29, v87
s_nop 0
v_cvt_pk_bf16_f32 v39, v28, v29
v_add_f32 v26, v26, v28
v_add_f32 v26, v26, v29
v_exp_f32_e64 v25, -v31
s_nop 1
v_mul_f32 v18, v18, v25
v_lshlrev_b32 v28, 16, v72
v_and_b32 v29, 0xffff0000, v72
v_mul_f32 v28, v28, v25
v_mul_f32 v29, v29, v25
v_cvt_pk_bf16_f32 v72, v28, v29
v_lshlrev_b32 v28, 16, v73
v_and_b32 v29, 0xffff0000, v73
v_mul_f32 v28, v28, v25
v_mul_f32 v29, v29, v25
v_cvt_pk_bf16_f32 v73, v28, v29
v_lshlrev_b32 v28, 16, v74
v_and_b32 v29, 0xffff0000, v74
v_mul_f32 v28, v28, v25
v_mul_f32 v29, v29, v25
v_cvt_pk_bf16_f32 v74, v28, v29
v_lshlrev_b32 v28, 16, v75
v_and_b32 v29, 0xffff0000, v75
v_mul_f32 v28, v28, v25
v_mul_f32 v29, v29, v25
v_cvt_pk_bf16_f32 v75, v28, v29
s_call_b64 s[0:1], OSC_1
v_max3_f32 v31, v100, v101, v102
v_max3_f32 v31, v31, v103, v88
v_max3_f32 v31, v31, v89, v90
v_max3_f32 v31, v31, v91, 0
v_mov_b32 v30, v31
s_nop 1
v_permlane16_swap_b32 v31, v30
s_nop 1
v_max_f32 v31, v31, v30
v_mov_b32 v30, v31
s_nop 1
v_permlane32_swap_b32 v31, v30
s_nop 1
v_max_f32 v31, v31, v30
v_sub_f32 v15, v15, v31
v_sub_f32 v100, v100, v31
v_sub_f32 v88, v88, v31
v_sub_f32 v101, v101, v31
v_sub_f32 v89, v89, v31
v_sub_f32 v102, v102, v31
v_sub_f32 v90, v90, v31
v_sub_f32 v103, v103, v31
v_sub_f32 v91, v91, v31
v_exp_f32 v28, v100
s_nop 0
v_exp_f32 v29, v101
s_nop 0
v_cvt_pk_bf16_f32 v40, v28, v29
v_add_f32 v27, v28, v29
v_exp_f32 v28, v102
s_nop 0
v_exp_f32 v29, v103
s_nop 0
v_cvt_pk_bf16_f32 v41, v28, v29
v_add_f32 v27, v27, v28
v_add_f32 v27, v27, v29
v_exp_f32 v28, v88
s_nop 0
v_exp_f32 v29, v89
s_nop 0
v_cvt_pk_bf16_f32 v42, v28, v29
v_add_f32 v27, v27, v28
v_add_f32 v27, v27, v29
v_exp_f32 v28, v90
s_nop 0
v_exp_f32 v29, v91
s_nop 0
v_cvt_pk_bf16_f32 v43, v28, v29
v_add_f32 v27, v27, v28
v_add_f32 v27, v27, v29
v_exp_f32_e64 v25, -v31
s_nop 1
v_mul_f32 v19, v19, v25
v_lshlrev_b32 v28, 16, v76
v_and_b32 v29, 0xffff0000, v76
v_mul_f32 v28, v28, v25
v_mul_f32 v29, v29, v25
v_cvt_pk_bf16_f32 v76, v28, v29
v_lshlrev_b32 v28, 16, v77
v_and_b32 v29, 0xffff0000, v77
v_mul_f32 v28, v28, v25
v_mul_f32 v29, v29, v25
v_cvt_pk_bf16_f32 v77, v28, v29
v_lshlrev_b32 v28, 16, v78
v_and_b32 v29, 0xffff0000, v78
v_mul_f32 v28, v28, v25
v_mul_f32 v29, v29, v25
v_cvt_pk_bf16_f32 v78, v28, v29
v_lshlrev_b32 v28, 16, v79
v_and_b32 v29, 0xffff0000, v79
v_mul_f32 v28, v28, v25
v_mul_f32 v29, v29, v25
v_cvt_pk_bf16_f32 v79, v28, v29
s_call_b64 s[0:1], OSC_2
s_nop 3
s_nop 7
s_nop 3
s_setpc_b64 s[72:73]
RARE_8:
s_nop 7
v_max3_f32 v31, v44, v45, v46
v_max3_f32 v31, v31, v47, v80
v_max3_f32 v31, v31, v81, v82
v_max3_f32 v31, v31, v83, 0
v_mov_b32 v30, v31
s_nop 1
v_permlane16_swap_b32 v31, v30
s_nop 1
v_max_f32 v31, v31, v30
v_mov_b32 v30, v31
s_nop 1
v_permlane32_swap_b32 v31, v30
s_nop 1
v_max_f32 v31, v31, v30
v_sub_f32 v11, v11, v31
v_sub_f32 v44, v44, v31
v_sub_f32 v80, v80, v31
v_sub_f32 v45, v45, v31
v_sub_f32 v81, v81, v31
v_sub_f32 v46, v46, v31
v_sub_f32 v82, v82, v31
v_sub_f32 v47, v47, v31
v_sub_f32 v83, v83, v31
v_exp_f32 v28, v44
s_nop 0
v_exp_f32 v29, v45
s_nop 0
v_cvt_pk_bf16_f32 v56, v28, v29
v_add_f32 v24, v28, v29
v_exp_f32 v28, v46
s_nop 0
v_exp_f32 v29, v47
s_nop 0
v_cvt_pk_bf16_f32 v57, v28, v29
v_add_f32 v24, v24, v28
v_add_f32 v24, v24, v29
v_exp_f32 v28, v80
s_nop 0
v_exp_f32 v29, v81
s_nop 0
v_cvt_pk_bf16_f32 v58, v28, v29
v_add_f32 v24, v24, v28
v_add_f32 v24, v24, v29
v_exp_f32 v28, v82
s_nop 0
v_exp_f32 v29, v83
s_nop 0
v_cvt_pk_bf16_f32 v59, v28, v29
v_add_f32 v24, v24, v28
v_add_f32 v24, v24, v29
v_exp_f32_e64 v25, -v31
s_nop 1
v_mul_f32 v17, v17, v25
v_lshlrev_b32 v28, 16, v68
v_and_b32 v29, 0xffff0000, v68
v_mul_f32 v28, v28, v25
v_mul_f32 v29, v29, v25
v_cvt_pk_bf16_f32 v68, v28, v29
v_lshlrev_b32 v28, 16, v69
v_and_b32 v29, 0xffff0000, v69
v_mul_f32 v28, v28, v25
v_mul_f32 v29, v29, v25
v_cvt_pk_bf16_f32 v69, v28, v29
v_lshlrev_b32 v28, 16, v70
v_and_b32 v29, 0xffff0000, v70
v_mul_f32 v28, v28, v25
v_mul_f32 v29, v29, v25
v_cvt_pk_bf16_f32 v70, v28, v29
v_lshlrev_b32 v28, 16, v71
v_and_b32 v29, 0xffff0000, v71
v_mul_f32 v28, v28, v25
v_mul_f32 v29, v29, v25
v_cvt_pk_bf16_f32 v71, v28, v29
v_lshlrev_b32 v28, 16, v32
v_and_b32 v29, 0xffff0000, v32
v_mul_f32 v28, v28, v25
v_mul_f32 v29, v29, v25
v_cvt_pk_bf16_f32 v32, v28, v29
v_lshlrev_b32 v28, 16, v33
v_and_b32 v29, 0xffff0000, v33
v_mul_f32 v28, v28, v25
v_mul_f32 v29, v29, v25
v_cvt_pk_bf16_f32 v33, v28, v29
v_lshlrev_b32 v28, 16, v34
v_and_b32 v29, 0xffff0000, v34
v_mul_f32 v28, v28, v25
v_mul_f32 v29, v29, v25
v_cvt_pk_bf16_f32 v34, v28, v29
v_lshlrev_b32 v28, 16, v35
v_and_b32 v29, 0xffff0000, v35
v_mul_f32 v28, v28, v25
v_mul_f32 v29, v29, v25
v_cvt_pk_bf16_f32 v35, v28, v29
s_call_b64 s[0:1], OSC_0
v_max3_f32 v31, v48, v49, v50
v_max3_f32 v31, v31, v51, v84
v_max3_f32 v31, v31, v85, v86
v_max3_f32 v31, v31, v87, 0
v_mov_b32 v30, v31
s_nop 1
v_permlane16_swap_b32 v31, v30
s_nop 1
v_max_f32 v31, v31, v30
v_mov_b32 v30, v31
s_nop 1
v_permlane32_swap_b32 v31, v30
s_nop 1
v_max_f32 v31, v31, v30
v_sub_f32 v13, v13, v31
v_sub_f32 v48, v48, v31
v_sub_f32 v84, v84, v31
v_sub_f32 v49, v49, v31
v_sub_f32 v85, v85, v31
v_sub_f32 v50, v50, v31
v_sub_f32 v86, v86, v31
v_sub_f32 v51, v51, v31
v_sub_f32 v87, v87, v31
v_exp_f32 v28, v48
s_nop 0
v_exp_f32 v29, v49
s_nop 0
v_cvt_pk_bf16_f32 v60, v28, v29
v_add_f32 v26, v28, v29
v_exp_f32 v28, v50
s_nop 0
v_exp_f32 v29, v51
s_nop 0
v_cvt_pk_bf16_f32 v61, v28, v29
v_add_f32 v26, v26, v28
v_add_f32 v26, v26, v29
v_exp_f32 v28, v84
s_nop 0
v_exp_f32 v29, v85
s_nop 0
v_cvt_pk_bf16_f32 v62, v28, v29
v_add_f32 v26, v26, v28
v_add_f32 v26, v26, v29
v_exp_f32 v28, v86
s_nop 0
v_exp_f32 v29, v87
s_nop 0
v_cvt_pk_bf16_f32 v63, v28, v29
v_add_f32 v26, v26, v28
v_add_f32 v26, v26, v29
v_exp_f32_e64 v25, -v31
s_nop 1
v_mul_f32 v18, v18, v25
v_lshlrev_b32 v28, 16, v72
v_and_b32 v29, 0xffff0000, v72
v_mul_f32 v28, v28, v25
v_mul_f32 v29, v29, v25
v_cvt_pk_bf16_f32 v72, v28, v29
v_lshlrev_b32 v28, 16, v73
v_and_b32 v29, 0xffff0000, v73
v_mul_f32 v28, v28, v25
v_mul_f32 v29, v29, v25
v_cvt_pk_bf16_f32 v73, v28, v29
v_lshlrev_b32 v28, 16, v74
v_and_b32 v29, 0xffff0000, v74
v_mul_f32 v28, v28, v25
v_mul_f32 v29, v29, v25
v_cvt_pk_bf16_f32 v74, v28, v29
v_lshlrev_b32 v28, 16, v75
v_and_b32 v29, 0xffff0000, v75
v_mul_f32 v28, v28, v25
v_mul_f32 v29, v29, v25
v_cvt_pk_bf16_f32 v75, v28, v29
v_lshlrev_b32 v28, 16, v36
v_and_b32 v29, 0xffff0000, v36
v_mul_f32 v28, v28, v25
v_mul_f32 v29, v29, v25
v_cvt_pk_bf16_f32 v36, v28, v29
v_lshlrev_b32 v28, 16, v37
v_and_b32 v29, 0xffff0000, v37
v_mul_f32 v28, v28, v25
v_mul_f32 v29, v29, v25
v_cvt_pk_bf16_f32 v37, v28, v29
v_lshlrev_b32 v28, 16, v38
v_and_b32 v29, 0xffff0000, v38
v_mul_f32 v28, v28, v25
v_mul_f32 v29, v29, v25
v_cvt_pk_bf16_f32 v38, v28, v29
v_lshlrev_b32 v28, 16, v39
v_and_b32 v29, 0xffff0000, v39
v_mul_f32 v28, v28, v25
v_mul_f32 v29, v29, v25
v_cvt_pk_bf16_f32 v39, v28, v29
s_call_b64 s[0:1], OSC_1
v_max3_f32 v31, v52, v53, v54
v_max3_f32 v31, v31, v55, v88
v_max3_f32 v31, v31, v89, v90
v_max3_f32 v31, v31, v91, 0
v_mov_b32 v30, v31
s_nop 1
v_permlane16_swap_b32 v31, v30
s_nop 1
v_max_f32 v31, v31, v30
v_mov_b32 v30, v31
s_nop 1
v_permlane32_swap_b32 v31, v30
s_nop 1
v_max_f32 v31, v31, v30
v_sub_f32 v15, v15, v31
v_sub_f32 v52, v52, v31
v_sub_f32 v88, v88, v31
v_sub_f32 v53, v53, v31
v_sub_f32 v89, v89, v31
v_sub_f32 v54, v54, v31
v_sub_f32 v90, v90, v31
v_sub_f32 v55, v55, v31
v_sub_f32 v91, v91, v31
v_exp_f32 v28, v52
s_nop 0
v_exp_f32 v29, v53
s_nop 0
v_cvt_pk_bf16_f32 v64, v28, v29
v_add_f32 v27, v28, v29
v_exp_f32 v28, v54
s_nop 0
v_exp_f32 v29, v55
s_nop 0
v_cvt_pk_bf16_f32 v65, v28, v29
v_add_f32 v27, v27, v28
v_add_f32 v27, v27, v29
v_exp_f32 v28, v88
s_nop 0
v_exp_f32 v29, v89
s_nop 0
v_cvt_pk_bf16_f32 v66, v28, v29
v_add_f32 v27, v27, v28
v_add_f32 v27, v27, v29
v_exp_f32 v28, v90
s_nop 0
v_exp_f32 v29, v91
s_nop 0
v_cvt_pk_bf16_f32 v67, v28, v29
v_add_f32 v27, v27, v28
v_add_f32 v27, v27, v29
v_exp_f32_e64 v25, -v31
s_nop 1
v_mul_f32 v19, v19, v25
v_lshlrev_b32 v28, 16, v76
v_and_b32 v29, 0xffff0000, v76
v_mul_f32 v28, v28, v25
v_mul_f32 v29, v29, v25
v_cvt_pk_bf16_f32 v76, v28, v29
v_lshlrev_b32 v28, 16, v77
v_and_b32 v29, 0xffff0000, v77
v_mul_f32 v28, v28, v25
v_mul_f32 v29, v29, v25
v_cvt_pk_bf16_f32 v77, v28, v29
v_lshlrev_b32 v28, 16, v78
v_and_b32 v29, 0xffff0000, v78
v_mul_f32 v28, v28, v25
v_mul_f32 v29, v29, v25
v_cvt_pk_bf16_f32 v78, v28, v29
v_lshlrev_b32 v28, 16, v79
v_and_b32 v29, 0xffff0000, v79
v_mul_f32 v28, v28, v25
v_mul_f32 v29, v29, v25
v_cvt_pk_bf16_f32 v79, v28, v29
v_lshlrev_b32 v28, 16, v40
v_and_b32 v29, 0xffff0000, v40
v_mul_f32 v28, v28, v25
v_mul_f32 v29, v29, v25
v_cvt_pk_bf16_f32 v40, v28, v29
v_lshlrev_b32 v28, 16, v41
v_and_b32 v29, 0xffff0000, v41
v_mul_f32 v28, v28, v25
v_mul_f32 v29, v29, v25
v_cvt_pk_bf16_f32 v41, v28, v29
v_lshlrev_b32 v28, 16, v42
v_and_b32 v29, 0xffff0000, v42
v_mul_f32 v28, v28, v25
v_mul_f32 v29, v29, v25
v_cvt_pk_bf16_f32 v42, v28, v29
v_lshlrev_b32 v28, 16, v43
v_and_b32 v29, 0xffff0000, v43
v_mul_f32 v28, v28, v25
v_mul_f32 v29, v29, v25
v_cvt_pk_bf16_f32 v43, v28, v29
s_call_b64 s[0:1], OSC_2
s_nop 3
s_nop 7
s_nop 3
s_setpc_b64 s[72:73]
RARE_9:
s_nop 7
v_max3_f32 v31, v32, v33, v34
v_max3_f32 v31, v31, v35, v80
v_max3_f32 v31, v31, v81, v82
v_max3_f32 v31, v31, v83, 0
v_mov_b32 v30, v31
s_nop 1
v_permlane16_swap_b32 v31, v30
s_nop 1
v_max_f32 v31, v31, v30
v_mov_b32 v30, v31
s_nop 1
v_permlane32_swap_b32 v31, v30
s_nop 1
v_max_f32 v31, v31, v30
v_sub_f32 v11, v11, v31
v_sub_f32 v32, v32, v31
v_sub_f32 v80, v80, v31
v_sub_f32 v33, v33, v31
v_sub_f32 v81, v81, v31
v_sub_f32 v34, v34, v31
v_sub_f32 v82, v82, v31
v_sub_f32 v35, v35, v31
v_sub_f32 v83, v83, v31
v_exp_f32 v28, v32
s_nop 0
v_exp_f32 v29, v33
s_nop 0
v_cvt_pk_bf16_f32 v68, v28, v29
v_add_f32 v24, v28, v29
v_exp_f32 v28, v34
s_nop 0
v_exp_f32 v29, v35
s_nop 0
v_cvt_pk_bf16_f32 v69, v28, v29
v_add_f32 v24, v24, v28
v_add_f32 v24, v24, v29
v_exp_f32 v28, v80
s_nop 0
v_exp_f32 v29, v81
s_nop 0
v_cvt_pk_bf16_f32 v70, v28, v29
v_add_f32 v24, v24, v28
v_add_f32 v24, v24, v29
v_exp_f32 v28, v82
s_nop 0
v_exp_f32 v29, v83
s_nop 0
v_cvt_pk_bf16_f32 v71, v28, v29
v_add_f32 v24, v24, v28
v_add_f32 v24, v24, v29
v_max3_f32 v31, v36, v37, v38
v_max3_f32 v31, v31, v39, v84
v_max3_f32 v31, v31, v85, v86
v_max3_f32 v31, v31, v87, 0
v_mov_b32 v30, v31
s_nop 1
v_permlane16_swap_b32 v31, v30
s_nop 1
v_max_f32 v31, v31, v30
v_mov_b32 v30, v31
s_nop 1
v_permlane32_swap_b32 v31, v30
s_nop 1
v_max_f32 v31, v31, v30
v_sub_f32 v13, v13, v31
v_sub_f32 v36, v36, v31
v_sub_f32 v84, v84, v31
v_sub_f32 v37, v37, v31
v_sub_f32 v85, v85, v31
v_sub_f32 v38, v38, v31
v_sub_f32 v86, v86, v31
v_sub_f32 v39, v39, v31
v_sub_f32 v87, v87, v31
v_exp_f32 v28, v36
s_nop 0
v_exp_f32 v29, v37
s_nop 0
v_cvt_pk_bf16_f32 v72, v28, v29
v_add_f32 v26, v28, v29
v_exp_f32 v28, v38
s_nop 0
v_exp_f32 v29, v39
s_nop 0
v_cvt_pk_bf16_f32 v73, v28, v29
v_add_f32 v26, v26, v28
v_add_f32 v26, v26, v29
v_exp_f32 v28, v84
s_nop 0
v_exp_f32 v29, v85
s_nop 0
v_cvt_pk_bf16_f32 v74, v28, v29
v_add_f32 v26, v26, v28
v_add_f32 v26, v26, v29
v_exp_f32 v28, v86
s_nop 0
v_exp_f32 v29, v87
s_nop 0
v_cvt_pk_bf16_f32 v75, v28, v29
v_add_f32 v26, v26, v28
v_add_f32 v26, v26, v29
v_max3_f32 v31, v40, v41, v42
v_max3_f32 v31, v31, v43, v88
v_max3_f32 v31, v31, v89, v90
v_max3_f32 v31, v31, v91, 0
v_mov_b32 v30, v31
s_nop 1
v_permlane16_swap_b32 v31, v30
s_nop 1
v_max_f32 v31, v31, v30
v_mov_b32 v30, v31
s_nop 1
v_permlane32_swap_b32 v31, v30
s_nop 1
v_max_f32 v31, v31, v30
v_sub_f32 v15, v15, v31
v_sub_f32 v40, v40, v31
v_sub_f32 v88, v88, v31
v_sub_f32 v41, v41, v31
v_sub_f32 v89, v89, v31
v_sub_f32 v42, v42, v31
v_sub_f32 v90, v90, v31
v_sub_f32 v43, v43, v31
v_sub_f32 v91, v91, v31
v_exp_f32 v28, v40
s_nop 0
v_exp_f32 v29, v41
s_nop 0
v_cvt_pk_bf16_f32 v76, v28, v29
v_add_f32 v27, v28, v29
v_exp_f32 v28, v42
s_nop 0
v_exp_f32 v29, v43
s_nop 0
v_cvt_pk_bf16_f32 v77, v28, v29
v_add_f32 v27, v27, v28
v_add_f32 v27, v27, v29
v_exp_f32 v28, v88
s_nop 0
v_exp_f32 v29, v89
s_nop 0
v_cvt_pk_bf16_f32 v78, v28, v29
v_add_f32 v27, v27, v28
v_add_f32 v27, v27, v29
v_exp_f32 v28, v90
s_nop 0
v_exp_f32 v29, v91
s_nop 0
v_cvt_pk_bf16_f32 v79, v28, v29
v_add_f32 v27, v27, v28
v_add_f32 v27, v27, v29
s_nop 3
s_nop 7
s_nop 3
s_setpc_b64 s[72:73]
RARE_10:
s_nop 7
v_max3_f32 v31, v92, v93, v94
v_max3_f32 v31, v31, v95, v80
v_max3_f32 v31, v31, v81, v82
v_max3_f32 v31, v31, v83, 0
v_mov_b32 v30, v31
s_nop 1
v_permlane16_swap_b32 v31, v30
s_nop 1
v_max_f32 v31, v31, v30
v_mov_b32 v30, v31
s_nop 1
v_permlane32_swap_b32 v31, v30
s_nop 1
v_max_f32 v31, v31, v30
v_sub_f32 v11, v11, v31
v_sub_f32 v92, v92, v31
v_sub_f32 v80, v80, v31
v_sub_f32 v93, v93, v31
v_sub_f32 v81, v81, v31
v_sub_f32 v94, v94, v31
v_sub_f32 v82, v82, v31
v_sub_f32 v95, v95, v31
v_sub_f32 v83, v83, v31
v_exp_f32 v28, v92
s_nop 0
v_exp_f32 v29, v93
s_nop 0
v_cvt_pk_bf16_f32 v32, v28, v29
v_add_f32 v24, v28, v29
v_exp_f32 v28, v94
s_nop 0
v_exp_f32 v29, v95
s_nop 0
v_cvt_pk_bf16_f32 v33, v28, v29
v_add_f32 v24, v24, v28
v_add_f32 v24, v24, v29
v_exp_f32 v28, v80
s_nop 0
v_exp_f32 v29, v81
s_nop 0
v_cvt_pk_bf16_f32 v34, v28, v29
v_add_f32 v24, v24, v28
v_add_f32 v24, v24, v29
v_exp_f32 v28, v82
s_nop 0
v_exp_f32 v29, v83
s_nop 0
v_cvt_pk_bf16_f32 v35, v28, v29
v_add_f32 v24, v24, v28
v_add_f32 v24, v24, v29
v_exp_f32_e64 v25, -v31
s_nop 1
v_mul_f32 v17, v17, v25
v_lshlrev_b32 v28, 16, v68
v_and_b32 v29, 0xffff0000, v68
v_mul_f32 v28, v28, v25
v_mul_f32 v29, v29, v25
v_cvt_pk_bf16_f32 v68, v28, v29
v_lshlrev_b32 v28, 16, v69
v_and_b32 v29, 0xffff0000, v69
v_mul_f32 v28, v28, v25
v_mul_f32 v29, v29, v25
v_cvt_pk_bf16_f32 v69, v28, v29
v_lshlrev_b32 v28, 16, v70
v_and_b32 v29, 0xffff0000, v70
v_mul_f32 v28, v28, v25
v_mul_f32 v29, v29, v25
v_cvt_pk_bf16_f32 v70, v28, v29
v_lshlrev_b32 v28, 16, v71
v_and_b32 v29, 0xffff0000, v71
v_mul_f32 v28, v28, v25
v_mul_f32 v29, v29, v25
v_cvt_pk_bf16_f32 v71, v28, v29
v_max3_f32 v31, v96, v97, v98
v_max3_f32 v31, v31, v99, v84
v_max3_f32 v31, v31, v85, v86
v_max3_f32 v31, v31, v87, 0
v_mov_b32 v30, v31
s_nop 1
v_permlane16_swap_b32 v31, v30
s_nop 1
v_max_f32 v31, v31, v30
v_mov_b32 v30, v31
s_nop 1
v_permlane32_swap_b32 v31, v30
s_nop 1
v_max_f32 v31, v31, v30
v_sub_f32 v13, v13, v31
v_sub_f32 v96, v96, v31
v_sub_f32 v84, v84, v31
v_sub_f32 v97, v97, v31
v_sub_f32 v85, v85, v31
v_sub_f32 v98, v98, v31
v_sub_f32 v86, v86, v31
v_sub_f32 v99, v99, v31
v_sub_f32 v87, v87, v31
v_exp_f32 v28, v96
s_nop 0
v_exp_f32 v29, v97
s_nop 0
v_cvt_pk_bf16_f32 v36, v28, v29
v_add_f32 v26, v28, v29
v_exp_f32 v28, v98
s_nop 0
v_exp_f32 v29, v99
s_nop 0
v_cvt_pk_bf16_f32 v37, v28, v29
v_add_f32 v26, v26, v28
v_add_f32 v26, v26, v29
v_exp_f32 v28, v84
s_nop 0
v_exp_f32 v29, v85
s_nop 0
v_cvt_pk_bf16_f32 v38, v28, v29
v_add_f32 v26, v26, v28
v_add_f32 v26, v26, v29
v_exp_f32 v28, v86
s_nop 0
v_exp_f32 v29, v87
s_nop 0
v_cvt_pk_bf16_f32 v39, v28, v29
v_add_f32 v26, v26, v28
v_add_f32 v26, v26, v29
v_exp_f32_e64 v25, -v31
s_nop 1
v_mul_f32 v18, v18, v25
v_lshlrev_b32 v28, 16, v72
v_and_b32 v29, 0xffff0000, v72
v_mul_f32 v28, v28, v25
v_mul_f32 v29, v29, v25
v_cvt_pk_bf16_f32 v72, v28, v29
v_lshlrev_b32 v28, 16, v73
v_and_b32 v29, 0xffff0000, v73
v_mul_f32 v28, v28, v25
v_mul_f32 v29, v29, v25
v_cvt_pk_bf16_f32 v73, v28, v29
v_lshlrev_b32 v28, 16, v74
v_and_b32 v29, 0xffff0000, v74
v_mul_f32 v28, v28, v25
v_mul_f32 v29, v29, v25
v_cvt_pk_bf16_f32 v74, v28, v29
v_lshlrev_b32 v28, 16, v75
v_and_b32 v29, 0xffff0000, v75
v_mul_f32 v28, v28, v25
v_mul_f32 v29, v29, v25
v_cvt_pk_bf16_f32 v75, v28, v29
v_max3_f32 v31, v100, v101, v102
v_max3_f32 v31, v31, v103, v88
v_max3_f32 v31, v31, v89, v90
v_max3_f32 v31, v31, v91, 0
v_mov_b32 v30, v31
s_nop 1
v_permlane16_swap_b32 v31, v30
s_nop 1
v_max_f32 v31, v31, v30
v_mov_b32 v30, v31
s_nop 1
v_permlane32_swap_b32 v31, v30
s_nop 1
v_max_f32 v31, v31, v30
v_sub_f32 v15, v15, v31
v_sub_f32 v100, v100, v31
v_sub_f32 v88, v88, v31
v_sub_f32 v101, v101, v31
v_sub_f32 v89, v89, v31
v_sub_f32 v102, v102, v31
v_sub_f32 v90, v90, v31
v_sub_f32 v103, v103, v31
v_sub_f32 v91, v91, v31
v_exp_f32 v28, v100
s_nop 0
v_exp_f32 v29, v101
s_nop 0
v_cvt_pk_bf16_f32 v40, v28, v29
v_add_f32 v27, v28, v29
v_exp_f32 v28, v102
s_nop 0
v_exp_f32 v29, v103
s_nop 0
v_cvt_pk_bf16_f32 v41, v28, v29
v_add_f32 v27, v27, v28
v_add_f32 v27, v27, v29
v_exp_f32 v28, v88
s_nop 0
v_exp_f32 v29, v89
s_nop 0
v_cvt_pk_bf16_f32 v42, v28, v29
v_add_f32 v27, v27, v28
v_add_f32 v27, v27, v29
v_exp_f32 v28, v90
s_nop 0
v_exp_f32 v29, v91
s_nop 0
v_cvt_pk_bf16_f32 v43, v28, v29
v_add_f32 v27, v27, v28
v_add_f32 v27, v27, v29
v_exp_f32_e64 v25, -v31
s_nop 1
v_mul_f32 v19, v19, v25
v_lshlrev_b32 v28, 16, v76
v_and_b32 v29, 0xffff0000, v76
v_mul_f32 v28, v28, v25
v_mul_f32 v29, v29, v25
v_cvt_pk_bf16_f32 v76, v28, v29
v_lshlrev_b32 v28, 16, v77
v_and_b32 v29, 0xffff0000, v77
v_mul_f32 v28, v28, v25
v_mul_f32 v29, v29, v25
v_cvt_pk_bf16_f32 v77, v28, v29
v_lshlrev_b32 v28, 16, v78
v_and_b32 v29, 0xffff0000, v78
v_mul_f32 v28, v28, v25
v_mul_f32 v29, v29, v25
v_cvt_pk_bf16_f32 v78, v28, v29
v_lshlrev_b32 v28, 16, v79
v_and_b32 v29, 0xffff0000, v79
v_mul_f32 v28, v28, v25
v_mul_f32 v29, v29, v25
v_cvt_pk_bf16_f32 v79, v28, v29
s_nop 3
s_nop 7
s_nop 3
s_setpc_b64 s[72:73]
RARE_11:
s_nop 7
v_max3_f32 v31, v44, v45, v46
v_max3_f32 v31, v31, v47, v80
v_max3_f32 v31, v31, v81, v82
v_max3_f32 v31, v31, v83, 0
v_mov_b32 v30, v31
s_nop 1
v_permlane16_swap_b32 v31, v30
s_nop 1
v_max_f32 v31, v31, v30
v_mov_b32 v30, v31
s_nop 1
v_permlane32_swap_b32 v31, v30
s_nop 1
v_max_f32 v31, v31, v30
v_sub_f32 v11, v11, v31
v_sub_f32 v44, v44, v31
v_sub_f32 v80, v80, v31
v_sub_f32 v45, v45, v31
v_sub_f32 v81, v81, v31
v_sub_f32 v46, v46, v31
v_sub_f32 v82, v82, v31
v_sub_f32 v47, v47, v31
v_sub_f32 v83, v83, v31
v_exp_f32 v28, v44
s_nop 0
v_exp_f32 v29, v45
s_nop 0
v_cvt_pk_bf16_f32 v56, v28, v29
v_add_f32 v24, v28, v29
v_exp_f32 v28, v46
s_nop 0
v_exp_f32 v29, v47
s_nop 0
v_cvt_pk_bf16_f32 v57, v28, v29
v_add_f32 v24, v24, v28
v_add_f32 v24, v24, v29
v_exp_f32 v28, v80
s_nop 0
v_exp_f32 v29, v81
s_nop 0
v_cvt_pk_bf16_f32 v58, v28, v29
v_add_f32 v24, v24, v28
v_add_f32 v24, v24, v29
v_exp_f32 v28, v82
s_nop 0
v_exp_f32 v29, v83
s_nop 0
v_cvt_pk_bf16_f32 v59, v28, v29
v_add_f32 v24, v24, v28
v_add_f32 v24, v24, v29
v_exp_f32_e64 v25, -v31
s_nop 1
v_mul_f32 v17, v17, v25
v_lshlrev_b32 v28, 16, v68
v_and_b32 v29, 0xffff0000, v68
v_mul_f32 v28, v28, v25
v_mul_f32 v29, v29, v25
v_cvt_pk_bf16_f32 v68, v28, v29
v_lshlrev_b32 v28, 16, v69
v_and_b32 v29, 0xffff0000, v69
v_mul_f32 v28, v28, v25
v_mul_f32 v29, v29, v25
v_cvt_pk_bf16_f32 v69, v28, v29
v_lshlrev_b32 v28, 16, v70
v_and_b32 v29, 0xffff0000, v70
v_mul_f32 v28, v28, v25
v_mul_f32 v29, v29, v25
v_cvt_pk_bf16_f32 v70, v28, v29
v_lshlrev_b32 v28, 16, v71
v_and_b32 v29, 0xffff0000, v71
v_mul_f32 v28, v28, v25
v_mul_f32 v29, v29, v25
v_cvt_pk_bf16_f32 v71, v28, v29
v_lshlrev_b32 v28, 16, v32
v_and_b32 v29, 0xffff0000, v32
v_mul_f32 v28, v28, v25
v_mul_f32 v29, v29, v25
v_cvt_pk_bf16_f32 v32, v28, v29
v_lshlrev_b32 v28, 16, v33
v_and_b32 v29, 0xffff0000, v33
v_mul_f32 v28, v28, v25
v_mul_f32 v29, v29, v25
v_cvt_pk_bf16_f32 v33, v28, v29
v_lshlrev_b32 v28, 16, v34
v_and_b32 v29, 0xffff0000, v34
v_mul_f32 v28, v28, v25
v_mul_f32 v29, v29, v25
v_cvt_pk_bf16_f32 v34, v28, v29
v_lshlrev_b32 v28, 16, v35
v_and_b32 v29, 0xffff0000, v35
v_mul_f32 v28, v28, v25
v_mul_f32 v29, v29, v25
v_cvt_pk_bf16_f32 v35, v28, v29
s_call_b64 s[0:1], OSC_3
v_max3_f32 v31, v48, v49, v50
v_max3_f32 v31, v31, v51, v84
v_max3_f32 v31, v31, v85, v86
v_max3_f32 v31, v31, v87, 0
v_mov_b32 v30, v31
s_nop 1
v_permlane16_swap_b32 v31, v30
s_nop 1
v_max_f32 v31, v31, v30
v_mov_b32 v30, v31
s_nop 1
v_permlane32_swap_b32 v31, v30
s_nop 1
v_max_f32 v31, v31, v30
v_sub_f32 v13, v13, v31
v_sub_f32 v48, v48, v31
v_sub_f32 v84, v84, v31
v_sub_f32 v49, v49, v31
v_sub_f32 v85, v85, v31
v_sub_f32 v50, v50, v31
v_sub_f32 v86, v86, v31
v_sub_f32 v51, v51, v31
v_sub_f32 v87, v87, v31
v_exp_f32 v28, v48
s_nop 0
v_exp_f32 v29, v49
s_nop 0
v_cvt_pk_bf16_f32 v60, v28, v29
v_add_f32 v26, v28, v29
v_exp_f32 v28, v50
s_nop 0
v_exp_f32 v29, v51
s_nop 0
v_cvt_pk_bf16_f32 v61, v28, v29
v_add_f32 v26, v26, v28
v_add_f32 v26, v26, v29
v_exp_f32 v28, v84
s_nop 0
v_exp_f32 v29, v85
s_nop 0
v_cvt_pk_bf16_f32 v62, v28, v29
v_add_f32 v26, v26, v28
v_add_f32 v26, v26, v29
v_exp_f32 v28, v86
s_nop 0
v_exp_f32 v29, v87
s_nop 0
v_cvt_pk_bf16_f32 v63, v28, v29
v_add_f32 v26, v26, v28
v_add_f32 v26, v26, v29
v_exp_f32_e64 v25, -v31
s_nop 1
v_mul_f32 v18, v18, v25
v_lshlrev_b32 v28, 16, v72
v_and_b32 v29, 0xffff0000, v72
v_mul_f32 v28, v28, v25
v_mul_f32 v29, v29, v25
v_cvt_pk_bf16_f32 v72, v28, v29
v_lshlrev_b32 v28, 16, v73
v_and_b32 v29, 0xffff0000, v73
v_mul_f32 v28, v28, v25
v_mul_f32 v29, v29, v25
v_cvt_pk_bf16_f32 v73, v28, v29
v_lshlrev_b32 v28, 16, v74
v_and_b32 v29, 0xffff0000, v74
v_mul_f32 v28, v28, v25
v_mul_f32 v29, v29, v25
v_cvt_pk_bf16_f32 v74, v28, v29
v_lshlrev_b32 v28, 16, v75
v_and_b32 v29, 0xffff0000, v75
v_mul_f32 v28, v28, v25
v_mul_f32 v29, v29, v25
v_cvt_pk_bf16_f32 v75, v28, v29
v_lshlrev_b32 v28, 16, v36
v_and_b32 v29, 0xffff0000, v36
v_mul_f32 v28, v28, v25
v_mul_f32 v29, v29, v25
v_cvt_pk_bf16_f32 v36, v28, v29
v_lshlrev_b32 v28, 16, v37
v_and_b32 v29, 0xffff0000, v37
v_mul_f32 v28, v28, v25
v_mul_f32 v29, v29, v25
v_cvt_pk_bf16_f32 v37, v28, v29
v_lshlrev_b32 v28, 16, v38
v_and_b32 v29, 0xffff0000, v38
v_mul_f32 v28, v28, v25
v_mul_f32 v29, v29, v25
v_cvt_pk_bf16_f32 v38, v28, v29
v_lshlrev_b32 v28, 16, v39
v_and_b32 v29, 0xffff0000, v39
v_mul_f32 v28, v28, v25
v_mul_f32 v29, v29, v25
v_cvt_pk_bf16_f32 v39, v28, v29
s_call_b64 s[0:1], OSC_4
v_max3_f32 v31, v52, v53, v54
v_max3_f32 v31, v31, v55, v88
v_max3_f32 v31, v31, v89, v90
v_max3_f32 v31, v31, v91, 0
v_mov_b32 v30, v31
s_nop 1
v_permlane16_swap_b32 v31, v30
s_nop 1
v_max_f32 v31, v31, v30
v_mov_b32 v30, v31
s_nop 1
v_permlane32_swap_b32 v31, v30
s_nop 1
v_max_f32 v31, v31, v30
v_sub_f32 v15, v15, v31
v_sub_f32 v52, v52, v31
v_sub_f32 v88, v88, v31
v_sub_f32 v53, v53, v31
v_sub_f32 v89, v89, v31
v_sub_f32 v54, v54, v31
v_sub_f32 v90, v90, v31
v_sub_f32 v55, v55, v31
v_sub_f32 v91, v91, v31
v_exp_f32 v28, v52
s_nop 0
v_exp_f32 v29, v53
s_nop 0
v_cvt_pk_bf16_f32 v64, v28, v29
v_add_f32 v27, v28, v29
v_exp_f32 v28, v54
s_nop 0
v_exp_f32 v29, v55
s_nop 0
v_cvt_pk_bf16_f32 v65, v28, v29
v_add_f32 v27, v27, v28
v_add_f32 v27, v27, v29
v_exp_f32 v28, v88
s_nop 0
v_exp_f32 v29, v89
s_nop 0
v_cvt_pk_bf16_f32 v66, v28, v29
v_add_f32 v27, v27, v28
v_add_f32 v27, v27, v29
v_exp_f32 v28, v90
s_nop 0
v_exp_f32 v29, v91
s_nop 0
v_cvt_pk_bf16_f32 v67, v28, v29
v_add_f32 v27, v27, v28
v_add_f32 v27, v27, v29
v_exp_f32_e64 v25, -v31
s_nop 1
v_mul_f32 v19, v19, v25
v_lshlrev_b32 v28, 16, v76
v_and_b32 v29, 0xffff0000, v76
v_mul_f32 v28, v28, v25
v_mul_f32 v29, v29, v25
v_cvt_pk_bf16_f32 v76, v28, v29
v_lshlrev_b32 v28, 16, v77
v_and_b32 v29, 0xffff0000, v77
v_mul_f32 v28, v28, v25
v_mul_f32 v29, v29, v25
v_cvt_pk_bf16_f32 v77, v28, v29
v_lshlrev_b32 v28, 16, v78
v_and_b32 v29, 0xffff0000, v78
v_mul_f32 v28, v28, v25
v_mul_f32 v29, v29, v25
v_cvt_pk_bf16_f32 v78, v28, v29
v_lshlrev_b32 v28, 16, v79
v_and_b32 v29, 0xffff0000, v79
v_mul_f32 v28, v28, v25
v_mul_f32 v29, v29, v25
v_cvt_pk_bf16_f32 v79, v28, v29
v_lshlrev_b32 v28, 16, v40
v_and_b32 v29, 0xffff0000, v40
v_mul_f32 v28, v28, v25
v_mul_f32 v29, v29, v25
v_cvt_pk_bf16_f32 v40, v28, v29
v_lshlrev_b32 v28, 16, v41
v_and_b32 v29, 0xffff0000, v41
v_mul_f32 v28, v28, v25
v_mul_f32 v29, v29, v25
v_cvt_pk_bf16_f32 v41, v28, v29
v_lshlrev_b32 v28, 16, v42
v_and_b32 v29, 0xffff0000, v42
v_mul_f32 v28, v28, v25
v_mul_f32 v29, v29, v25
v_cvt_pk_bf16_f32 v42, v28, v29
v_lshlrev_b32 v28, 16, v43
v_and_b32 v29, 0xffff0000, v43
v_mul_f32 v28, v28, v25
v_mul_f32 v29, v29, v25
v_cvt_pk_bf16_f32 v43, v28, v29
s_call_b64 s[0:1], OSC_5
s_nop 3
s_nop 7
s_nop 3
s_setpc_b64 s[72:73]
RARE_12:
s_nop 7
v_max3_f32 v31, v92, v93, v94
v_max3_f32 v31, v31, v95, v80
v_max3_f32 v31, v31, v81, v82
v_max3_f32 v31, v31, v83, 0
v_mov_b32 v30, v31
s_nop 1
v_permlane16_swap_b32 v31, v30
s_nop 1
v_max_f32 v31, v31, v30
v_mov_b32 v30, v31
s_nop 1
v_permlane32_swap_b32 v31, v30
s_nop 1
v_max_f32 v31, v31, v30
v_sub_f32 v11, v11, v31
v_sub_f32 v92, v92, v31
v_sub_f32 v80, v80, v31
v_sub_f32 v93, v93, v31
v_sub_f32 v81, v81, v31
v_sub_f32 v94, v94, v31
v_sub_f32 v82, v82, v31
v_sub_f32 v95, v95, v31
v_sub_f32 v83, v83, v31
v_exp_f32 v28, v92
s_nop 0
v_exp_f32 v29, v93
s_nop 0
v_cvt_pk_bf16_f32 v44, v28, v29
v_add_f32 v24, v28, v29
v_exp_f32 v28, v94
s_nop 0
v_exp_f32 v29, v95
s_nop 0
v_cvt_pk_bf16_f32 v45, v28, v29
v_add_f32 v24, v24, v28
v_add_f32 v24, v24, v29
v_exp_f32 v28, v80
s_nop 0
v_exp_f32 v29, v81
s_nop 0
v_cvt_pk_bf16_f32 v46, v28, v29
v_add_f32 v24, v24, v28
v_add_f32 v24, v24, v29
v_exp_f32 v28, v82
s_nop 0
v_exp_f32 v29, v83
s_nop 0
v_cvt_pk_bf16_f32 v47, v28, v29
v_add_f32 v24, v24, v28
v_add_f32 v24, v24, v29
v_exp_f32_e64 v25, -v31
s_nop 1
v_mul_f32 v17, v17, v25
v_accvgpr_read_b32 v30, a0
s_nop 0
v_lshlrev_b32 v28, 16, v30
v_and_b32 v29, 0xffff0000, v30
v_mul_f32 v28, v28, v25
v_mul_f32 v29, v29, v25
v_cvt_pk_bf16_f32 v30, v28, v29
s_nop 0
v_accvgpr_write_b32 a0, v30
v_accvgpr_read_b32 v30, a1
s_nop 0
v_lshlrev_b32 v28, 16, v30
v_and_b32 v29, 0xffff0000, v30
v_mul_f32 v28, v28, v25
v_mul_f32 v29, v29, v25
v_cvt_pk_bf16_f32 v30, v28, v29
s_nop 0
v_accvgpr_write_b32 a1, v30
v_accvgpr_read_b32 v30, a2
s_nop 0
v_lshlrev_b32 v28, 16, v30
v_and_b32 v29, 0xffff0000, v30
v_mul_f32 v28, v28, v25
v_mul_f32 v29, v29, v25
v_cvt_pk_bf16_f32 v30, v28, v29
s_nop 0
v_accvgpr_write_b32 a2, v30
v_accvgpr_read_b32 v30, a3
s_nop 0
v_lshlrev_b32 v28, 16, v30
v_and_b32 v29, 0xffff0000, v30
v_mul_f32 v28, v28, v25
v_mul_f32 v29, v29, v25
v_cvt_pk_bf16_f32 v30, v28, v29
s_nop 0
v_accvgpr_write_b32 a3, v30
s_call_b64 s[0:1], OSC_0
v_max3_f32 v31, v96, v97, v98
v_max3_f32 v31, v31, v99, v84
v_max3_f32 v31, v31, v85, v86
v_max3_f32 v31, v31, v87, 0
v_mov_b32 v30, v31
s_nop 1
v_permlane16_swap_b32 v31, v30
s_nop 1
v_max_f32 v31, v31, v30
v_mov_b32 v30, v31
s_nop 1
v_permlane32_swap_b32 v31, v30
s_nop 1
v_max_f32 v31, v31, v30
v_sub_f32 v13, v13, v31
v_sub_f32 v96, v96, v31
v_sub_f32 v84, v84, v31
v_sub_f32 v97, v97, v31
v_sub_f32 v85, v85, v31
v_sub_f32 v98, v98, v31
v_sub_f32 v86, v86, v31
v_sub_f32 v99, v99, v31
v_sub_f32 v87, v87, v31
v_exp_f32 v28, v96
s_nop 0
v_exp_f32 v29, v97
s_nop 0
v_cvt_pk_bf16_f32 v48, v28, v29
v_add_f32 v26, v28, v29
v_exp_f32 v28, v98
s_nop 0
v_exp_f32 v29, v99
s_nop 0
v_cvt_pk_bf16_f32 v49, v28, v29
v_add_f32 v26, v26, v28
v_add_f32 v26, v26, v29
v_exp_f32 v28, v84
s_nop 0
v_exp_f32 v29, v85
s_nop 0
v_cvt_pk_bf16_f32 v50, v28, v29
v_add_f32 v26, v26, v28
v_add_f32 v26, v26, v29
v_exp_f32 v28, v86
s_nop 0
v_exp_f32 v29, v87
s_nop 0
v_cvt_pk_bf16_f32 v51, v28, v29
v_add_f32 v26, v26, v28
v_add_f32 v26, v26, v29
v_exp_f32_e64 v25, -v31
s_nop 1
v_mul_f32 v18, v18, v25
v_accvgpr_read_b32 v30, a4
s_nop 0
v_lshlrev_b32 v28, 16, v30
v_and_b32 v29, 0xffff0000, v30
v_mul_f32 v28, v28, v25
v_mul_f32 v29, v29, v25
v_cvt_pk_bf16_f32 v30, v28, v29
s_nop 0
v_accvgpr_write_b32 a4, v30
v_accvgpr_read_b32 v30, a5
s_nop 0
v_lshlrev_b32 v28, 16, v30
v_and_b32 v29, 0xffff0000, v30
v_mul_f32 v28, v28, v25
v_mul_f32 v29, v29, v25
v_cvt_pk_bf16_f32 v30, v28, v29
s_nop 0
v_accvgpr_write_b32 a5, v30
v_accvgpr_read_b32 v30, a6
s_nop 0
v_lshlrev_b32 v28, 16, v30
v_and_b32 v29, 0xffff0000, v30
v_mul_f32 v28, v28, v25
v_mul_f32 v29, v29, v25
v_cvt_pk_bf16_f32 v30, v28, v29
s_nop 0
v_accvgpr_write_b32 a6, v30
v_accvgpr_read_b32 v30, a7
s_nop 0
v_lshlrev_b32 v28, 16, v30
v_and_b32 v29, 0xffff0000, v30
v_mul_f32 v28, v28, v25
v_mul_f32 v29, v29, v25
v_cvt_pk_bf16_f32 v30, v28, v29
s_nop 0
v_accvgpr_write_b32 a7, v30
s_call_b64 s[0:1], OSC_1
v_max3_f32 v31, v100, v101, v102
v_max3_f32 v31, v31, v103, v88
v_max3_f32 v31, v31, v89, v90
v_max3_f32 v31, v31, v91, 0
v_mov_b32 v30, v31
s_nop 1
v_permlane16_swap_b32 v31, v30
s_nop 1
v_max_f32 v31, v31, v30
v_mov_b32 v30, v31
s_nop 1
v_permlane32_swap_b32 v31, v30
s_nop 1
v_max_f32 v31, v31, v30
v_sub_f32 v15, v15, v31
v_sub_f32 v100, v100, v31
v_sub_f32 v88, v88, v31
v_sub_f32 v101, v101, v31
v_sub_f32 v89, v89, v31
v_sub_f32 v102, v102, v31
v_sub_f32 v90, v90, v31
v_sub_f32 v103, v103, v31
v_sub_f32 v91, v91, v31
v_exp_f32 v28, v100
s_nop 0
v_exp_f32 v29, v101
s_nop 0
v_cvt_pk_bf16_f32 v52, v28, v29
v_add_f32 v27, v28, v29
v_exp_f32 v28, v102
s_nop 0
v_exp_f32 v29, v103
s_nop 0
v_cvt_pk_bf16_f32 v53, v28, v29
v_add_f32 v27, v27, v28
v_add_f32 v27, v27, v29
v_exp_f32 v28, v88
s_nop 0
v_exp_f32 v29, v89
s_nop 0
v_cvt_pk_bf16_f32 v54, v28, v29
v_add_f32 v27, v27, v28
v_add_f32 v27, v27, v29
v_exp_f32 v28, v90
s_nop 0
v_exp_f32 v29, v91
s_nop 0
v_cvt_pk_bf16_f32 v55, v28, v29
v_add_f32 v27, v27, v28
v_add_f32 v27, v27, v29
v_exp_f32_e64 v25, -v31
s_nop 1
v_mul_f32 v19, v19, v25
v_accvgpr_read_b32 v30, a8
s_nop 0
v_lshlrev_b32 v28, 16, v30
v_and_b32 v29, 0xffff0000, v30
v_mul_f32 v28, v28, v25
v_mul_f32 v29, v29, v25
v_cvt_pk_bf16_f32 v30, v28, v29
s_nop 0
v_accvgpr_write_b32 a8, v30
v_accvgpr_read_b32 v30, a9
s_nop 0
v_lshlrev_b32 v28, 16, v30
v_and_b32 v29, 0xffff0000, v30
v_mul_f32 v28, v28, v25
v_mul_f32 v29, v29, v25
v_cvt_pk_bf16_f32 v30, v28, v29
s_nop 0
v_accvgpr_write_b32 a9, v30
v_accvgpr_read_b32 v30, a10
s_nop 0
v_lshlrev_b32 v28, 16, v30
v_and_b32 v29, 0xffff0000, v30
v_mul_f32 v28, v28, v25
v_mul_f32 v29, v29, v25
v_cvt_pk_bf16_f32 v30, v28, v29
s_nop 0
v_accvgpr_write_b32 a10, v30
v_accvgpr_read_b32 v30, a11
s_nop 0
v_lshlrev_b32 v28, 16, v30
v_and_b32 v29, 0xffff0000, v30
v_mul_f32 v28, v28, v25
v_mul_f32 v29, v29, v25
v_cvt_pk_bf16_f32 v30, v28, v29
s_nop 0
v_accvgpr_write_b32 a11, v30
s_call_b64 s[0:1], OSC_2
s_nop 3
s_nop 7
s_nop 3
s_setpc_b64 s[72:73]
RARE_13:
s_nop 7
v_max3_f32 v31, v32, v33, v34
v_max3_f32 v31, v31, v35, v68
v_max3_f32 v31, v31, v69, v70
v_max3_f32 v31, v31, v71, 0
v_mov_b32 v30, v31
s_nop 1
v_permlane16_swap_b32 v31, v30
s_nop 1
v_max_f32 v31, v31, v30
v_mov_b32 v30, v31
s_nop 1
v_permlane32_swap_b32 v31, v30
s_nop 1
v_max_f32 v31, v31, v30
v_sub_f32 v11, v11, v31
v_sub_f32 v32, v32, v31
v_sub_f32 v68, v68, v31
v_sub_f32 v33, v33, v31
v_sub_f32 v69, v69, v31
v_sub_f32 v34, v34, v31
v_sub_f32 v70, v70, v31
v_sub_f32 v35, v35, v31
v_sub_f32 v71, v71, v31
v_exp_f32 v28, v32
s_nop 0
v_exp_f32 v29, v33
s_nop 0
v_cvt_pk_bf16_f32 v56, v28, v29
v_add_f32 v24, v28, v29
v_exp_f32 v28, v34
s_nop 0
v_exp_f32 v29, v35
s_nop 0
v_cvt_pk_bf16_f32 v57, v28, v29
v_add_f32 v24, v24, v28
v_add_f32 v24, v24, v29
v_exp_f32 v28, v68
s_nop 0
v_exp_f32 v29, v69
s_nop 0
v_cvt_pk_bf16_f32 v58, v28, v29
v_add_f32 v24, v24, v28
v_add_f32 v24, v24, v29
v_exp_f32 v28, v70
s_nop 0
v_exp_f32 v29, v71
s_nop 0
v_cvt_pk_bf16_f32 v59, v28, v29
v_add_f32 v24, v24, v28
v_add_f32 v24, v24, v29
v_exp_f32_e64 v25, -v31
s_nop 1
v_mul_f32 v17, v17, v25
v_accvgpr_read_b32 v30, a0
s_nop 0
v_lshlrev_b32 v28, 16, v30
v_and_b32 v29, 0xffff0000, v30
v_mul_f32 v28, v28, v25
v_mul_f32 v29, v29, v25
v_cvt_pk_bf16_f32 v30, v28, v29
s_nop 0
v_accvgpr_write_b32 a0, v30
v_accvgpr_read_b32 v30, a1
s_nop 0
v_lshlrev_b32 v28, 16, v30
v_and_b32 v29, 0xffff0000, v30
v_mul_f32 v28, v28, v25
v_mul_f32 v29, v29, v25
v_cvt_pk_bf16_f32 v30, v28, v29
s_nop 0
v_accvgpr_write_b32 a1, v30
v_accvgpr_read_b32 v30, a2
s_nop 0
v_lshlrev_b32 v28, 16, v30
v_and_b32 v29, 0xffff0000, v30
v_mul_f32 v28, v28, v25
v_mul_f32 v29, v29, v25
v_cvt_pk_bf16_f32 v30, v28, v29
s_nop 0
v_accvgpr_write_b32 a2, v30
v_accvgpr_read_b32 v30, a3
s_nop 0
v_lshlrev_b32 v28, 16, v30
v_and_b32 v29, 0xffff0000, v30
v_mul_f32 v28, v28, v25
v_mul_f32 v29, v29, v25
v_cvt_pk_bf16_f32 v30, v28, v29
s_nop 0
v_accvgpr_write_b32 a3, v30
v_accvgpr_read_b32 v30, a12
s_nop 0
v_lshlrev_b32 v28, 16, v30
v_and_b32 v29, 0xffff0000, v30
v_mul_f32 v28, v28, v25
v_mul_f32 v29, v29, v25
v_cvt_pk_bf16_f32 v30, v28, v29
s_nop 0
v_accvgpr_write_b32 a12, v30
v_accvgpr_read_b32 v30, a13
s_nop 0
v_lshlrev_b32 v28, 16, v30
v_and_b32 v29, 0xffff0000, v30
v_mul_f32 v28, v28, v25
v_mul_f32 v29, v29, v25
v_cvt_pk_bf16_f32 v30, v28, v29
s_nop 0
v_accvgpr_write_b32 a13, v30
v_accvgpr_read_b32 v30, a14
s_nop 0
v_lshlrev_b32 v28, 16, v30
v_and_b32 v29, 0xffff0000, v30
v_mul_f32 v28, v28, v25
v_mul_f32 v29, v29, v25
v_cvt_pk_bf16_f32 v30, v28, v29
s_nop 0
v_accvgpr_write_b32 a14, v30
v_accvgpr_read_b32 v30, a15
s_nop 0
v_lshlrev_b32 v28, 16, v30
v_and_b32 v29, 0xffff0000, v30
v_mul_f32 v28, v28, v25
v_mul_f32 v29, v29, v25
v_cvt_pk_bf16_f32 v30, v28, v29
s_nop 0
v_accvgpr_write_b32 a15, v30
s_call_b64 s[0:1], OSC_0
v_max3_f32 v31, v36, v37, v38
v_max3_f32 v31, v31, v39, v72
v_max3_f32 v31, v31, v73, v74
v_max3_f32 v31, v31, v75, 0
v_mov_b32 v30, v31
s_nop 1
v_permlane16_swap_b32 v31, v30
s_nop 1
v_max_f32 v31, v31, v30
v_mov_b32 v30, v31
s_nop 1
v_permlane32_swap_b32 v31, v30
s_nop 1
v_max_f32 v31, v31, v30
v_sub_f32 v13, v13, v31
v_sub_f32 v36, v36, v31
v_sub_f32 v72, v72, v31
v_sub_f32 v37, v37, v31
v_sub_f32 v73, v73, v31
v_sub_f32 v38, v38, v31
v_sub_f32 v74, v74, v31
v_sub_f32 v39, v39, v31
v_sub_f32 v75, v75, v31
v_exp_f32 v28, v36
s_nop 0
v_exp_f32 v29, v37
s_nop 0
v_cvt_pk_bf16_f32 v60, v28, v29
v_add_f32 v26, v28, v29
v_exp_f32 v28, v38
s_nop 0
v_exp_f32 v29, v39
s_nop 0
v_cvt_pk_bf16_f32 v61, v28, v29
v_add_f32 v26, v26, v28
v_add_f32 v26, v26, v29
v_exp_f32 v28, v72
s_nop 0
v_exp_f32 v29, v73
s_nop 0
v_cvt_pk_bf16_f32 v62, v28, v29
v_add_f32 v26, v26, v28
v_add_f32 v26, v26, v29
v_exp_f32 v28, v74
s_nop 0
v_exp_f32 v29, v75
s_nop 0
v_cvt_pk_bf16_f32 v63, v28, v29
v_add_f32 v26, v26, v28
v_add_f32 v26, v26, v29
v_exp_f32_e64 v25, -v31
s_nop 1
v_mul_f32 v18, v18, v25
v_accvgpr_read_b32 v30, a4
s_nop 0
v_lshlrev_b32 v28, 16, v30
v_and_b32 v29, 0xffff0000, v30
v_mul_f32 v28, v28, v25
v_mul_f32 v29, v29, v25
v_cvt_pk_bf16_f32 v30, v28, v29
s_nop 0
v_accvgpr_write_b32 a4, v30
v_accvgpr_read_b32 v30, a5
s_nop 0
v_lshlrev_b32 v28, 16, v30
v_and_b32 v29, 0xffff0000, v30
v_mul_f32 v28, v28, v25
v_mul_f32 v29, v29, v25
v_cvt_pk_bf16_f32 v30, v28, v29
s_nop 0
v_accvgpr_write_b32 a5, v30
v_accvgpr_read_b32 v30, a6
s_nop 0
v_lshlrev_b32 v28, 16, v30
v_and_b32 v29, 0xffff0000, v30
v_mul_f32 v28, v28, v25
v_mul_f32 v29, v29, v25
v_cvt_pk_bf16_f32 v30, v28, v29
s_nop 0
v_accvgpr_write_b32 a6, v30
v_accvgpr_read_b32 v30, a7
s_nop 0
v_lshlrev_b32 v28, 16, v30
v_and_b32 v29, 0xffff0000, v30
v_mul_f32 v28, v28, v25
v_mul_f32 v29, v29, v25
v_cvt_pk_bf16_f32 v30, v28, v29
s_nop 0
v_accvgpr_write_b32 a7, v30
v_accvgpr_read_b32 v30, a16
s_nop 0
v_lshlrev_b32 v28, 16, v30
v_and_b32 v29, 0xffff0000, v30
v_mul_f32 v28, v28, v25
v_mul_f32 v29, v29, v25
v_cvt_pk_bf16_f32 v30, v28, v29
s_nop 0
v_accvgpr_write_b32 a16, v30
v_accvgpr_read_b32 v30, a17
s_nop 0
v_lshlrev_b32 v28, 16, v30
v_and_b32 v29, 0xffff0000, v30
v_mul_f32 v28, v28, v25
v_mul_f32 v29, v29, v25
v_cvt_pk_bf16_f32 v30, v28, v29
s_nop 0
v_accvgpr_write_b32 a17, v30
v_accvgpr_read_b32 v30, a18
s_nop 0
v_lshlrev_b32 v28, 16, v30
v_and_b32 v29, 0xffff0000, v30
v_mul_f32 v28, v28, v25
v_mul_f32 v29, v29, v25
v_cvt_pk_bf16_f32 v30, v28, v29
s_nop 0
v_accvgpr_write_b32 a18, v30
v_accvgpr_read_b32 v30, a19
s_nop 0
v_lshlrev_b32 v28, 16, v30
v_and_b32 v29, 0xffff0000, v30
v_mul_f32 v28, v28, v25
v_mul_f32 v29, v29, v25
v_cvt_pk_bf16_f32 v30, v28, v29
s_nop 0
v_accvgpr_write_b32 a19, v30
s_call_b64 s[0:1], OSC_1
v_max3_f32 v31, v40, v41, v42
v_max3_f32 v31, v31, v43, v76
v_max3_f32 v31, v31, v77, v78
v_max3_f32 v31, v31, v79, 0
v_mov_b32 v30, v31
s_nop 1
v_permlane16_swap_b32 v31, v30
s_nop 1
v_max_f32 v31, v31, v30
v_mov_b32 v30, v31
s_nop 1
v_permlane32_swap_b32 v31, v30
s_nop 1
v_max_f32 v31, v31, v30
v_sub_f32 v15, v15, v31
v_sub_f32 v40, v40, v31
v_sub_f32 v76, v76, v31
v_sub_f32 v41, v41, v31
v_sub_f32 v77, v77, v31
v_sub_f32 v42, v42, v31
v_sub_f32 v78, v78, v31
v_sub_f32 v43, v43, v31
v_sub_f32 v79, v79, v31
v_exp_f32 v28, v40
s_nop 0
v_exp_f32 v29, v41
s_nop 0
v_cvt_pk_bf16_f32 v64, v28, v29
v_add_f32 v27, v28, v29
v_exp_f32 v28, v42
s_nop 0
v_exp_f32 v29, v43
s_nop 0
v_cvt_pk_bf16_f32 v65, v28, v29
v_add_f32 v27, v27, v28
v_add_f32 v27, v27, v29
v_exp_f32 v28, v76
s_nop 0
v_exp_f32 v29, v77
s_nop 0
v_cvt_pk_bf16_f32 v66, v28, v29
v_add_f32 v27, v27, v28
v_add_f32 v27, v27, v29
v_exp_f32 v28, v78
s_nop 0
v_exp_f32 v29, v79
s_nop 0
v_cvt_pk_bf16_f32 v67, v28, v29
v_add_f32 v27, v27, v28
v_add_f32 v27, v27, v29
v_exp_f32_e64 v25, -v31
s_nop 1
v_mul_f32 v19, v19, v25
v_accvgpr_read_b32 v30, a8
s_nop 0
v_lshlrev_b32 v28, 16, v30
v_and_b32 v29, 0xffff0000, v30
v_mul_f32 v28, v28, v25
v_mul_f32 v29, v29, v25
v_cvt_pk_bf16_f32 v30, v28, v29
s_nop 0
v_accvgpr_write_b32 a8, v30
v_accvgpr_read_b32 v30, a9
s_nop 0
v_lshlrev_b32 v28, 16, v30
v_and_b32 v29, 0xffff0000, v30
v_mul_f32 v28, v28, v25
v_mul_f32 v29, v29, v25
v_cvt_pk_bf16_f32 v30, v28, v29
s_nop 0
v_accvgpr_write_b32 a9, v30
v_accvgpr_read_b32 v30, a10
s_nop 0
v_lshlrev_b32 v28, 16, v30
v_and_b32 v29, 0xffff0000, v30
v_mul_f32 v28, v28, v25
v_mul_f32 v29, v29, v25
v_cvt_pk_bf16_f32 v30, v28, v29
s_nop 0
v_accvgpr_write_b32 a10, v30
v_accvgpr_read_b32 v30, a11
s_nop 0
v_lshlrev_b32 v28, 16, v30
v_and_b32 v29, 0xffff0000, v30
v_mul_f32 v28, v28, v25
v_mul_f32 v29, v29, v25
v_cvt_pk_bf16_f32 v30, v28, v29
s_nop 0
v_accvgpr_write_b32 a11, v30
v_accvgpr_read_b32 v30, a20
s_nop 0
v_lshlrev_b32 v28, 16, v30
v_and_b32 v29, 0xffff0000, v30
v_mul_f32 v28, v28, v25
v_mul_f32 v29, v29, v25
v_cvt_pk_bf16_f32 v30, v28, v29
s_nop 0
v_accvgpr_write_b32 a20, v30
v_accvgpr_read_b32 v30, a21
s_nop 0
v_lshlrev_b32 v28, 16, v30
v_and_b32 v29, 0xffff0000, v30
v_mul_f32 v28, v28, v25
v_mul_f32 v29, v29, v25
v_cvt_pk_bf16_f32 v30, v28, v29
s_nop 0
v_accvgpr_write_b32 a21, v30
v_accvgpr_read_b32 v30, a22
s_nop 0
v_lshlrev_b32 v28, 16, v30
v_and_b32 v29, 0xffff0000, v30
v_mul_f32 v28, v28, v25
v_mul_f32 v29, v29, v25
v_cvt_pk_bf16_f32 v30, v28, v29
s_nop 0
v_accvgpr_write_b32 a22, v30
v_accvgpr_read_b32 v30, a23
s_nop 0
v_lshlrev_b32 v28, 16, v30
v_and_b32 v29, 0xffff0000, v30
v_mul_f32 v28, v28, v25
v_mul_f32 v29, v29, v25
v_cvt_pk_bf16_f32 v30, v28, v29
s_nop 0
v_accvgpr_write_b32 a23, v30
s_call_b64 s[0:1], OSC_2
s_nop 3
s_nop 7
s_nop 3
s_setpc_b64 s[72:73]
RARE_14:
s_nop 7
v_max3_f32 v31, v80, v81, v82
v_max3_f32 v31, v31, v83, v44
v_max3_f32 v31, v31, v45, v46
v_max3_f32 v31, v31, v47, 0
v_mov_b32 v30, v31
s_nop 1
v_permlane16_swap_b32 v31, v30
s_nop 1
v_max_f32 v31, v31, v30
v_mov_b32 v30, v31
s_nop 1
v_permlane32_swap_b32 v31, v30
s_nop 1
v_max_f32 v31, v31, v30
v_sub_f32 v11, v11, v31
v_sub_f32 v80, v80, v31
v_sub_f32 v44, v44, v31
v_sub_f32 v81, v81, v31
v_sub_f32 v45, v45, v31
v_sub_f32 v82, v82, v31
v_sub_f32 v46, v46, v31
v_sub_f32 v83, v83, v31
v_sub_f32 v47, v47, v31
v_exp_f32 v28, v80
s_nop 0
v_exp_f32 v29, v81
s_nop 0
v_cvt_pk_bf16_f32 v32, v28, v29
v_add_f32 v24, v28, v29
v_exp_f32 v28, v82
s_nop 0
v_exp_f32 v29, v83
s_nop 0
v_cvt_pk_bf16_f32 v33, v28, v29
v_add_f32 v24, v24, v28
v_add_f32 v24, v24, v29
v_exp_f32 v28, v44
s_nop 0
v_exp_f32 v29, v45
s_nop 0
v_cvt_pk_bf16_f32 v34, v28, v29
v_add_f32 v24, v24, v28
v_add_f32 v24, v24, v29
v_exp_f32 v28, v46
s_nop 0
v_exp_f32 v29, v47
s_nop 0
v_cvt_pk_bf16_f32 v35, v28, v29
v_add_f32 v24, v24, v28
v_add_f32 v24, v24, v29
v_exp_f32_e64 v25, -v31
s_nop 1
v_mul_f32 v17, v17, v25
v_accvgpr_read_b32 v30, a0
s_nop 0
v_lshlrev_b32 v28, 16, v30
v_and_b32 v29, 0xffff0000, v30
v_mul_f32 v28, v28, v25
v_mul_f32 v29, v29, v25
v_cvt_pk_bf16_f32 v30, v28, v29
s_nop 0
v_accvgpr_write_b32 a0, v30
v_accvgpr_read_b32 v30, a1
s_nop 0
v_lshlrev_b32 v28, 16, v30
v_and_b32 v29, 0xffff0000, v30
v_mul_f32 v28, v28, v25
v_mul_f32 v29, v29, v25
v_cvt_pk_bf16_f32 v30, v28, v29
s_nop 0
v_accvgpr_write_b32 a1, v30
v_accvgpr_read_b32 v30, a2
s_nop 0
v_lshlrev_b32 v28, 16, v30
v_and_b32 v29, 0xffff0000, v30
v_mul_f32 v28, v28, v25
v_mul_f32 v29, v29, v25
v_cvt_pk_bf16_f32 v30, v28, v29
s_nop 0
v_accvgpr_write_b32 a2, v30
v_accvgpr_read_b32 v30, a3
s_nop 0
v_lshlrev_b32 v28, 16, v30
v_and_b32 v29, 0xffff0000, v30
v_mul_f32 v28, v28, v25
v_mul_f32 v29, v29, v25
v_cvt_pk_bf16_f32 v30, v28, v29
s_nop 0
v_accvgpr_write_b32 a3, v30
v_accvgpr_read_b32 v30, a12
s_nop 0
v_lshlrev_b32 v28, 16, v30
v_and_b32 v29, 0xffff0000, v30
v_mul_f32 v28, v28, v25
v_mul_f32 v29, v29, v25
v_cvt_pk_bf16_f32 v30, v28, v29
s_nop 0
v_accvgpr_write_b32 a12, v30
v_accvgpr_read_b32 v30, a13
s_nop 0
v_lshlrev_b32 v28, 16, v30
v_and_b32 v29, 0xffff0000, v30
v_mul_f32 v28, v28, v25
v_mul_f32 v29, v29, v25
v_cvt_pk_bf16_f32 v30, v28, v29
s_nop 0
v_accvgpr_write_b32 a13, v30
v_accvgpr_read_b32 v30, a14
s_nop 0
v_lshlrev_b32 v28, 16, v30
v_and_b32 v29, 0xffff0000, v30
v_mul_f32 v28, v28, v25
v_mul_f32 v29, v29, v25
v_cvt_pk_bf16_f32 v30, v28, v29
s_nop 0
v_accvgpr_write_b32 a14, v30
v_accvgpr_read_b32 v30, a15
s_nop 0
v_lshlrev_b32 v28, 16, v30
v_and_b32 v29, 0xffff0000, v30
v_mul_f32 v28, v28, v25
v_mul_f32 v29, v29, v25
v_cvt_pk_bf16_f32 v30, v28, v29
s_nop 0
v_accvgpr_write_b32 a15, v30
v_lshlrev_b32 v28, 16, v56
v_and_b32 v29, 0xffff0000, v56
v_mul_f32 v28, v28, v25
v_mul_f32 v29, v29, v25
v_cvt_pk_bf16_f32 v56, v28, v29
v_lshlrev_b32 v28, 16, v57
v_and_b32 v29, 0xffff0000, v57
v_mul_f32 v28, v28, v25
v_mul_f32 v29, v29, v25
v_cvt_pk_bf16_f32 v57, v28, v29
v_lshlrev_b32 v28, 16, v58
v_and_b32 v29, 0xffff0000, v58
v_mul_f32 v28, v28, v25
v_mul_f32 v29, v29, v25
v_cvt_pk_bf16_f32 v58, v28, v29
v_lshlrev_b32 v28, 16, v59
v_and_b32 v29, 0xffff0000, v59
v_mul_f32 v28, v28, v25
v_mul_f32 v29, v29, v25
v_cvt_pk_bf16_f32 v59, v28, v29
s_call_b64 s[0:1], OSC_0
v_max3_f32 v31, v84, v85, v86
v_max3_f32 v31, v31, v87, v48
v_max3_f32 v31, v31, v49, v50
v_max3_f32 v31, v31, v51, 0
v_mov_b32 v30, v31
s_nop 1
v_permlane16_swap_b32 v31, v30
s_nop 1
v_max_f32 v31, v31, v30
v_mov_b32 v30, v31
s_nop 1
v_permlane32_swap_b32 v31, v30
s_nop 1
v_max_f32 v31, v31, v30
v_sub_f32 v13, v13, v31
v_sub_f32 v84, v84, v31
v_sub_f32 v48, v48, v31
v_sub_f32 v85, v85, v31
v_sub_f32 v49, v49, v31
v_sub_f32 v86, v86, v31
v_sub_f32 v50, v50, v31
v_sub_f32 v87, v87, v31
v_sub_f32 v51, v51, v31
v_exp_f32 v28, v84
s_nop 0
v_exp_f32 v29, v85
s_nop 0
v_cvt_pk_bf16_f32 v36, v28, v29
v_add_f32 v26, v28, v29
v_exp_f32 v28, v86
s_nop 0
v_exp_f32 v29, v87
s_nop 0
v_cvt_pk_bf16_f32 v37, v28, v29
v_add_f32 v26, v26, v28
v_add_f32 v26, v26, v29
v_exp_f32 v28, v48
s_nop 0
v_exp_f32 v29, v49
s_nop 0
v_cvt_pk_bf16_f32 v38, v28, v29
v_add_f32 v26, v26, v28
v_add_f32 v26, v26, v29
v_exp_f32 v28, v50
s_nop 0
v_exp_f32 v29, v51
s_nop 0
v_cvt_pk_bf16_f32 v39, v28, v29
v_add_f32 v26, v26, v28
v_add_f32 v26, v26, v29
v_exp_f32_e64 v25, -v31
s_nop 1
v_mul_f32 v18, v18, v25
v_accvgpr_read_b32 v30, a4
s_nop 0
v_lshlrev_b32 v28, 16, v30
v_and_b32 v29, 0xffff0000, v30
v_mul_f32 v28, v28, v25
v_mul_f32 v29, v29, v25
v_cvt_pk_bf16_f32 v30, v28, v29
s_nop 0
v_accvgpr_write_b32 a4, v30
v_accvgpr_read_b32 v30, a5
s_nop 0
v_lshlrev_b32 v28, 16, v30
v_and_b32 v29, 0xffff0000, v30
v_mul_f32 v28, v28, v25
v_mul_f32 v29, v29, v25
v_cvt_pk_bf16_f32 v30, v28, v29
s_nop 0
v_accvgpr_write_b32 a5, v30
v_accvgpr_read_b32 v30, a6
s_nop 0
v_lshlrev_b32 v28, 16, v30
v_and_b32 v29, 0xffff0000, v30
v_mul_f32 v28, v28, v25
v_mul_f32 v29, v29, v25
v_cvt_pk_bf16_f32 v30, v28, v29
s_nop 0
v_accvgpr_write_b32 a6, v30
v_accvgpr_read_b32 v30, a7
s_nop 0
v_lshlrev_b32 v28, 16, v30
v_and_b32 v29, 0xffff0000, v30
v_mul_f32 v28, v28, v25
v_mul_f32 v29, v29, v25
v_cvt_pk_bf16_f32 v30, v28, v29
s_nop 0
v_accvgpr_write_b32 a7, v30
v_accvgpr_read_b32 v30, a16
s_nop 0
v_lshlrev_b32 v28, 16, v30
v_and_b32 v29, 0xffff0000, v30
v_mul_f32 v28, v28, v25
v_mul_f32 v29, v29, v25
v_cvt_pk_bf16_f32 v30, v28, v29
s_nop 0
v_accvgpr_write_b32 a16, v30
v_accvgpr_read_b32 v30, a17
s_nop 0
v_lshlrev_b32 v28, 16, v30
v_and_b32 v29, 0xffff0000, v30
v_mul_f32 v28, v28, v25
v_mul_f32 v29, v29, v25
v_cvt_pk_bf16_f32 v30, v28, v29
s_nop 0
v_accvgpr_write_b32 a17, v30
v_accvgpr_read_b32 v30, a18
s_nop 0
v_lshlrev_b32 v28, 16, v30
v_and_b32 v29, 0xffff0000, v30
v_mul_f32 v28, v28, v25
v_mul_f32 v29, v29, v25
v_cvt_pk_bf16_f32 v30, v28, v29
s_nop 0
v_accvgpr_write_b32 a18, v30
v_accvgpr_read_b32 v30, a19
s_nop 0
v_lshlrev_b32 v28, 16, v30
v_and_b32 v29, 0xffff0000, v30
v_mul_f32 v28, v28, v25
v_mul_f32 v29, v29, v25
v_cvt_pk_bf16_f32 v30, v28, v29
s_nop 0
v_accvgpr_write_b32 a19, v30
v_lshlrev_b32 v28, 16, v60
v_and_b32 v29, 0xffff0000, v60
v_mul_f32 v28, v28, v25
v_mul_f32 v29, v29, v25
v_cvt_pk_bf16_f32 v60, v28, v29
v_lshlrev_b32 v28, 16, v61
v_and_b32 v29, 0xffff0000, v61
v_mul_f32 v28, v28, v25
v_mul_f32 v29, v29, v25
v_cvt_pk_bf16_f32 v61, v28, v29
v_lshlrev_b32 v28, 16, v62
v_and_b32 v29, 0xffff0000, v62
v_mul_f32 v28, v28, v25
v_mul_f32 v29, v29, v25
v_cvt_pk_bf16_f32 v62, v28, v29
v_lshlrev_b32 v28, 16, v63
v_and_b32 v29, 0xffff0000, v63
v_mul_f32 v28, v28, v25
v_mul_f32 v29, v29, v25
v_cvt_pk_bf16_f32 v63, v28, v29
s_call_b64 s[0:1], OSC_1
v_max3_f32 v31, v88, v89, v90
v_max3_f32 v31, v31, v91, v52
v_max3_f32 v31, v31, v53, v54
v_max3_f32 v31, v31, v55, 0
v_mov_b32 v30, v31
s_nop 1
v_permlane16_swap_b32 v31, v30
s_nop 1
v_max_f32 v31, v31, v30
v_mov_b32 v30, v31
s_nop 1
v_permlane32_swap_b32 v31, v30
s_nop 1
v_max_f32 v31, v31, v30
v_sub_f32 v15, v15, v31
v_sub_f32 v88, v88, v31
v_sub_f32 v52, v52, v31
v_sub_f32 v89, v89, v31
v_sub_f32 v53, v53, v31
v_sub_f32 v90, v90, v31
v_sub_f32 v54, v54, v31
v_sub_f32 v91, v91, v31
v_sub_f32 v55, v55, v31
v_exp_f32 v28, v88
s_nop 0
v_exp_f32 v29, v89
s_nop 0
v_cvt_pk_bf16_f32 v40, v28, v29
v_add_f32 v27, v28, v29
v_exp_f32 v28, v90
s_nop 0
v_exp_f32 v29, v91
s_nop 0
v_cvt_pk_bf16_f32 v41, v28, v29
v_add_f32 v27, v27, v28
v_add_f32 v27, v27, v29
v_exp_f32 v28, v52
s_nop 0
v_exp_f32 v29, v53
s_nop 0
v_cvt_pk_bf16_f32 v42, v28, v29
v_add_f32 v27, v27, v28
v_add_f32 v27, v27, v29
v_exp_f32 v28, v54
s_nop 0
v_exp_f32 v29, v55
s_nop 0
v_cvt_pk_bf16_f32 v43, v28, v29
v_add_f32 v27, v27, v28
v_add_f32 v27, v27, v29
v_exp_f32_e64 v25, -v31
s_nop 1
v_mul_f32 v19, v19, v25
v_accvgpr_read_b32 v30, a8
s_nop 0
v_lshlrev_b32 v28, 16, v30
v_and_b32 v29, 0xffff0000, v30
v_mul_f32 v28, v28, v25
v_mul_f32 v29, v29, v25
v_cvt_pk_bf16_f32 v30, v28, v29
s_nop 0
v_accvgpr_write_b32 a8, v30
v_accvgpr_read_b32 v30, a9
s_nop 0
v_lshlrev_b32 v28, 16, v30
v_and_b32 v29, 0xffff0000, v30
v_mul_f32 v28, v28, v25
v_mul_f32 v29, v29, v25
v_cvt_pk_bf16_f32 v30, v28, v29
s_nop 0
v_accvgpr_write_b32 a9, v30
v_accvgpr_read_b32 v30, a10
s_nop 0
v_lshlrev_b32 v28, 16, v30
v_and_b32 v29, 0xffff0000, v30
v_mul_f32 v28, v28, v25
v_mul_f32 v29, v29, v25
v_cvt_pk_bf16_f32 v30, v28, v29
s_nop 0
v_accvgpr_write_b32 a10, v30
v_accvgpr_read_b32 v30, a11
s_nop 0
v_lshlrev_b32 v28, 16, v30
v_and_b32 v29, 0xffff0000, v30
v_mul_f32 v28, v28, v25
v_mul_f32 v29, v29, v25
v_cvt_pk_bf16_f32 v30, v28, v29
s_nop 0
v_accvgpr_write_b32 a11, v30
v_accvgpr_read_b32 v30, a20
s_nop 0
v_lshlrev_b32 v28, 16, v30
v_and_b32 v29, 0xffff0000, v30
v_mul_f32 v28, v28, v25
v_mul_f32 v29, v29, v25
v_cvt_pk_bf16_f32 v30, v28, v29
s_nop 0
v_accvgpr_write_b32 a20, v30
v_accvgpr_read_b32 v30, a21
s_nop 0
v_lshlrev_b32 v28, 16, v30
v_and_b32 v29, 0xffff0000, v30
v_mul_f32 v28, v28, v25
v_mul_f32 v29, v29, v25
v_cvt_pk_bf16_f32 v30, v28, v29
s_nop 0
v_accvgpr_write_b32 a21, v30
v_accvgpr_read_b32 v30, a22
s_nop 0
v_lshlrev_b32 v28, 16, v30
v_and_b32 v29, 0xffff0000, v30
v_mul_f32 v28, v28, v25
v_mul_f32 v29, v29, v25
v_cvt_pk_bf16_f32 v30, v28, v29
s_nop 0
v_accvgpr_write_b32 a22, v30
v_accvgpr_read_b32 v30, a23
s_nop 0
v_lshlrev_b32 v28, 16, v30
v_and_b32 v29, 0xffff0000, v30
v_mul_f32 v28, v28, v25
v_mul_f32 v29, v29, v25
v_cvt_pk_bf16_f32 v30, v28, v29
s_nop 0
v_accvgpr_write_b32 a23, v30
v_lshlrev_b32 v28, 16, v64
v_and_b32 v29, 0xffff0000, v64
v_mul_f32 v28, v28, v25
v_mul_f32 v29, v29, v25
v_cvt_pk_bf16_f32 v64, v28, v29
v_lshlrev_b32 v28, 16, v65
v_and_b32 v29, 0xffff0000, v65
v_mul_f32 v28, v28, v25
v_mul_f32 v29, v29, v25
v_cvt_pk_bf16_f32 v65, v28, v29
v_lshlrev_b32 v28, 16, v66
v_and_b32 v29, 0xffff0000, v66
v_mul_f32 v28, v28, v25
v_mul_f32 v29, v29, v25
v_cvt_pk_bf16_f32 v66, v28, v29
v_lshlrev_b32 v28, 16, v67
v_and_b32 v29, 0xffff0000, v67
v_mul_f32 v28, v28, v25
v_mul_f32 v29, v29, v25
v_cvt_pk_bf16_f32 v67, v28, v29
s_call_b64 s[0:1], OSC_2
s_nop 3
s_nop 7
s_nop 3
s_setpc_b64 s[72:73]
RARE_15:
s_nop 7
v_max3_f32 v31, v68, v69, v70
v_max3_f32 v31, v31, v71, v80
v_max3_f32 v31, v31, v81, v82
v_max3_f32 v31, v31, v83, 0
v_mov_b32 v30, v31
s_nop 1
v_permlane16_swap_b32 v31, v30
s_nop 1
v_max_f32 v31, v31, v30
v_mov_b32 v30, v31
s_nop 1
v_permlane32_swap_b32 v31, v30
s_nop 1
v_max_f32 v31, v31, v30
v_sub_f32 v11, v11, v31
v_sub_f32 v68, v68, v31
v_sub_f32 v80, v80, v31
v_sub_f32 v69, v69, v31
v_sub_f32 v81, v81, v31
v_sub_f32 v70, v70, v31
v_sub_f32 v82, v82, v31
v_sub_f32 v71, v71, v31
v_sub_f32 v83, v83, v31
v_exp_f32 v28, v68
s_nop 0
v_exp_f32 v29, v69
s_nop 0
v_cvt_pk_bf16_f32 v44, v28, v29
v_add_f32 v24, v28, v29
v_exp_f32 v28, v70
s_nop 0
v_exp_f32 v29, v71
s_nop 0
v_cvt_pk_bf16_f32 v45, v28, v29
v_add_f32 v24, v24, v28
v_add_f32 v24, v24, v29
v_exp_f32 v28, v80
s_nop 0
v_exp_f32 v29, v81
s_nop 0
v_cvt_pk_bf16_f32 v46, v28, v29
v_add_f32 v24, v24, v28
v_add_f32 v24, v24, v29
v_exp_f32 v28, v82
s_nop 0
v_exp_f32 v29, v83
s_nop 0
v_cvt_pk_bf16_f32 v47, v28, v29
v_add_f32 v24, v24, v28
v_add_f32 v24, v24, v29
v_exp_f32_e64 v25, -v31
s_nop 1
v_mul_f32 v17, v17, v25
v_accvgpr_read_b32 v30, a0
s_nop 0
v_lshlrev_b32 v28, 16, v30
v_and_b32 v29, 0xffff0000, v30
v_mul_f32 v28, v28, v25
v_mul_f32 v29, v29, v25
v_cvt_pk_bf16_f32 v30, v28, v29
s_nop 0
v_accvgpr_write_b32 a0, v30
v_accvgpr_read_b32 v30, a1
s_nop 0
v_lshlrev_b32 v28, 16, v30
v_and_b32 v29, 0xffff0000, v30
v_mul_f32 v28, v28, v25
v_mul_f32 v29, v29, v25
v_cvt_pk_bf16_f32 v30, v28, v29
s_nop 0
v_accvgpr_write_b32 a1, v30
v_accvgpr_read_b32 v30, a2
s_nop 0
v_lshlrev_b32 v28, 16, v30
v_and_b32 v29, 0xffff0000, v30
v_mul_f32 v28, v28, v25
v_mul_f32 v29, v29, v25
v_cvt_pk_bf16_f32 v30, v28, v29
s_nop 0
v_accvgpr_write_b32 a2, v30
v_accvgpr_read_b32 v30, a3
s_nop 0
v_lshlrev_b32 v28, 16, v30
v_and_b32 v29, 0xffff0000, v30
v_mul_f32 v28, v28, v25
v_mul_f32 v29, v29, v25
v_cvt_pk_bf16_f32 v30, v28, v29
s_nop 0
v_accvgpr_write_b32 a3, v30
v_accvgpr_read_b32 v30, a12
s_nop 0
v_lshlrev_b32 v28, 16, v30
v_and_b32 v29, 0xffff0000, v30
v_mul_f32 v28, v28, v25
v_mul_f32 v29, v29, v25
v_cvt_pk_bf16_f32 v30, v28, v29
s_nop 0
v_accvgpr_write_b32 a12, v30
v_accvgpr_read_b32 v30, a13
s_nop 0
v_lshlrev_b32 v28, 16, v30
v_and_b32 v29, 0xffff0000, v30
v_mul_f32 v28, v28, v25
v_mul_f32 v29, v29, v25
v_cvt_pk_bf16_f32 v30, v28, v29
s_nop 0
v_accvgpr_write_b32 a13, v30
v_accvgpr_read_b32 v30, a14
s_nop 0
v_lshlrev_b32 v28, 16, v30
v_and_b32 v29, 0xffff0000, v30
v_mul_f32 v28, v28, v25
v_mul_f32 v29, v29, v25
v_cvt_pk_bf16_f32 v30, v28, v29
s_nop 0
v_accvgpr_write_b32 a14, v30
v_accvgpr_read_b32 v30, a15
s_nop 0
v_lshlrev_b32 v28, 16, v30
v_and_b32 v29, 0xffff0000, v30
v_mul_f32 v28, v28, v25
v_mul_f32 v29, v29, v25
v_cvt_pk_bf16_f32 v30, v28, v29
s_nop 0
v_accvgpr_write_b32 a15, v30
v_lshlrev_b32 v28, 16, v56
v_and_b32 v29, 0xffff0000, v56
v_mul_f32 v28, v28, v25
v_mul_f32 v29, v29, v25
v_cvt_pk_bf16_f32 v56, v28, v29
v_lshlrev_b32 v28, 16, v57
v_and_b32 v29, 0xffff0000, v57
v_mul_f32 v28, v28, v25
v_mul_f32 v29, v29, v25
v_cvt_pk_bf16_f32 v57, v28, v29
v_lshlrev_b32 v28, 16, v58
v_and_b32 v29, 0xffff0000, v58
v_mul_f32 v28, v28, v25
v_mul_f32 v29, v29, v25
v_cvt_pk_bf16_f32 v58, v28, v29
v_lshlrev_b32 v28, 16, v59
v_and_b32 v29, 0xffff0000, v59
v_mul_f32 v28, v28, v25
v_mul_f32 v29, v29, v25
v_cvt_pk_bf16_f32 v59, v28, v29
v_lshlrev_b32 v28, 16, v32
v_and_b32 v29, 0xffff0000, v32
v_mul_f32 v28, v28, v25
v_mul_f32 v29, v29, v25
v_cvt_pk_bf16_f32 v32, v28, v29
v_lshlrev_b32 v28, 16, v33
v_and_b32 v29, 0xffff0000, v33
v_mul_f32 v28, v28, v25
v_mul_f32 v29, v29, v25
v_cvt_pk_bf16_f32 v33, v28, v29
v_lshlrev_b32 v28, 16, v34
v_and_b32 v29, 0xffff0000, v34
v_mul_f32 v28, v28, v25
v_mul_f32 v29, v29, v25
v_cvt_pk_bf16_f32 v34, v28, v29
v_lshlrev_b32 v28, 16, v35
v_and_b32 v29, 0xffff0000, v35
v_mul_f32 v28, v28, v25
v_mul_f32 v29, v29, v25
v_cvt_pk_bf16_f32 v35, v28, v29
s_call_b64 s[0:1], OSC_0
v_max3_f32 v31, v72, v73, v74
v_max3_f32 v31, v31, v75, v84
v_max3_f32 v31, v31, v85, v86
v_max3_f32 v31, v31, v87, 0
v_mov_b32 v30, v31
s_nop 1
v_permlane16_swap_b32 v31, v30
s_nop 1
v_max_f32 v31, v31, v30
v_mov_b32 v30, v31
s_nop 1
v_permlane32_swap_b32 v31, v30
s_nop 1
v_max_f32 v31, v31, v30
v_sub_f32 v13, v13, v31
v_sub_f32 v72, v72, v31
v_sub_f32 v84, v84, v31
v_sub_f32 v73, v73, v31
v_sub_f32 v85, v85, v31
v_sub_f32 v74, v74, v31
v_sub_f32 v86, v86, v31
v_sub_f32 v75, v75, v31
v_sub_f32 v87, v87, v31
v_exp_f32 v28, v72
s_nop 0
v_exp_f32 v29, v73
s_nop 0
v_cvt_pk_bf16_f32 v48, v28, v29
v_add_f32 v26, v28, v29
v_exp_f32 v28, v74
s_nop 0
v_exp_f32 v29, v75
s_nop 0
v_cvt_pk_bf16_f32 v49, v28, v29
v_add_f32 v26, v26, v28
v_add_f32 v26, v26, v29
v_exp_f32 v28, v84
s_nop 0
v_exp_f32 v29, v85
s_nop 0
v_cvt_pk_bf16_f32 v50, v28, v29
v_add_f32 v26, v26, v28
v_add_f32 v26, v26, v29
v_exp_f32 v28, v86
s_nop 0
v_exp_f32 v29, v87
s_nop 0
v_cvt_pk_bf16_f32 v51, v28, v29
v_add_f32 v26, v26, v28
v_add_f32 v26, v26, v29
v_exp_f32_e64 v25, -v31
s_nop 1
v_mul_f32 v18, v18, v25
v_accvgpr_read_b32 v30, a4
s_nop 0
v_lshlrev_b32 v28, 16, v30
v_and_b32 v29, 0xffff0000, v30
v_mul_f32 v28, v28, v25
v_mul_f32 v29, v29, v25
v_cvt_pk_bf16_f32 v30, v28, v29
s_nop 0
v_accvgpr_write_b32 a4, v30
v_accvgpr_read_b32 v30, a5
s_nop 0
v_lshlrev_b32 v28, 16, v30
v_and_b32 v29, 0xffff0000, v30
v_mul_f32 v28, v28, v25
v_mul_f32 v29, v29, v25
v_cvt_pk_bf16_f32 v30, v28, v29
s_nop 0
v_accvgpr_write_b32 a5, v30
v_accvgpr_read_b32 v30, a6
s_nop 0
v_lshlrev_b32 v28, 16, v30
v_and_b32 v29, 0xffff0000, v30
v_mul_f32 v28, v28, v25
v_mul_f32 v29, v29, v25
v_cvt_pk_bf16_f32 v30, v28, v29
s_nop 0
v_accvgpr_write_b32 a6, v30
v_accvgpr_read_b32 v30, a7
s_nop 0
v_lshlrev_b32 v28, 16, v30
v_and_b32 v29, 0xffff0000, v30
v_mul_f32 v28, v28, v25
v_mul_f32 v29, v29, v25
v_cvt_pk_bf16_f32 v30, v28, v29
s_nop 0
v_accvgpr_write_b32 a7, v30
v_accvgpr_read_b32 v30, a16
s_nop 0
v_lshlrev_b32 v28, 16, v30
v_and_b32 v29, 0xffff0000, v30
v_mul_f32 v28, v28, v25
v_mul_f32 v29, v29, v25
v_cvt_pk_bf16_f32 v30, v28, v29
s_nop 0
v_accvgpr_write_b32 a16, v30
v_accvgpr_read_b32 v30, a17
s_nop 0
v_lshlrev_b32 v28, 16, v30
v_and_b32 v29, 0xffff0000, v30
v_mul_f32 v28, v28, v25
v_mul_f32 v29, v29, v25
v_cvt_pk_bf16_f32 v30, v28, v29
s_nop 0
v_accvgpr_write_b32 a17, v30
v_accvgpr_read_b32 v30, a18
s_nop 0
v_lshlrev_b32 v28, 16, v30
v_and_b32 v29, 0xffff0000, v30
v_mul_f32 v28, v28, v25
v_mul_f32 v29, v29, v25
v_cvt_pk_bf16_f32 v30, v28, v29
s_nop 0
v_accvgpr_write_b32 a18, v30
v_accvgpr_read_b32 v30, a19
s_nop 0
v_lshlrev_b32 v28, 16, v30
v_and_b32 v29, 0xffff0000, v30
v_mul_f32 v28, v28, v25
v_mul_f32 v29, v29, v25
v_cvt_pk_bf16_f32 v30, v28, v29
s_nop 0
v_accvgpr_write_b32 a19, v30
v_lshlrev_b32 v28, 16, v60
v_and_b32 v29, 0xffff0000, v60
v_mul_f32 v28, v28, v25
v_mul_f32 v29, v29, v25
v_cvt_pk_bf16_f32 v60, v28, v29
v_lshlrev_b32 v28, 16, v61
v_and_b32 v29, 0xffff0000, v61
v_mul_f32 v28, v28, v25
v_mul_f32 v29, v29, v25
v_cvt_pk_bf16_f32 v61, v28, v29
v_lshlrev_b32 v28, 16, v62
v_and_b32 v29, 0xffff0000, v62
v_mul_f32 v28, v28, v25
v_mul_f32 v29, v29, v25
v_cvt_pk_bf16_f32 v62, v28, v29
v_lshlrev_b32 v28, 16, v63
v_and_b32 v29, 0xffff0000, v63
v_mul_f32 v28, v28, v25
v_mul_f32 v29, v29, v25
v_cvt_pk_bf16_f32 v63, v28, v29
v_lshlrev_b32 v28, 16, v36
v_and_b32 v29, 0xffff0000, v36
v_mul_f32 v28, v28, v25
v_mul_f32 v29, v29, v25
v_cvt_pk_bf16_f32 v36, v28, v29
v_lshlrev_b32 v28, 16, v37
v_and_b32 v29, 0xffff0000, v37
v_mul_f32 v28, v28, v25
v_mul_f32 v29, v29, v25
v_cvt_pk_bf16_f32 v37, v28, v29
v_lshlrev_b32 v28, 16, v38
v_and_b32 v29, 0xffff0000, v38
v_mul_f32 v28, v28, v25
v_mul_f32 v29, v29, v25
v_cvt_pk_bf16_f32 v38, v28, v29
v_lshlrev_b32 v28, 16, v39
v_and_b32 v29, 0xffff0000, v39
v_mul_f32 v28, v28, v25
v_mul_f32 v29, v29, v25
v_cvt_pk_bf16_f32 v39, v28, v29
s_call_b64 s[0:1], OSC_1
v_max3_f32 v31, v76, v77, v78
v_max3_f32 v31, v31, v79, v88
v_max3_f32 v31, v31, v89, v90
v_max3_f32 v31, v31, v91, 0
v_mov_b32 v30, v31
s_nop 1
v_permlane16_swap_b32 v31, v30
s_nop 1
v_max_f32 v31, v31, v30
v_mov_b32 v30, v31
s_nop 1
v_permlane32_swap_b32 v31, v30
s_nop 1
v_max_f32 v31, v31, v30
v_sub_f32 v15, v15, v31
v_sub_f32 v76, v76, v31
v_sub_f32 v88, v88, v31
v_sub_f32 v77, v77, v31
v_sub_f32 v89, v89, v31
v_sub_f32 v78, v78, v31
v_sub_f32 v90, v90, v31
v_sub_f32 v79, v79, v31
v_sub_f32 v91, v91, v31
v_exp_f32 v28, v76
s_nop 0
v_exp_f32 v29, v77
s_nop 0
v_cvt_pk_bf16_f32 v52, v28, v29
v_add_f32 v27, v28, v29
v_exp_f32 v28, v78
s_nop 0
v_exp_f32 v29, v79
s_nop 0
v_cvt_pk_bf16_f32 v53, v28, v29
v_add_f32 v27, v27, v28
v_add_f32 v27, v27, v29
v_exp_f32 v28, v88
s_nop 0
v_exp_f32 v29, v89
s_nop 0
v_cvt_pk_bf16_f32 v54, v28, v29
v_add_f32 v27, v27, v28
v_add_f32 v27, v27, v29
v_exp_f32 v28, v90
s_nop 0
v_exp_f32 v29, v91
s_nop 0
v_cvt_pk_bf16_f32 v55, v28, v29
v_add_f32 v27, v27, v28
v_add_f32 v27, v27, v29
v_exp_f32_e64 v25, -v31
s_nop 1
v_mul_f32 v19, v19, v25
v_accvgpr_read_b32 v30, a8
s_nop 0
v_lshlrev_b32 v28, 16, v30
v_and_b32 v29, 0xffff0000, v30
v_mul_f32 v28, v28, v25
v_mul_f32 v29, v29, v25
v_cvt_pk_bf16_f32 v30, v28, v29
s_nop 0
v_accvgpr_write_b32 a8, v30
v_accvgpr_read_b32 v30, a9
s_nop 0
v_lshlrev_b32 v28, 16, v30
v_and_b32 v29, 0xffff0000, v30
v_mul_f32 v28, v28, v25
v_mul_f32 v29, v29, v25
v_cvt_pk_bf16_f32 v30, v28, v29
s_nop 0
v_accvgpr_write_b32 a9, v30
v_accvgpr_read_b32 v30, a10
s_nop 0
v_lshlrev_b32 v28, 16, v30
v_and_b32 v29, 0xffff0000, v30
v_mul_f32 v28, v28, v25
v_mul_f32 v29, v29, v25
v_cvt_pk_bf16_f32 v30, v28, v29
s_nop 0
v_accvgpr_write_b32 a10, v30
v_accvgpr_read_b32 v30, a11
s_nop 0
v_lshlrev_b32 v28, 16, v30
v_and_b32 v29, 0xffff0000, v30
v_mul_f32 v28, v28, v25
v_mul_f32 v29, v29, v25
v_cvt_pk_bf16_f32 v30, v28, v29
s_nop 0
v_accvgpr_write_b32 a11, v30
v_accvgpr_read_b32 v30, a20
s_nop 0
v_lshlrev_b32 v28, 16, v30
v_and_b32 v29, 0xffff0000, v30
v_mul_f32 v28, v28, v25
v_mul_f32 v29, v29, v25
v_cvt_pk_bf16_f32 v30, v28, v29
s_nop 0
v_accvgpr_write_b32 a20, v30
v_accvgpr_read_b32 v30, a21
s_nop 0
v_lshlrev_b32 v28, 16, v30
v_and_b32 v29, 0xffff0000, v30
v_mul_f32 v28, v28, v25
v_mul_f32 v29, v29, v25
v_cvt_pk_bf16_f32 v30, v28, v29
s_nop 0
v_accvgpr_write_b32 a21, v30
v_accvgpr_read_b32 v30, a22
s_nop 0
v_lshlrev_b32 v28, 16, v30
v_and_b32 v29, 0xffff0000, v30
v_mul_f32 v28, v28, v25
v_mul_f32 v29, v29, v25
v_cvt_pk_bf16_f32 v30, v28, v29
s_nop 0
v_accvgpr_write_b32 a22, v30
v_accvgpr_read_b32 v30, a23
s_nop 0
v_lshlrev_b32 v28, 16, v30
v_and_b32 v29, 0xffff0000, v30
v_mul_f32 v28, v28, v25
v_mul_f32 v29, v29, v25
v_cvt_pk_bf16_f32 v30, v28, v29
s_nop 0
v_accvgpr_write_b32 a23, v30
v_lshlrev_b32 v28, 16, v64
v_and_b32 v29, 0xffff0000, v64
v_mul_f32 v28, v28, v25
v_mul_f32 v29, v29, v25
v_cvt_pk_bf16_f32 v64, v28, v29
v_lshlrev_b32 v28, 16, v65
v_and_b32 v29, 0xffff0000, v65
v_mul_f32 v28, v28, v25
v_mul_f32 v29, v29, v25
v_cvt_pk_bf16_f32 v65, v28, v29
v_lshlrev_b32 v28, 16, v66
v_and_b32 v29, 0xffff0000, v66
v_mul_f32 v28, v28, v25
v_mul_f32 v29, v29, v25
v_cvt_pk_bf16_f32 v66, v28, v29
v_lshlrev_b32 v28, 16, v67
v_and_b32 v29, 0xffff0000, v67
v_mul_f32 v28, v28, v25
v_mul_f32 v29, v29, v25
v_cvt_pk_bf16_f32 v67, v28, v29
v_lshlrev_b32 v28, 16, v40
v_and_b32 v29, 0xffff0000, v40
v_mul_f32 v28, v28, v25
v_mul_f32 v29, v29, v25
v_cvt_pk_bf16_f32 v40, v28, v29
v_lshlrev_b32 v28, 16, v41
v_and_b32 v29, 0xffff0000, v41
v_mul_f32 v28, v28, v25
v_mul_f32 v29, v29, v25
v_cvt_pk_bf16_f32 v41, v28, v29
v_lshlrev_b32 v28, 16, v42
v_and_b32 v29, 0xffff0000, v42
v_mul_f32 v28, v28, v25
v_mul_f32 v29, v29, v25
v_cvt_pk_bf16_f32 v42, v28, v29
v_lshlrev_b32 v28, 16, v43
v_and_b32 v29, 0xffff0000, v43
v_mul_f32 v28, v28, v25
v_mul_f32 v29, v29, v25
v_cvt_pk_bf16_f32 v43, v28, v29
s_call_b64 s[0:1], OSC_2
s_nop 3
s_nop 7
s_nop 3
s_setpc_b64 s[72:73]
RARE_16:
s_nop 7
v_max3_f32 v31, v92, v93, v94
v_max3_f32 v31, v31, v95, v80
v_max3_f32 v31, v31, v81, v82
v_max3_f32 v31, v31, v83, 0
v_mov_b32 v30, v31
s_nop 1
v_permlane16_swap_b32 v31, v30
s_nop 1
v_max_f32 v31, v31, v30
v_mov_b32 v30, v31
s_nop 1
v_permlane32_swap_b32 v31, v30
s_nop 1
v_max_f32 v31, v31, v30
v_sub_f32 v11, v11, v31
v_sub_f32 v92, v92, v31
v_sub_f32 v80, v80, v31
v_sub_f32 v93, v93, v31
v_sub_f32 v81, v81, v31
v_sub_f32 v94, v94, v31
v_sub_f32 v82, v82, v31
v_sub_f32 v95, v95, v31
v_sub_f32 v83, v83, v31
v_exp_f32 v28, v92
s_nop 0
v_exp_f32 v29, v93
s_nop 0
v_cvt_pk_bf16_f32 v68, v28, v29
v_add_f32 v24, v28, v29
v_exp_f32 v28, v94
s_nop 0
v_exp_f32 v29, v95
s_nop 0
v_cvt_pk_bf16_f32 v69, v28, v29
v_add_f32 v24, v24, v28
v_add_f32 v24, v24, v29
v_exp_f32 v28, v80
s_nop 0
v_exp_f32 v29, v81
s_nop 0
v_cvt_pk_bf16_f32 v70, v28, v29
v_add_f32 v24, v24, v28
v_add_f32 v24, v24, v29
v_exp_f32 v28, v82
s_nop 0
v_exp_f32 v29, v83
s_nop 0
v_cvt_pk_bf16_f32 v71, v28, v29
v_add_f32 v24, v24, v28
v_add_f32 v24, v24, v29
v_exp_f32_e64 v25, -v31
s_nop 1
v_mul_f32 v17, v17, v25
v_accvgpr_read_b32 v30, a0
s_nop 0
v_lshlrev_b32 v28, 16, v30
v_and_b32 v29, 0xffff0000, v30
v_mul_f32 v28, v28, v25
v_mul_f32 v29, v29, v25
v_cvt_pk_bf16_f32 v30, v28, v29
s_nop 0
v_accvgpr_write_b32 a0, v30
v_accvgpr_read_b32 v30, a1
s_nop 0
v_lshlrev_b32 v28, 16, v30
v_and_b32 v29, 0xffff0000, v30
v_mul_f32 v28, v28, v25
v_mul_f32 v29, v29, v25
v_cvt_pk_bf16_f32 v30, v28, v29
s_nop 0
v_accvgpr_write_b32 a1, v30
v_accvgpr_read_b32 v30, a2
s_nop 0
v_lshlrev_b32 v28, 16, v30
v_and_b32 v29, 0xffff0000, v30
v_mul_f32 v28, v28, v25
v_mul_f32 v29, v29, v25
v_cvt_pk_bf16_f32 v30, v28, v29
s_nop 0
v_accvgpr_write_b32 a2, v30
v_accvgpr_read_b32 v30, a3
s_nop 0
v_lshlrev_b32 v28, 16, v30
v_and_b32 v29, 0xffff0000, v30
v_mul_f32 v28, v28, v25
v_mul_f32 v29, v29, v25
v_cvt_pk_bf16_f32 v30, v28, v29
s_nop 0
v_accvgpr_write_b32 a3, v30
v_accvgpr_read_b32 v30, a12
s_nop 0
v_lshlrev_b32 v28, 16, v30
v_and_b32 v29, 0xffff0000, v30
v_mul_f32 v28, v28, v25
v_mul_f32 v29, v29, v25
v_cvt_pk_bf16_f32 v30, v28, v29
s_nop 0
v_accvgpr_write_b32 a12, v30
v_accvgpr_read_b32 v30, a13
s_nop 0
v_lshlrev_b32 v28, 16, v30
v_and_b32 v29, 0xffff0000, v30
v_mul_f32 v28, v28, v25
v_mul_f32 v29, v29, v25
v_cvt_pk_bf16_f32 v30, v28, v29
s_nop 0
v_accvgpr_write_b32 a13, v30
v_accvgpr_read_b32 v30, a14
s_nop 0
v_lshlrev_b32 v28, 16, v30
v_and_b32 v29, 0xffff0000, v30
v_mul_f32 v28, v28, v25
v_mul_f32 v29, v29, v25
v_cvt_pk_bf16_f32 v30, v28, v29
s_nop 0
v_accvgpr_write_b32 a14, v30
v_accvgpr_read_b32 v30, a15
s_nop 0
v_lshlrev_b32 v28, 16, v30
v_and_b32 v29, 0xffff0000, v30
v_mul_f32 v28, v28, v25
v_mul_f32 v29, v29, v25
v_cvt_pk_bf16_f32 v30, v28, v29
s_nop 0
v_accvgpr_write_b32 a15, v30
v_lshlrev_b32 v28, 16, v56
v_and_b32 v29, 0xffff0000, v56
v_mul_f32 v28, v28, v25
v_mul_f32 v29, v29, v25
v_cvt_pk_bf16_f32 v56, v28, v29
v_lshlrev_b32 v28, 16, v57
v_and_b32 v29, 0xffff0000, v57
v_mul_f32 v28, v28, v25
v_mul_f32 v29, v29, v25
v_cvt_pk_bf16_f32 v57, v28, v29
v_lshlrev_b32 v28, 16, v58
v_and_b32 v29, 0xffff0000, v58
v_mul_f32 v28, v28, v25
v_mul_f32 v29, v29, v25
v_cvt_pk_bf16_f32 v58, v28, v29
v_lshlrev_b32 v28, 16, v59
v_and_b32 v29, 0xffff0000, v59
v_mul_f32 v28, v28, v25
v_mul_f32 v29, v29, v25
v_cvt_pk_bf16_f32 v59, v28, v29
v_lshlrev_b32 v28, 16, v32
v_and_b32 v29, 0xffff0000, v32
v_mul_f32 v28, v28, v25
v_mul_f32 v29, v29, v25
v_cvt_pk_bf16_f32 v32, v28, v29
v_lshlrev_b32 v28, 16, v33
v_and_b32 v29, 0xffff0000, v33
v_mul_f32 v28, v28, v25
v_mul_f32 v29, v29, v25
v_cvt_pk_bf16_f32 v33, v28, v29
v_lshlrev_b32 v28, 16, v34
v_and_b32 v29, 0xffff0000, v34
v_mul_f32 v28, v28, v25
v_mul_f32 v29, v29, v25
v_cvt_pk_bf16_f32 v34, v28, v29
v_lshlrev_b32 v28, 16, v35
v_and_b32 v29, 0xffff0000, v35
v_mul_f32 v28, v28, v25
v_mul_f32 v29, v29, v25
v_cvt_pk_bf16_f32 v35, v28, v29
v_lshlrev_b32 v28, 16, v44
v_and_b32 v29, 0xffff0000, v44
v_mul_f32 v28, v28, v25
v_mul_f32 v29, v29, v25
v_cvt_pk_bf16_f32 v44, v28, v29
v_lshlrev_b32 v28, 16, v45
v_and_b32 v29, 0xffff0000, v45
v_mul_f32 v28, v28, v25
v_mul_f32 v29, v29, v25
v_cvt_pk_bf16_f32 v45, v28, v29
v_lshlrev_b32 v28, 16, v46
v_and_b32 v29, 0xffff0000, v46
v_mul_f32 v28, v28, v25
v_mul_f32 v29, v29, v25
v_cvt_pk_bf16_f32 v46, v28, v29
v_lshlrev_b32 v28, 16, v47
v_and_b32 v29, 0xffff0000, v47
v_mul_f32 v28, v28, v25
v_mul_f32 v29, v29, v25
v_cvt_pk_bf16_f32 v47, v28, v29
s_call_b64 s[0:1], OSC_0
v_max3_f32 v31, v96, v97, v98
v_max3_f32 v31, v31, v99, v84
v_max3_f32 v31, v31, v85, v86
v_max3_f32 v31, v31, v87, 0
v_mov_b32 v30, v31
s_nop 1
v_permlane16_swap_b32 v31, v30
s_nop 1
v_max_f32 v31, v31, v30
v_mov_b32 v30, v31
s_nop 1
v_permlane32_swap_b32 v31, v30
s_nop 1
v_max_f32 v31, v31, v30
v_sub_f32 v13, v13, v31
v_sub_f32 v96, v96, v31
v_sub_f32 v84, v84, v31
v_sub_f32 v97, v97, v31
v_sub_f32 v85, v85, v31
v_sub_f32 v98, v98, v31
v_sub_f32 v86, v86, v31
v_sub_f32 v99, v99, v31
v_sub_f32 v87, v87, v31
v_exp_f32 v28, v96
s_nop 0
v_exp_f32 v29, v97
s_nop 0
v_cvt_pk_bf16_f32 v72, v28, v29
v_add_f32 v26, v28, v29
v_exp_f32 v28, v98
s_nop 0
v_exp_f32 v29, v99
s_nop 0
v_cvt_pk_bf16_f32 v73, v28, v29
v_add_f32 v26, v26, v28
v_add_f32 v26, v26, v29
v_exp_f32 v28, v84
s_nop 0
v_exp_f32 v29, v85
s_nop 0
v_cvt_pk_bf16_f32 v74, v28, v29
v_add_f32 v26, v26, v28
v_add_f32 v26, v26, v29
v_exp_f32 v28, v86
s_nop 0
v_exp_f32 v29, v87
s_nop 0
v_cvt_pk_bf16_f32 v75, v28, v29
v_add_f32 v26, v26, v28
v_add_f32 v26, v26, v29
v_exp_f32_e64 v25, -v31
s_nop 1
v_mul_f32 v18, v18, v25
v_accvgpr_read_b32 v30, a4
s_nop 0
v_lshlrev_b32 v28, 16, v30
v_and_b32 v29, 0xffff0000, v30
v_mul_f32 v28, v28, v25
v_mul_f32 v29, v29, v25
v_cvt_pk_bf16_f32 v30, v28, v29
s_nop 0
v_accvgpr_write_b32 a4, v30
v_accvgpr_read_b32 v30, a5
s_nop 0
v_lshlrev_b32 v28, 16, v30
v_and_b32 v29, 0xffff0000, v30
v_mul_f32 v28, v28, v25
v_mul_f32 v29, v29, v25
v_cvt_pk_bf16_f32 v30, v28, v29
s_nop 0
v_accvgpr_write_b32 a5, v30
v_accvgpr_read_b32 v30, a6
s_nop 0
v_lshlrev_b32 v28, 16, v30
v_and_b32 v29, 0xffff0000, v30
v_mul_f32 v28, v28, v25
v_mul_f32 v29, v29, v25
v_cvt_pk_bf16_f32 v30, v28, v29
s_nop 0
v_accvgpr_write_b32 a6, v30
v_accvgpr_read_b32 v30, a7
s_nop 0
v_lshlrev_b32 v28, 16, v30
v_and_b32 v29, 0xffff0000, v30
v_mul_f32 v28, v28, v25
v_mul_f32 v29, v29, v25
v_cvt_pk_bf16_f32 v30, v28, v29
s_nop 0
v_accvgpr_write_b32 a7, v30
v_accvgpr_read_b32 v30, a16
s_nop 0
v_lshlrev_b32 v28, 16, v30
v_and_b32 v29, 0xffff0000, v30
v_mul_f32 v28, v28, v25
v_mul_f32 v29, v29, v25
v_cvt_pk_bf16_f32 v30, v28, v29
s_nop 0
v_accvgpr_write_b32 a16, v30
v_accvgpr_read_b32 v30, a17
s_nop 0
v_lshlrev_b32 v28, 16, v30
v_and_b32 v29, 0xffff0000, v30
v_mul_f32 v28, v28, v25
v_mul_f32 v29, v29, v25
v_cvt_pk_bf16_f32 v30, v28, v29
s_nop 0
v_accvgpr_write_b32 a17, v30
v_accvgpr_read_b32 v30, a18
s_nop 0
v_lshlrev_b32 v28, 16, v30
v_and_b32 v29, 0xffff0000, v30
v_mul_f32 v28, v28, v25
v_mul_f32 v29, v29, v25
v_cvt_pk_bf16_f32 v30, v28, v29
s_nop 0
v_accvgpr_write_b32 a18, v30
v_accvgpr_read_b32 v30, a19
s_nop 0
v_lshlrev_b32 v28, 16, v30
v_and_b32 v29, 0xffff0000, v30
v_mul_f32 v28, v28, v25
v_mul_f32 v29, v29, v25
v_cvt_pk_bf16_f32 v30, v28, v29
s_nop 0
v_accvgpr_write_b32 a19, v30
v_lshlrev_b32 v28, 16, v60
v_and_b32 v29, 0xffff0000, v60
v_mul_f32 v28, v28, v25
v_mul_f32 v29, v29, v25
v_cvt_pk_bf16_f32 v60, v28, v29
v_lshlrev_b32 v28, 16, v61
v_and_b32 v29, 0xffff0000, v61
v_mul_f32 v28, v28, v25
v_mul_f32 v29, v29, v25
v_cvt_pk_bf16_f32 v61, v28, v29
v_lshlrev_b32 v28, 16, v62
v_and_b32 v29, 0xffff0000, v62
v_mul_f32 v28, v28, v25
v_mul_f32 v29, v29, v25
v_cvt_pk_bf16_f32 v62, v28, v29
v_lshlrev_b32 v28, 16, v63
v_and_b32 v29, 0xffff0000, v63
v_mul_f32 v28, v28, v25
v_mul_f32 v29, v29, v25
v_cvt_pk_bf16_f32 v63, v28, v29
v_lshlrev_b32 v28, 16, v36
v_and_b32 v29, 0xffff0000, v36
v_mul_f32 v28, v28, v25
v_mul_f32 v29, v29, v25
v_cvt_pk_bf16_f32 v36, v28, v29
v_lshlrev_b32 v28, 16, v37
v_and_b32 v29, 0xffff0000, v37
v_mul_f32 v28, v28, v25
v_mul_f32 v29, v29, v25
v_cvt_pk_bf16_f32 v37, v28, v29
v_lshlrev_b32 v28, 16, v38
v_and_b32 v29, 0xffff0000, v38
v_mul_f32 v28, v28, v25
v_mul_f32 v29, v29, v25
v_cvt_pk_bf16_f32 v38, v28, v29
v_lshlrev_b32 v28, 16, v39
v_and_b32 v29, 0xffff0000, v39
v_mul_f32 v28, v28, v25
v_mul_f32 v29, v29, v25
v_cvt_pk_bf16_f32 v39, v28, v29
v_lshlrev_b32 v28, 16, v48
v_and_b32 v29, 0xffff0000, v48
v_mul_f32 v28, v28, v25
v_mul_f32 v29, v29, v25
v_cvt_pk_bf16_f32 v48, v28, v29
v_lshlrev_b32 v28, 16, v49
v_and_b32 v29, 0xffff0000, v49
v_mul_f32 v28, v28, v25
v_mul_f32 v29, v29, v25
v_cvt_pk_bf16_f32 v49, v28, v29
v_lshlrev_b32 v28, 16, v50
v_and_b32 v29, 0xffff0000, v50
v_mul_f32 v28, v28, v25
v_mul_f32 v29, v29, v25
v_cvt_pk_bf16_f32 v50, v28, v29
v_lshlrev_b32 v28, 16, v51
v_and_b32 v29, 0xffff0000, v51
v_mul_f32 v28, v28, v25
v_mul_f32 v29, v29, v25
v_cvt_pk_bf16_f32 v51, v28, v29
s_call_b64 s[0:1], OSC_1
v_max3_f32 v31, v100, v101, v102
v_max3_f32 v31, v31, v103, v88
v_max3_f32 v31, v31, v89, v90
v_max3_f32 v31, v31, v91, 0
v_mov_b32 v30, v31
s_nop 1
v_permlane16_swap_b32 v31, v30
s_nop 1
v_max_f32 v31, v31, v30
v_mov_b32 v30, v31
s_nop 1
v_permlane32_swap_b32 v31, v30
s_nop 1
v_max_f32 v31, v31, v30
v_sub_f32 v15, v15, v31
v_sub_f32 v100, v100, v31
v_sub_f32 v88, v88, v31
v_sub_f32 v101, v101, v31
v_sub_f32 v89, v89, v31
v_sub_f32 v102, v102, v31
v_sub_f32 v90, v90, v31
v_sub_f32 v103, v103, v31
v_sub_f32 v91, v91, v31
v_exp_f32 v28, v100
s_nop 0
v_exp_f32 v29, v101
s_nop 0
v_cvt_pk_bf16_f32 v76, v28, v29
v_add_f32 v27, v28, v29
v_exp_f32 v28, v102
s_nop 0
v_exp_f32 v29, v103
s_nop 0
v_cvt_pk_bf16_f32 v77, v28, v29
v_add_f32 v27, v27, v28
v_add_f32 v27, v27, v29
v_exp_f32 v28, v88
s_nop 0
v_exp_f32 v29, v89
s_nop 0
v_cvt_pk_bf16_f32 v78, v28, v29
v_add_f32 v27, v27, v28
v_add_f32 v27, v27, v29
v_exp_f32 v28, v90
s_nop 0
v_exp_f32 v29, v91
s_nop 0
v_cvt_pk_bf16_f32 v79, v28, v29
v_add_f32 v27, v27, v28
v_add_f32 v27, v27, v29
v_exp_f32_e64 v25, -v31
s_nop 1
v_mul_f32 v19, v19, v25
v_accvgpr_read_b32 v30, a8
s_nop 0
v_lshlrev_b32 v28, 16, v30
v_and_b32 v29, 0xffff0000, v30
v_mul_f32 v28, v28, v25
v_mul_f32 v29, v29, v25
v_cvt_pk_bf16_f32 v30, v28, v29
s_nop 0
v_accvgpr_write_b32 a8, v30
v_accvgpr_read_b32 v30, a9
s_nop 0
v_lshlrev_b32 v28, 16, v30
v_and_b32 v29, 0xffff0000, v30
v_mul_f32 v28, v28, v25
v_mul_f32 v29, v29, v25
v_cvt_pk_bf16_f32 v30, v28, v29
s_nop 0
v_accvgpr_write_b32 a9, v30
v_accvgpr_read_b32 v30, a10
s_nop 0
v_lshlrev_b32 v28, 16, v30
v_and_b32 v29, 0xffff0000, v30
v_mul_f32 v28, v28, v25
v_mul_f32 v29, v29, v25
v_cvt_pk_bf16_f32 v30, v28, v29
s_nop 0
v_accvgpr_write_b32 a10, v30
v_accvgpr_read_b32 v30, a11
s_nop 0
v_lshlrev_b32 v28, 16, v30
v_and_b32 v29, 0xffff0000, v30
v_mul_f32 v28, v28, v25
v_mul_f32 v29, v29, v25
v_cvt_pk_bf16_f32 v30, v28, v29
s_nop 0
v_accvgpr_write_b32 a11, v30
v_accvgpr_read_b32 v30, a20
s_nop 0
v_lshlrev_b32 v28, 16, v30
v_and_b32 v29, 0xffff0000, v30
v_mul_f32 v28, v28, v25
v_mul_f32 v29, v29, v25
v_cvt_pk_bf16_f32 v30, v28, v29
s_nop 0
v_accvgpr_write_b32 a20, v30
v_accvgpr_read_b32 v30, a21
s_nop 0
v_lshlrev_b32 v28, 16, v30
v_and_b32 v29, 0xffff0000, v30
v_mul_f32 v28, v28, v25
v_mul_f32 v29, v29, v25
v_cvt_pk_bf16_f32 v30, v28, v29
s_nop 0
v_accvgpr_write_b32 a21, v30
v_accvgpr_read_b32 v30, a22
s_nop 0
v_lshlrev_b32 v28, 16, v30
v_and_b32 v29, 0xffff0000, v30
v_mul_f32 v28, v28, v25
v_mul_f32 v29, v29, v25
v_cvt_pk_bf16_f32 v30, v28, v29
s_nop 0
v_accvgpr_write_b32 a22, v30
v_accvgpr_read_b32 v30, a23
s_nop 0
v_lshlrev_b32 v28, 16, v30
v_and_b32 v29, 0xffff0000, v30
v_mul_f32 v28, v28, v25
v_mul_f32 v29, v29, v25
v_cvt_pk_bf16_f32 v30, v28, v29
s_nop 0
v_accvgpr_write_b32 a23, v30
v_lshlrev_b32 v28, 16, v64
v_and_b32 v29, 0xffff0000, v64
v_mul_f32 v28, v28, v25
v_mul_f32 v29, v29, v25
v_cvt_pk_bf16_f32 v64, v28, v29
v_lshlrev_b32 v28, 16, v65
v_and_b32 v29, 0xffff0000, v65
v_mul_f32 v28, v28, v25
v_mul_f32 v29, v29, v25
v_cvt_pk_bf16_f32 v65, v28, v29
v_lshlrev_b32 v28, 16, v66
v_and_b32 v29, 0xffff0000, v66
v_mul_f32 v28, v28, v25
v_mul_f32 v29, v29, v25
v_cvt_pk_bf16_f32 v66, v28, v29
v_lshlrev_b32 v28, 16, v67
v_and_b32 v29, 0xffff0000, v67
v_mul_f32 v28, v28, v25
v_mul_f32 v29, v29, v25
v_cvt_pk_bf16_f32 v67, v28, v29
v_lshlrev_b32 v28, 16, v40
v_and_b32 v29, 0xffff0000, v40
v_mul_f32 v28, v28, v25
v_mul_f32 v29, v29, v25
v_cvt_pk_bf16_f32 v40, v28, v29
v_lshlrev_b32 v28, 16, v41
v_and_b32 v29, 0xffff0000, v41
v_mul_f32 v28, v28, v25
v_mul_f32 v29, v29, v25
v_cvt_pk_bf16_f32 v41, v28, v29
v_lshlrev_b32 v28, 16, v42
v_and_b32 v29, 0xffff0000, v42
v_mul_f32 v28, v28, v25
v_mul_f32 v29, v29, v25
v_cvt_pk_bf16_f32 v42, v28, v29
v_lshlrev_b32 v28, 16, v43
v_and_b32 v29, 0xffff0000, v43
v_mul_f32 v28, v28, v25
v_mul_f32 v29, v29, v25
v_cvt_pk_bf16_f32 v43, v28, v29
v_lshlrev_b32 v28, 16, v52
v_and_b32 v29, 0xffff0000, v52
v_mul_f32 v28, v28, v25
v_mul_f32 v29, v29, v25
v_cvt_pk_bf16_f32 v52, v28, v29
v_lshlrev_b32 v28, 16, v53
v_and_b32 v29, 0xffff0000, v53
v_mul_f32 v28, v28, v25
v_mul_f32 v29, v29, v25
v_cvt_pk_bf16_f32 v53, v28, v29
v_lshlrev_b32 v28, 16, v54
v_and_b32 v29, 0xffff0000, v54
v_mul_f32 v28, v28, v25
v_mul_f32 v29, v29, v25
v_cvt_pk_bf16_f32 v54, v28, v29
v_lshlrev_b32 v28, 16, v55
v_and_b32 v29, 0xffff0000, v55
v_mul_f32 v28, v28, v25
v_mul_f32 v29, v29, v25
v_cvt_pk_bf16_f32 v55, v28, v29
s_call_b64 s[0:1], OSC_2
s_nop 3
s_nop 7
s_nop 3
s_setpc_b64 s[72:73]
OSC_0:
v_mul_f32 v104, v104, v25
v_mul_f32 v105, v105, v25
v_mul_f32 v106, v106, v25
v_mul_f32 v107, v107, v25
v_mul_f32 v116, v116, v25
v_mul_f32 v117, v117, v25
v_mul_f32 v118, v118, v25
v_mul_f32 v119, v119, v25
v_mul_f32 v128, v128, v25
v_mul_f32 v129, v129, v25
v_mul_f32 v130, v130, v25
v_mul_f32 v131, v131, v25
v_mul_f32 v140, v140, v25
v_mul_f32 v141, v141, v25
v_mul_f32 v142, v142, v25
v_mul_f32 v143, v143, v25
v_mul_f32 v152, v152, v25
v_mul_f32 v153, v153, v25
v_mul_f32 v154, v154, v25
v_mul_f32 v155, v155, v25
v_mul_f32 v164, v164, v25
v_mul_f32 v165, v165, v25
v_mul_f32 v166, v166, v25
v_mul_f32 v167, v167, v25
v_mul_f32 v176, v176, v25
v_mul_f32 v177, v177, v25
v_mul_f32 v178, v178, v25
v_mul_f32 v179, v179, v25
v_mul_f32 v188, v188, v25
v_mul_f32 v189, v189, v25
v_mul_f32 v190, v190, v25
v_mul_f32 v191, v191, v25
v_mul_f32 v200, v200, v25
v_mul_f32 v201, v201, v25
v_mul_f32 v202, v202, v25
v_mul_f32 v203, v203, v25
v_mul_f32 v212, v212, v25
v_mul_f32 v213, v213, v25
v_mul_f32 v214, v214, v25
v_mul_f32 v215, v215, v25
v_accvgpr_read_b32 v30, a216
s_nop 0
v_mul_f32 v30, v30, v25
s_nop 0
v_accvgpr_write_b32 a216, v30
v_accvgpr_read_b32 v30, a217
s_nop 0
v_mul_f32 v30, v30, v25
s_nop 0
v_accvgpr_write_b32 a217, v30
v_accvgpr_read_b32 v30, a218
s_nop 0
v_mul_f32 v30, v30, v25
s_nop 0
v_accvgpr_write_b32 a218, v30
v_accvgpr_read_b32 v30, a219
s_nop 0
v_mul_f32 v30, v30, v25
s_nop 0
v_accvgpr_write_b32 a219, v30
v_accvgpr_read_b32 v30, a228
s_nop 0
v_mul_f32 v30, v30, v25
s_nop 0
v_accvgpr_write_b32 a228, v30
v_accvgpr_read_b32 v30, a229
s_nop 0
v_mul_f32 v30, v30, v25
s_nop 0
v_accvgpr_write_b32 a229, v30
v_accvgpr_read_b32 v30, a230
s_nop 0
v_mul_f32 v30, v30, v25
s_nop 0
v_accvgpr_write_b32 a230, v30
v_accvgpr_read_b32 v30, a231
s_nop 0
v_mul_f32 v30, v30, v25
s_nop 0
v_accvgpr_write_b32 a231, v30
v_accvgpr_read_b32 v30, a240
s_nop 0
v_mul_f32 v30, v30, v25
s_nop 0
v_accvgpr_write_b32 a240, v30
v_accvgpr_read_b32 v30, a241
s_nop 0
v_mul_f32 v30, v30, v25
s_nop 0
v_accvgpr_write_b32 a241, v30
v_accvgpr_read_b32 v30, a242
s_nop 0
v_mul_f32 v30, v30, v25
s_nop 0
v_accvgpr_write_b32 a242, v30
v_accvgpr_read_b32 v30, a243
s_nop 0
v_mul_f32 v30, v30, v25
s_nop 0
v_accvgpr_write_b32 a243, v30
v_accvgpr_read_b32 v30, a252
s_nop 0
v_mul_f32 v30, v30, v25
s_nop 0
v_accvgpr_write_b32 a252, v30
v_accvgpr_read_b32 v30, a253
s_nop 0
v_mul_f32 v30, v30, v25
s_nop 0
v_accvgpr_write_b32 a253, v30
v_accvgpr_read_b32 v30, a254
s_nop 0
v_mul_f32 v30, v30, v25
s_nop 0
v_accvgpr_write_b32 a254, v30
v_accvgpr_read_b32 v30, a255
s_nop 0
v_mul_f32 v30, v30, v25
s_nop 0
v_accvgpr_write_b32 a255, v30
v_mul_f32 v232, v232, v25
v_mul_f32 v233, v233, v25
v_mul_f32 v234, v234, v25
v_mul_f32 v235, v235, v25
v_mul_f32 v244, v244, v25
v_mul_f32 v245, v245, v25
v_mul_f32 v246, v246, v25
v_mul_f32 v247, v247, v25
s_setpc_b64 s[0:1]
OSC_1:
v_mul_f32 v108, v108, v25
v_mul_f32 v109, v109, v25
v_mul_f32 v110, v110, v25
v_mul_f32 v111, v111, v25
v_mul_f32 v120, v120, v25
v_mul_f32 v121, v121, v25
v_mul_f32 v122, v122, v25
v_mul_f32 v123, v123, v25
v_mul_f32 v132, v132, v25
v_mul_f32 v133, v133, v25
v_mul_f32 v134, v134, v25
v_mul_f32 v135, v135, v25
v_mul_f32 v144, v144, v25
v_mul_f32 v145, v145, v25
v_mul_f32 v146, v146, v25
v_mul_f32 v147, v147, v25
v_mul_f32 v156, v156, v25
v_mul_f32 v157, v157, v25
v_mul_f32 v158, v158, v25
v_mul_f32 v159, v159, v25
v_mul_f32 v168, v168, v25
v_mul_f32 v169, v169, v25
v_mul_f32 v170, v170, v25
v_mul_f32 v171, v171, v25
v_mul_f32 v180, v180, v25
v_mul_f32 v181, v181, v25
v_mul_f32 v182, v182, v25
v_mul_f32 v183, v183, v25
v_mul_f32 v192, v192, v25
v_mul_f32 v193, v193, v25
v_mul_f32 v194, v194, v25
v_mul_f32 v195, v195, v25
v_mul_f32 v204, v204, v25
v_mul_f32 v205, v205, v25
v_mul_f32 v206, v206, v25
v_mul_f32 v207, v207, v25
v_mul_f32 v216, v216, v25
v_mul_f32 v217, v217, v25
v_mul_f32 v218, v218, v25
v_mul_f32 v219, v219, v25
v_accvgpr_read_b32 v30, a220
s_nop 0
v_mul_f32 v30, v30, v25
s_nop 0
v_accvgpr_write_b32 a220, v30
v_accvgpr_read_b32 v30, a221
s_nop 0
v_mul_f32 v30, v30, v25
s_nop 0
v_accvgpr_write_b32 a221, v30
v_accvgpr_read_b32 v30, a222
s_nop 0
v_mul_f32 v30, v30, v25
s_nop 0
v_accvgpr_write_b32 a222, v30
v_accvgpr_read_b32 v30, a223
s_nop 0
v_mul_f32 v30, v30, v25
s_nop 0
v_accvgpr_write_b32 a223, v30
v_accvgpr_read_b32 v30, a232
s_nop 0
v_mul_f32 v30, v30, v25
s_nop 0
v_accvgpr_write_b32 a232, v30
v_accvgpr_read_b32 v30, a233
s_nop 0
v_mul_f32 v30, v30, v25
s_nop 0
v_accvgpr_write_b32 a233, v30
v_accvgpr_read_b32 v30, a234
s_nop 0
v_mul_f32 v30, v30, v25
s_nop 0
v_accvgpr_write_b32 a234, v30
v_accvgpr_read_b32 v30, a235
s_nop 0
v_mul_f32 v30, v30, v25
s_nop 0
v_accvgpr_write_b32 a235, v30
v_accvgpr_read_b32 v30, a244
s_nop 0
v_mul_f32 v30, v30, v25
s_nop 0
v_accvgpr_write_b32 a244, v30
v_accvgpr_read_b32 v30, a245
s_nop 0
v_mul_f32 v30, v30, v25
s_nop 0
v_accvgpr_write_b32 a245, v30
v_accvgpr_read_b32 v30, a246
s_nop 0
v_mul_f32 v30, v30, v25
s_nop 0
v_accvgpr_write_b32 a246, v30
v_accvgpr_read_b32 v30, a247
s_nop 0
v_mul_f32 v30, v30, v25
s_nop 0
v_accvgpr_write_b32 a247, v30
v_mul_f32 v224, v224, v25
v_mul_f32 v225, v225, v25
v_mul_f32 v226, v226, v25
v_mul_f32 v227, v227, v25
v_mul_f32 v236, v236, v25
v_mul_f32 v237, v237, v25
v_mul_f32 v238, v238, v25
v_mul_f32 v239, v239, v25
v_mul_f32 v248, v248, v25
v_mul_f32 v249, v249, v25
v_mul_f32 v250, v250, v25
v_mul_f32 v251, v251, v25
s_setpc_b64 s[0:1]
OSC_2:
v_mul_f32 v112, v112, v25
v_mul_f32 v113, v113, v25
v_mul_f32 v114, v114, v25
v_mul_f32 v115, v115, v25
v_mul_f32 v124, v124, v25
v_mul_f32 v125, v125, v25
v_mul_f32 v126, v126, v25
v_mul_f32 v127, v127, v25
v_mul_f32 v136, v136, v25
v_mul_f32 v137, v137, v25
v_mul_f32 v138, v138, v25
v_mul_f32 v139, v139, v25
v_mul_f32 v148, v148, v25
v_mul_f32 v149, v149, v25
v_mul_f32 v150, v150, v25
v_mul_f32 v151, v151, v25
v_mul_f32 v160, v160, v25
v_mul_f32 v161, v161, v25
v_mul_f32 v162, v162, v25
v_mul_f32 v163, v163, v25
v_mul_f32 v172, v172, v25
v_mul_f32 v173, v173, v25
v_mul_f32 v174, v174, v25
v_mul_f32 v175, v175, v25
v_mul_f32 v184, v184, v25
v_mul_f32 v185, v185, v25
v_mul_f32 v186, v186, v25
v_mul_f32 v187, v187, v25
v_mul_f32 v196, v196, v25
v_mul_f32 v197, v197, v25
v_mul_f32 v198, v198, v25
v_mul_f32 v199, v199, v25
v_mul_f32 v208, v208, v25
v_mul_f32 v209, v209, v25
v_mul_f32 v210, v210, v25
v_mul_f32 v211, v211, v25
v_mul_f32 v220, v220, v25
v_mul_f32 v221, v221, v25
v_mul_f32 v222, v222, v25
v_mul_f32 v223, v223, v25
v_accvgpr_read_b32 v30, a224
s_nop 0
v_mul_f32 v30, v30, v25
s_nop 0
v_accvgpr_write_b32 a224, v30
v_accvgpr_read_b32 v30, a225
s_nop 0
v_mul_f32 v30, v30, v25
s_nop 0
v_accvgpr_write_b32 a225, v30
v_accvgpr_read_b32 v30, a226
s_nop 0
v_mul_f32 v30, v30, v25
s_nop 0
v_accvgpr_write_b32 a226, v30
v_accvgpr_read_b32 v30, a227
s_nop 0
v_mul_f32 v30, v30, v25
s_nop 0
v_accvgpr_write_b32 a227, v30
v_accvgpr_read_b32 v30, a236
s_nop 0
v_mul_f32 v30, v30, v25
s_nop 0
v_accvgpr_write_b32 a236, v30
v_accvgpr_read_b32 v30, a237
s_nop 0
v_mul_f32 v30, v30, v25
s_nop 0
v_accvgpr_write_b32 a237, v30
v_accvgpr_read_b32 v30, a238
s_nop 0
v_mul_f32 v30, v30, v25
s_nop 0
v_accvgpr_write_b32 a238, v30
v_accvgpr_read_b32 v30, a239
s_nop 0
v_mul_f32 v30, v30, v25
s_nop 0
v_accvgpr_write_b32 a239, v30
v_accvgpr_read_b32 v30, a248
s_nop 0
v_mul_f32 v30, v30, v25
s_nop 0
v_accvgpr_write_b32 a248, v30
v_accvgpr_read_b32 v30, a249
s_nop 0
v_mul_f32 v30, v30, v25
s_nop 0
v_accvgpr_write_b32 a249, v30
v_accvgpr_read_b32 v30, a250
s_nop 0
v_mul_f32 v30, v30, v25
s_nop 0
v_accvgpr_write_b32 a250, v30
v_accvgpr_read_b32 v30, a251
s_nop 0
v_mul_f32 v30, v30, v25
s_nop 0
v_accvgpr_write_b32 a251, v30
v_mul_f32 v228, v228, v25
v_mul_f32 v229, v229, v25
v_mul_f32 v230, v230, v25
v_mul_f32 v231, v231, v25
v_mul_f32 v240, v240, v25
v_mul_f32 v241, v241, v25
v_mul_f32 v242, v242, v25
v_mul_f32 v243, v243, v25
v_mul_f32 v252, v252, v25
v_mul_f32 v253, v253, v25
v_mul_f32 v254, v254, v25
v_mul_f32 v255, v255, v25
s_setpc_b64 s[0:1]
OSC_3:
v_mul_f32 v104, v104, v25
v_mul_f32 v105, v105, v25
v_mul_f32 v106, v106, v25
v_mul_f32 v107, v107, v25
v_mul_f32 v116, v116, v25
v_mul_f32 v117, v117, v25
v_mul_f32 v118, v118, v25
v_mul_f32 v119, v119, v25
v_mul_f32 v128, v128, v25
v_mul_f32 v129, v129, v25
v_mul_f32 v130, v130, v25
v_mul_f32 v131, v131, v25
v_mul_f32 v140, v140, v25
v_mul_f32 v141, v141, v25
v_mul_f32 v142, v142, v25
v_mul_f32 v143, v143, v25
v_mul_f32 v152, v152, v25
v_mul_f32 v153, v153, v25
v_mul_f32 v154, v154, v25
v_mul_f32 v155, v155, v25
v_mul_f32 v164, v164, v25
v_mul_f32 v165, v165, v25
v_mul_f32 v166, v166, v25
v_mul_f32 v167, v167, v25
v_mul_f32 v176, v176, v25
v_mul_f32 v177, v177, v25
v_mul_f32 v178, v178, v25
v_mul_f32 v179, v179, v25
v_mul_f32 v188, v188, v25
v_mul_f32 v189, v189, v25
v_mul_f32 v190, v190, v25
v_mul_f32 v191, v191, v25
s_setpc_b64 s[0:1]
OSC_4:
v_mul_f32 v108, v108, v25
v_mul_f32 v109, v109, v25
v_mul_f32 v110, v110, v25
v_mul_f32 v111, v111, v25
v_mul_f32 v120, v120, v25
v_mul_f32 v121, v121, v25
v_mul_f32 v122, v122, v25
v_mul_f32 v123, v123, v25
v_mul_f32 v132, v132, v25
v_mul_f32 v133, v133, v25
v_mul_f32 v134, v134, v25
v_mul_f32 v135, v135, v25
v_mul_f32 v144, v144, v25
v_mul_f32 v145, v145, v25
v_mul_f32 v146, v146, v25
v_mul_f32 v147, v147, v25
v_mul_f32 v156, v156, v25
v_mul_f32 v157, v157, v25
v_mul_f32 v158, v158, v25
v_mul_f32 v159, v159, v25
v_mul_f32 v168, v168, v25
v_mul_f32 v169, v169, v25
v_mul_f32 v170, v170, v25
v_mul_f32 v171, v171, v25
v_mul_f32 v180, v180, v25
v_mul_f32 v181, v181, v25
v_mul_f32 v182, v182, v25
v_mul_f32 v183, v183, v25
v_mul_f32 v192, v192, v25
v_mul_f32 v193, v193, v25
v_mul_f32 v194, v194, v25
v_mul_f32 v195, v195, v25
s_setpc_b64 s[0:1]
OSC_5:
v_mul_f32 v112, v112, v25
v_mul_f32 v113, v113, v25
v_mul_f32 v114, v114, v25
v_mul_f32 v115, v115, v25
v_mul_f32 v124, v124, v25
v_mul_f32 v125, v125, v25
v_mul_f32 v126, v126, v25
v_mul_f32 v127, v127, v25
v_mul_f32 v136, v136, v25
v_mul_f32 v137, v137, v25
v_mul_f32 v138, v138, v25
v_mul_f32 v139, v139, v25
v_mul_f32 v148, v148, v25
v_mul_f32 v149, v149, v25
v_mul_f32 v150, v150, v25
v_mul_f32 v151, v151, v25
v_mul_f32 v160, v160, v25
v_mul_f32 v161, v161, v25
v_mul_f32 v162, v162, v25
v_mul_f32 v163, v163, v25
v_mul_f32 v172, v172, v25
v_mul_f32 v173, v173, v25
v_mul_f32 v174, v174, v25
v_mul_f32 v175, v175, v25
v_mul_f32 v184, v184, v25
v_mul_f32 v185, v185, v25
v_mul_f32 v186, v186, v25
v_mul_f32 v187, v187, v25
v_mul_f32 v196, v196, v25
v_mul_f32 v197, v197, v25
v_mul_f32 v198, v198, v25
v_mul_f32 v199, v199, v25
s_setpc_b64 s[0:1]
s_endpgm
.section .rodata,"a"
.p2align 6
.amdhsa_kernel standalone__gqa_softmax__near_ridge_kernel
  .amdhsa_next_free_vgpr 512
  .amdhsa_next_free_sgpr 102
  .amdhsa_accum_offset 256
  .amdhsa_group_segment_fixed_size 0
  .amdhsa_kernarg_size 48
  .amdhsa_user_sgpr_count 2
  .amdhsa_user_sgpr_kernarg_segment_ptr 1
  .amdhsa_system_sgpr_workgroup_id_x 1
.end_amdhsa_kernel
```
